```python
import torch

def _softmax(x, axis=-1):
    return torch.softmax(x, dim=axis)

def _gelu(x):
    return torch.nn.functional.gelu(x, approximate='tanh')

def _silu(x):
    return torch.nn.functional.silu(x)

def _sigmoid(x):
    return torch.sigmoid(x)

def _layernorm(x, axis=-1, eps=1e-05):
    m = x.mean(dim=axis, keepdim=True)
    v = x.var(dim=axis, keepdim=True, unbiased=False)
    return (x - m) / torch.sqrt(v + eps)

def _scatter_add(tgt, idx, src, axis=0):
    return tgt.clone().index_add_(axis, idx, src)

def _segment_sum(src, seg, n):
    out = torch.zeros((n,) + src.shape[1:], dtype=src.dtype)
    return out.index_add_(0, seg, src)

def _pad(x, pw):
    flat = tuple((v for pair in reversed(pw) for v in pair))
    return torch.nn.functional.pad(x, flat)
kernel_name = 'gated_mix__memory_aug_recurrent_mem_tr__mha_block__prompt'

def setup_inputs():

    _w = lambda a: (lambda t: t.to(torch.bfloat16) if t.is_floating_point() else t)(torch.as_tensor(a))

    def _A_setup():
        B, S, Dm = (1, 2048, 640)
        H, Dh = (32, 192)
        M, seg = (8, 32)
        seg = min(seg, S)
        S = S // seg * seg
        return {'x': _w((lambda *s: torch.randn(*s, dtype=torch.bfloat16) * 0.05)(B, S, Dm)), 'mem0': _w((lambda *s: torch.randn(*s, dtype=torch.bfloat16) * 0.8)(B, M, Dm)), 'Wq': _w((lambda *s: torch.randn(*s, dtype=torch.bfloat16) * 1.6)(Dm, H, Dh) * Dm ** (-0.5)), 'Wk': _w((lambda *s: torch.randn(*s, dtype=torch.bfloat16) * 1.6)(Dm, H, Dh) * Dm ** (-0.5)), 'Wv': _w((lambda *s: torch.randn(*s, dtype=torch.bfloat16) * 0.8)(Dm, H, Dh) * Dm ** (-0.5)), 'Wo': _w((lambda *s: torch.randn(*s, dtype=torch.bfloat16) * 0.8)(H, Dh, Dm) * (H * Dh) ** (-0.5)), 'seg_len': seg}
    _A_in = _A_setup()

    def _B_setup():
        B, S, D, H = (1, 2048, 640, 32)
        return {'x': _w((lambda *s: torch.randn(*s, dtype=torch.bfloat16) * 0.05)(B, S, D)), 'wqkv': _w((lambda *s: torch.randn(*s, dtype=torch.bfloat16) * 0.8)(D, 3 * D)), 'wo': _w((lambda *s: torch.randn(*s, dtype=torch.bfloat16) * 0.05)(D, D))}
    _B_in = _B_setup()
    return {'A_x': _A_in['x'], 'A_mem0': _A_in['mem0'], 'A_Wq': _A_in['Wq'], 'A_Wk': _A_in['Wk'], 'A_Wv': _A_in['Wv'], 'A_Wo': _A_in['Wo'], 'A_seg_len': _A_in['seg_len'], 'B_x': _B_in['x'], 'B_wqkv': _B_in['wqkv'], 'B_wo': _B_in['wo'], 'gate_w': _w((lambda *s: torch.randn(*s, dtype=torch.bfloat16) * 0.05)(640) * 16.0)}

def reference(A_x, A_mem0, A_Wq, A_Wk, A_Wv, A_Wo, A_seg_len, B_x, B_wqkv, B_wo, gate_w):

    def _A_ref(x, mem0, Wq, Wk, Wv, Wo, seg_len):
        B, S, Dm = x.shape
        H, Dh = (Wq.shape[1], Wq.shape[2])
        M = mem0.shape[1]
        scale = Dh ** (-0.5)
        n_seg = S // seg_len
        L = M + seg_len
        idx = torch.arange(L)
        mask = (idx[:, None] < M) | (idx[:, None] >= idx[None, :])
        mem = mem0
        outs = []
        for s in range(n_seg):
            xs = x[:, s * seg_len:(s + 1) * seg_len, :].clone()
            h = torch.concatenate([mem, xs], axis=1)
            q = torch.einsum('btd,dhe->bhte', h, Wq)
            k = torch.einsum('btd,dhe->bhte', h, Wk)
            v = torch.einsum('btd,dhe->bhte', h, Wv)
            scores = torch.einsum('bhqe,bhke->bhqk', q, k) * scale
            scores = torch.where(mask[None, None], scores, -1000000000.0)
            p = _softmax(scores, axis=-1)
            o = torch.einsum('bhqk,bhke->bhqe', p, v)
            o = torch.einsum('bhte,hed->btd', o, Wo)
            mem = o[:, :M, :].clone()
            outs.append(o[:, M:, :])
        return torch.concatenate(outs, axis=1)

    def _B_ref(x, wqkv, wo):
        B, S, D = x.shape
        H = 32
        Dh = D // H
        qkv = (lambda x, *d: x.permute(*d))((x @ wqkv).reshape(B, S, 3, H, Dh), 2, 0, 3, 1, 4)
        q, k, v = (qkv[0], qkv[1], qkv[2])
        scores = torch.einsum('bhqd,bhkd->bhqk', q, k) * Dh ** (-0.5)
        p = _softmax(scores, axis=-1)
        o = torch.einsum('bhqk,bhkd->bhqd', p, v)
        return (lambda x, *d: x.permute(*d))(o, 0, 2, 1, 3).reshape(B, S, D) @ wo
    x = A_x
    g = _sigmoid((x * gate_w).sum(-1, keepdims=True))
    a = _A_ref(x, A_mem0, A_Wq, A_Wk, A_Wv, A_Wo, A_seg_len)
    b = _B_ref(x, B_wqkv, B_wo)
    return g * a + (1 - g) * b
```

```asm
; @launch grid=(256,1,1) block=(256,1,1) lds=163840
.amdgcn_target "amdgcn-amd-amdhsa--gfx950"
.text
.globl gated_mix__memory_aug_recurrent_mem_tr__mha_block__prompt_kernel
.p2align 8
.type gated_mix__memory_aug_recurrent_mem_tr__mha_block__prompt_kernel,@function
gated_mix__memory_aug_recurrent_mem_tr__mha_block__prompt_kernel:
s_cmp_ge_u32 s2, 256
s_cbranch_scc1 L_end
s_load_dwordx16 s[64:79], s[0:1], 0
s_load_dwordx8 s[80:87], s[0:1], 64
s_load_dwordx4 s[88:91], s[0:1], 96
v_lshrrev_b32 v1, 6, v0
v_and_b32 v0, 63, v0
v_readfirstlane_b32 s24, v1
v_lshlrev_b32 v1, 4, v0
v_and_b32 v2, 15, v0
v_lshrrev_b32 v3, 4, v0
s_getreg_b32 s27, hwreg(HW_REG_XCC_ID)
s_and_b32 s27, s27, 7
s_mov_b32 s62, 0
s_waitcnt lgkmcnt(0)
s_mov_b32 s4, s90
s_and_b32 s5, s91, 0xffff
s_mov_b32 s6, 0x10000000
s_mov_b32 s7, 0x20000
s_mov_b32 s8, s64
s_and_b32 s9, s65, 0xffff
s_mov_b32 s10, 0x280000
s_mov_b32 s11, 0x20000
s_mov_b32 s20, s88
s_and_b32 s21, s89, 0xffff
s_mov_b32 s22, 0x100
s_mov_b32 s23, 0x20000
s_mov_b32 s12, s68
s_and_b32 s13, s69, 0xffff
s_mov_b32 s14, 0x780000
s_mov_b32 s15, 0x20000
s_mov_b32 s16, s74
s_and_b32 s17, s75, 0xffff
s_mov_b32 s18, 0x780000
s_mov_b32 s19, 0x20000
s_and_b32 s28, s2, 7
s_lshr_b32 s29, s2, 3
s_cmp_ge_u32 s28, 4
s_cbranch_scc1 L_X
s_lshl_b32 s25, s28, 3
s_add_u32 s25, s25, s29
s_cmp_lt_u32 s29, 8
s_cbranch_scc1 L_A
s_sub_u32 s25, s25, 8
s_cmp_lt_u32 s29, 16
s_cbranch_scc1 L_B
s_mul_i32 s25, s28, 10
s_add_u32 s25, s25, s29
s_sub_u32 s25, s25, 16
s_cmp_lt_u32 s29, 26
s_cbranch_scc1 L_R
s_mul_i32 s25, s28, 6
s_add_u32 s25, s25, s29
s_sub_u32 s25, s25, 26
s_branch L_B1
L_X:
s_sub_u32 s25, s28, 4
s_lshl_b32 s25, s25, 3
s_and_b32 s30, s29, 7
s_add_u32 s25, s25, s30
s_lshr_b32 s26, s29, 4
s_lshr_b32 s30, s29, 3
s_lshl_b32 s30, s30, 5
s_add_u32 s34, s30, s25
s_lshl_b32 s34, s34, 7
s_add_u32 s34, s34, 4194304
s_bitcmp1_b32 s29, 3
s_cbranch_scc1 L_XVO
s_branch L_XQK
L_XQK:
s_mov_b32 s32, s26
s_mov_b32 s33, 2
s_lshl_b32 s45, s25, 2
s_cmp_lt_u32 s24, 2
s_cselect_b32 s41, 2, 0
s_add_u32 s45, s45, s41
s_and_b32 s46, s24, 1
s_mul_i32 s46, s46, 3072
v_lshrrev_b32 v8, 3, v0
s_lshl_b32 s35, s24, 3
v_add_u32 v7, s35, v8
v_mul_u32_u24 v7, 1280, v7
v_and_b32 v9, 7, v0
v_xor_b32 v9, v9, v8
v_lshl_add_u32 v7, v9, 4, v7
v_and_b32 v8, 7, v2
v_xor_b32 v9, v3, v8
v_lshlrev_b32 v9, 4, v9
v_lshl_add_u32 v9, v8, 7, v9
v_lshrrev_b32 v8, 3, v2
v_mul_u32_u24 v8, 5120, v8
v_add_u32 v10, v8, v9
v_xor_b32 v11, 64, v10
s_mov_b32 s36, 0
s_mov_b32 s37, 0
s_mov_b32 s39, s32
s_mov_b32 s40, 0
s_mov_b32 s44, 98304
s_mov_b32 s48, s4
s_mov_b32 s49, s5
s_mov_b32 s50, 0
s_mov_b32 s51, 0x20000
s_min_u32 s41, s36, 63
s_lshr_b32 s41, s41, 1
s_mul_i32 s41, s41, s33
s_add_u32 s41, s41, s32
s_mul_i32 s41, s41, 40960
s_and_b32 s42, s36, 1
s_mul_i32 s42, s42, 640
s_add_u32 s41, s41, s42
s_mul_i32 s42, s37, 20480
s_mul_i32 s43, s24, 5120
s_add_u32 s42, s42, s43
s_add_u32 s42, s42, 98304
s_add_u32 s36, s36, 1
s_add_u32 s37, s37, 1
s_cmp_eq_u32 s37, 3
s_cselect_b32 s37, 0, s37
s_mov_b32 m0, s42
s_add_u32 s42, s42, 1024
buffer_load_dwordx4 v7, s[8:11], s41 offen lds
s_add_u32 s41, s41, 128
s_mov_b32 m0, s42
s_add_u32 s42, s42, 1024
buffer_load_dwordx4 v7, s[8:11], s41 offen lds
s_add_u32 s41, s41, 128
s_mov_b32 m0, s42
s_add_u32 s42, s42, 1024
buffer_load_dwordx4 v7, s[8:11], s41 offen lds
s_add_u32 s41, s41, 128
s_mov_b32 m0, s42
s_add_u32 s42, s42, 1024
buffer_load_dwordx4 v7, s[8:11], s41 offen lds
s_add_u32 s41, s41, 128
s_mov_b32 m0, s42
s_add_u32 s42, s42, 1024
buffer_load_dwordx4 v7, s[8:11], s41 offen lds
s_add_u32 s41, s41, 128
s_min_u32 s41, s36, 63
s_lshr_b32 s41, s41, 1
s_mul_i32 s41, s41, s33
s_add_u32 s41, s41, s32
s_mul_i32 s41, s41, 40960
s_and_b32 s42, s36, 1
s_mul_i32 s42, s42, 640
s_add_u32 s41, s41, s42
s_mul_i32 s42, s37, 20480
s_mul_i32 s43, s24, 5120
s_add_u32 s42, s42, s43
s_add_u32 s42, s42, 98304
s_add_u32 s36, s36, 1
s_add_u32 s37, s37, 1
s_cmp_eq_u32 s37, 3
s_cselect_b32 s37, 0, s37
s_mov_b32 m0, s42
s_add_u32 s42, s42, 1024
buffer_load_dwordx4 v7, s[8:11], s41 offen lds
s_add_u32 s41, s41, 128
s_mov_b32 m0, s42
s_add_u32 s42, s42, 1024
buffer_load_dwordx4 v7, s[8:11], s41 offen lds
s_add_u32 s41, s41, 128
s_mov_b32 m0, s42
s_add_u32 s42, s42, 1024
buffer_load_dwordx4 v7, s[8:11], s41 offen lds
s_add_u32 s41, s41, 128
s_mov_b32 m0, s42
s_add_u32 s42, s42, 1024
buffer_load_dwordx4 v7, s[8:11], s41 offen lds
s_add_u32 s41, s41, 128
s_mov_b32 m0, s42
s_add_u32 s42, s42, 1024
buffer_load_dwordx4 v7, s[8:11], s41 offen lds
s_add_u32 s41, s41, 128
s_min_u32 s41, s36, 63
s_lshr_b32 s41, s41, 1
s_mul_i32 s41, s41, s33
s_add_u32 s41, s41, s32
s_mul_i32 s41, s41, 40960
s_and_b32 s42, s36, 1
s_mul_i32 s42, s42, 640
s_add_u32 s41, s41, s42
s_mul_i32 s42, s37, 20480
s_mul_i32 s43, s24, 5120
s_add_u32 s42, s42, s43
s_add_u32 s42, s42, 98304
s_add_u32 s36, s36, 1
s_add_u32 s37, s37, 1
s_cmp_eq_u32 s37, 3
s_cselect_b32 s37, 0, s37
s_mov_b32 m0, s42
s_add_u32 s42, s42, 1024
buffer_load_dwordx4 v7, s[8:11], s41 offen lds
s_add_u32 s41, s41, 128
s_mov_b32 m0, s42
s_add_u32 s42, s42, 1024
buffer_load_dwordx4 v7, s[8:11], s41 offen lds
s_add_u32 s41, s41, 128
s_mov_b32 m0, s42
s_add_u32 s42, s42, 1024
buffer_load_dwordx4 v7, s[8:11], s41 offen lds
s_add_u32 s41, s41, 128
s_mov_b32 m0, s42
s_add_u32 s42, s42, 1024
buffer_load_dwordx4 v7, s[8:11], s41 offen lds
s_add_u32 s41, s41, 128
s_mov_b32 m0, s42
s_add_u32 s42, s42, 1024
buffer_load_dwordx4 v7, s[8:11], s41 offen lds
s_add_u32 s41, s41, 128
v_mov_b32 v124, v7
v_add_u32 v125, 98304, v10
v_add_u32 v126, 98304, v11
s_mov_b32 s12, s68
s_and_b32 s13, s69, 0xffff
s_mov_b32 s14, 0x780000
s_mov_b32 s15, 0x20000
s_mov_b32 s16, s70
s_and_b32 s17, s71, 0xffff
s_mov_b32 s18, 0x780000
s_mov_b32 s19, 0x20000
s_mul_i32 s29, s25, 384
s_mov_b32 s30, 0
s_mul_i32 s61, s24, 192
v_add_u32 v15, s61, v0
v_add_u32 v10, 0, v15
v_mul_u32_u24 v11, 43691, v10
v_lshrrev_b32 v11, 20, v11
v_mul_u32_u24 v13, 24, v11
v_sub_u32 v12, v10, v13
v_mul_u32_u24 v11, 12288, v11
v_lshlrev_b32 v12, 4, v12
v_add3_u32 v120, v11, v12, s29
v_add_u32 v10, 64, v15
v_mul_u32_u24 v11, 43691, v10
v_lshrrev_b32 v11, 20, v11
v_mul_u32_u24 v13, 24, v11
v_sub_u32 v12, v10, v13
v_mul_u32_u24 v11, 12288, v11
v_lshlrev_b32 v12, 4, v12
v_add3_u32 v121, v11, v12, s29
v_add_u32 v10, 128, v15
v_mul_u32_u24 v11, 43691, v10
v_lshrrev_b32 v11, 20, v11
v_mul_u32_u24 v13, 24, v11
v_sub_u32 v12, v10, v13
v_mul_u32_u24 v11, 12288, v11
v_lshlrev_b32 v12, 4, v12
v_add3_u32 v122, v11, v12, s29
s_lshr_b32 s29, s24, 1
s_mul_i32 s29, s29, 12288
s_and_b32 s31, s24, 1
s_mul_i32 s31, s31, 192
s_add_u32 s29, s29, s31
v_bfe_u32 v10, v0, 2, 2
v_lshl_add_u32 v10, v3, 3, v10
v_mov_b32 v11, 0
v_mul_u32_u24 v10, 384, v10
v_and_b32 v12, 3, v0
v_lshl_add_u32 v11, v12, 3, v11
v_add3_u32 v6, v10, v11, s29
v_add_u32 v7, 49152, v6
s_mul_i32 s28, s24, 6144
v_add_u32 v5, s28, v1
v_add_u32 v123, 49152, v5
s_add_u32 s60, s30, 0
s_mul_i32 s61, s24, 3072
s_add_u32 s61, s61, 0
s_add_u32 m0, s61, 0
s_nop 0
buffer_load_dwordx4 v120, s[12:15], s60 offen lds
s_add_u32 m0, s61, 1024
s_nop 0
buffer_load_dwordx4 v121, s[12:15], s60 offen lds
s_add_u32 m0, s61, 2048
s_nop 0
buffer_load_dwordx4 v122, s[12:15], s60 offen lds
s_add_u32 s60, s30, 0
s_mul_i32 s61, s24, 3072
s_add_u32 s61, s61, 12288
s_add_u32 m0, s61, 0
s_nop 0
buffer_load_dwordx4 v120, s[16:19], s60 offen lds
s_add_u32 m0, s61, 1024
s_nop 0
buffer_load_dwordx4 v121, s[16:19], s60 offen lds
s_add_u32 m0, s61, 2048
s_nop 0
buffer_load_dwordx4 v122, s[16:19], s60 offen lds
s_add_u32 s60, s30, 393216
s_mul_i32 s61, s24, 3072
s_add_u32 s61, s61, 24576
s_add_u32 m0, s61, 0
s_nop 0
buffer_load_dwordx4 v120, s[12:15], s60 offen lds
s_add_u32 m0, s61, 1024
s_nop 0
buffer_load_dwordx4 v121, s[12:15], s60 offen lds
s_add_u32 m0, s61, 2048
s_nop 0
buffer_load_dwordx4 v122, s[12:15], s60 offen lds
s_add_u32 s60, s30, 393216
s_mul_i32 s61, s24, 3072
s_add_u32 s61, s61, 36864
s_add_u32 m0, s61, 0
s_nop 0
buffer_load_dwordx4 v120, s[16:19], s60 offen lds
s_add_u32 m0, s61, 1024
s_nop 0
buffer_load_dwordx4 v121, s[16:19], s60 offen lds
s_add_u32 m0, s61, 2048
s_nop 0
buffer_load_dwordx4 v122, s[16:19], s60 offen lds
s_add_u32 s60, s30, 786432
s_mul_i32 s61, s24, 3072
s_add_u32 s61, s61, 49152
s_add_u32 m0, s61, 0
s_nop 0
buffer_load_dwordx4 v120, s[12:15], s60 offen lds
s_add_u32 m0, s61, 1024
s_nop 0
buffer_load_dwordx4 v121, s[12:15], s60 offen lds
s_add_u32 m0, s61, 2048
s_nop 0
buffer_load_dwordx4 v122, s[12:15], s60 offen lds
s_add_u32 s60, s30, 786432
s_mul_i32 s61, s24, 3072
s_add_u32 s61, s61, 61440
s_add_u32 m0, s61, 0
s_nop 0
buffer_load_dwordx4 v120, s[16:19], s60 offen lds
s_add_u32 m0, s61, 1024
s_nop 0
buffer_load_dwordx4 v121, s[16:19], s60 offen lds
s_add_u32 m0, s61, 2048
s_nop 0
buffer_load_dwordx4 v122, s[16:19], s60 offen lds
s_add_u32 s60, s30, 1179648
s_mul_i32 s61, s24, 3072
s_add_u32 s61, s61, 73728
s_add_u32 m0, s61, 0
s_nop 0
buffer_load_dwordx4 v120, s[12:15], s60 offen lds
s_add_u32 m0, s61, 1024
s_nop 0
buffer_load_dwordx4 v121, s[12:15], s60 offen lds
s_add_u32 m0, s61, 2048
s_nop 0
buffer_load_dwordx4 v122, s[12:15], s60 offen lds
s_add_u32 s60, s30, 1179648
s_mul_i32 s61, s24, 3072
s_add_u32 s61, s61, 86016
s_add_u32 m0, s61, 0
s_nop 0
buffer_load_dwordx4 v120, s[16:19], s60 offen lds
s_add_u32 m0, s61, 1024
s_nop 0
buffer_load_dwordx4 v121, s[16:19], s60 offen lds
s_add_u32 m0, s61, 2048
s_nop 0
buffer_load_dwordx4 v122, s[16:19], s60 offen lds
s_waitcnt vmcnt(18)
s_barrier
ds_read_b128 v[64:67], v125 offset:0
ds_read_b128 v[68:71], v125 offset:10240
ds_read_b64_tr_b16 a[0:1], v6 offset:0
ds_read_b64_tr_b16 a[2:3], v6 offset:1536
ds_read_b64_tr_b16 a[8:9], v6 offset:32
ds_read_b64_tr_b16 a[10:11], v6 offset:1568
ds_read_b64_tr_b16 a[16:17], v6 offset:64
ds_read_b64_tr_b16 a[18:19], v6 offset:1600
ds_read_b64_tr_b16 a[24:25], v6 offset:96
ds_read_b64_tr_b16 a[26:27], v6 offset:1632
ds_read_b64_tr_b16 a[32:33], v6 offset:128
ds_read_b64_tr_b16 a[34:35], v6 offset:1664
ds_read_b64_tr_b16 a[40:41], v6 offset:160
ds_read_b64_tr_b16 a[42:43], v6 offset:1696
s_waitcnt lgkmcnt(0)
v_mfma_f32_16x16x32_bf16 v[16:19], a[0:3], v[64:67], 0
v_mfma_f32_16x16x32_bf16 v[20:23], a[0:3], v[68:71], 0
v_mfma_f32_16x16x32_bf16 v[24:27], a[8:11], v[64:67], 0
v_mfma_f32_16x16x32_bf16 v[28:31], a[8:11], v[68:71], 0
v_mfma_f32_16x16x32_bf16 v[32:35], a[16:19], v[64:67], 0
v_mfma_f32_16x16x32_bf16 v[36:39], a[16:19], v[68:71], 0
v_mfma_f32_16x16x32_bf16 v[40:43], a[24:27], v[64:67], 0
v_mfma_f32_16x16x32_bf16 v[44:47], a[24:27], v[68:71], 0
v_mfma_f32_16x16x32_bf16 v[48:51], a[32:35], v[64:67], 0
v_mfma_f32_16x16x32_bf16 v[52:55], a[32:35], v[68:71], 0
v_mfma_f32_16x16x32_bf16 v[56:59], a[40:43], v[64:67], 0
v_mfma_f32_16x16x32_bf16 v[60:63], a[40:43], v[68:71], 0
s_waitcnt vmcnt(12)
s_barrier
s_add_u32 s60, s30, 1572864
s_mul_i32 s61, s24, 3072
s_add_u32 s61, s61, 0
s_add_u32 m0, s61, 0
s_nop 0
buffer_load_dwordx4 v120, s[12:15], s60 offen lds
s_add_u32 m0, s61, 1024
s_nop 0
buffer_load_dwordx4 v121, s[12:15], s60 offen lds
s_add_u32 m0, s61, 2048
s_nop 0
buffer_load_dwordx4 v122, s[12:15], s60 offen lds
s_add_u32 s60, s30, 1572864
s_mul_i32 s61, s24, 3072
s_add_u32 s61, s61, 12288
s_add_u32 m0, s61, 0
s_nop 0
buffer_load_dwordx4 v120, s[16:19], s60 offen lds
s_add_u32 m0, s61, 1024
s_nop 0
buffer_load_dwordx4 v121, s[16:19], s60 offen lds
s_add_u32 m0, s61, 2048
s_nop 0
buffer_load_dwordx4 v122, s[16:19], s60 offen lds
ds_read_b128 v[64:67], v126 offset:0
ds_read_b128 v[68:71], v126 offset:10240
ds_read_b64_tr_b16 a[4:5], v6 offset:24576
ds_read_b64_tr_b16 a[6:7], v6 offset:26112
ds_read_b64_tr_b16 a[12:13], v6 offset:24608
ds_read_b64_tr_b16 a[14:15], v6 offset:26144
ds_read_b64_tr_b16 a[20:21], v6 offset:24640
ds_read_b64_tr_b16 a[22:23], v6 offset:26176
ds_read_b64_tr_b16 a[28:29], v6 offset:24672
ds_read_b64_tr_b16 a[30:31], v6 offset:26208
ds_read_b64_tr_b16 a[36:37], v6 offset:24704
ds_read_b64_tr_b16 a[38:39], v6 offset:26240
ds_read_b64_tr_b16 a[44:45], v6 offset:24736
ds_read_b64_tr_b16 a[46:47], v6 offset:26272
s_waitcnt lgkmcnt(0)
v_mfma_f32_16x16x32_bf16 v[16:19], a[4:7], v[64:67], v[16:19]
v_mfma_f32_16x16x32_bf16 v[20:23], a[4:7], v[68:71], v[20:23]
v_mfma_f32_16x16x32_bf16 v[24:27], a[12:15], v[64:67], v[24:27]
v_mfma_f32_16x16x32_bf16 v[28:31], a[12:15], v[68:71], v[28:31]
v_mfma_f32_16x16x32_bf16 v[32:35], a[20:23], v[64:67], v[32:35]
v_mfma_f32_16x16x32_bf16 v[36:39], a[20:23], v[68:71], v[36:39]
v_mfma_f32_16x16x32_bf16 v[40:43], a[28:31], v[64:67], v[40:43]
v_mfma_f32_16x16x32_bf16 v[44:47], a[28:31], v[68:71], v[44:47]
v_mfma_f32_16x16x32_bf16 v[48:51], a[36:39], v[64:67], v[48:51]
v_mfma_f32_16x16x32_bf16 v[52:55], a[36:39], v[68:71], v[52:55]
v_mfma_f32_16x16x32_bf16 v[56:59], a[44:47], v[64:67], v[56:59]
v_mfma_f32_16x16x32_bf16 v[60:63], a[44:47], v[68:71], v[60:63]
s_waitcnt vmcnt(12)
s_barrier
s_add_u32 s60, s30, 1966080
s_mul_i32 s61, s24, 3072
s_add_u32 s61, s61, 24576
s_add_u32 m0, s61, 0
s_nop 0
buffer_load_dwordx4 v120, s[12:15], s60 offen lds
s_add_u32 m0, s61, 1024
s_nop 0
buffer_load_dwordx4 v121, s[12:15], s60 offen lds
s_add_u32 m0, s61, 2048
s_nop 0
buffer_load_dwordx4 v122, s[12:15], s60 offen lds
s_add_u32 s60, s30, 1966080
s_mul_i32 s61, s24, 3072
s_add_u32 s61, s61, 36864
s_add_u32 m0, s61, 0
s_nop 0
buffer_load_dwordx4 v120, s[16:19], s60 offen lds
s_add_u32 m0, s61, 1024
s_nop 0
buffer_load_dwordx4 v121, s[16:19], s60 offen lds
s_add_u32 m0, s61, 2048
s_nop 0
buffer_load_dwordx4 v122, s[16:19], s60 offen lds
ds_read_b128 v[64:67], v125 offset:1024
ds_read_b128 v[68:71], v125 offset:11264
ds_read_b64_tr_b16 a[48:49], v7 offset:0
ds_read_b64_tr_b16 a[50:51], v7 offset:1536
ds_read_b64_tr_b16 a[56:57], v7 offset:32
ds_read_b64_tr_b16 a[58:59], v7 offset:1568
ds_read_b64_tr_b16 a[64:65], v7 offset:64
ds_read_b64_tr_b16 a[66:67], v7 offset:1600
ds_read_b64_tr_b16 a[72:73], v7 offset:96
ds_read_b64_tr_b16 a[74:75], v7 offset:1632
ds_read_b64_tr_b16 a[80:81], v7 offset:128
ds_read_b64_tr_b16 a[82:83], v7 offset:1664
ds_read_b64_tr_b16 a[88:89], v7 offset:160
ds_read_b64_tr_b16 a[90:91], v7 offset:1696
s_waitcnt lgkmcnt(0)
v_mfma_f32_16x16x32_bf16 v[16:19], a[48:51], v[64:67], v[16:19]
v_mfma_f32_16x16x32_bf16 v[20:23], a[48:51], v[68:71], v[20:23]
v_mfma_f32_16x16x32_bf16 v[24:27], a[56:59], v[64:67], v[24:27]
v_mfma_f32_16x16x32_bf16 v[28:31], a[56:59], v[68:71], v[28:31]
v_mfma_f32_16x16x32_bf16 v[32:35], a[64:67], v[64:67], v[32:35]
v_mfma_f32_16x16x32_bf16 v[36:39], a[64:67], v[68:71], v[36:39]
v_mfma_f32_16x16x32_bf16 v[40:43], a[72:75], v[64:67], v[40:43]
v_mfma_f32_16x16x32_bf16 v[44:47], a[72:75], v[68:71], v[44:47]
v_mfma_f32_16x16x32_bf16 v[48:51], a[80:83], v[64:67], v[48:51]
v_mfma_f32_16x16x32_bf16 v[52:55], a[80:83], v[68:71], v[52:55]
v_mfma_f32_16x16x32_bf16 v[56:59], a[88:91], v[64:67], v[56:59]
v_mfma_f32_16x16x32_bf16 v[60:63], a[88:91], v[68:71], v[60:63]
s_waitcnt vmcnt(12)
s_barrier
s_add_u32 s60, s30, 2359296
s_mul_i32 s61, s24, 3072
s_add_u32 s61, s61, 49152
s_add_u32 m0, s61, 0
s_nop 0
buffer_load_dwordx4 v120, s[12:15], s60 offen lds
s_add_u32 m0, s61, 1024
s_nop 0
buffer_load_dwordx4 v121, s[12:15], s60 offen lds
s_add_u32 m0, s61, 2048
s_nop 0
buffer_load_dwordx4 v122, s[12:15], s60 offen lds
s_add_u32 s60, s30, 2359296
s_mul_i32 s61, s24, 3072
s_add_u32 s61, s61, 61440
s_add_u32 m0, s61, 0
s_nop 0
buffer_load_dwordx4 v120, s[16:19], s60 offen lds
s_add_u32 m0, s61, 1024
s_nop 0
buffer_load_dwordx4 v121, s[16:19], s60 offen lds
s_add_u32 m0, s61, 2048
s_nop 0
buffer_load_dwordx4 v122, s[16:19], s60 offen lds
ds_read_b128 v[64:67], v126 offset:1024
ds_read_b128 v[68:71], v126 offset:11264
ds_read_b64_tr_b16 a[52:53], v7 offset:24576
ds_read_b64_tr_b16 a[54:55], v7 offset:26112
ds_read_b64_tr_b16 a[60:61], v7 offset:24608
ds_read_b64_tr_b16 a[62:63], v7 offset:26144
ds_read_b64_tr_b16 a[68:69], v7 offset:24640
ds_read_b64_tr_b16 a[70:71], v7 offset:26176
ds_read_b64_tr_b16 a[76:77], v7 offset:24672
ds_read_b64_tr_b16 a[78:79], v7 offset:26208
ds_read_b64_tr_b16 a[84:85], v7 offset:24704
ds_read_b64_tr_b16 a[86:87], v7 offset:26240
ds_read_b64_tr_b16 a[92:93], v7 offset:24736
ds_read_b64_tr_b16 a[94:95], v7 offset:26272
s_waitcnt lgkmcnt(0)
v_mfma_f32_16x16x32_bf16 v[16:19], a[52:55], v[64:67], v[16:19]
v_mfma_f32_16x16x32_bf16 v[20:23], a[52:55], v[68:71], v[20:23]
v_mfma_f32_16x16x32_bf16 v[24:27], a[60:63], v[64:67], v[24:27]
v_mfma_f32_16x16x32_bf16 v[28:31], a[60:63], v[68:71], v[28:31]
v_mfma_f32_16x16x32_bf16 v[32:35], a[68:71], v[64:67], v[32:35]
v_mfma_f32_16x16x32_bf16 v[36:39], a[68:71], v[68:71], v[36:39]
v_mfma_f32_16x16x32_bf16 v[40:43], a[76:79], v[64:67], v[40:43]
v_mfma_f32_16x16x32_bf16 v[44:47], a[76:79], v[68:71], v[44:47]
v_mfma_f32_16x16x32_bf16 v[48:51], a[84:87], v[64:67], v[48:51]
v_mfma_f32_16x16x32_bf16 v[52:55], a[84:87], v[68:71], v[52:55]
v_mfma_f32_16x16x32_bf16 v[56:59], a[92:95], v[64:67], v[56:59]
v_mfma_f32_16x16x32_bf16 v[60:63], a[92:95], v[68:71], v[60:63]
s_waitcnt vmcnt(12)
s_barrier
s_add_u32 s60, s30, 2752512
s_mul_i32 s61, s24, 3072
s_add_u32 s61, s61, 73728
s_add_u32 m0, s61, 0
s_nop 0
buffer_load_dwordx4 v120, s[12:15], s60 offen lds
s_add_u32 m0, s61, 1024
s_nop 0
buffer_load_dwordx4 v121, s[12:15], s60 offen lds
s_add_u32 m0, s61, 2048
s_nop 0
buffer_load_dwordx4 v122, s[12:15], s60 offen lds
s_add_u32 s60, s30, 2752512
s_mul_i32 s61, s24, 3072
s_add_u32 s61, s61, 86016
s_add_u32 m0, s61, 0
s_nop 0
buffer_load_dwordx4 v120, s[16:19], s60 offen lds
s_add_u32 m0, s61, 1024
s_nop 0
buffer_load_dwordx4 v121, s[16:19], s60 offen lds
s_add_u32 m0, s61, 2048
s_nop 0
buffer_load_dwordx4 v122, s[16:19], s60 offen lds
ds_read_b128 v[64:67], v125 offset:2048
ds_read_b128 v[68:71], v125 offset:12288
ds_read_b64_tr_b16 a[96:97], v6 offset:0
ds_read_b64_tr_b16 a[98:99], v6 offset:1536
ds_read_b64_tr_b16 a[104:105], v6 offset:32
ds_read_b64_tr_b16 a[106:107], v6 offset:1568
ds_read_b64_tr_b16 a[112:113], v6 offset:64
ds_read_b64_tr_b16 a[114:115], v6 offset:1600
ds_read_b64_tr_b16 a[120:121], v6 offset:96
ds_read_b64_tr_b16 a[122:123], v6 offset:1632
ds_read_b64_tr_b16 a[128:129], v6 offset:128
ds_read_b64_tr_b16 a[130:131], v6 offset:1664
ds_read_b64_tr_b16 a[136:137], v6 offset:160
ds_read_b64_tr_b16 a[138:139], v6 offset:1696
s_waitcnt lgkmcnt(0)
v_mfma_f32_16x16x32_bf16 v[16:19], a[96:99], v[64:67], v[16:19]
v_mfma_f32_16x16x32_bf16 v[20:23], a[96:99], v[68:71], v[20:23]
v_mfma_f32_16x16x32_bf16 v[24:27], a[104:107], v[64:67], v[24:27]
v_mfma_f32_16x16x32_bf16 v[28:31], a[104:107], v[68:71], v[28:31]
v_mfma_f32_16x16x32_bf16 v[32:35], a[112:115], v[64:67], v[32:35]
v_mfma_f32_16x16x32_bf16 v[36:39], a[112:115], v[68:71], v[36:39]
v_mfma_f32_16x16x32_bf16 v[40:43], a[120:123], v[64:67], v[40:43]
v_mfma_f32_16x16x32_bf16 v[44:47], a[120:123], v[68:71], v[44:47]
v_mfma_f32_16x16x32_bf16 v[48:51], a[128:131], v[64:67], v[48:51]
v_mfma_f32_16x16x32_bf16 v[52:55], a[128:131], v[68:71], v[52:55]
v_mfma_f32_16x16x32_bf16 v[56:59], a[136:139], v[64:67], v[56:59]
v_mfma_f32_16x16x32_bf16 v[60:63], a[136:139], v[68:71], v[60:63]
s_waitcnt vmcnt(12)
s_barrier
s_add_u32 s60, s30, 3145728
s_mul_i32 s61, s24, 3072
s_add_u32 s61, s61, 0
s_add_u32 m0, s61, 0
s_nop 0
buffer_load_dwordx4 v120, s[12:15], s60 offen lds
s_add_u32 m0, s61, 1024
s_nop 0
buffer_load_dwordx4 v121, s[12:15], s60 offen lds
s_add_u32 m0, s61, 2048
s_nop 0
buffer_load_dwordx4 v122, s[12:15], s60 offen lds
s_add_u32 s60, s30, 3145728
s_mul_i32 s61, s24, 3072
s_add_u32 s61, s61, 12288
s_add_u32 m0, s61, 0
s_nop 0
buffer_load_dwordx4 v120, s[16:19], s60 offen lds
s_add_u32 m0, s61, 1024
s_nop 0
buffer_load_dwordx4 v121, s[16:19], s60 offen lds
s_add_u32 m0, s61, 2048
s_nop 0
buffer_load_dwordx4 v122, s[16:19], s60 offen lds
ds_read_b128 v[64:67], v126 offset:2048
ds_read_b128 v[68:71], v126 offset:12288
ds_read_b64_tr_b16 a[100:101], v6 offset:24576
ds_read_b64_tr_b16 a[102:103], v6 offset:26112
ds_read_b64_tr_b16 a[108:109], v6 offset:24608
ds_read_b64_tr_b16 a[110:111], v6 offset:26144
ds_read_b64_tr_b16 a[116:117], v6 offset:24640
ds_read_b64_tr_b16 a[118:119], v6 offset:26176
ds_read_b64_tr_b16 a[124:125], v6 offset:24672
ds_read_b64_tr_b16 a[126:127], v6 offset:26208
ds_read_b64_tr_b16 a[132:133], v6 offset:24704
ds_read_b64_tr_b16 a[134:135], v6 offset:26240
ds_read_b64_tr_b16 a[140:141], v6 offset:24736
ds_read_b64_tr_b16 a[142:143], v6 offset:26272
s_waitcnt lgkmcnt(0)
v_mfma_f32_16x16x32_bf16 v[16:19], a[100:103], v[64:67], v[16:19]
v_mfma_f32_16x16x32_bf16 v[20:23], a[100:103], v[68:71], v[20:23]
v_mfma_f32_16x16x32_bf16 v[24:27], a[108:111], v[64:67], v[24:27]
v_mfma_f32_16x16x32_bf16 v[28:31], a[108:111], v[68:71], v[28:31]
v_mfma_f32_16x16x32_bf16 v[32:35], a[116:119], v[64:67], v[32:35]
v_mfma_f32_16x16x32_bf16 v[36:39], a[116:119], v[68:71], v[36:39]
v_mfma_f32_16x16x32_bf16 v[40:43], a[124:127], v[64:67], v[40:43]
v_mfma_f32_16x16x32_bf16 v[44:47], a[124:127], v[68:71], v[44:47]
v_mfma_f32_16x16x32_bf16 v[48:51], a[132:135], v[64:67], v[48:51]
v_mfma_f32_16x16x32_bf16 v[52:55], a[132:135], v[68:71], v[52:55]
v_mfma_f32_16x16x32_bf16 v[56:59], a[140:143], v[64:67], v[56:59]
v_mfma_f32_16x16x32_bf16 v[60:63], a[140:143], v[68:71], v[60:63]
s_waitcnt vmcnt(12)
s_barrier
s_add_u32 s60, s30, 3538944
s_mul_i32 s61, s24, 3072
s_add_u32 s61, s61, 24576
s_add_u32 m0, s61, 0
s_nop 0
buffer_load_dwordx4 v120, s[12:15], s60 offen lds
s_add_u32 m0, s61, 1024
s_nop 0
buffer_load_dwordx4 v121, s[12:15], s60 offen lds
s_add_u32 m0, s61, 2048
s_nop 0
buffer_load_dwordx4 v122, s[12:15], s60 offen lds
s_add_u32 s60, s30, 3538944
s_mul_i32 s61, s24, 3072
s_add_u32 s61, s61, 36864
s_add_u32 m0, s61, 0
s_nop 0
buffer_load_dwordx4 v120, s[16:19], s60 offen lds
s_add_u32 m0, s61, 1024
s_nop 0
buffer_load_dwordx4 v121, s[16:19], s60 offen lds
s_add_u32 m0, s61, 2048
s_nop 0
buffer_load_dwordx4 v122, s[16:19], s60 offen lds
ds_read_b128 v[64:67], v125 offset:3072
ds_read_b128 v[68:71], v125 offset:13312
ds_read_b64_tr_b16 a[144:145], v7 offset:0
ds_read_b64_tr_b16 a[146:147], v7 offset:1536
ds_read_b64_tr_b16 a[152:153], v7 offset:32
ds_read_b64_tr_b16 a[154:155], v7 offset:1568
ds_read_b64_tr_b16 a[160:161], v7 offset:64
ds_read_b64_tr_b16 a[162:163], v7 offset:1600
ds_read_b64_tr_b16 a[168:169], v7 offset:96
ds_read_b64_tr_b16 a[170:171], v7 offset:1632
ds_read_b64_tr_b16 a[176:177], v7 offset:128
ds_read_b64_tr_b16 a[178:179], v7 offset:1664
ds_read_b64_tr_b16 a[184:185], v7 offset:160
ds_read_b64_tr_b16 a[186:187], v7 offset:1696
s_waitcnt lgkmcnt(0)
v_mfma_f32_16x16x32_bf16 v[16:19], a[144:147], v[64:67], v[16:19]
v_mfma_f32_16x16x32_bf16 v[20:23], a[144:147], v[68:71], v[20:23]
v_mfma_f32_16x16x32_bf16 v[24:27], a[152:155], v[64:67], v[24:27]
v_mfma_f32_16x16x32_bf16 v[28:31], a[152:155], v[68:71], v[28:31]
v_mfma_f32_16x16x32_bf16 v[32:35], a[160:163], v[64:67], v[32:35]
v_mfma_f32_16x16x32_bf16 v[36:39], a[160:163], v[68:71], v[36:39]
v_mfma_f32_16x16x32_bf16 v[40:43], a[168:171], v[64:67], v[40:43]
v_mfma_f32_16x16x32_bf16 v[44:47], a[168:171], v[68:71], v[44:47]
v_mfma_f32_16x16x32_bf16 v[48:51], a[176:179], v[64:67], v[48:51]
v_mfma_f32_16x16x32_bf16 v[52:55], a[176:179], v[68:71], v[52:55]
v_mfma_f32_16x16x32_bf16 v[56:59], a[184:187], v[64:67], v[56:59]
v_mfma_f32_16x16x32_bf16 v[60:63], a[184:187], v[68:71], v[60:63]
s_waitcnt vmcnt(12)
s_barrier
s_add_u32 s60, s30, 3932160
s_mul_i32 s61, s24, 3072
s_add_u32 s61, s61, 49152
s_add_u32 m0, s61, 0
s_nop 0
buffer_load_dwordx4 v120, s[12:15], s60 offen lds
s_add_u32 m0, s61, 1024
s_nop 0
buffer_load_dwordx4 v121, s[12:15], s60 offen lds
s_add_u32 m0, s61, 2048
s_nop 0
buffer_load_dwordx4 v122, s[12:15], s60 offen lds
s_add_u32 s60, s30, 3932160
s_mul_i32 s61, s24, 3072
s_add_u32 s61, s61, 61440
s_add_u32 m0, s61, 0
s_nop 0
buffer_load_dwordx4 v120, s[16:19], s60 offen lds
s_add_u32 m0, s61, 1024
s_nop 0
buffer_load_dwordx4 v121, s[16:19], s60 offen lds
s_add_u32 m0, s61, 2048
s_nop 0
buffer_load_dwordx4 v122, s[16:19], s60 offen lds
ds_read_b128 v[64:67], v126 offset:3072
ds_read_b128 v[68:71], v126 offset:13312
ds_read_b64_tr_b16 a[148:149], v7 offset:24576
ds_read_b64_tr_b16 a[150:151], v7 offset:26112
ds_read_b64_tr_b16 a[156:157], v7 offset:24608
ds_read_b64_tr_b16 a[158:159], v7 offset:26144
ds_read_b64_tr_b16 a[164:165], v7 offset:24640
ds_read_b64_tr_b16 a[166:167], v7 offset:26176
ds_read_b64_tr_b16 a[172:173], v7 offset:24672
ds_read_b64_tr_b16 a[174:175], v7 offset:26208
ds_read_b64_tr_b16 a[180:181], v7 offset:24704
ds_read_b64_tr_b16 a[182:183], v7 offset:26240
ds_read_b64_tr_b16 a[188:189], v7 offset:24736
ds_read_b64_tr_b16 a[190:191], v7 offset:26272
s_waitcnt lgkmcnt(0)
v_mfma_f32_16x16x32_bf16 v[16:19], a[148:151], v[64:67], v[16:19]
v_mfma_f32_16x16x32_bf16 v[20:23], a[148:151], v[68:71], v[20:23]
v_mfma_f32_16x16x32_bf16 v[24:27], a[156:159], v[64:67], v[24:27]
v_mfma_f32_16x16x32_bf16 v[28:31], a[156:159], v[68:71], v[28:31]
v_mfma_f32_16x16x32_bf16 v[32:35], a[164:167], v[64:67], v[32:35]
v_mfma_f32_16x16x32_bf16 v[36:39], a[164:167], v[68:71], v[36:39]
v_mfma_f32_16x16x32_bf16 v[40:43], a[172:175], v[64:67], v[40:43]
v_mfma_f32_16x16x32_bf16 v[44:47], a[172:175], v[68:71], v[44:47]
v_mfma_f32_16x16x32_bf16 v[48:51], a[180:183], v[64:67], v[48:51]
v_mfma_f32_16x16x32_bf16 v[52:55], a[180:183], v[68:71], v[52:55]
v_mfma_f32_16x16x32_bf16 v[56:59], a[188:191], v[64:67], v[56:59]
v_mfma_f32_16x16x32_bf16 v[60:63], a[188:191], v[68:71], v[60:63]
s_waitcnt vmcnt(12)
s_barrier
s_add_u32 s60, s30, 4325376
s_mul_i32 s61, s24, 3072
s_add_u32 s61, s61, 73728
s_add_u32 m0, s61, 0
s_nop 0
buffer_load_dwordx4 v120, s[12:15], s60 offen lds
s_add_u32 m0, s61, 1024
s_nop 0
buffer_load_dwordx4 v121, s[12:15], s60 offen lds
s_add_u32 m0, s61, 2048
s_nop 0
buffer_load_dwordx4 v122, s[12:15], s60 offen lds
s_add_u32 s60, s30, 4325376
s_mul_i32 s61, s24, 3072
s_add_u32 s61, s61, 86016
s_add_u32 m0, s61, 0
s_nop 0
buffer_load_dwordx4 v120, s[16:19], s60 offen lds
s_add_u32 m0, s61, 1024
s_nop 0
buffer_load_dwordx4 v121, s[16:19], s60 offen lds
s_add_u32 m0, s61, 2048
s_nop 0
buffer_load_dwordx4 v122, s[16:19], s60 offen lds
ds_read_b128 v[64:67], v125 offset:4096
ds_read_b128 v[68:71], v125 offset:14336
ds_read_b64_tr_b16 a[192:193], v6 offset:0
ds_read_b64_tr_b16 a[194:195], v6 offset:1536
ds_read_b64_tr_b16 a[200:201], v6 offset:32
ds_read_b64_tr_b16 a[202:203], v6 offset:1568
ds_read_b64_tr_b16 a[208:209], v6 offset:64
ds_read_b64_tr_b16 a[210:211], v6 offset:1600
ds_read_b64_tr_b16 a[216:217], v6 offset:96
ds_read_b64_tr_b16 a[218:219], v6 offset:1632
ds_read_b64_tr_b16 a[224:225], v6 offset:128
ds_read_b64_tr_b16 a[226:227], v6 offset:1664
ds_read_b64_tr_b16 a[232:233], v6 offset:160
ds_read_b64_tr_b16 a[234:235], v6 offset:1696
s_waitcnt lgkmcnt(0)
v_mfma_f32_16x16x32_bf16 v[16:19], a[192:195], v[64:67], v[16:19]
v_mfma_f32_16x16x32_bf16 v[20:23], a[192:195], v[68:71], v[20:23]
v_mfma_f32_16x16x32_bf16 v[24:27], a[200:203], v[64:67], v[24:27]
v_mfma_f32_16x16x32_bf16 v[28:31], a[200:203], v[68:71], v[28:31]
v_mfma_f32_16x16x32_bf16 v[32:35], a[208:211], v[64:67], v[32:35]
v_mfma_f32_16x16x32_bf16 v[36:39], a[208:211], v[68:71], v[36:39]
v_mfma_f32_16x16x32_bf16 v[40:43], a[216:219], v[64:67], v[40:43]
v_mfma_f32_16x16x32_bf16 v[44:47], a[216:219], v[68:71], v[44:47]
v_mfma_f32_16x16x32_bf16 v[48:51], a[224:227], v[64:67], v[48:51]
v_mfma_f32_16x16x32_bf16 v[52:55], a[224:227], v[68:71], v[52:55]
v_mfma_f32_16x16x32_bf16 v[56:59], a[232:235], v[64:67], v[56:59]
v_mfma_f32_16x16x32_bf16 v[60:63], a[232:235], v[68:71], v[60:63]
s_waitcnt vmcnt(12)
s_barrier
s_add_u32 s60, s30, 4718592
s_mul_i32 s61, s24, 3072
s_add_u32 s61, s61, 0
s_add_u32 m0, s61, 0
s_nop 0
buffer_load_dwordx4 v120, s[12:15], s60 offen lds
s_add_u32 m0, s61, 1024
s_nop 0
buffer_load_dwordx4 v121, s[12:15], s60 offen lds
s_add_u32 m0, s61, 2048
s_nop 0
buffer_load_dwordx4 v122, s[12:15], s60 offen lds
s_add_u32 s60, s30, 4718592
s_mul_i32 s61, s24, 3072
s_add_u32 s61, s61, 12288
s_add_u32 m0, s61, 0
s_nop 0
buffer_load_dwordx4 v120, s[16:19], s60 offen lds
s_add_u32 m0, s61, 1024
s_nop 0
buffer_load_dwordx4 v121, s[16:19], s60 offen lds
s_add_u32 m0, s61, 2048
s_nop 0
buffer_load_dwordx4 v122, s[16:19], s60 offen lds
ds_read_b128 v[64:67], v126 offset:4096
ds_read_b128 v[68:71], v126 offset:14336
ds_read_b64_tr_b16 a[196:197], v6 offset:24576
ds_read_b64_tr_b16 a[198:199], v6 offset:26112
ds_read_b64_tr_b16 a[204:205], v6 offset:24608
ds_read_b64_tr_b16 a[206:207], v6 offset:26144
ds_read_b64_tr_b16 a[212:213], v6 offset:24640
ds_read_b64_tr_b16 a[214:215], v6 offset:26176
ds_read_b64_tr_b16 a[220:221], v6 offset:24672
ds_read_b64_tr_b16 a[222:223], v6 offset:26208
ds_read_b64_tr_b16 a[228:229], v6 offset:24704
ds_read_b64_tr_b16 a[230:231], v6 offset:26240
ds_read_b64_tr_b16 a[236:237], v6 offset:24736
ds_read_b64_tr_b16 a[238:239], v6 offset:26272
s_waitcnt lgkmcnt(0)
v_mfma_f32_16x16x32_bf16 v[16:19], a[196:199], v[64:67], v[16:19]
v_mfma_f32_16x16x32_bf16 v[20:23], a[196:199], v[68:71], v[20:23]
v_mfma_f32_16x16x32_bf16 v[24:27], a[204:207], v[64:67], v[24:27]
v_mfma_f32_16x16x32_bf16 v[28:31], a[204:207], v[68:71], v[28:31]
v_mfma_f32_16x16x32_bf16 v[32:35], a[212:215], v[64:67], v[32:35]
v_mfma_f32_16x16x32_bf16 v[36:39], a[212:215], v[68:71], v[36:39]
v_mfma_f32_16x16x32_bf16 v[40:43], a[220:223], v[64:67], v[40:43]
v_mfma_f32_16x16x32_bf16 v[44:47], a[220:223], v[68:71], v[44:47]
v_mfma_f32_16x16x32_bf16 v[48:51], a[228:231], v[64:67], v[48:51]
v_mfma_f32_16x16x32_bf16 v[52:55], a[228:231], v[68:71], v[52:55]
v_mfma_f32_16x16x32_bf16 v[56:59], a[236:239], v[64:67], v[56:59]
v_mfma_f32_16x16x32_bf16 v[60:63], a[236:239], v[68:71], v[60:63]
s_waitcnt vmcnt(12)
s_barrier
s_add_u32 s60, s30, 5111808
s_mul_i32 s61, s24, 3072
s_add_u32 s61, s61, 24576
s_add_u32 m0, s61, 0
s_nop 0
buffer_load_dwordx4 v120, s[12:15], s60 offen lds
s_add_u32 m0, s61, 1024
s_nop 0
buffer_load_dwordx4 v121, s[12:15], s60 offen lds
s_add_u32 m0, s61, 2048
s_nop 0
buffer_load_dwordx4 v122, s[12:15], s60 offen lds
s_add_u32 s60, s30, 5111808
s_mul_i32 s61, s24, 3072
s_add_u32 s61, s61, 36864
s_add_u32 m0, s61, 0
s_nop 0
buffer_load_dwordx4 v120, s[16:19], s60 offen lds
s_add_u32 m0, s61, 1024
s_nop 0
buffer_load_dwordx4 v121, s[16:19], s60 offen lds
s_add_u32 m0, s61, 2048
s_nop 0
buffer_load_dwordx4 v122, s[16:19], s60 offen lds
ds_read_b128 v[64:67], v125 offset:20480
ds_read_b128 v[68:71], v125 offset:30720
ds_read_b64_tr_b16 a[240:241], v7 offset:0
ds_read_b64_tr_b16 a[242:243], v7 offset:1536
ds_read_b64_tr_b16 a[248:249], v7 offset:32
ds_read_b64_tr_b16 a[250:251], v7 offset:1568
ds_read_b64_tr_b16 v[128:129], v7 offset:64
ds_read_b64_tr_b16 v[130:131], v7 offset:1600
ds_read_b64_tr_b16 v[136:137], v7 offset:96
ds_read_b64_tr_b16 v[138:139], v7 offset:1632
ds_read_b64_tr_b16 v[144:145], v7 offset:128
ds_read_b64_tr_b16 v[146:147], v7 offset:1664
ds_read_b64_tr_b16 v[152:153], v7 offset:160
ds_read_b64_tr_b16 v[154:155], v7 offset:1696
s_waitcnt lgkmcnt(0)
v_mfma_f32_16x16x32_bf16 v[16:19], a[240:243], v[64:67], v[16:19]
v_mfma_f32_16x16x32_bf16 v[20:23], a[240:243], v[68:71], v[20:23]
v_mfma_f32_16x16x32_bf16 v[24:27], a[248:251], v[64:67], v[24:27]
v_mfma_f32_16x16x32_bf16 v[28:31], a[248:251], v[68:71], v[28:31]
v_mfma_f32_16x16x32_bf16 v[32:35], v[128:131], v[64:67], v[32:35]
v_mfma_f32_16x16x32_bf16 v[36:39], v[128:131], v[68:71], v[36:39]
v_mfma_f32_16x16x32_bf16 v[40:43], v[136:139], v[64:67], v[40:43]
v_mfma_f32_16x16x32_bf16 v[44:47], v[136:139], v[68:71], v[44:47]
v_mfma_f32_16x16x32_bf16 v[48:51], v[144:147], v[64:67], v[48:51]
v_mfma_f32_16x16x32_bf16 v[52:55], v[144:147], v[68:71], v[52:55]
v_mfma_f32_16x16x32_bf16 v[56:59], v[152:155], v[64:67], v[56:59]
v_mfma_f32_16x16x32_bf16 v[60:63], v[152:155], v[68:71], v[60:63]
s_waitcnt vmcnt(12)
s_barrier
s_add_u32 s60, s30, 5505024
s_mul_i32 s61, s24, 3072
s_add_u32 s61, s61, 49152
s_add_u32 m0, s61, 0
s_nop 0
buffer_load_dwordx4 v120, s[12:15], s60 offen lds
s_add_u32 m0, s61, 1024
s_nop 0
buffer_load_dwordx4 v121, s[12:15], s60 offen lds
s_add_u32 m0, s61, 2048
s_nop 0
buffer_load_dwordx4 v122, s[12:15], s60 offen lds
s_add_u32 s60, s30, 5505024
s_mul_i32 s61, s24, 3072
s_add_u32 s61, s61, 61440
s_add_u32 m0, s61, 0
s_nop 0
buffer_load_dwordx4 v120, s[16:19], s60 offen lds
s_add_u32 m0, s61, 1024
s_nop 0
buffer_load_dwordx4 v121, s[16:19], s60 offen lds
s_add_u32 m0, s61, 2048
s_nop 0
buffer_load_dwordx4 v122, s[16:19], s60 offen lds
s_min_u32 s41, s36, 63
s_lshr_b32 s41, s41, 1
s_mul_i32 s41, s41, s33
s_add_u32 s41, s41, s32
s_mul_i32 s41, s41, 40960
s_and_b32 s42, s36, 1
s_mul_i32 s42, s42, 640
s_add_u32 s41, s41, s42
s_mul_i32 s42, s37, 20480
s_mul_i32 s43, s24, 5120
s_add_u32 s42, s42, s43
s_add_u32 s42, s42, 98304
s_add_u32 s36, s36, 1
s_add_u32 s37, s37, 1
s_cmp_eq_u32 s37, 3
s_cselect_b32 s37, 0, s37
s_mov_b32 m0, s42
s_add_u32 s42, s42, 1024
buffer_load_dwordx4 v124, s[8:11], s41 offen lds
s_add_u32 s41, s41, 128
s_mov_b32 m0, s42
s_add_u32 s42, s42, 1024
buffer_load_dwordx4 v124, s[8:11], s41 offen lds
s_add_u32 s41, s41, 128
s_mov_b32 m0, s42
s_add_u32 s42, s42, 1024
buffer_load_dwordx4 v124, s[8:11], s41 offen lds
s_add_u32 s41, s41, 128
s_mov_b32 m0, s42
s_add_u32 s42, s42, 1024
buffer_load_dwordx4 v124, s[8:11], s41 offen lds
s_add_u32 s41, s41, 128
ds_read_b128 v[64:67], v126 offset:20480
ds_read_b128 v[68:71], v126 offset:30720
ds_read_b64_tr_b16 a[244:245], v7 offset:24576
ds_read_b64_tr_b16 a[246:247], v7 offset:26112
ds_read_b64_tr_b16 a[252:253], v7 offset:24608
ds_read_b64_tr_b16 a[254:255], v7 offset:26144
ds_read_b64_tr_b16 v[132:133], v7 offset:24640
ds_read_b64_tr_b16 v[134:135], v7 offset:26176
ds_read_b64_tr_b16 v[140:141], v7 offset:24672
ds_read_b64_tr_b16 v[142:143], v7 offset:26208
ds_read_b64_tr_b16 v[148:149], v7 offset:24704
ds_read_b64_tr_b16 v[150:151], v7 offset:26240
ds_read_b64_tr_b16 v[156:157], v7 offset:24736
ds_read_b64_tr_b16 v[158:159], v7 offset:26272
s_waitcnt lgkmcnt(0)
v_mfma_f32_16x16x32_bf16 v[16:19], a[244:247], v[64:67], v[16:19]
v_mfma_f32_16x16x32_bf16 v[20:23], a[244:247], v[68:71], v[20:23]
v_mfma_f32_16x16x32_bf16 v[24:27], a[252:255], v[64:67], v[24:27]
v_mfma_f32_16x16x32_bf16 v[28:31], a[252:255], v[68:71], v[28:31]
v_mfma_f32_16x16x32_bf16 v[32:35], v[132:135], v[64:67], v[32:35]
v_mfma_f32_16x16x32_bf16 v[36:39], v[132:135], v[68:71], v[36:39]
v_mfma_f32_16x16x32_bf16 v[40:43], v[140:143], v[64:67], v[40:43]
v_mfma_f32_16x16x32_bf16 v[44:47], v[140:143], v[68:71], v[44:47]
v_mfma_f32_16x16x32_bf16 v[48:51], v[148:151], v[64:67], v[48:51]
v_mfma_f32_16x16x32_bf16 v[52:55], v[148:151], v[68:71], v[52:55]
v_mfma_f32_16x16x32_bf16 v[56:59], v[156:159], v[64:67], v[56:59]
v_mfma_f32_16x16x32_bf16 v[60:63], v[156:159], v[68:71], v[60:63]
s_waitcnt vmcnt(12)
s_barrier
s_add_u32 s60, s30, 5898240
s_mul_i32 s61, s24, 3072
s_add_u32 s61, s61, 73728
s_add_u32 m0, s61, 0
s_nop 0
buffer_load_dwordx4 v120, s[12:15], s60 offen lds
s_add_u32 m0, s61, 1024
s_nop 0
buffer_load_dwordx4 v121, s[12:15], s60 offen lds
s_add_u32 m0, s61, 2048
s_nop 0
buffer_load_dwordx4 v122, s[12:15], s60 offen lds
s_add_u32 s60, s30, 5898240
s_mul_i32 s61, s24, 3072
s_add_u32 s61, s61, 86016
s_add_u32 m0, s61, 0
s_nop 0
buffer_load_dwordx4 v120, s[16:19], s60 offen lds
s_add_u32 m0, s61, 1024
s_nop 0
buffer_load_dwordx4 v121, s[16:19], s60 offen lds
s_add_u32 m0, s61, 2048
s_nop 0
buffer_load_dwordx4 v122, s[16:19], s60 offen lds
ds_read_b128 v[64:67], v125 offset:21504
ds_read_b128 v[68:71], v125 offset:31744
ds_read_b64_tr_b16 v[160:161], v6 offset:0
ds_read_b64_tr_b16 v[162:163], v6 offset:1536
ds_read_b64_tr_b16 v[168:169], v6 offset:32
ds_read_b64_tr_b16 v[170:171], v6 offset:1568
ds_read_b64_tr_b16 v[176:177], v6 offset:64
ds_read_b64_tr_b16 v[178:179], v6 offset:1600
ds_read_b64_tr_b16 v[184:185], v6 offset:96
ds_read_b64_tr_b16 v[186:187], v6 offset:1632
ds_read_b64_tr_b16 v[192:193], v6 offset:128
ds_read_b64_tr_b16 v[194:195], v6 offset:1664
ds_read_b64_tr_b16 v[200:201], v6 offset:160
ds_read_b64_tr_b16 v[202:203], v6 offset:1696
s_waitcnt lgkmcnt(0)
v_mfma_f32_16x16x32_bf16 v[16:19], v[160:163], v[64:67], v[16:19]
v_mfma_f32_16x16x32_bf16 v[20:23], v[160:163], v[68:71], v[20:23]
v_mfma_f32_16x16x32_bf16 v[24:27], v[168:171], v[64:67], v[24:27]
v_mfma_f32_16x16x32_bf16 v[28:31], v[168:171], v[68:71], v[28:31]
v_mfma_f32_16x16x32_bf16 v[32:35], v[176:179], v[64:67], v[32:35]
v_mfma_f32_16x16x32_bf16 v[36:39], v[176:179], v[68:71], v[36:39]
v_mfma_f32_16x16x32_bf16 v[40:43], v[184:187], v[64:67], v[40:43]
v_mfma_f32_16x16x32_bf16 v[44:47], v[184:187], v[68:71], v[44:47]
v_mfma_f32_16x16x32_bf16 v[48:51], v[192:195], v[64:67], v[48:51]
v_mfma_f32_16x16x32_bf16 v[52:55], v[192:195], v[68:71], v[52:55]
v_mfma_f32_16x16x32_bf16 v[56:59], v[200:203], v[64:67], v[56:59]
v_mfma_f32_16x16x32_bf16 v[60:63], v[200:203], v[68:71], v[60:63]
s_waitcnt vmcnt(12)
s_barrier
s_add_u32 s60, s30, 6291456
s_mul_i32 s61, s24, 3072
s_add_u32 s61, s61, 0
s_add_u32 m0, s61, 0
s_nop 0
buffer_load_dwordx4 v120, s[12:15], s60 offen lds
s_add_u32 m0, s61, 1024
s_nop 0
buffer_load_dwordx4 v121, s[12:15], s60 offen lds
s_add_u32 m0, s61, 2048
s_nop 0
buffer_load_dwordx4 v122, s[12:15], s60 offen lds
s_add_u32 s60, s30, 6291456
s_mul_i32 s61, s24, 3072
s_add_u32 s61, s61, 12288
s_add_u32 m0, s61, 0
s_nop 0
buffer_load_dwordx4 v120, s[16:19], s60 offen lds
s_add_u32 m0, s61, 1024
s_nop 0
buffer_load_dwordx4 v121, s[16:19], s60 offen lds
s_add_u32 m0, s61, 2048
s_nop 0
buffer_load_dwordx4 v122, s[16:19], s60 offen lds
ds_read_b128 v[64:67], v126 offset:21504
ds_read_b128 v[68:71], v126 offset:31744
ds_read_b64_tr_b16 v[164:165], v6 offset:24576
ds_read_b64_tr_b16 v[166:167], v6 offset:26112
ds_read_b64_tr_b16 v[172:173], v6 offset:24608
ds_read_b64_tr_b16 v[174:175], v6 offset:26144
ds_read_b64_tr_b16 v[180:181], v6 offset:24640
ds_read_b64_tr_b16 v[182:183], v6 offset:26176
ds_read_b64_tr_b16 v[188:189], v6 offset:24672
ds_read_b64_tr_b16 v[190:191], v6 offset:26208
ds_read_b64_tr_b16 v[196:197], v6 offset:24704
ds_read_b64_tr_b16 v[198:199], v6 offset:26240
ds_read_b64_tr_b16 v[204:205], v6 offset:24736
ds_read_b64_tr_b16 v[206:207], v6 offset:26272
s_waitcnt lgkmcnt(0)
v_mfma_f32_16x16x32_bf16 v[16:19], v[164:167], v[64:67], v[16:19]
v_mfma_f32_16x16x32_bf16 v[20:23], v[164:167], v[68:71], v[20:23]
v_mfma_f32_16x16x32_bf16 v[24:27], v[172:175], v[64:67], v[24:27]
v_mfma_f32_16x16x32_bf16 v[28:31], v[172:175], v[68:71], v[28:31]
v_mfma_f32_16x16x32_bf16 v[32:35], v[180:183], v[64:67], v[32:35]
v_mfma_f32_16x16x32_bf16 v[36:39], v[180:183], v[68:71], v[36:39]
v_mfma_f32_16x16x32_bf16 v[40:43], v[188:191], v[64:67], v[40:43]
v_mfma_f32_16x16x32_bf16 v[44:47], v[188:191], v[68:71], v[44:47]
v_mfma_f32_16x16x32_bf16 v[48:51], v[196:199], v[64:67], v[48:51]
v_mfma_f32_16x16x32_bf16 v[52:55], v[196:199], v[68:71], v[52:55]
v_mfma_f32_16x16x32_bf16 v[56:59], v[204:207], v[64:67], v[56:59]
v_mfma_f32_16x16x32_bf16 v[60:63], v[204:207], v[68:71], v[60:63]
s_waitcnt vmcnt(12)
s_barrier
s_add_u32 s60, s30, 6684672
s_mul_i32 s61, s24, 3072
s_add_u32 s61, s61, 24576
s_add_u32 m0, s61, 0
s_nop 0
buffer_load_dwordx4 v120, s[12:15], s60 offen lds
s_add_u32 m0, s61, 1024
s_nop 0
buffer_load_dwordx4 v121, s[12:15], s60 offen lds
s_add_u32 m0, s61, 2048
s_nop 0
buffer_load_dwordx4 v122, s[12:15], s60 offen lds
s_add_u32 s60, s30, 6684672
s_mul_i32 s61, s24, 3072
s_add_u32 s61, s61, 36864
s_add_u32 m0, s61, 0
s_nop 0
buffer_load_dwordx4 v120, s[16:19], s60 offen lds
s_add_u32 m0, s61, 1024
s_nop 0
buffer_load_dwordx4 v121, s[16:19], s60 offen lds
s_add_u32 m0, s61, 2048
s_nop 0
buffer_load_dwordx4 v122, s[16:19], s60 offen lds
ds_read_b128 v[64:67], v125 offset:22528
ds_read_b128 v[68:71], v125 offset:32768
ds_read_b64_tr_b16 v[208:209], v7 offset:0
ds_read_b64_tr_b16 v[210:211], v7 offset:1536
ds_read_b64_tr_b16 v[216:217], v7 offset:32
ds_read_b64_tr_b16 v[218:219], v7 offset:1568
ds_read_b64_tr_b16 v[224:225], v7 offset:64
ds_read_b64_tr_b16 v[226:227], v7 offset:1600
ds_read_b64_tr_b16 v[232:233], v7 offset:96
ds_read_b64_tr_b16 v[234:235], v7 offset:1632
ds_read_b64_tr_b16 v[240:241], v7 offset:128
ds_read_b64_tr_b16 v[242:243], v7 offset:1664
ds_read_b64_tr_b16 v[248:249], v7 offset:160
ds_read_b64_tr_b16 v[250:251], v7 offset:1696
s_waitcnt lgkmcnt(0)
v_mfma_f32_16x16x32_bf16 v[16:19], v[208:211], v[64:67], v[16:19]
v_mfma_f32_16x16x32_bf16 v[20:23], v[208:211], v[68:71], v[20:23]
v_mfma_f32_16x16x32_bf16 v[24:27], v[216:219], v[64:67], v[24:27]
v_mfma_f32_16x16x32_bf16 v[28:31], v[216:219], v[68:71], v[28:31]
v_mfma_f32_16x16x32_bf16 v[32:35], v[224:227], v[64:67], v[32:35]
v_mfma_f32_16x16x32_bf16 v[36:39], v[224:227], v[68:71], v[36:39]
v_mfma_f32_16x16x32_bf16 v[40:43], v[232:235], v[64:67], v[40:43]
v_mfma_f32_16x16x32_bf16 v[44:47], v[232:235], v[68:71], v[44:47]
v_mfma_f32_16x16x32_bf16 v[48:51], v[240:243], v[64:67], v[48:51]
v_mfma_f32_16x16x32_bf16 v[52:55], v[240:243], v[68:71], v[52:55]
v_mfma_f32_16x16x32_bf16 v[56:59], v[248:251], v[64:67], v[56:59]
v_mfma_f32_16x16x32_bf16 v[60:63], v[248:251], v[68:71], v[60:63]
s_waitcnt vmcnt(12)
s_barrier
s_add_u32 s60, s30, 7077888
s_mul_i32 s61, s24, 3072
s_add_u32 s61, s61, 49152
s_add_u32 m0, s61, 0
s_nop 0
buffer_load_dwordx4 v120, s[12:15], s60 offen lds
s_add_u32 m0, s61, 1024
s_nop 0
buffer_load_dwordx4 v121, s[12:15], s60 offen lds
s_add_u32 m0, s61, 2048
s_nop 0
buffer_load_dwordx4 v122, s[12:15], s60 offen lds
s_add_u32 s60, s30, 7077888
s_mul_i32 s61, s24, 3072
s_add_u32 s61, s61, 61440
s_add_u32 m0, s61, 0
s_nop 0
buffer_load_dwordx4 v120, s[16:19], s60 offen lds
s_add_u32 m0, s61, 1024
s_nop 0
buffer_load_dwordx4 v121, s[16:19], s60 offen lds
s_add_u32 m0, s61, 2048
s_nop 0
buffer_load_dwordx4 v122, s[16:19], s60 offen lds
ds_read_b128 v[64:67], v126 offset:22528
ds_read_b128 v[68:71], v126 offset:32768
ds_read_b64_tr_b16 v[212:213], v7 offset:24576
ds_read_b64_tr_b16 v[214:215], v7 offset:26112
ds_read_b64_tr_b16 v[220:221], v7 offset:24608
ds_read_b64_tr_b16 v[222:223], v7 offset:26144
ds_read_b64_tr_b16 v[228:229], v7 offset:24640
ds_read_b64_tr_b16 v[230:231], v7 offset:26176
ds_read_b64_tr_b16 v[236:237], v7 offset:24672
ds_read_b64_tr_b16 v[238:239], v7 offset:26208
ds_read_b64_tr_b16 v[244:245], v7 offset:24704
ds_read_b64_tr_b16 v[246:247], v7 offset:26240
ds_read_b64_tr_b16 v[252:253], v7 offset:24736
ds_read_b64_tr_b16 v[254:255], v7 offset:26272
s_waitcnt lgkmcnt(0)
v_mfma_f32_16x16x32_bf16 v[16:19], v[212:215], v[64:67], v[16:19]
v_mfma_f32_16x16x32_bf16 v[20:23], v[212:215], v[68:71], v[20:23]
v_mfma_f32_16x16x32_bf16 v[24:27], v[220:223], v[64:67], v[24:27]
v_mfma_f32_16x16x32_bf16 v[28:31], v[220:223], v[68:71], v[28:31]
v_mfma_f32_16x16x32_bf16 v[32:35], v[228:231], v[64:67], v[32:35]
v_mfma_f32_16x16x32_bf16 v[36:39], v[228:231], v[68:71], v[36:39]
v_mfma_f32_16x16x32_bf16 v[40:43], v[236:239], v[64:67], v[40:43]
v_mfma_f32_16x16x32_bf16 v[44:47], v[236:239], v[68:71], v[44:47]
v_mfma_f32_16x16x32_bf16 v[48:51], v[244:247], v[64:67], v[48:51]
v_mfma_f32_16x16x32_bf16 v[52:55], v[244:247], v[68:71], v[52:55]
v_mfma_f32_16x16x32_bf16 v[56:59], v[252:255], v[64:67], v[56:59]
v_mfma_f32_16x16x32_bf16 v[60:63], v[252:255], v[68:71], v[60:63]
s_waitcnt vmcnt(12)
s_barrier
s_add_u32 s60, s30, 7471104
s_mul_i32 s61, s24, 3072
s_add_u32 s61, s61, 73728
s_add_u32 m0, s61, 0
s_nop 0
buffer_load_dwordx4 v120, s[12:15], s60 offen lds
s_add_u32 m0, s61, 1024
s_nop 0
buffer_load_dwordx4 v121, s[12:15], s60 offen lds
s_add_u32 m0, s61, 2048
s_nop 0
buffer_load_dwordx4 v122, s[12:15], s60 offen lds
s_add_u32 s60, s30, 7471104
s_mul_i32 s61, s24, 3072
s_add_u32 s61, s61, 86016
s_add_u32 m0, s61, 0
s_nop 0
buffer_load_dwordx4 v120, s[16:19], s60 offen lds
s_add_u32 m0, s61, 1024
s_nop 0
buffer_load_dwordx4 v121, s[16:19], s60 offen lds
s_add_u32 m0, s61, 2048
s_nop 0
buffer_load_dwordx4 v122, s[16:19], s60 offen lds
ds_read_b128 v[64:67], v125 offset:23552
ds_read_b128 v[68:71], v125 offset:33792
ds_read_b64_tr_b16 v[72:73], v6 offset:0
ds_read_b64_tr_b16 v[74:75], v6 offset:1536
ds_read_b64_tr_b16 v[76:77], v6 offset:32
ds_read_b64_tr_b16 v[78:79], v6 offset:1568
ds_read_b64_tr_b16 v[80:81], v6 offset:64
ds_read_b64_tr_b16 v[82:83], v6 offset:1600
ds_read_b64_tr_b16 v[84:85], v6 offset:96
ds_read_b64_tr_b16 v[86:87], v6 offset:1632
ds_read_b64_tr_b16 v[88:89], v6 offset:128
ds_read_b64_tr_b16 v[90:91], v6 offset:1664
ds_read_b64_tr_b16 v[92:93], v6 offset:160
ds_read_b64_tr_b16 v[94:95], v6 offset:1696
s_waitcnt lgkmcnt(0)
v_mfma_f32_16x16x32_bf16 v[16:19], v[72:75], v[64:67], v[16:19]
v_mfma_f32_16x16x32_bf16 v[20:23], v[72:75], v[68:71], v[20:23]
v_mfma_f32_16x16x32_bf16 v[24:27], v[76:79], v[64:67], v[24:27]
v_mfma_f32_16x16x32_bf16 v[28:31], v[76:79], v[68:71], v[28:31]
v_mfma_f32_16x16x32_bf16 v[32:35], v[80:83], v[64:67], v[32:35]
v_mfma_f32_16x16x32_bf16 v[36:39], v[80:83], v[68:71], v[36:39]
v_mfma_f32_16x16x32_bf16 v[40:43], v[84:87], v[64:67], v[40:43]
v_mfma_f32_16x16x32_bf16 v[44:47], v[84:87], v[68:71], v[44:47]
v_mfma_f32_16x16x32_bf16 v[48:51], v[88:91], v[64:67], v[48:51]
v_mfma_f32_16x16x32_bf16 v[52:55], v[88:91], v[68:71], v[52:55]
v_mfma_f32_16x16x32_bf16 v[56:59], v[92:95], v[64:67], v[56:59]
v_mfma_f32_16x16x32_bf16 v[60:63], v[92:95], v[68:71], v[60:63]
s_waitcnt vmcnt(12)
s_barrier
ds_read_b128 v[64:67], v126 offset:23552
ds_read_b128 v[68:71], v126 offset:33792
ds_write_b128 v5, v[72:75] offset:0
ds_write_b128 v5, v[76:79] offset:1024
ds_write_b128 v5, v[80:83] offset:2048
ds_write_b128 v5, v[84:87] offset:3072
ds_write_b128 v5, v[88:91] offset:4096
ds_write_b128 v5, v[92:95] offset:5120
ds_read_b64_tr_b16 v[96:97], v6 offset:24576
ds_read_b64_tr_b16 v[98:99], v6 offset:26112
ds_read_b64_tr_b16 v[100:101], v6 offset:24608
ds_read_b64_tr_b16 v[102:103], v6 offset:26144
ds_read_b64_tr_b16 v[104:105], v6 offset:24640
ds_read_b64_tr_b16 v[106:107], v6 offset:26176
ds_read_b64_tr_b16 v[108:109], v6 offset:24672
ds_read_b64_tr_b16 v[110:111], v6 offset:26208
ds_read_b64_tr_b16 v[112:113], v6 offset:24704
ds_read_b64_tr_b16 v[114:115], v6 offset:26240
ds_read_b64_tr_b16 v[116:117], v6 offset:24736
ds_read_b64_tr_b16 v[118:119], v6 offset:26272
s_waitcnt lgkmcnt(0)
v_mfma_f32_16x16x32_bf16 v[16:19], v[96:99], v[64:67], v[16:19]
v_mfma_f32_16x16x32_bf16 v[20:23], v[96:99], v[68:71], v[20:23]
v_mfma_f32_16x16x32_bf16 v[24:27], v[100:103], v[64:67], v[24:27]
v_mfma_f32_16x16x32_bf16 v[28:31], v[100:103], v[68:71], v[28:31]
v_mfma_f32_16x16x32_bf16 v[32:35], v[104:107], v[64:67], v[32:35]
v_mfma_f32_16x16x32_bf16 v[36:39], v[104:107], v[68:71], v[36:39]
v_mfma_f32_16x16x32_bf16 v[40:43], v[108:111], v[64:67], v[40:43]
v_mfma_f32_16x16x32_bf16 v[44:47], v[108:111], v[68:71], v[44:47]
v_mfma_f32_16x16x32_bf16 v[48:51], v[112:115], v[64:67], v[48:51]
v_mfma_f32_16x16x32_bf16 v[52:55], v[112:115], v[68:71], v[52:55]
v_mfma_f32_16x16x32_bf16 v[56:59], v[116:119], v[64:67], v[56:59]
v_mfma_f32_16x16x32_bf16 v[60:63], v[116:119], v[68:71], v[60:63]
s_waitcnt vmcnt(6)
s_barrier
ds_read_b128 v[64:67], v125 offset:24576
ds_read_b128 v[68:71], v125 offset:34816
ds_write_b128 v5, v[96:99] offset:24576
ds_write_b128 v5, v[100:103] offset:25600
ds_write_b128 v5, v[104:107] offset:26624
ds_write_b128 v5, v[108:111] offset:27648
ds_write_b128 v5, v[112:115] offset:28672
ds_write_b128 v5, v[116:119] offset:29696
ds_read_b64_tr_b16 v[72:73], v7 offset:0
ds_read_b64_tr_b16 v[74:75], v7 offset:1536
ds_read_b64_tr_b16 v[76:77], v7 offset:32
ds_read_b64_tr_b16 v[78:79], v7 offset:1568
ds_read_b64_tr_b16 v[80:81], v7 offset:64
ds_read_b64_tr_b16 v[82:83], v7 offset:1600
ds_read_b64_tr_b16 v[84:85], v7 offset:96
ds_read_b64_tr_b16 v[86:87], v7 offset:1632
ds_read_b64_tr_b16 v[88:89], v7 offset:128
ds_read_b64_tr_b16 v[90:91], v7 offset:1664
ds_read_b64_tr_b16 v[92:93], v7 offset:160
ds_read_b64_tr_b16 v[94:95], v7 offset:1696
s_waitcnt lgkmcnt(0)
v_mfma_f32_16x16x32_bf16 v[16:19], v[72:75], v[64:67], v[16:19]
v_mfma_f32_16x16x32_bf16 v[20:23], v[72:75], v[68:71], v[20:23]
v_mfma_f32_16x16x32_bf16 v[24:27], v[76:79], v[64:67], v[24:27]
v_mfma_f32_16x16x32_bf16 v[28:31], v[76:79], v[68:71], v[28:31]
v_mfma_f32_16x16x32_bf16 v[32:35], v[80:83], v[64:67], v[32:35]
v_mfma_f32_16x16x32_bf16 v[36:39], v[80:83], v[68:71], v[36:39]
v_mfma_f32_16x16x32_bf16 v[40:43], v[84:87], v[64:67], v[40:43]
v_mfma_f32_16x16x32_bf16 v[44:47], v[84:87], v[68:71], v[44:47]
v_mfma_f32_16x16x32_bf16 v[48:51], v[88:91], v[64:67], v[48:51]
v_mfma_f32_16x16x32_bf16 v[52:55], v[88:91], v[68:71], v[52:55]
v_mfma_f32_16x16x32_bf16 v[56:59], v[92:95], v[64:67], v[56:59]
v_mfma_f32_16x16x32_bf16 v[60:63], v[92:95], v[68:71], v[60:63]
s_waitcnt vmcnt(0)
s_barrier
ds_read_b128 v[64:67], v126 offset:24576
ds_read_b128 v[68:71], v126 offset:34816
ds_write_b128 v123, v[72:75] offset:0
ds_write_b128 v123, v[76:79] offset:1024
ds_write_b128 v123, v[80:83] offset:2048
ds_write_b128 v123, v[84:87] offset:3072
ds_write_b128 v123, v[88:91] offset:4096
ds_write_b128 v123, v[92:95] offset:5120
ds_read_b64_tr_b16 v[96:97], v7 offset:24576
ds_read_b64_tr_b16 v[98:99], v7 offset:26112
ds_read_b64_tr_b16 v[100:101], v7 offset:24608
ds_read_b64_tr_b16 v[102:103], v7 offset:26144
ds_read_b64_tr_b16 v[104:105], v7 offset:24640
ds_read_b64_tr_b16 v[106:107], v7 offset:26176
ds_read_b64_tr_b16 v[108:109], v7 offset:24672
ds_read_b64_tr_b16 v[110:111], v7 offset:26208
ds_read_b64_tr_b16 v[112:113], v7 offset:24704
ds_read_b64_tr_b16 v[114:115], v7 offset:26240
ds_read_b64_tr_b16 v[116:117], v7 offset:24736
ds_read_b64_tr_b16 v[118:119], v7 offset:26272
s_waitcnt lgkmcnt(0)
v_mfma_f32_16x16x32_bf16 v[16:19], v[96:99], v[64:67], v[16:19]
v_mfma_f32_16x16x32_bf16 v[20:23], v[96:99], v[68:71], v[20:23]
v_mfma_f32_16x16x32_bf16 v[24:27], v[100:103], v[64:67], v[24:27]
v_mfma_f32_16x16x32_bf16 v[28:31], v[100:103], v[68:71], v[28:31]
v_mfma_f32_16x16x32_bf16 v[32:35], v[104:107], v[64:67], v[32:35]
v_mfma_f32_16x16x32_bf16 v[36:39], v[104:107], v[68:71], v[36:39]
v_mfma_f32_16x16x32_bf16 v[40:43], v[108:111], v[64:67], v[40:43]
v_mfma_f32_16x16x32_bf16 v[44:47], v[108:111], v[68:71], v[44:47]
v_mfma_f32_16x16x32_bf16 v[48:51], v[112:115], v[64:67], v[48:51]
v_mfma_f32_16x16x32_bf16 v[52:55], v[112:115], v[68:71], v[52:55]
v_mfma_f32_16x16x32_bf16 v[56:59], v[116:119], v[64:67], v[56:59]
v_mfma_f32_16x16x32_bf16 v[60:63], v[116:119], v[68:71], v[60:63]
s_barrier
ds_write_b128 v123, v[96:99] offset:24576
ds_write_b128 v123, v[100:103] offset:25600
ds_write_b128 v123, v[104:107] offset:26624
ds_write_b128 v123, v[108:111] offset:27648
ds_write_b128 v123, v[112:115] offset:28672
ds_write_b128 v123, v[116:119] offset:29696
s_waitcnt lgkmcnt(0)
v_mov_b32 v6, v123
s_mov_b32 s62, 0
v_mov_b32 v15, 128
XQwn:
s_add_u32 s62, s62, 1
s_mov_b32 s63, 9
s_cmp_gt_u32 s62, 400000
s_cbranch_scc1 L_err
buffer_load_dwordx3 v[12:14], v15, s[20:23], 0 offen sc1
s_waitcnt vmcnt(0)
v_readfirstlane_b32 s3, v12
v_readfirstlane_b32 s57, v14
s_cmp_eq_u32 s57, 0
s_cselect_b32 s3, 0, s3
s_bitcmp1_b32 s3, 8
s_cbranch_scc0 XQwn
s_bfe_u32 s3, s3, 0x10001
s_lshl_b32 s60, s32, 7
s_add_u32 s60, s60, s45
s_add_u32 s60, s60, 0
s_lshl_b32 s52, s60, 14
s_add_u32 s52, s52, 5242880
s_bfe_u32 s61, s52, 0x10015
s_xor_b32 s61, s61, s3
s_xor_b32 s61, s61, 1
s_lshl_b32 s61, s61, 13
s_add_u32 s52, s52, s61
s_add_u32 s52, s52, s46
s_sub_u32 s52, s52, 0x400000
s_lshl_b32 s60, s32, 7
s_add_u32 s60, s60, s45
s_add_u32 s60, s60, 1
s_lshl_b32 s53, s60, 14
s_add_u32 s53, s53, 5242880
s_bfe_u32 s61, s53, 0x10015
s_xor_b32 s61, s61, s3
s_xor_b32 s61, s61, 1
s_lshl_b32 s61, s61, 13
s_add_u32 s53, s53, s61
s_add_u32 s53, s53, s46
s_sub_u32 s53, s53, 0x400000
v_lshrrev_b32 v8, 3, v0
s_lshl_b32 s35, s24, 3
v_add_u32 v7, s35, v8
v_mul_u32_u24 v7, 1280, v7
v_and_b32 v9, 7, v0
v_xor_b32 v9, v9, v8
v_lshl_add_u32 v7, v9, 4, v7
v_and_b32 v8, 7, v2
v_xor_b32 v9, v3, v8
v_lshlrev_b32 v9, 4, v9
v_lshl_add_u32 v9, v8, 7, v9
v_lshrrev_b32 v8, 3, v2
v_mul_u32_u24 v8, 5120, v8
v_add_u32 v10, v8, v9
v_xor_b32 v11, 64, v10
s_mov_b32 s44, 139264
v_add_u32 v4, s44, v10
v_add_u32 v12, s44, v11
ds_read_b128 v[64:67], v4 offset:0
ds_read_b128 v[68:71], v4 offset:10240
ds_read_b128 v[72:75], v12 offset:0
ds_read_b128 v[76:79], v12 offset:10240
v_cvt_pk_bf16_f32 v88, v16, v17
v_cvt_pk_bf16_f32 v89, v18, v19
v_cvt_pk_bf16_f32 v92, v20, v21
v_cvt_pk_bf16_f32 v93, v22, v23
v_cvt_pk_bf16_f32 v90, v24, v25
v_cvt_pk_bf16_f32 v91, v26, v27
v_cvt_pk_bf16_f32 v94, v28, v29
v_cvt_pk_bf16_f32 v95, v30, v31
v_cvt_pk_bf16_f32 v96, v32, v33
v_cvt_pk_bf16_f32 v97, v34, v35
v_cvt_pk_bf16_f32 v100, v36, v37
v_cvt_pk_bf16_f32 v101, v38, v39
v_cvt_pk_bf16_f32 v98, v40, v41
v_cvt_pk_bf16_f32 v99, v42, v43
v_cvt_pk_bf16_f32 v102, v44, v45
v_cvt_pk_bf16_f32 v103, v46, v47
s_branch XQtail
XQloop:
s_waitcnt lgkmcnt(2)
v_mfma_f32_16x16x32_bf16 v[16:19], a[0:3], v[64:67], 0
s_mov_b32 m0, s42
s_add_u32 s42, s42, 1024
v_mfma_f32_16x16x32_bf16 v[20:23], a[0:3], v[68:71], 0
buffer_load_dwordx4 v7, s[8:11], s41 offen lds
s_add_u32 s41, s41, 128
v_mfma_f32_16x16x32_bf16 v[24:27], a[8:11], v[64:67], 0
v_mfma_f32_16x16x32_bf16 v[28:31], a[8:11], v[68:71], 0
buffer_store_dwordx4 v[88:91], v1, s[48:51], s52 offen offset:0 sc1
v_mfma_f32_16x16x32_bf16 v[32:35], a[16:19], v[64:67], 0
v_mfma_f32_16x16x32_bf16 v[36:39], a[16:19], v[68:71], 0
v_mfma_f32_16x16x32_bf16 v[40:43], a[24:27], v[64:67], 0
v_mfma_f32_16x16x32_bf16 v[44:47], a[24:27], v[68:71], 0
v_mfma_f32_16x16x32_bf16 v[48:51], a[32:35], v[64:67], 0
ds_read_b128 v[80:83], v4 offset:1024
v_mfma_f32_16x16x32_bf16 v[52:55], a[32:35], v[68:71], 0
ds_read_b128 v[84:87], v4 offset:11264
v_mfma_f32_16x16x32_bf16 v[56:59], a[40:43], v[64:67], 0
v_mfma_f32_16x16x32_bf16 v[60:63], a[40:43], v[68:71], 0
s_waitcnt lgkmcnt(2)
v_mfma_f32_16x16x32_bf16 v[16:19], a[4:7], v[72:75], v[16:19]
v_mfma_f32_16x16x32_bf16 v[20:23], a[4:7], v[76:79], v[20:23]
v_mfma_f32_16x16x32_bf16 v[24:27], a[12:15], v[72:75], v[24:27]
v_mfma_f32_16x16x32_bf16 v[28:31], a[12:15], v[76:79], v[28:31]
buffer_store_dwordx4 v[92:95], v1, s[48:51], s53 offen offset:0 sc1
v_mfma_f32_16x16x32_bf16 v[32:35], a[20:23], v[72:75], v[32:35]
v_mfma_f32_16x16x32_bf16 v[36:39], a[20:23], v[76:79], v[36:39]
v_mfma_f32_16x16x32_bf16 v[40:43], a[28:31], v[72:75], v[40:43]
v_mfma_f32_16x16x32_bf16 v[44:47], a[28:31], v[76:79], v[44:47]
v_mfma_f32_16x16x32_bf16 v[48:51], a[36:39], v[72:75], v[48:51]
ds_read_b128 v[112:115], v12 offset:1024
v_mfma_f32_16x16x32_bf16 v[52:55], a[36:39], v[76:79], v[52:55]
ds_read_b128 v[116:119], v12 offset:11264
v_mfma_f32_16x16x32_bf16 v[56:59], a[44:47], v[72:75], v[56:59]
v_mfma_f32_16x16x32_bf16 v[60:63], a[44:47], v[76:79], v[60:63]
s_waitcnt lgkmcnt(2)
v_mfma_f32_16x16x32_bf16 v[16:19], a[48:51], v[80:83], v[16:19]
v_mfma_f32_16x16x32_bf16 v[20:23], a[48:51], v[84:87], v[20:23]
v_mfma_f32_16x16x32_bf16 v[24:27], a[56:59], v[80:83], v[24:27]
v_mfma_f32_16x16x32_bf16 v[28:31], a[56:59], v[84:87], v[28:31]
buffer_store_dwordx4 v[96:99], v1, s[48:51], s52 offen offset:1024 sc1
v_mfma_f32_16x16x32_bf16 v[32:35], a[64:67], v[80:83], v[32:35]
v_mfma_f32_16x16x32_bf16 v[36:39], a[64:67], v[84:87], v[36:39]
v_mfma_f32_16x16x32_bf16 v[40:43], a[72:75], v[80:83], v[40:43]
v_mfma_f32_16x16x32_bf16 v[44:47], a[72:75], v[84:87], v[44:47]
v_mfma_f32_16x16x32_bf16 v[48:51], a[80:83], v[80:83], v[48:51]
ds_read_b128 v[64:67], v4 offset:2048
v_mfma_f32_16x16x32_bf16 v[52:55], a[80:83], v[84:87], v[52:55]
ds_read_b128 v[68:71], v4 offset:12288
v_mfma_f32_16x16x32_bf16 v[56:59], a[88:91], v[80:83], v[56:59]
v_mfma_f32_16x16x32_bf16 v[60:63], a[88:91], v[84:87], v[60:63]
s_waitcnt lgkmcnt(2)
v_mfma_f32_16x16x32_bf16 v[16:19], a[52:55], v[112:115], v[16:19]
v_mfma_f32_16x16x32_bf16 v[20:23], a[52:55], v[116:119], v[20:23]
v_mfma_f32_16x16x32_bf16 v[24:27], a[60:63], v[112:115], v[24:27]
v_mfma_f32_16x16x32_bf16 v[28:31], a[60:63], v[116:119], v[28:31]
buffer_store_dwordx4 v[100:103], v1, s[48:51], s53 offen offset:1024 sc1
v_mfma_f32_16x16x32_bf16 v[32:35], a[68:71], v[112:115], v[32:35]
v_mfma_f32_16x16x32_bf16 v[36:39], a[68:71], v[116:119], v[36:39]
v_mfma_f32_16x16x32_bf16 v[40:43], a[76:79], v[112:115], v[40:43]
v_mfma_f32_16x16x32_bf16 v[44:47], a[76:79], v[116:119], v[44:47]
v_mfma_f32_16x16x32_bf16 v[48:51], a[84:87], v[112:115], v[48:51]
ds_read_b128 v[72:75], v12 offset:2048
v_mfma_f32_16x16x32_bf16 v[52:55], a[84:87], v[116:119], v[52:55]
ds_read_b128 v[76:79], v12 offset:12288
v_mfma_f32_16x16x32_bf16 v[56:59], a[92:95], v[112:115], v[56:59]
v_mfma_f32_16x16x32_bf16 v[60:63], a[92:95], v[116:119], v[60:63]
s_waitcnt lgkmcnt(2)
v_mfma_f32_16x16x32_bf16 v[16:19], a[96:99], v[64:67], v[16:19]
v_mfma_f32_16x16x32_bf16 v[20:23], a[96:99], v[68:71], v[20:23]
v_mfma_f32_16x16x32_bf16 v[24:27], a[104:107], v[64:67], v[24:27]
v_mfma_f32_16x16x32_bf16 v[28:31], a[104:107], v[68:71], v[28:31]
buffer_store_dwordx4 v[104:107], v1, s[48:51], s52 offen offset:2048 sc1
v_mfma_f32_16x16x32_bf16 v[32:35], a[112:115], v[64:67], v[32:35]
v_mfma_f32_16x16x32_bf16 v[36:39], a[112:115], v[68:71], v[36:39]
v_mfma_f32_16x16x32_bf16 v[40:43], a[120:123], v[64:67], v[40:43]
v_mfma_f32_16x16x32_bf16 v[44:47], a[120:123], v[68:71], v[44:47]
v_mfma_f32_16x16x32_bf16 v[48:51], a[128:131], v[64:67], v[48:51]
ds_read_b128 v[80:83], v4 offset:3072
v_mfma_f32_16x16x32_bf16 v[52:55], a[128:131], v[68:71], v[52:55]
ds_read_b128 v[84:87], v4 offset:13312
v_mfma_f32_16x16x32_bf16 v[56:59], a[136:139], v[64:67], v[56:59]
v_mfma_f32_16x16x32_bf16 v[60:63], a[136:139], v[68:71], v[60:63]
s_waitcnt lgkmcnt(2)
v_mfma_f32_16x16x32_bf16 v[16:19], a[100:103], v[72:75], v[16:19]
v_mfma_f32_16x16x32_bf16 v[20:23], a[100:103], v[76:79], v[20:23]
v_mfma_f32_16x16x32_bf16 v[24:27], a[108:111], v[72:75], v[24:27]
v_mfma_f32_16x16x32_bf16 v[28:31], a[108:111], v[76:79], v[28:31]
buffer_store_dwordx4 v[108:111], v1, s[48:51], s53 offen offset:2048 sc1
v_mfma_f32_16x16x32_bf16 v[32:35], a[116:119], v[72:75], v[32:35]
v_mfma_f32_16x16x32_bf16 v[36:39], a[116:119], v[76:79], v[36:39]
v_mfma_f32_16x16x32_bf16 v[40:43], a[124:127], v[72:75], v[40:43]
v_mfma_f32_16x16x32_bf16 v[44:47], a[124:127], v[76:79], v[44:47]
v_mfma_f32_16x16x32_bf16 v[48:51], a[132:135], v[72:75], v[48:51]
ds_read_b128 v[112:115], v12 offset:3072
v_mfma_f32_16x16x32_bf16 v[52:55], a[132:135], v[76:79], v[52:55]
ds_read_b128 v[116:119], v12 offset:13312
v_mfma_f32_16x16x32_bf16 v[56:59], a[140:143], v[72:75], v[56:59]
v_mfma_f32_16x16x32_bf16 v[60:63], a[140:143], v[76:79], v[60:63]
s_waitcnt lgkmcnt(2)
v_mfma_f32_16x16x32_bf16 v[16:19], a[144:147], v[80:83], v[16:19]
v_mfma_f32_16x16x32_bf16 v[20:23], a[144:147], v[84:87], v[20:23]
v_mfma_f32_16x16x32_bf16 v[24:27], a[152:155], v[80:83], v[24:27]
v_mfma_f32_16x16x32_bf16 v[28:31], a[152:155], v[84:87], v[28:31]
v_mfma_f32_16x16x32_bf16 v[32:35], a[160:163], v[80:83], v[32:35]
v_mfma_f32_16x16x32_bf16 v[36:39], a[160:163], v[84:87], v[36:39]
v_mfma_f32_16x16x32_bf16 v[40:43], a[168:171], v[80:83], v[40:43]
v_mfma_f32_16x16x32_bf16 v[44:47], a[168:171], v[84:87], v[44:47]
v_mfma_f32_16x16x32_bf16 v[48:51], a[176:179], v[80:83], v[48:51]
ds_read_b128 v[64:67], v4 offset:4096
v_mfma_f32_16x16x32_bf16 v[52:55], a[176:179], v[84:87], v[52:55]
ds_read_b128 v[68:71], v4 offset:14336
v_mfma_f32_16x16x32_bf16 v[56:59], a[184:187], v[80:83], v[56:59]
v_mfma_f32_16x16x32_bf16 v[60:63], a[184:187], v[84:87], v[60:63]
s_cmp_lt_u32 s40, 8
s_cbranch_scc0 xq_1
s_waitcnt vmcnt(0)
s_barrier
s_add_u32 s61, s57, s40
v_mov_b32 v14, s61
v_mov_b32 v15, 0
s_mov_b64 exec, 1
buffer_store_dword v14, v15, s[4:7], s34 offen sc1
s_mov_b64 exec, -1
s_branch xq_2
xq_1:
s_waitcnt vmcnt(6)
s_barrier
xq_2:
s_waitcnt lgkmcnt(2)
v_mfma_f32_16x16x32_bf16 v[16:19], a[148:151], v[112:115], v[16:19]
s_add_u32 s44, s44, 20480
s_cmp_eq_u32 s44, 159744
v_mfma_f32_16x16x32_bf16 v[20:23], a[148:151], v[116:119], v[20:23]
s_cselect_b32 s44, 98304, s44
v_add_u32 v9, s44, v10
v_mfma_f32_16x16x32_bf16 v[24:27], a[156:159], v[112:115], v[24:27]
v_add_u32 v13, s44, v11
s_min_u32 s41, s36, 63
v_mfma_f32_16x16x32_bf16 v[28:31], a[156:159], v[116:119], v[28:31]
s_lshr_b32 s41, s41, 1
s_mul_i32 s41, s41, s33
v_mfma_f32_16x16x32_bf16 v[32:35], a[164:167], v[112:115], v[32:35]
s_add_u32 s41, s41, s32
s_mul_i32 s41, s41, 40960
v_mfma_f32_16x16x32_bf16 v[36:39], a[164:167], v[116:119], v[36:39]
s_and_b32 s42, s36, 1
s_mul_i32 s42, s42, 640
v_mfma_f32_16x16x32_bf16 v[40:43], a[172:175], v[112:115], v[40:43]
s_add_u32 s41, s41, s42
s_mul_i32 s42, s37, 20480
v_mfma_f32_16x16x32_bf16 v[44:47], a[172:175], v[116:119], v[44:47]
s_mul_i32 s43, s24, 5120
s_add_u32 s42, s42, s43
v_mfma_f32_16x16x32_bf16 v[48:51], a[180:183], v[112:115], v[48:51]
ds_read_b128 v[72:75], v12 offset:4096
s_add_u32 s42, s42, 98304
v_mfma_f32_16x16x32_bf16 v[52:55], a[180:183], v[116:119], v[52:55]
ds_read_b128 v[76:79], v12 offset:14336
s_add_u32 s36, s36, 1
v_mfma_f32_16x16x32_bf16 v[56:59], a[188:191], v[112:115], v[56:59]
s_add_u32 s37, s37, 1
s_cmp_eq_u32 s37, 3
v_mfma_f32_16x16x32_bf16 v[60:63], a[188:191], v[116:119], v[60:63]
s_cselect_b32 s37, 0, s37
s_mov_b32 m0, s42
s_waitcnt lgkmcnt(2)
v_mfma_f32_16x16x32_bf16 v[16:19], a[192:195], v[64:67], v[16:19]
s_add_u32 s42, s42, 1024
buffer_load_dwordx4 v7, s[8:11], s41 offen lds
v_mfma_f32_16x16x32_bf16 v[20:23], a[192:195], v[68:71], v[20:23]
s_add_u32 s41, s41, 128
s_mov_b32 m0, s42
v_mfma_f32_16x16x32_bf16 v[24:27], a[200:203], v[64:67], v[24:27]
s_add_u32 s42, s42, 1024
buffer_load_dwordx4 v7, s[8:11], s41 offen lds
v_mfma_f32_16x16x32_bf16 v[28:31], a[200:203], v[68:71], v[28:31]
s_add_u32 s41, s41, 128
s_mov_b32 m0, s42
v_mfma_f32_16x16x32_bf16 v[32:35], a[208:211], v[64:67], v[32:35]
s_add_u32 s42, s42, 1024
buffer_load_dwordx4 v7, s[8:11], s41 offen lds
v_mfma_f32_16x16x32_bf16 v[36:39], a[208:211], v[68:71], v[36:39]
s_add_u32 s41, s41, 128
s_mov_b32 m0, s42
v_mfma_f32_16x16x32_bf16 v[40:43], a[216:219], v[64:67], v[40:43]
s_add_u32 s42, s42, 1024
buffer_load_dwordx4 v7, s[8:11], s41 offen lds
v_mfma_f32_16x16x32_bf16 v[44:47], a[216:219], v[68:71], v[44:47]
s_add_u32 s41, s41, 128
s_mov_b32 m0, s42
v_mfma_f32_16x16x32_bf16 v[48:51], a[224:227], v[64:67], v[48:51]
ds_read_b128 v[80:83], v9 offset:0
s_add_u32 s42, s42, 1024
v_mfma_f32_16x16x32_bf16 v[52:55], a[224:227], v[68:71], v[52:55]
ds_read_b128 v[84:87], v9 offset:10240
buffer_load_dwordx4 v7, s[8:11], s41 offen lds
v_mfma_f32_16x16x32_bf16 v[56:59], a[232:235], v[64:67], v[56:59]
s_add_u32 s41, s41, 128
v_mfma_f32_16x16x32_bf16 v[60:63], a[232:235], v[68:71], v[60:63]
s_waitcnt lgkmcnt(2)
v_mfma_f32_16x16x32_bf16 v[16:19], a[196:199], v[72:75], v[16:19]
v_mfma_f32_16x16x32_bf16 v[20:23], a[196:199], v[76:79], v[20:23]
v_mfma_f32_16x16x32_bf16 v[24:27], a[204:207], v[72:75], v[24:27]
v_mfma_f32_16x16x32_bf16 v[28:31], a[204:207], v[76:79], v[28:31]
v_mfma_f32_16x16x32_bf16 v[32:35], a[212:215], v[72:75], v[32:35]
v_mfma_f32_16x16x32_bf16 v[36:39], a[212:215], v[76:79], v[36:39]
v_mfma_f32_16x16x32_bf16 v[40:43], a[220:223], v[72:75], v[40:43]
v_mfma_f32_16x16x32_bf16 v[44:47], a[220:223], v[76:79], v[44:47]
v_mfma_f32_16x16x32_bf16 v[48:51], a[228:231], v[72:75], v[48:51]
ds_read_b128 v[112:115], v13 offset:0
v_mfma_f32_16x16x32_bf16 v[52:55], a[228:231], v[76:79], v[52:55]
ds_read_b128 v[116:119], v13 offset:10240
v_mfma_f32_16x16x32_bf16 v[56:59], a[236:239], v[72:75], v[56:59]
v_mfma_f32_16x16x32_bf16 v[60:63], a[236:239], v[76:79], v[60:63]
v_mov_b32 v4, v9
v_mov_b32 v12, v13
s_waitcnt lgkmcnt(2)
v_mfma_f32_16x16x32_bf16 v[16:19], a[240:243], v[80:83], v[16:19]
v_mfma_f32_16x16x32_bf16 v[20:23], a[240:243], v[84:87], v[20:23]
v_mfma_f32_16x16x32_bf16 v[24:27], a[248:251], v[80:83], v[24:27]
v_mfma_f32_16x16x32_bf16 v[28:31], a[248:251], v[84:87], v[28:31]
v_mfma_f32_16x16x32_bf16 v[32:35], v[128:131], v[80:83], v[32:35]
v_mfma_f32_16x16x32_bf16 v[36:39], v[128:131], v[84:87], v[36:39]
v_mfma_f32_16x16x32_bf16 v[40:43], v[136:139], v[80:83], v[40:43]
v_mfma_f32_16x16x32_bf16 v[44:47], v[136:139], v[84:87], v[44:47]
v_mfma_f32_16x16x32_bf16 v[48:51], v[144:147], v[80:83], v[48:51]
ds_read_b128 v[64:67], v4 offset:1024
v_mfma_f32_16x16x32_bf16 v[52:55], v[144:147], v[84:87], v[52:55]
ds_read_b128 v[68:71], v4 offset:11264
v_mfma_f32_16x16x32_bf16 v[56:59], v[152:155], v[80:83], v[56:59]
v_mfma_f32_16x16x32_bf16 v[60:63], v[152:155], v[84:87], v[60:63]
s_waitcnt lgkmcnt(2)
v_mfma_f32_16x16x32_bf16 v[16:19], a[244:247], v[112:115], v[16:19]
v_mfma_f32_16x16x32_bf16 v[20:23], a[244:247], v[116:119], v[20:23]
v_mfma_f32_16x16x32_bf16 v[24:27], a[252:255], v[112:115], v[24:27]
v_mfma_f32_16x16x32_bf16 v[28:31], a[252:255], v[116:119], v[28:31]
v_mfma_f32_16x16x32_bf16 v[32:35], v[132:135], v[112:115], v[32:35]
v_mfma_f32_16x16x32_bf16 v[36:39], v[132:135], v[116:119], v[36:39]
v_mfma_f32_16x16x32_bf16 v[40:43], v[140:143], v[112:115], v[40:43]
v_mfma_f32_16x16x32_bf16 v[44:47], v[140:143], v[116:119], v[44:47]
v_mfma_f32_16x16x32_bf16 v[48:51], v[148:151], v[112:115], v[48:51]
ds_read_b128 v[72:75], v12 offset:1024
v_mfma_f32_16x16x32_bf16 v[52:55], v[148:151], v[116:119], v[52:55]
ds_read_b128 v[76:79], v12 offset:11264
v_mfma_f32_16x16x32_bf16 v[56:59], v[156:159], v[112:115], v[56:59]
v_mfma_f32_16x16x32_bf16 v[60:63], v[156:159], v[116:119], v[60:63]
s_waitcnt lgkmcnt(2)
v_mfma_f32_16x16x32_bf16 v[16:19], v[160:163], v[64:67], v[16:19]
v_mfma_f32_16x16x32_bf16 v[20:23], v[160:163], v[68:71], v[20:23]
v_mfma_f32_16x16x32_bf16 v[24:27], v[168:171], v[64:67], v[24:27]
v_mfma_f32_16x16x32_bf16 v[28:31], v[168:171], v[68:71], v[28:31]
v_mfma_f32_16x16x32_bf16 v[32:35], v[176:179], v[64:67], v[32:35]
v_mfma_f32_16x16x32_bf16 v[36:39], v[176:179], v[68:71], v[36:39]
v_mfma_f32_16x16x32_bf16 v[40:43], v[184:187], v[64:67], v[40:43]
v_mfma_f32_16x16x32_bf16 v[44:47], v[184:187], v[68:71], v[44:47]
v_mfma_f32_16x16x32_bf16 v[48:51], v[192:195], v[64:67], v[48:51]
ds_read_b128 v[80:83], v4 offset:2048
v_mfma_f32_16x16x32_bf16 v[52:55], v[192:195], v[68:71], v[52:55]
ds_read_b128 v[84:87], v4 offset:12288
v_mfma_f32_16x16x32_bf16 v[56:59], v[200:203], v[64:67], v[56:59]
v_mfma_f32_16x16x32_bf16 v[60:63], v[200:203], v[68:71], v[60:63]
s_waitcnt lgkmcnt(2)
v_mfma_f32_16x16x32_bf16 v[16:19], v[164:167], v[72:75], v[16:19]
v_mfma_f32_16x16x32_bf16 v[20:23], v[164:167], v[76:79], v[20:23]
v_mfma_f32_16x16x32_bf16 v[24:27], v[172:175], v[72:75], v[24:27]
v_mfma_f32_16x16x32_bf16 v[28:31], v[172:175], v[76:79], v[28:31]
v_mfma_f32_16x16x32_bf16 v[32:35], v[180:183], v[72:75], v[32:35]
v_mfma_f32_16x16x32_bf16 v[36:39], v[180:183], v[76:79], v[36:39]
v_mfma_f32_16x16x32_bf16 v[40:43], v[188:191], v[72:75], v[40:43]
v_mfma_f32_16x16x32_bf16 v[44:47], v[188:191], v[76:79], v[44:47]
v_mfma_f32_16x16x32_bf16 v[48:51], v[196:199], v[72:75], v[48:51]
ds_read_b128 v[112:115], v12 offset:2048
v_mfma_f32_16x16x32_bf16 v[52:55], v[196:199], v[76:79], v[52:55]
ds_read_b128 v[116:119], v12 offset:12288
v_mfma_f32_16x16x32_bf16 v[56:59], v[204:207], v[72:75], v[56:59]
v_mfma_f32_16x16x32_bf16 v[60:63], v[204:207], v[76:79], v[60:63]
s_waitcnt lgkmcnt(2)
v_mfma_f32_16x16x32_bf16 v[16:19], v[208:211], v[80:83], v[16:19]
v_mfma_f32_16x16x32_bf16 v[20:23], v[208:211], v[84:87], v[20:23]
v_mfma_f32_16x16x32_bf16 v[24:27], v[216:219], v[80:83], v[24:27]
v_mfma_f32_16x16x32_bf16 v[28:31], v[216:219], v[84:87], v[28:31]
v_mfma_f32_16x16x32_bf16 v[32:35], v[224:227], v[80:83], v[32:35]
v_mfma_f32_16x16x32_bf16 v[36:39], v[224:227], v[84:87], v[36:39]
v_mfma_f32_16x16x32_bf16 v[40:43], v[232:235], v[80:83], v[40:43]
v_mfma_f32_16x16x32_bf16 v[44:47], v[232:235], v[84:87], v[44:47]
v_mfma_f32_16x16x32_bf16 v[48:51], v[240:243], v[80:83], v[48:51]
ds_read_b128 v[64:67], v4 offset:3072
v_mfma_f32_16x16x32_bf16 v[52:55], v[240:243], v[84:87], v[52:55]
ds_read_b128 v[68:71], v4 offset:13312
v_mfma_f32_16x16x32_bf16 v[56:59], v[248:251], v[80:83], v[56:59]
v_mfma_f32_16x16x32_bf16 v[60:63], v[248:251], v[84:87], v[60:63]
s_waitcnt lgkmcnt(2)
v_mfma_f32_16x16x32_bf16 v[16:19], v[212:215], v[112:115], v[16:19]
v_mfma_f32_16x16x32_bf16 v[20:23], v[212:215], v[116:119], v[20:23]
v_mfma_f32_16x16x32_bf16 v[24:27], v[220:223], v[112:115], v[24:27]
v_mfma_f32_16x16x32_bf16 v[28:31], v[220:223], v[116:119], v[28:31]
v_mfma_f32_16x16x32_bf16 v[32:35], v[228:231], v[112:115], v[32:35]
ds_read_b128 v[88:91], v5 offset:0
v_mfma_f32_16x16x32_bf16 v[36:39], v[228:231], v[116:119], v[36:39]
v_mfma_f32_16x16x32_bf16 v[40:43], v[236:239], v[112:115], v[40:43]
ds_read_b128 v[92:95], v5 offset:1024
v_mfma_f32_16x16x32_bf16 v[44:47], v[236:239], v[116:119], v[44:47]
v_mfma_f32_16x16x32_bf16 v[48:51], v[244:247], v[112:115], v[48:51]
ds_read_b128 v[72:75], v12 offset:3072
ds_read_b128 v[96:99], v5 offset:2048
v_mfma_f32_16x16x32_bf16 v[52:55], v[244:247], v[116:119], v[52:55]
ds_read_b128 v[76:79], v12 offset:13312
v_mfma_f32_16x16x32_bf16 v[56:59], v[252:255], v[112:115], v[56:59]
ds_read_b128 v[100:103], v5 offset:3072
v_mfma_f32_16x16x32_bf16 v[60:63], v[252:255], v[116:119], v[60:63]
s_waitcnt lgkmcnt(5)
v_mfma_f32_16x16x32_bf16 v[16:19], v[88:91], v[64:67], v[16:19]
ds_read_b128 v[104:107], v5 offset:4096
v_mfma_f32_16x16x32_bf16 v[20:23], v[88:91], v[68:71], v[20:23]
s_waitcnt lgkmcnt(5)
v_mfma_f32_16x16x32_bf16 v[24:27], v[92:95], v[64:67], v[24:27]
ds_read_b128 v[108:111], v5 offset:5120
v_mfma_f32_16x16x32_bf16 v[28:31], v[92:95], v[68:71], v[28:31]
s_waitcnt lgkmcnt(4)
v_mfma_f32_16x16x32_bf16 v[32:35], v[96:99], v[64:67], v[32:35]
ds_read_b128 v[88:91], v5 offset:24576
v_mfma_f32_16x16x32_bf16 v[36:39], v[96:99], v[68:71], v[36:39]
s_waitcnt lgkmcnt(3)
v_mfma_f32_16x16x32_bf16 v[40:43], v[100:103], v[64:67], v[40:43]
ds_read_b128 v[92:95], v5 offset:25600
v_mfma_f32_16x16x32_bf16 v[44:47], v[100:103], v[68:71], v[44:47]
s_waitcnt lgkmcnt(3)
v_mfma_f32_16x16x32_bf16 v[48:51], v[104:107], v[64:67], v[48:51]
ds_read_b128 v[80:83], v4 offset:4096
ds_read_b128 v[96:99], v5 offset:26624
v_mfma_f32_16x16x32_bf16 v[52:55], v[104:107], v[68:71], v[52:55]
ds_read_b128 v[84:87], v4 offset:14336
s_waitcnt lgkmcnt(5)
v_mfma_f32_16x16x32_bf16 v[56:59], v[108:111], v[64:67], v[56:59]
ds_read_b128 v[100:103], v5 offset:27648
v_mfma_f32_16x16x32_bf16 v[60:63], v[108:111], v[68:71], v[60:63]
s_waitcnt vmcnt(0)
s_barrier
s_waitcnt lgkmcnt(5)
v_mfma_f32_16x16x32_bf16 v[16:19], v[88:91], v[72:75], v[16:19]
ds_read_b128 v[104:107], v5 offset:28672
s_add_u32 s44, s44, 20480
v_mfma_f32_16x16x32_bf16 v[20:23], v[88:91], v[76:79], v[20:23]
s_cmp_eq_u32 s44, 159744
s_cselect_b32 s44, 98304, s44
s_waitcnt lgkmcnt(5)
v_mfma_f32_16x16x32_bf16 v[24:27], v[92:95], v[72:75], v[24:27]
ds_read_b128 v[108:111], v5 offset:29696
v_add_u32 v9, s44, v10
v_mfma_f32_16x16x32_bf16 v[28:31], v[92:95], v[76:79], v[28:31]
v_add_u32 v13, s44, v11
s_min_u32 s41, s36, 63
s_waitcnt lgkmcnt(4)
v_mfma_f32_16x16x32_bf16 v[32:35], v[96:99], v[72:75], v[32:35]
ds_read_b128 v[88:91], v6 offset:0
s_lshr_b32 s41, s41, 1
v_mfma_f32_16x16x32_bf16 v[36:39], v[96:99], v[76:79], v[36:39]
s_mul_i32 s41, s41, s33
s_add_u32 s41, s41, s32
s_waitcnt lgkmcnt(3)
v_mfma_f32_16x16x32_bf16 v[40:43], v[100:103], v[72:75], v[40:43]
ds_read_b128 v[92:95], v6 offset:1024
s_mul_i32 s41, s41, 40960
v_mfma_f32_16x16x32_bf16 v[44:47], v[100:103], v[76:79], v[44:47]
s_and_b32 s42, s36, 1
s_mul_i32 s42, s42, 640
s_waitcnt lgkmcnt(3)
v_mfma_f32_16x16x32_bf16 v[48:51], v[104:107], v[72:75], v[48:51]
ds_read_b128 v[112:115], v12 offset:4096
ds_read_b128 v[96:99], v6 offset:2048
v_mfma_f32_16x16x32_bf16 v[52:55], v[104:107], v[76:79], v[52:55]
ds_read_b128 v[116:119], v12 offset:14336
s_add_u32 s41, s41, s42
s_waitcnt lgkmcnt(5)
v_mfma_f32_16x16x32_bf16 v[56:59], v[108:111], v[72:75], v[56:59]
ds_read_b128 v[100:103], v6 offset:3072
s_mul_i32 s42, s37, 20480
v_mfma_f32_16x16x32_bf16 v[60:63], v[108:111], v[76:79], v[60:63]
s_mul_i32 s43, s24, 5120
s_add_u32 s42, s42, s43
s_waitcnt lgkmcnt(5)
v_mfma_f32_16x16x32_bf16 v[16:19], v[88:91], v[80:83], v[16:19]
ds_read_b128 v[104:107], v6 offset:4096
s_add_u32 s42, s42, 98304
v_mfma_f32_16x16x32_bf16 v[20:23], v[88:91], v[84:87], v[20:23]
s_add_u32 s36, s36, 1
s_add_u32 s37, s37, 1
s_waitcnt lgkmcnt(5)
v_mfma_f32_16x16x32_bf16 v[24:27], v[92:95], v[80:83], v[24:27]
ds_read_b128 v[108:111], v6 offset:5120
s_cmp_eq_u32 s37, 3
v_mfma_f32_16x16x32_bf16 v[28:31], v[92:95], v[84:87], v[28:31]
s_cselect_b32 s37, 0, s37
s_add_u32 s61, s57, s40
s_waitcnt lgkmcnt(4)
v_mfma_f32_16x16x32_bf16 v[32:35], v[96:99], v[80:83], v[32:35]
ds_read_b128 v[88:91], v6 offset:24576
v_mov_b32 v14, s61
v_mfma_f32_16x16x32_bf16 v[36:39], v[96:99], v[84:87], v[36:39]
v_mov_b32 v15, 0
s_mov_b64 exec, 1
buffer_store_dword v14, v15, s[4:7], s34 offen sc1
s_mov_b64 exec, -1
s_waitcnt lgkmcnt(3)
v_mfma_f32_16x16x32_bf16 v[40:43], v[100:103], v[80:83], v[40:43]
ds_read_b128 v[92:95], v6 offset:25600
s_mov_b32 m0, s42
v_mfma_f32_16x16x32_bf16 v[44:47], v[100:103], v[84:87], v[44:47]
s_add_u32 s42, s42, 1024
buffer_load_dwordx4 v7, s[8:11], s41 offen lds
s_waitcnt lgkmcnt(3)
v_mfma_f32_16x16x32_bf16 v[48:51], v[104:107], v[80:83], v[48:51]
ds_read_b128 v[64:67], v9 offset:0
ds_read_b128 v[96:99], v6 offset:26624
v_mfma_f32_16x16x32_bf16 v[52:55], v[104:107], v[84:87], v[52:55]
ds_read_b128 v[68:71], v9 offset:10240
s_add_u32 s41, s41, 128
s_waitcnt lgkmcnt(5)
v_mfma_f32_16x16x32_bf16 v[56:59], v[108:111], v[80:83], v[56:59]
ds_read_b128 v[100:103], v6 offset:27648
s_mov_b32 m0, s42
v_mfma_f32_16x16x32_bf16 v[60:63], v[108:111], v[84:87], v[60:63]
s_add_u32 s42, s42, 1024
buffer_load_dwordx4 v7, s[8:11], s41 offen lds
s_waitcnt lgkmcnt(5)
v_mfma_f32_16x16x32_bf16 v[16:19], v[88:91], v[112:115], v[16:19]
ds_read_b128 v[104:107], v6 offset:28672
s_add_u32 s41, s41, 128
v_mfma_f32_16x16x32_bf16 v[20:23], v[88:91], v[116:119], v[20:23]
s_mov_b32 m0, s42
s_add_u32 s42, s42, 1024
s_waitcnt lgkmcnt(5)
v_mfma_f32_16x16x32_bf16 v[24:27], v[92:95], v[112:115], v[24:27]
ds_read_b128 v[108:111], v6 offset:29696
buffer_load_dwordx4 v7, s[8:11], s41 offen lds
v_mfma_f32_16x16x32_bf16 v[28:31], v[92:95], v[116:119], v[28:31]
s_add_u32 s41, s41, 128
s_mov_b32 m0, s42
s_waitcnt lgkmcnt(4)
v_mfma_f32_16x16x32_bf16 v[32:35], v[96:99], v[112:115], v[32:35]
s_add_u32 s42, s42, 1024
buffer_load_dwordx4 v7, s[8:11], s41 offen lds
v_mfma_f32_16x16x32_bf16 v[36:39], v[96:99], v[116:119], v[36:39]
s_add_u32 s41, s41, 128
v_cvt_pk_bf16_f32 v88, v16, v17
v_cvt_pk_bf16_f32 v89, v18, v19
v_cvt_pk_bf16_f32 v92, v20, v21
v_cvt_pk_bf16_f32 v93, v22, v23
s_waitcnt lgkmcnt(2)
v_mfma_f32_16x16x32_bf16 v[40:43], v[100:103], v[112:115], v[40:43]
v_mfma_f32_16x16x32_bf16 v[44:47], v[100:103], v[116:119], v[44:47]
v_cvt_pk_bf16_f32 v90, v24, v25
v_cvt_pk_bf16_f32 v91, v26, v27
v_cvt_pk_bf16_f32 v94, v28, v29
v_cvt_pk_bf16_f32 v95, v30, v31
s_waitcnt lgkmcnt(1)
v_mfma_f32_16x16x32_bf16 v[48:51], v[104:107], v[112:115], v[48:51]
ds_read_b128 v[72:75], v13 offset:0
v_mfma_f32_16x16x32_bf16 v[52:55], v[104:107], v[116:119], v[52:55]
ds_read_b128 v[76:79], v13 offset:10240
v_cvt_pk_bf16_f32 v96, v32, v33
v_cvt_pk_bf16_f32 v97, v34, v35
v_cvt_pk_bf16_f32 v100, v36, v37
v_cvt_pk_bf16_f32 v101, v38, v39
s_waitcnt lgkmcnt(2)
v_mfma_f32_16x16x32_bf16 v[56:59], v[108:111], v[112:115], v[56:59]
v_mfma_f32_16x16x32_bf16 v[60:63], v[108:111], v[116:119], v[60:63]
v_cvt_pk_bf16_f32 v98, v40, v41
v_cvt_pk_bf16_f32 v99, v42, v43
v_cvt_pk_bf16_f32 v102, v44, v45
v_cvt_pk_bf16_f32 v103, v46, v47
v_mov_b32 v4, v9
v_mov_b32 v12, v13
XQtail:
v_cvt_pk_bf16_f32 v104, v48, v49
v_cvt_pk_bf16_f32 v105, v50, v51
v_cvt_pk_bf16_f32 v108, v52, v53
v_cvt_pk_bf16_f32 v109, v54, v55
v_cvt_pk_bf16_f32 v106, v56, v57
v_cvt_pk_bf16_f32 v107, v58, v59
v_cvt_pk_bf16_f32 v110, v60, v61
v_cvt_pk_bf16_f32 v111, v62, v63
s_add_u32 s52, s52, 0x400000
s_add_u32 s53, s53, 0x400000
s_add_u32 s40, s40, 1
s_mov_b32 s47, s39
s_add_u32 s39, s39, s33
s_mov_b32 s50, 0x10000000
s_cmp_le_u32 s40, 1
s_cselect_b32 s43, 1, 0
s_cmp_eq_u32 s40, 32
s_cselect_b32 s43, 1, s43
s_cmp_eq_u32 s43, 0
s_cbranch_scc1 xe_3
buffer_store_dwordx4 v[88:91], v1, s[4:7], s52 offen offset:0 sc1
buffer_store_dwordx4 v[92:95], v1, s[4:7], s53 offen offset:0 sc1
buffer_store_dwordx4 v[96:99], v1, s[4:7], s52 offen offset:1024 sc1
buffer_store_dwordx4 v[100:103], v1, s[4:7], s53 offen offset:1024 sc1
buffer_store_dwordx4 v[104:107], v1, s[4:7], s52 offen offset:2048 sc1
buffer_store_dwordx4 v[108:111], v1, s[4:7], s53 offen offset:2048 sc1
s_mov_b32 s50, 0
s_waitcnt vmcnt(0)
s_barrier
s_add_u32 s61, s57, s40
v_mov_b32 v14, s61
v_mov_b32 v15, 0
s_mov_b64 exec, 1
buffer_store_dword v14, v15, s[4:7], s34 offen sc1
s_mov_b64 exec, -1
xe_3:
s_cmp_lt_u32 s40, 32
s_cbranch_scc1 XQloop
s_waitcnt lgkmcnt(0)
s_waitcnt vmcnt(0)
s_branch L_T
L_XVO:
s_mov_b32 s39, s26
s_mov_b32 s40, 0
v_lshrrev_b32 v8, 3, v0
s_lshl_b32 s35, s24, 3
v_add_u32 v7, s35, v8
v_mul_u32_u24 v7, 1280, v7
v_and_b32 v9, 7, v0
v_xor_b32 v9, v9, v8
v_lshl_add_u32 v7, v9, 4, v7
v_and_b32 v8, 7, v2
v_xor_b32 v9, v3, v8
v_lshlrev_b32 v9, 4, v9
v_lshl_add_u32 v9, v8, 7, v9
v_lshrrev_b32 v8, 3, v2
v_mul_u32_u24 v8, 10240, v8
v_add_u32 v10, v8, v9
v_xor_b32 v11, 64, v10
s_mul_i32 s41, s39, 40960
s_sub_u32 s41, s41, 128
s_mul_i32 s42, s24, 10240
s_add_u32 m0, s42, 80896
s_add_u32 m0, m0, 1024
s_add_u32 s41, s41, 128
buffer_load_dwordx4 v7, s[8:11], s41 offen lds
s_add_u32 m0, m0, 1024
s_add_u32 s41, s41, 128
buffer_load_dwordx4 v7, s[8:11], s41 offen lds
s_add_u32 m0, m0, 1024
s_add_u32 s41, s41, 128
buffer_load_dwordx4 v7, s[8:11], s41 offen lds
s_add_u32 m0, m0, 1024
s_add_u32 s41, s41, 128
buffer_load_dwordx4 v7, s[8:11], s41 offen lds
s_add_u32 m0, m0, 1024
s_add_u32 s41, s41, 128
buffer_load_dwordx4 v7, s[8:11], s41 offen lds
s_add_u32 m0, m0, 1024
s_add_u32 s41, s41, 128
buffer_load_dwordx4 v7, s[8:11], s41 offen lds
s_add_u32 m0, m0, 1024
s_add_u32 s41, s41, 128
buffer_load_dwordx4 v7, s[8:11], s41 offen lds
s_add_u32 m0, m0, 1024
s_add_u32 s41, s41, 128
buffer_load_dwordx4 v7, s[8:11], s41 offen lds
s_add_u32 m0, m0, 1024
s_add_u32 s41, s41, 128
buffer_load_dwordx4 v7, s[8:11], s41 offen lds
s_add_u32 m0, m0, 1024
s_add_u32 s41, s41, 128
buffer_load_dwordx4 v7, s[8:11], s41 offen lds
v_add_u32 v96, 81920, v10
v_add_u32 v97, 81920, v11
s_mov_b32 s12, s72
s_and_b32 s13, s73, 0xffff
s_mov_b32 s14, 0x780000
s_mov_b32 s15, 0x20000
s_mov_b32 s16, s74
s_and_b32 s17, s75, 0xffff
s_mov_b32 s18, 0x780000
s_mov_b32 s19, 0x20000
s_mul_i32 s29, s25, 384
s_mov_b32 s30, 0
s_mul_i32 s31, s25, 245760
s_mul_i32 s61, s24, 192
v_add_u32 v15, s61, v0
v_add_u32 v10, 0, v15
v_mul_u32_u24 v11, 43691, v10
v_lshrrev_b32 v11, 20, v11
v_mul_u32_u24 v13, 24, v11
v_sub_u32 v12, v10, v13
v_mul_u32_u24 v11, 12288, v11
v_lshlrev_b32 v12, 4, v12
v_add3_u32 v100, v11, v12, s29
v_add_u32 v10, 64, v15
v_mul_u32_u24 v11, 43691, v10
v_lshrrev_b32 v11, 20, v11
v_mul_u32_u24 v13, 24, v11
v_sub_u32 v12, v10, v13
v_mul_u32_u24 v11, 12288, v11
v_lshlrev_b32 v12, 4, v12
v_add3_u32 v101, v11, v12, s29
v_add_u32 v10, 128, v15
v_mul_u32_u24 v11, 43691, v10
v_lshrrev_b32 v11, 20, v11
v_mul_u32_u24 v13, 24, v11
v_sub_u32 v12, v10, v13
v_mul_u32_u24 v11, 12288, v11
v_lshlrev_b32 v12, 4, v12
v_add3_u32 v102, v11, v12, s29
s_mul_i32 s61, s24, 320
v_add_u32 v15, s61, v0
v_add_u32 v10, 0, v15
v_mul_u32_u24 v11, 13108, v10
v_lshrrev_b32 v11, 20, v11
v_mul_u32_u24 v13, 80, v11
v_sub_u32 v12, v10, v13
v_mul_u32_u24 v11, 1280, v11
v_lshlrev_b32 v12, 4, v12
v_add3_u32 v104, v11, v12, s30
v_add_u32 v10, 64, v15
v_mul_u32_u24 v11, 13108, v10
v_lshrrev_b32 v11, 20, v11
v_mul_u32_u24 v13, 80, v11
v_sub_u32 v12, v10, v13
v_mul_u32_u24 v11, 1280, v11
v_lshlrev_b32 v12, 4, v12
v_add3_u32 v105, v11, v12, s30
v_add_u32 v10, 128, v15
v_mul_u32_u24 v11, 13108, v10
v_lshrrev_b32 v11, 20, v11
v_mul_u32_u24 v13, 80, v11
v_sub_u32 v12, v10, v13
v_mul_u32_u24 v11, 1280, v11
v_lshlrev_b32 v12, 4, v12
v_add3_u32 v106, v11, v12, s30
v_add_u32 v10, 192, v15
v_mul_u32_u24 v11, 13108, v10
v_lshrrev_b32 v11, 20, v11
v_mul_u32_u24 v13, 80, v11
v_sub_u32 v12, v10, v13
v_mul_u32_u24 v11, 1280, v11
v_lshlrev_b32 v12, 4, v12
v_add3_u32 v107, v11, v12, s30
v_add_u32 v10, 256, v15
v_mul_u32_u24 v11, 13108, v10
v_lshrrev_b32 v11, 20, v11
v_mul_u32_u24 v13, 80, v11
v_sub_u32 v12, v10, v13
v_mul_u32_u24 v11, 1280, v11
v_lshlrev_b32 v12, 4, v12
v_add3_u32 v108, v11, v12, s30
s_mul_i32 s29, s24, 96
v_bfe_u32 v10, v0, 2, 2
v_lshl_add_u32 v10, v3, 3, v10
v_mov_b32 v11, 0
v_mul_u32_u24 v10, 384, v10
v_and_b32 v12, 3, v0
v_lshl_add_u32 v11, v12, 3, v11
v_add3_u32 v6, v10, v11, s29
v_add_u32 v7, 49152, v6
s_mul_i32 s29, s24, 320
v_bfe_u32 v10, v0, 2, 2
v_lshl_add_u32 v10, v3, 2, v10
v_mov_b32 v11, 0
v_mul_u32_u24 v10, 1280, v10
v_and_b32 v12, 3, v0
v_lshl_add_u32 v11, v12, 3, v11
v_add3_u32 v8, v10, v11, s29
v_add_u32 v9, 49152, v8
s_add_u32 s60, s30, 0
s_mul_i32 s61, s24, 3072
s_add_u32 s61, s61, 0
s_add_u32 m0, s61, 0
s_nop 0
buffer_load_dwordx4 v100, s[12:15], s60 offen lds
s_add_u32 m0, s61, 1024
s_nop 0
buffer_load_dwordx4 v101, s[12:15], s60 offen lds
s_add_u32 m0, s61, 2048
s_nop 0
buffer_load_dwordx4 v102, s[12:15], s60 offen lds
s_add_u32 s60, s30, 393216
s_mul_i32 s61, s24, 3072
s_add_u32 s61, s61, 12288
s_add_u32 m0, s61, 0
s_nop 0
buffer_load_dwordx4 v100, s[12:15], s60 offen lds
s_add_u32 m0, s61, 1024
s_nop 0
buffer_load_dwordx4 v101, s[12:15], s60 offen lds
s_add_u32 m0, s61, 2048
s_nop 0
buffer_load_dwordx4 v102, s[12:15], s60 offen lds
s_add_u32 s60, s30, 786432
s_mul_i32 s61, s24, 3072
s_add_u32 s61, s61, 24576
s_add_u32 m0, s61, 0
s_nop 0
buffer_load_dwordx4 v100, s[12:15], s60 offen lds
s_add_u32 m0, s61, 1024
s_nop 0
buffer_load_dwordx4 v101, s[12:15], s60 offen lds
s_add_u32 m0, s61, 2048
s_nop 0
buffer_load_dwordx4 v102, s[12:15], s60 offen lds
s_add_u32 s60, s30, 1179648
s_mul_i32 s61, s24, 3072
s_add_u32 s61, s61, 36864
s_add_u32 m0, s61, 0
s_nop 0
buffer_load_dwordx4 v100, s[12:15], s60 offen lds
s_add_u32 m0, s61, 1024
s_nop 0
buffer_load_dwordx4 v101, s[12:15], s60 offen lds
s_add_u32 m0, s61, 2048
s_nop 0
buffer_load_dwordx4 v102, s[12:15], s60 offen lds
s_add_u32 s60, s30, 1572864
s_mul_i32 s61, s24, 3072
s_add_u32 s61, s61, 49152
s_add_u32 m0, s61, 0
s_nop 0
buffer_load_dwordx4 v100, s[12:15], s60 offen lds
s_add_u32 m0, s61, 1024
s_nop 0
buffer_load_dwordx4 v101, s[12:15], s60 offen lds
s_add_u32 m0, s61, 2048
s_nop 0
buffer_load_dwordx4 v102, s[12:15], s60 offen lds
s_add_u32 s60, s30, 1966080
s_mul_i32 s61, s24, 3072
s_add_u32 s61, s61, 61440
s_add_u32 m0, s61, 0
s_nop 0
buffer_load_dwordx4 v100, s[12:15], s60 offen lds
s_add_u32 m0, s61, 1024
s_nop 0
buffer_load_dwordx4 v101, s[12:15], s60 offen lds
s_add_u32 m0, s61, 2048
s_nop 0
buffer_load_dwordx4 v102, s[12:15], s60 offen lds
s_waitcnt vmcnt(15)
s_barrier
ds_read_b128 v[40:43], v96 offset:0
ds_read_b128 v[44:47], v96 offset:20480
ds_read_b64_tr_b16 a[0:1], v6 offset:0
ds_read_b64_tr_b16 a[2:3], v6 offset:1536
ds_read_b64_tr_b16 a[8:9], v6 offset:32
ds_read_b64_tr_b16 a[10:11], v6 offset:1568
ds_read_b64_tr_b16 a[16:17], v6 offset:64
ds_read_b64_tr_b16 a[18:19], v6 offset:1600
s_waitcnt lgkmcnt(0)
v_mfma_f32_16x16x32_bf16 v[16:19], a[0:3], v[40:43], 0
v_mfma_f32_16x16x32_bf16 v[20:23], a[0:3], v[44:47], 0
v_mfma_f32_16x16x32_bf16 v[24:27], a[8:11], v[40:43], 0
v_mfma_f32_16x16x32_bf16 v[28:31], a[8:11], v[44:47], 0
v_mfma_f32_16x16x32_bf16 v[32:35], a[16:19], v[40:43], 0
v_mfma_f32_16x16x32_bf16 v[36:39], a[16:19], v[44:47], 0
s_waitcnt vmcnt(12)
s_barrier
s_add_u32 s60, s30, 2359296
s_mul_i32 s61, s24, 3072
s_add_u32 s61, s61, 0
s_add_u32 m0, s61, 0
s_nop 0
buffer_load_dwordx4 v100, s[12:15], s60 offen lds
s_add_u32 m0, s61, 1024
s_nop 0
buffer_load_dwordx4 v101, s[12:15], s60 offen lds
s_add_u32 m0, s61, 2048
s_nop 0
buffer_load_dwordx4 v102, s[12:15], s60 offen lds
ds_read_b128 v[40:43], v97 offset:0
ds_read_b128 v[44:47], v97 offset:20480
ds_read_b64_tr_b16 a[4:5], v6 offset:12288
ds_read_b64_tr_b16 a[6:7], v6 offset:13824
ds_read_b64_tr_b16 a[12:13], v6 offset:12320
ds_read_b64_tr_b16 a[14:15], v6 offset:13856
ds_read_b64_tr_b16 a[20:21], v6 offset:12352
ds_read_b64_tr_b16 a[22:23], v6 offset:13888
s_waitcnt lgkmcnt(0)
v_mfma_f32_16x16x32_bf16 v[16:19], a[4:7], v[40:43], v[16:19]
v_mfma_f32_16x16x32_bf16 v[20:23], a[4:7], v[44:47], v[20:23]
v_mfma_f32_16x16x32_bf16 v[24:27], a[12:15], v[40:43], v[24:27]
v_mfma_f32_16x16x32_bf16 v[28:31], a[12:15], v[44:47], v[28:31]
v_mfma_f32_16x16x32_bf16 v[32:35], a[20:23], v[40:43], v[32:35]
v_mfma_f32_16x16x32_bf16 v[36:39], a[20:23], v[44:47], v[36:39]
s_waitcnt vmcnt(12)
s_barrier
s_add_u32 s60, s30, 2752512
s_mul_i32 s61, s24, 3072
s_add_u32 s61, s61, 12288
s_add_u32 m0, s61, 0
s_nop 0
buffer_load_dwordx4 v100, s[12:15], s60 offen lds
s_add_u32 m0, s61, 1024
s_nop 0
buffer_load_dwordx4 v101, s[12:15], s60 offen lds
s_add_u32 m0, s61, 2048
s_nop 0
buffer_load_dwordx4 v102, s[12:15], s60 offen lds
ds_read_b128 v[40:43], v96 offset:1024
ds_read_b128 v[44:47], v96 offset:21504
ds_read_b64_tr_b16 a[24:25], v6 offset:24576
ds_read_b64_tr_b16 a[26:27], v6 offset:26112
ds_read_b64_tr_b16 a[32:33], v6 offset:24608
ds_read_b64_tr_b16 a[34:35], v6 offset:26144
ds_read_b64_tr_b16 a[40:41], v6 offset:24640
ds_read_b64_tr_b16 a[42:43], v6 offset:26176
s_waitcnt lgkmcnt(0)
v_mfma_f32_16x16x32_bf16 v[16:19], a[24:27], v[40:43], v[16:19]
v_mfma_f32_16x16x32_bf16 v[20:23], a[24:27], v[44:47], v[20:23]
v_mfma_f32_16x16x32_bf16 v[24:27], a[32:35], v[40:43], v[24:27]
v_mfma_f32_16x16x32_bf16 v[28:31], a[32:35], v[44:47], v[28:31]
v_mfma_f32_16x16x32_bf16 v[32:35], a[40:43], v[40:43], v[32:35]
v_mfma_f32_16x16x32_bf16 v[36:39], a[40:43], v[44:47], v[36:39]
s_waitcnt vmcnt(12)
s_barrier
s_add_u32 s60, s30, 3145728
s_mul_i32 s61, s24, 3072
s_add_u32 s61, s61, 24576
s_add_u32 m0, s61, 0
s_nop 0
buffer_load_dwordx4 v100, s[12:15], s60 offen lds
s_add_u32 m0, s61, 1024
s_nop 0
buffer_load_dwordx4 v101, s[12:15], s60 offen lds
s_add_u32 m0, s61, 2048
s_nop 0
buffer_load_dwordx4 v102, s[12:15], s60 offen lds
ds_read_b128 v[40:43], v97 offset:1024
ds_read_b128 v[44:47], v97 offset:21504
ds_read_b64_tr_b16 a[28:29], v6 offset:36864
ds_read_b64_tr_b16 a[30:31], v6 offset:38400
ds_read_b64_tr_b16 a[36:37], v6 offset:36896
ds_read_b64_tr_b16 a[38:39], v6 offset:38432
ds_read_b64_tr_b16 a[44:45], v6 offset:36928
ds_read_b64_tr_b16 a[46:47], v6 offset:38464
s_waitcnt lgkmcnt(0)
v_mfma_f32_16x16x32_bf16 v[16:19], a[28:31], v[40:43], v[16:19]
v_mfma_f32_16x16x32_bf16 v[20:23], a[28:31], v[44:47], v[20:23]
v_mfma_f32_16x16x32_bf16 v[24:27], a[36:39], v[40:43], v[24:27]
v_mfma_f32_16x16x32_bf16 v[28:31], a[36:39], v[44:47], v[28:31]
v_mfma_f32_16x16x32_bf16 v[32:35], a[44:47], v[40:43], v[32:35]
v_mfma_f32_16x16x32_bf16 v[36:39], a[44:47], v[44:47], v[36:39]
s_waitcnt vmcnt(12)
s_barrier
s_add_u32 s60, s30, 3538944
s_mul_i32 s61, s24, 3072
s_add_u32 s61, s61, 36864
s_add_u32 m0, s61, 0
s_nop 0
buffer_load_dwordx4 v100, s[12:15], s60 offen lds
s_add_u32 m0, s61, 1024
s_nop 0
buffer_load_dwordx4 v101, s[12:15], s60 offen lds
s_add_u32 m0, s61, 2048
s_nop 0
buffer_load_dwordx4 v102, s[12:15], s60 offen lds
ds_read_b128 v[40:43], v96 offset:2048
ds_read_b128 v[44:47], v96 offset:22528
ds_read_b64_tr_b16 a[48:49], v7 offset:0
ds_read_b64_tr_b16 a[50:51], v7 offset:1536
ds_read_b64_tr_b16 a[56:57], v7 offset:32
ds_read_b64_tr_b16 a[58:59], v7 offset:1568
ds_read_b64_tr_b16 a[64:65], v7 offset:64
ds_read_b64_tr_b16 a[66:67], v7 offset:1600
s_waitcnt lgkmcnt(0)
v_mfma_f32_16x16x32_bf16 v[16:19], a[48:51], v[40:43], v[16:19]
v_mfma_f32_16x16x32_bf16 v[20:23], a[48:51], v[44:47], v[20:23]
v_mfma_f32_16x16x32_bf16 v[24:27], a[56:59], v[40:43], v[24:27]
v_mfma_f32_16x16x32_bf16 v[28:31], a[56:59], v[44:47], v[28:31]
v_mfma_f32_16x16x32_bf16 v[32:35], a[64:67], v[40:43], v[32:35]
v_mfma_f32_16x16x32_bf16 v[36:39], a[64:67], v[44:47], v[36:39]
s_waitcnt vmcnt(12)
s_barrier
s_add_u32 s60, s30, 3932160
s_mul_i32 s61, s24, 3072
s_add_u32 s61, s61, 49152
s_add_u32 m0, s61, 0
s_nop 0
buffer_load_dwordx4 v100, s[12:15], s60 offen lds
s_add_u32 m0, s61, 1024
s_nop 0
buffer_load_dwordx4 v101, s[12:15], s60 offen lds
s_add_u32 m0, s61, 2048
s_nop 0
buffer_load_dwordx4 v102, s[12:15], s60 offen lds
ds_read_b128 v[40:43], v97 offset:2048
ds_read_b128 v[44:47], v97 offset:22528
ds_read_b64_tr_b16 a[52:53], v7 offset:12288
ds_read_b64_tr_b16 a[54:55], v7 offset:13824
ds_read_b64_tr_b16 a[60:61], v7 offset:12320
ds_read_b64_tr_b16 a[62:63], v7 offset:13856
ds_read_b64_tr_b16 a[68:69], v7 offset:12352
ds_read_b64_tr_b16 a[70:71], v7 offset:13888
s_waitcnt lgkmcnt(0)
v_mfma_f32_16x16x32_bf16 v[16:19], a[52:55], v[40:43], v[16:19]
v_mfma_f32_16x16x32_bf16 v[20:23], a[52:55], v[44:47], v[20:23]
v_mfma_f32_16x16x32_bf16 v[24:27], a[60:63], v[40:43], v[24:27]
v_mfma_f32_16x16x32_bf16 v[28:31], a[60:63], v[44:47], v[28:31]
v_mfma_f32_16x16x32_bf16 v[32:35], a[68:71], v[40:43], v[32:35]
v_mfma_f32_16x16x32_bf16 v[36:39], a[68:71], v[44:47], v[36:39]
s_waitcnt vmcnt(12)
s_barrier
s_add_u32 s60, s30, 4325376
s_mul_i32 s61, s24, 3072
s_add_u32 s61, s61, 61440
s_add_u32 m0, s61, 0
s_nop 0
buffer_load_dwordx4 v100, s[12:15], s60 offen lds
s_add_u32 m0, s61, 1024
s_nop 0
buffer_load_dwordx4 v101, s[12:15], s60 offen lds
s_add_u32 m0, s61, 2048
s_nop 0
buffer_load_dwordx4 v102, s[12:15], s60 offen lds
ds_read_b128 v[40:43], v96 offset:3072
ds_read_b128 v[44:47], v96 offset:23552
ds_read_b64_tr_b16 a[72:73], v6 offset:0
ds_read_b64_tr_b16 a[74:75], v6 offset:1536
ds_read_b64_tr_b16 a[80:81], v6 offset:32
ds_read_b64_tr_b16 a[82:83], v6 offset:1568
ds_read_b64_tr_b16 a[88:89], v6 offset:64
ds_read_b64_tr_b16 a[90:91], v6 offset:1600
s_waitcnt lgkmcnt(0)
v_mfma_f32_16x16x32_bf16 v[16:19], a[72:75], v[40:43], v[16:19]
v_mfma_f32_16x16x32_bf16 v[20:23], a[72:75], v[44:47], v[20:23]
v_mfma_f32_16x16x32_bf16 v[24:27], a[80:83], v[40:43], v[24:27]
v_mfma_f32_16x16x32_bf16 v[28:31], a[80:83], v[44:47], v[28:31]
v_mfma_f32_16x16x32_bf16 v[32:35], a[88:91], v[40:43], v[32:35]
v_mfma_f32_16x16x32_bf16 v[36:39], a[88:91], v[44:47], v[36:39]
s_waitcnt vmcnt(12)
s_barrier
s_add_u32 s60, s30, 4718592
s_mul_i32 s61, s24, 3072
s_add_u32 s61, s61, 0
s_add_u32 m0, s61, 0
s_nop 0
buffer_load_dwordx4 v100, s[12:15], s60 offen lds
s_add_u32 m0, s61, 1024
s_nop 0
buffer_load_dwordx4 v101, s[12:15], s60 offen lds
s_add_u32 m0, s61, 2048
s_nop 0
buffer_load_dwordx4 v102, s[12:15], s60 offen lds
ds_read_b128 v[40:43], v97 offset:3072
ds_read_b128 v[44:47], v97 offset:23552
ds_read_b64_tr_b16 a[76:77], v6 offset:12288
ds_read_b64_tr_b16 a[78:79], v6 offset:13824
ds_read_b64_tr_b16 a[84:85], v6 offset:12320
ds_read_b64_tr_b16 a[86:87], v6 offset:13856
ds_read_b64_tr_b16 a[92:93], v6 offset:12352
ds_read_b64_tr_b16 a[94:95], v6 offset:13888
s_waitcnt lgkmcnt(0)
v_mfma_f32_16x16x32_bf16 v[16:19], a[76:79], v[40:43], v[16:19]
v_mfma_f32_16x16x32_bf16 v[20:23], a[76:79], v[44:47], v[20:23]
v_mfma_f32_16x16x32_bf16 v[24:27], a[84:87], v[40:43], v[24:27]
v_mfma_f32_16x16x32_bf16 v[28:31], a[84:87], v[44:47], v[28:31]
v_mfma_f32_16x16x32_bf16 v[32:35], a[92:95], v[40:43], v[32:35]
v_mfma_f32_16x16x32_bf16 v[36:39], a[92:95], v[44:47], v[36:39]
s_waitcnt vmcnt(12)
s_barrier
s_add_u32 s60, s30, 5111808
s_mul_i32 s61, s24, 3072
s_add_u32 s61, s61, 12288
s_add_u32 m0, s61, 0
s_nop 0
buffer_load_dwordx4 v100, s[12:15], s60 offen lds
s_add_u32 m0, s61, 1024
s_nop 0
buffer_load_dwordx4 v101, s[12:15], s60 offen lds
s_add_u32 m0, s61, 2048
s_nop 0
buffer_load_dwordx4 v102, s[12:15], s60 offen lds
ds_read_b128 v[40:43], v96 offset:4096
ds_read_b128 v[44:47], v96 offset:24576
ds_read_b64_tr_b16 a[96:97], v6 offset:24576
ds_read_b64_tr_b16 a[98:99], v6 offset:26112
ds_read_b64_tr_b16 a[104:105], v6 offset:24608
ds_read_b64_tr_b16 a[106:107], v6 offset:26144
ds_read_b64_tr_b16 a[112:113], v6 offset:24640
ds_read_b64_tr_b16 a[114:115], v6 offset:26176
s_waitcnt lgkmcnt(0)
v_mfma_f32_16x16x32_bf16 v[16:19], a[96:99], v[40:43], v[16:19]
v_mfma_f32_16x16x32_bf16 v[20:23], a[96:99], v[44:47], v[20:23]
v_mfma_f32_16x16x32_bf16 v[24:27], a[104:107], v[40:43], v[24:27]
v_mfma_f32_16x16x32_bf16 v[28:31], a[104:107], v[44:47], v[28:31]
v_mfma_f32_16x16x32_bf16 v[32:35], a[112:115], v[40:43], v[32:35]
v_mfma_f32_16x16x32_bf16 v[36:39], a[112:115], v[44:47], v[36:39]
s_waitcnt vmcnt(12)
s_barrier
s_add_u32 s60, s30, 5505024
s_mul_i32 s61, s24, 3072
s_add_u32 s61, s61, 24576
s_add_u32 m0, s61, 0
s_nop 0
buffer_load_dwordx4 v100, s[12:15], s60 offen lds
s_add_u32 m0, s61, 1024
s_nop 0
buffer_load_dwordx4 v101, s[12:15], s60 offen lds
s_add_u32 m0, s61, 2048
s_nop 0
buffer_load_dwordx4 v102, s[12:15], s60 offen lds
ds_read_b128 v[40:43], v97 offset:4096
ds_read_b128 v[44:47], v97 offset:24576
ds_read_b64_tr_b16 a[100:101], v6 offset:36864
ds_read_b64_tr_b16 a[102:103], v6 offset:38400
ds_read_b64_tr_b16 a[108:109], v6 offset:36896
ds_read_b64_tr_b16 a[110:111], v6 offset:38432
ds_read_b64_tr_b16 a[116:117], v6 offset:36928
ds_read_b64_tr_b16 a[118:119], v6 offset:38464
s_waitcnt lgkmcnt(0)
v_mfma_f32_16x16x32_bf16 v[16:19], a[100:103], v[40:43], v[16:19]
v_mfma_f32_16x16x32_bf16 v[20:23], a[100:103], v[44:47], v[20:23]
v_mfma_f32_16x16x32_bf16 v[24:27], a[108:111], v[40:43], v[24:27]
v_mfma_f32_16x16x32_bf16 v[28:31], a[108:111], v[44:47], v[28:31]
v_mfma_f32_16x16x32_bf16 v[32:35], a[116:119], v[40:43], v[32:35]
v_mfma_f32_16x16x32_bf16 v[36:39], a[116:119], v[44:47], v[36:39]
s_waitcnt vmcnt(12)
s_barrier
s_add_u32 s60, s30, 5898240
s_mul_i32 s61, s24, 3072
s_add_u32 s61, s61, 36864
s_add_u32 m0, s61, 0
s_nop 0
buffer_load_dwordx4 v100, s[12:15], s60 offen lds
s_add_u32 m0, s61, 1024
s_nop 0
buffer_load_dwordx4 v101, s[12:15], s60 offen lds
s_add_u32 m0, s61, 2048
s_nop 0
buffer_load_dwordx4 v102, s[12:15], s60 offen lds
ds_read_b128 v[40:43], v96 offset:5120
ds_read_b128 v[44:47], v96 offset:25600
ds_read_b64_tr_b16 a[120:121], v7 offset:0
ds_read_b64_tr_b16 a[122:123], v7 offset:1536
ds_read_b64_tr_b16 a[128:129], v7 offset:32
ds_read_b64_tr_b16 a[130:131], v7 offset:1568
ds_read_b64_tr_b16 a[136:137], v7 offset:64
ds_read_b64_tr_b16 a[138:139], v7 offset:1600
s_waitcnt lgkmcnt(0)
v_mfma_f32_16x16x32_bf16 v[16:19], a[120:123], v[40:43], v[16:19]
v_mfma_f32_16x16x32_bf16 v[20:23], a[120:123], v[44:47], v[20:23]
v_mfma_f32_16x16x32_bf16 v[24:27], a[128:131], v[40:43], v[24:27]
v_mfma_f32_16x16x32_bf16 v[28:31], a[128:131], v[44:47], v[28:31]
v_mfma_f32_16x16x32_bf16 v[32:35], a[136:139], v[40:43], v[32:35]
v_mfma_f32_16x16x32_bf16 v[36:39], a[136:139], v[44:47], v[36:39]
s_waitcnt vmcnt(12)
s_barrier
s_add_u32 s60, s30, 6291456
s_mul_i32 s61, s24, 3072
s_add_u32 s61, s61, 49152
s_add_u32 m0, s61, 0
s_nop 0
buffer_load_dwordx4 v100, s[12:15], s60 offen lds
s_add_u32 m0, s61, 1024
s_nop 0
buffer_load_dwordx4 v101, s[12:15], s60 offen lds
s_add_u32 m0, s61, 2048
s_nop 0
buffer_load_dwordx4 v102, s[12:15], s60 offen lds
ds_read_b128 v[40:43], v97 offset:5120
ds_read_b128 v[44:47], v97 offset:25600
ds_read_b64_tr_b16 a[124:125], v7 offset:12288
ds_read_b64_tr_b16 a[126:127], v7 offset:13824
ds_read_b64_tr_b16 a[132:133], v7 offset:12320
ds_read_b64_tr_b16 a[134:135], v7 offset:13856
ds_read_b64_tr_b16 a[140:141], v7 offset:12352
ds_read_b64_tr_b16 a[142:143], v7 offset:13888
s_waitcnt lgkmcnt(0)
v_mfma_f32_16x16x32_bf16 v[16:19], a[124:127], v[40:43], v[16:19]
v_mfma_f32_16x16x32_bf16 v[20:23], a[124:127], v[44:47], v[20:23]
v_mfma_f32_16x16x32_bf16 v[24:27], a[132:135], v[40:43], v[24:27]
v_mfma_f32_16x16x32_bf16 v[28:31], a[132:135], v[44:47], v[28:31]
v_mfma_f32_16x16x32_bf16 v[32:35], a[140:143], v[40:43], v[32:35]
v_mfma_f32_16x16x32_bf16 v[36:39], a[140:143], v[44:47], v[36:39]
s_waitcnt vmcnt(12)
s_barrier
s_add_u32 s60, s30, 6684672
s_mul_i32 s61, s24, 3072
s_add_u32 s61, s61, 61440
s_add_u32 m0, s61, 0
s_nop 0
buffer_load_dwordx4 v100, s[12:15], s60 offen lds
s_add_u32 m0, s61, 1024
s_nop 0
buffer_load_dwordx4 v101, s[12:15], s60 offen lds
s_add_u32 m0, s61, 2048
s_nop 0
buffer_load_dwordx4 v102, s[12:15], s60 offen lds
ds_read_b128 v[40:43], v96 offset:6144
ds_read_b128 v[44:47], v96 offset:26624
ds_read_b64_tr_b16 a[144:145], v6 offset:0
ds_read_b64_tr_b16 a[146:147], v6 offset:1536
ds_read_b64_tr_b16 a[152:153], v6 offset:32
ds_read_b64_tr_b16 a[154:155], v6 offset:1568
ds_read_b64_tr_b16 a[160:161], v6 offset:64
ds_read_b64_tr_b16 a[162:163], v6 offset:1600
s_waitcnt lgkmcnt(0)
v_mfma_f32_16x16x32_bf16 v[16:19], a[144:147], v[40:43], v[16:19]
v_mfma_f32_16x16x32_bf16 v[20:23], a[144:147], v[44:47], v[20:23]
v_mfma_f32_16x16x32_bf16 v[24:27], a[152:155], v[40:43], v[24:27]
v_mfma_f32_16x16x32_bf16 v[28:31], a[152:155], v[44:47], v[28:31]
v_mfma_f32_16x16x32_bf16 v[32:35], a[160:163], v[40:43], v[32:35]
v_mfma_f32_16x16x32_bf16 v[36:39], a[160:163], v[44:47], v[36:39]
s_waitcnt vmcnt(12)
s_barrier
s_add_u32 s60, s30, 7077888
s_mul_i32 s61, s24, 3072
s_add_u32 s61, s61, 0
s_add_u32 m0, s61, 0
s_nop 0
buffer_load_dwordx4 v100, s[12:15], s60 offen lds
s_add_u32 m0, s61, 1024
s_nop 0
buffer_load_dwordx4 v101, s[12:15], s60 offen lds
s_add_u32 m0, s61, 2048
s_nop 0
buffer_load_dwordx4 v102, s[12:15], s60 offen lds
ds_read_b128 v[40:43], v97 offset:6144
ds_read_b128 v[44:47], v97 offset:26624
ds_read_b64_tr_b16 a[148:149], v6 offset:12288
ds_read_b64_tr_b16 a[150:151], v6 offset:13824
ds_read_b64_tr_b16 a[156:157], v6 offset:12320
ds_read_b64_tr_b16 a[158:159], v6 offset:13856
ds_read_b64_tr_b16 a[164:165], v6 offset:12352
ds_read_b64_tr_b16 a[166:167], v6 offset:13888
s_waitcnt lgkmcnt(0)
v_mfma_f32_16x16x32_bf16 v[16:19], a[148:151], v[40:43], v[16:19]
v_mfma_f32_16x16x32_bf16 v[20:23], a[148:151], v[44:47], v[20:23]
v_mfma_f32_16x16x32_bf16 v[24:27], a[156:159], v[40:43], v[24:27]
v_mfma_f32_16x16x32_bf16 v[28:31], a[156:159], v[44:47], v[28:31]
v_mfma_f32_16x16x32_bf16 v[32:35], a[164:167], v[40:43], v[32:35]
v_mfma_f32_16x16x32_bf16 v[36:39], a[164:167], v[44:47], v[36:39]
s_waitcnt vmcnt(12)
s_barrier
s_add_u32 s60, s30, 7471104
s_mul_i32 s61, s24, 3072
s_add_u32 s61, s61, 12288
s_add_u32 m0, s61, 0
s_nop 0
buffer_load_dwordx4 v100, s[12:15], s60 offen lds
s_add_u32 m0, s61, 1024
s_nop 0
buffer_load_dwordx4 v101, s[12:15], s60 offen lds
s_add_u32 m0, s61, 2048
s_nop 0
buffer_load_dwordx4 v102, s[12:15], s60 offen lds
ds_read_b128 v[40:43], v96 offset:7168
ds_read_b128 v[44:47], v96 offset:27648
ds_read_b64_tr_b16 a[168:169], v6 offset:24576
ds_read_b64_tr_b16 a[170:171], v6 offset:26112
ds_read_b64_tr_b16 a[176:177], v6 offset:24608
ds_read_b64_tr_b16 a[178:179], v6 offset:26144
ds_read_b64_tr_b16 a[184:185], v6 offset:24640
ds_read_b64_tr_b16 a[186:187], v6 offset:26176
s_waitcnt lgkmcnt(0)
v_mfma_f32_16x16x32_bf16 v[16:19], a[168:171], v[40:43], v[16:19]
v_mfma_f32_16x16x32_bf16 v[20:23], a[168:171], v[44:47], v[20:23]
v_mfma_f32_16x16x32_bf16 v[24:27], a[176:179], v[40:43], v[24:27]
v_mfma_f32_16x16x32_bf16 v[28:31], a[176:179], v[44:47], v[28:31]
v_mfma_f32_16x16x32_bf16 v[32:35], a[184:187], v[40:43], v[32:35]
v_mfma_f32_16x16x32_bf16 v[36:39], a[184:187], v[44:47], v[36:39]
s_waitcnt vmcnt(12)
s_barrier
ds_read_b128 v[40:43], v97 offset:7168
ds_read_b128 v[44:47], v97 offset:27648
ds_read_b64_tr_b16 a[172:173], v6 offset:36864
ds_read_b64_tr_b16 a[174:175], v6 offset:38400
ds_read_b64_tr_b16 a[180:181], v6 offset:36896
ds_read_b64_tr_b16 a[182:183], v6 offset:38432
ds_read_b64_tr_b16 a[188:189], v6 offset:36928
ds_read_b64_tr_b16 a[190:191], v6 offset:38464
s_waitcnt lgkmcnt(0)
v_mfma_f32_16x16x32_bf16 v[16:19], a[172:175], v[40:43], v[16:19]
v_mfma_f32_16x16x32_bf16 v[20:23], a[172:175], v[44:47], v[20:23]
v_mfma_f32_16x16x32_bf16 v[24:27], a[180:183], v[40:43], v[24:27]
v_mfma_f32_16x16x32_bf16 v[28:31], a[180:183], v[44:47], v[28:31]
v_mfma_f32_16x16x32_bf16 v[32:35], a[188:191], v[40:43], v[32:35]
v_mfma_f32_16x16x32_bf16 v[36:39], a[188:191], v[44:47], v[36:39]
s_waitcnt vmcnt(9)
s_barrier
s_add_u32 s60, s31, 0
s_mul_i32 s61, s24, 5120
s_add_u32 s61, s61, 24576
s_add_u32 m0, s61, 0
s_nop 0
buffer_load_dwordx4 v104, s[16:19], s60 offen lds
s_add_u32 m0, s61, 1024
s_nop 0
buffer_load_dwordx4 v105, s[16:19], s60 offen lds
s_add_u32 m0, s61, 2048
s_nop 0
buffer_load_dwordx4 v106, s[16:19], s60 offen lds
s_add_u32 m0, s61, 3072
s_nop 0
buffer_load_dwordx4 v107, s[16:19], s60 offen lds
s_add_u32 m0, s61, 4096
s_nop 0
buffer_load_dwordx4 v108, s[16:19], s60 offen lds
ds_read_b128 v[40:43], v96 offset:8192
ds_read_b128 v[44:47], v96 offset:28672
ds_read_b64_tr_b16 a[192:193], v7 offset:0
ds_read_b64_tr_b16 a[194:195], v7 offset:1536
ds_read_b64_tr_b16 a[200:201], v7 offset:32
ds_read_b64_tr_b16 a[202:203], v7 offset:1568
ds_read_b64_tr_b16 a[208:209], v7 offset:64
ds_read_b64_tr_b16 a[210:211], v7 offset:1600
s_waitcnt lgkmcnt(0)
v_mfma_f32_16x16x32_bf16 v[16:19], a[192:195], v[40:43], v[16:19]
v_mfma_f32_16x16x32_bf16 v[20:23], a[192:195], v[44:47], v[20:23]
v_mfma_f32_16x16x32_bf16 v[24:27], a[200:203], v[40:43], v[24:27]
v_mfma_f32_16x16x32_bf16 v[28:31], a[200:203], v[44:47], v[28:31]
v_mfma_f32_16x16x32_bf16 v[32:35], a[208:211], v[40:43], v[32:35]
v_mfma_f32_16x16x32_bf16 v[36:39], a[208:211], v[44:47], v[36:39]
s_waitcnt vmcnt(11)
s_barrier
ds_read_b128 v[40:43], v97 offset:8192
ds_read_b128 v[44:47], v97 offset:28672
ds_read_b64_tr_b16 a[196:197], v7 offset:12288
ds_read_b64_tr_b16 a[198:199], v7 offset:13824
ds_read_b64_tr_b16 a[204:205], v7 offset:12320
ds_read_b64_tr_b16 a[206:207], v7 offset:13856
ds_read_b64_tr_b16 a[212:213], v7 offset:12352
ds_read_b64_tr_b16 a[214:215], v7 offset:13888
s_waitcnt lgkmcnt(0)
v_mfma_f32_16x16x32_bf16 v[16:19], a[196:199], v[40:43], v[16:19]
v_mfma_f32_16x16x32_bf16 v[20:23], a[196:199], v[44:47], v[20:23]
v_mfma_f32_16x16x32_bf16 v[24:27], a[204:207], v[40:43], v[24:27]
v_mfma_f32_16x16x32_bf16 v[28:31], a[204:207], v[44:47], v[28:31]
v_mfma_f32_16x16x32_bf16 v[32:35], a[212:215], v[40:43], v[32:35]
v_mfma_f32_16x16x32_bf16 v[36:39], a[212:215], v[44:47], v[36:39]
s_waitcnt vmcnt(8)
s_barrier
s_add_u32 s60, s31, 20480
s_mul_i32 s61, s24, 5120
s_add_u32 s61, s61, 45056
s_add_u32 m0, s61, 0
s_nop 0
buffer_load_dwordx4 v104, s[16:19], s60 offen lds
s_add_u32 m0, s61, 1024
s_nop 0
buffer_load_dwordx4 v105, s[16:19], s60 offen lds
s_add_u32 m0, s61, 2048
s_nop 0
buffer_load_dwordx4 v106, s[16:19], s60 offen lds
s_add_u32 m0, s61, 3072
s_nop 0
buffer_load_dwordx4 v107, s[16:19], s60 offen lds
s_add_u32 m0, s61, 4096
s_nop 0
buffer_load_dwordx4 v108, s[16:19], s60 offen lds
ds_read_b128 v[40:43], v96 offset:9216
ds_read_b128 v[44:47], v96 offset:29696
ds_read_b64_tr_b16 a[216:217], v6 offset:0
ds_read_b64_tr_b16 a[218:219], v6 offset:1536
ds_read_b64_tr_b16 a[224:225], v6 offset:32
ds_read_b64_tr_b16 a[226:227], v6 offset:1568
ds_read_b64_tr_b16 a[232:233], v6 offset:64
ds_read_b64_tr_b16 a[234:235], v6 offset:1600
s_waitcnt lgkmcnt(0)
v_mfma_f32_16x16x32_bf16 v[16:19], a[216:219], v[40:43], v[16:19]
v_mfma_f32_16x16x32_bf16 v[20:23], a[216:219], v[44:47], v[20:23]
v_mfma_f32_16x16x32_bf16 v[24:27], a[224:227], v[40:43], v[24:27]
v_mfma_f32_16x16x32_bf16 v[28:31], a[224:227], v[44:47], v[28:31]
v_mfma_f32_16x16x32_bf16 v[32:35], a[232:235], v[40:43], v[32:35]
v_mfma_f32_16x16x32_bf16 v[36:39], a[232:235], v[44:47], v[36:39]
s_waitcnt vmcnt(10)
s_barrier
ds_read_b128 v[40:43], v97 offset:9216
ds_read_b128 v[44:47], v97 offset:29696
ds_read_b64_tr_b16 a[220:221], v6 offset:12288
ds_read_b64_tr_b16 a[222:223], v6 offset:13824
ds_read_b64_tr_b16 a[228:229], v6 offset:12320
ds_read_b64_tr_b16 a[230:231], v6 offset:13856
ds_read_b64_tr_b16 a[236:237], v6 offset:12352
ds_read_b64_tr_b16 a[238:239], v6 offset:13888
s_waitcnt lgkmcnt(0)
v_mfma_f32_16x16x32_bf16 v[16:19], a[220:223], v[40:43], v[16:19]
v_mfma_f32_16x16x32_bf16 v[20:23], a[220:223], v[44:47], v[20:23]
v_mfma_f32_16x16x32_bf16 v[24:27], a[228:231], v[40:43], v[24:27]
v_mfma_f32_16x16x32_bf16 v[28:31], a[228:231], v[44:47], v[28:31]
v_mfma_f32_16x16x32_bf16 v[32:35], a[236:239], v[40:43], v[32:35]
v_mfma_f32_16x16x32_bf16 v[36:39], a[236:239], v[44:47], v[36:39]
s_mul_i32 s41, s24, 3
s_add_u32 s41, s41, 0
s_lshr_b32 s42, s41, 1
s_lshl_b32 s42, s42, 10
s_and_b32 s41, s41, 1
s_lshl_b32 s41, s41, 3
s_add_u32 s41, s41, s42
s_add_u32 s41, s41, 122880
v_add_u32 v48, s41, v1
s_mul_i32 s41, s24, 3
s_add_u32 s41, s41, 1
s_lshr_b32 s42, s41, 1
s_lshl_b32 s42, s42, 10
s_and_b32 s41, s41, 1
s_lshl_b32 s41, s41, 3
s_add_u32 s41, s41, s42
s_add_u32 s41, s41, 122880
v_add_u32 v49, s41, v1
s_mul_i32 s41, s24, 3
s_add_u32 s41, s41, 2
s_lshr_b32 s42, s41, 1
s_lshl_b32 s42, s42, 10
s_and_b32 s41, s41, 1
s_lshl_b32 s41, s41, 3
s_add_u32 s41, s41, s42
s_add_u32 s41, s41, 122880
v_add_u32 v50, s41, v1
v_cvt_pk_bf16_f32 v52, v16, v17
v_cvt_pk_bf16_f32 v53, v18, v19
ds_write_b64 v48, v[52:53] offset:0
v_cvt_pk_bf16_f32 v54, v20, v21
v_cvt_pk_bf16_f32 v55, v22, v23
ds_write_b64 v48, v[54:55] offset:6144
v_cvt_pk_bf16_f32 v56, v24, v25
v_cvt_pk_bf16_f32 v57, v26, v27
ds_write_b64 v49, v[56:57] offset:0
v_cvt_pk_bf16_f32 v58, v28, v29
v_cvt_pk_bf16_f32 v59, v30, v31
ds_write_b64 v49, v[58:59] offset:6144
v_cvt_pk_bf16_f32 v60, v32, v33
v_cvt_pk_bf16_f32 v61, v34, v35
ds_write_b64 v50, v[60:61] offset:0
v_cvt_pk_bf16_f32 v62, v36, v37
v_cvt_pk_bf16_f32 v63, v38, v39
ds_write_b64 v50, v[62:63] offset:6144
s_waitcnt lgkmcnt(0)
s_waitcnt vmcnt(5)
s_barrier
s_add_u32 s60, s31, 40960
s_mul_i32 s61, s24, 5120
s_add_u32 s61, s61, 0
s_add_u32 m0, s61, 0
s_nop 0
buffer_load_dwordx4 v104, s[16:19], s60 offen lds
s_add_u32 m0, s61, 1024
s_nop 0
buffer_load_dwordx4 v105, s[16:19], s60 offen lds
s_add_u32 m0, s61, 2048
s_nop 0
buffer_load_dwordx4 v106, s[16:19], s60 offen lds
s_add_u32 m0, s61, 3072
s_nop 0
buffer_load_dwordx4 v107, s[16:19], s60 offen lds
s_add_u32 m0, s61, 4096
s_nop 0
buffer_load_dwordx4 v108, s[16:19], s60 offen lds
ds_read_b64_tr_b16 a[240:241], v8 offset:24576
ds_read_b64_tr_b16 a[248:249], v8 offset:24608
ds_read_b64_tr_b16 v[112:113], v8 offset:24640
ds_read_b64_tr_b16 v[120:121], v8 offset:24672
ds_read_b64_tr_b16 v[128:129], v8 offset:24704
ds_read_b64_tr_b16 v[136:137], v8 offset:24736
ds_read_b64_tr_b16 v[144:145], v8 offset:24768
ds_read_b64_tr_b16 v[152:153], v8 offset:24800
ds_read_b64_tr_b16 v[160:161], v8 offset:24832
ds_read_b64_tr_b16 v[168:169], v8 offset:24864
s_waitcnt lgkmcnt(0)
s_waitcnt vmcnt(5)
s_barrier
s_add_u32 s60, s31, 61440
s_mul_i32 s61, s24, 5120
s_add_u32 s61, s61, 20480
s_add_u32 m0, s61, 0
s_nop 0
buffer_load_dwordx4 v104, s[16:19], s60 offen lds
s_add_u32 m0, s61, 1024
s_nop 0
buffer_load_dwordx4 v105, s[16:19], s60 offen lds
s_add_u32 m0, s61, 2048
s_nop 0
buffer_load_dwordx4 v106, s[16:19], s60 offen lds
s_add_u32 m0, s61, 3072
s_nop 0
buffer_load_dwordx4 v107, s[16:19], s60 offen lds
s_add_u32 m0, s61, 4096
s_nop 0
buffer_load_dwordx4 v108, s[16:19], s60 offen lds
ds_read_b64_tr_b16 a[242:243], v8 offset:45056
ds_read_b64_tr_b16 a[250:251], v8 offset:45088
ds_read_b64_tr_b16 v[114:115], v8 offset:45120
ds_read_b64_tr_b16 v[122:123], v8 offset:45152
ds_read_b64_tr_b16 v[130:131], v8 offset:45184
ds_read_b64_tr_b16 v[138:139], v8 offset:45216
ds_read_b64_tr_b16 v[146:147], v8 offset:45248
ds_read_b64_tr_b16 v[154:155], v8 offset:45280
ds_read_b64_tr_b16 v[162:163], v8 offset:45312
ds_read_b64_tr_b16 v[170:171], v8 offset:45344
s_waitcnt lgkmcnt(0)
s_waitcnt vmcnt(5)
s_barrier
s_add_u32 s60, s31, 81920
s_mul_i32 s61, s24, 5120
s_add_u32 s61, s61, 40960
s_add_u32 m0, s61, 0
s_nop 0
buffer_load_dwordx4 v104, s[16:19], s60 offen lds
s_add_u32 m0, s61, 1024
s_nop 0
buffer_load_dwordx4 v105, s[16:19], s60 offen lds
s_add_u32 m0, s61, 2048
s_nop 0
buffer_load_dwordx4 v106, s[16:19], s60 offen lds
s_add_u32 m0, s61, 3072
s_nop 0
buffer_load_dwordx4 v107, s[16:19], s60 offen lds
s_add_u32 m0, s61, 4096
s_nop 0
buffer_load_dwordx4 v108, s[16:19], s60 offen lds
s_add_u32 s60, s31, 102400
s_mul_i32 s61, s24, 5120
s_add_u32 s61, s61, 61440
s_add_u32 m0, s61, 0
s_nop 0
buffer_load_dwordx4 v104, s[16:19], s60 offen lds
s_add_u32 m0, s61, 1024
s_nop 0
buffer_load_dwordx4 v105, s[16:19], s60 offen lds
s_add_u32 m0, s61, 2048
s_nop 0
buffer_load_dwordx4 v106, s[16:19], s60 offen lds
s_add_u32 m0, s61, 3072
s_nop 0
buffer_load_dwordx4 v107, s[16:19], s60 offen lds
s_add_u32 m0, s61, 4096
s_nop 0
buffer_load_dwordx4 v108, s[16:19], s60 offen lds
ds_read_b64_tr_b16 a[244:245], v8 offset:0
ds_read_b64_tr_b16 a[252:253], v8 offset:32
ds_read_b64_tr_b16 v[116:117], v8 offset:64
ds_read_b64_tr_b16 v[124:125], v8 offset:96
ds_read_b64_tr_b16 v[132:133], v8 offset:128
ds_read_b64_tr_b16 v[140:141], v8 offset:160
ds_read_b64_tr_b16 v[148:149], v8 offset:192
ds_read_b64_tr_b16 v[156:157], v8 offset:224
ds_read_b64_tr_b16 v[164:165], v8 offset:256
ds_read_b64_tr_b16 v[172:173], v8 offset:288
s_waitcnt lgkmcnt(0)
s_waitcnt vmcnt(10)
s_barrier
s_add_u32 s60, s31, 122880
s_mul_i32 s61, s24, 5120
s_add_u32 s61, s61, 0
s_add_u32 m0, s61, 0
s_nop 0
buffer_load_dwordx4 v104, s[16:19], s60 offen lds
s_add_u32 m0, s61, 1024
s_nop 0
buffer_load_dwordx4 v105, s[16:19], s60 offen lds
s_add_u32 m0, s61, 2048
s_nop 0
buffer_load_dwordx4 v106, s[16:19], s60 offen lds
s_add_u32 m0, s61, 3072
s_nop 0
buffer_load_dwordx4 v107, s[16:19], s60 offen lds
s_add_u32 m0, s61, 4096
s_nop 0
buffer_load_dwordx4 v108, s[16:19], s60 offen lds
ds_read_b64_tr_b16 a[246:247], v8 offset:20480
ds_read_b64_tr_b16 a[254:255], v8 offset:20512
ds_read_b64_tr_b16 v[118:119], v8 offset:20544
ds_read_b64_tr_b16 v[126:127], v8 offset:20576
ds_read_b64_tr_b16 v[134:135], v8 offset:20608
ds_read_b64_tr_b16 v[142:143], v8 offset:20640
ds_read_b64_tr_b16 v[150:151], v8 offset:20672
ds_read_b64_tr_b16 v[158:159], v8 offset:20704
ds_read_b64_tr_b16 v[166:167], v8 offset:20736
ds_read_b64_tr_b16 v[174:175], v8 offset:20768
s_waitcnt lgkmcnt(0)
s_waitcnt vmcnt(10)
s_barrier
s_add_u32 s60, s31, 143360
s_mul_i32 s61, s24, 5120
s_add_u32 s61, s61, 20480
s_add_u32 m0, s61, 0
s_nop 0
buffer_load_dwordx4 v104, s[16:19], s60 offen lds
s_add_u32 m0, s61, 1024
s_nop 0
buffer_load_dwordx4 v105, s[16:19], s60 offen lds
s_add_u32 m0, s61, 2048
s_nop 0
buffer_load_dwordx4 v106, s[16:19], s60 offen lds
s_add_u32 m0, s61, 3072
s_nop 0
buffer_load_dwordx4 v107, s[16:19], s60 offen lds
s_add_u32 m0, s61, 4096
s_nop 0
buffer_load_dwordx4 v108, s[16:19], s60 offen lds
ds_read_b64_tr_b16 v[176:177], v8 offset:40960
ds_read_b64_tr_b16 v[184:185], v8 offset:40992
ds_read_b64_tr_b16 v[192:193], v8 offset:41024
ds_read_b64_tr_b16 v[200:201], v8 offset:41056
ds_read_b64_tr_b16 v[208:209], v8 offset:41088
ds_read_b64_tr_b16 v[216:217], v8 offset:41120
ds_read_b64_tr_b16 v[224:225], v8 offset:41152
ds_read_b64_tr_b16 v[232:233], v8 offset:41184
ds_read_b64_tr_b16 v[240:241], v8 offset:41216
ds_read_b64_tr_b16 v[248:249], v8 offset:41248
s_waitcnt lgkmcnt(0)
s_waitcnt vmcnt(10)
s_barrier
s_add_u32 s60, s31, 163840
s_mul_i32 s61, s24, 5120
s_add_u32 s61, s61, 40960
s_add_u32 m0, s61, 0
s_nop 0
buffer_load_dwordx4 v104, s[16:19], s60 offen lds
s_add_u32 m0, s61, 1024
s_nop 0
buffer_load_dwordx4 v105, s[16:19], s60 offen lds
s_add_u32 m0, s61, 2048
s_nop 0
buffer_load_dwordx4 v106, s[16:19], s60 offen lds
s_add_u32 m0, s61, 3072
s_nop 0
buffer_load_dwordx4 v107, s[16:19], s60 offen lds
s_add_u32 m0, s61, 4096
s_nop 0
buffer_load_dwordx4 v108, s[16:19], s60 offen lds
ds_read_b64_tr_b16 v[178:179], v9 offset:12288
ds_read_b64_tr_b16 v[186:187], v9 offset:12320
ds_read_b64_tr_b16 v[194:195], v9 offset:12352
ds_read_b64_tr_b16 v[202:203], v9 offset:12384
ds_read_b64_tr_b16 v[210:211], v9 offset:12416
ds_read_b64_tr_b16 v[218:219], v9 offset:12448
ds_read_b64_tr_b16 v[226:227], v9 offset:12480
ds_read_b64_tr_b16 v[234:235], v9 offset:12512
ds_read_b64_tr_b16 v[242:243], v9 offset:12544
ds_read_b64_tr_b16 v[250:251], v9 offset:12576
s_waitcnt lgkmcnt(0)
s_waitcnt vmcnt(10)
s_barrier
s_add_u32 s60, s31, 184320
s_mul_i32 s61, s24, 5120
s_add_u32 s61, s61, 61440
s_add_u32 m0, s61, 0
s_nop 0
buffer_load_dwordx4 v104, s[16:19], s60 offen lds
s_add_u32 m0, s61, 1024
s_nop 0
buffer_load_dwordx4 v105, s[16:19], s60 offen lds
s_add_u32 m0, s61, 2048
s_nop 0
buffer_load_dwordx4 v106, s[16:19], s60 offen lds
s_add_u32 m0, s61, 3072
s_nop 0
buffer_load_dwordx4 v107, s[16:19], s60 offen lds
s_add_u32 m0, s61, 4096
s_nop 0
buffer_load_dwordx4 v108, s[16:19], s60 offen lds
ds_read_b64_tr_b16 v[180:181], v8 offset:0
ds_read_b64_tr_b16 v[188:189], v8 offset:32
ds_read_b64_tr_b16 v[196:197], v8 offset:64
ds_read_b64_tr_b16 v[204:205], v8 offset:96
ds_read_b64_tr_b16 v[212:213], v8 offset:128
ds_read_b64_tr_b16 v[220:221], v8 offset:160
ds_read_b64_tr_b16 v[228:229], v8 offset:192
ds_read_b64_tr_b16 v[236:237], v8 offset:224
ds_read_b64_tr_b16 v[244:245], v8 offset:256
ds_read_b64_tr_b16 v[252:253], v8 offset:288
s_waitcnt lgkmcnt(0)
s_waitcnt vmcnt(10)
s_barrier
s_add_u32 s60, s31, 204800
s_mul_i32 s61, s24, 5120
s_add_u32 s61, s61, 0
s_add_u32 m0, s61, 0
s_nop 0
buffer_load_dwordx4 v104, s[16:19], s60 offen lds
s_add_u32 m0, s61, 1024
s_nop 0
buffer_load_dwordx4 v105, s[16:19], s60 offen lds
s_add_u32 m0, s61, 2048
s_nop 0
buffer_load_dwordx4 v106, s[16:19], s60 offen lds
s_add_u32 m0, s61, 3072
s_nop 0
buffer_load_dwordx4 v107, s[16:19], s60 offen lds
s_add_u32 m0, s61, 4096
s_nop 0
buffer_load_dwordx4 v108, s[16:19], s60 offen lds
ds_read_b64_tr_b16 v[182:183], v8 offset:20480
ds_read_b64_tr_b16 v[190:191], v8 offset:20512
ds_read_b64_tr_b16 v[198:199], v8 offset:20544
ds_read_b64_tr_b16 v[206:207], v8 offset:20576
ds_read_b64_tr_b16 v[214:215], v8 offset:20608
ds_read_b64_tr_b16 v[222:223], v8 offset:20640
ds_read_b64_tr_b16 v[230:231], v8 offset:20672
ds_read_b64_tr_b16 v[238:239], v8 offset:20704
ds_read_b64_tr_b16 v[246:247], v8 offset:20736
ds_read_b64_tr_b16 v[254:255], v8 offset:20768
s_waitcnt lgkmcnt(0)
s_waitcnt vmcnt(10)
s_barrier
s_add_u32 s60, s31, 225280
s_mul_i32 s61, s24, 5120
s_add_u32 s61, s61, 20480
s_add_u32 m0, s61, 0
s_nop 0
buffer_load_dwordx4 v104, s[16:19], s60 offen lds
s_add_u32 m0, s61, 1024
s_nop 0
buffer_load_dwordx4 v105, s[16:19], s60 offen lds
s_add_u32 m0, s61, 2048
s_nop 0
buffer_load_dwordx4 v106, s[16:19], s60 offen lds
s_add_u32 m0, s61, 3072
s_nop 0
buffer_load_dwordx4 v107, s[16:19], s60 offen lds
s_add_u32 m0, s61, 4096
s_nop 0
buffer_load_dwordx4 v108, s[16:19], s60 offen lds
ds_read_b64_tr_b16 v[16:17], v8 offset:40960
ds_read_b64_tr_b16 v[20:21], v8 offset:40992
ds_read_b64_tr_b16 v[24:25], v8 offset:41024
ds_read_b64_tr_b16 v[28:29], v8 offset:41056
ds_read_b64_tr_b16 v[32:33], v8 offset:41088
ds_read_b64_tr_b16 v[36:37], v8 offset:41120
ds_read_b64_tr_b16 v[40:41], v8 offset:41152
ds_read_b64_tr_b16 v[44:45], v8 offset:41184
ds_read_b64_tr_b16 v[48:49], v8 offset:41216
ds_read_b64_tr_b16 v[52:53], v8 offset:41248
s_waitcnt lgkmcnt(0)
s_waitcnt vmcnt(10)
s_barrier
ds_read_b64_tr_b16 v[18:19], v9 offset:12288
ds_read_b64_tr_b16 v[22:23], v9 offset:12320
ds_read_b64_tr_b16 v[26:27], v9 offset:12352
ds_read_b64_tr_b16 v[30:31], v9 offset:12384
ds_read_b64_tr_b16 v[34:35], v9 offset:12416
ds_read_b64_tr_b16 v[38:39], v9 offset:12448
ds_read_b64_tr_b16 v[42:43], v9 offset:12480
ds_read_b64_tr_b16 v[46:47], v9 offset:12512
ds_read_b64_tr_b16 v[50:51], v9 offset:12544
ds_read_b64_tr_b16 v[54:55], v9 offset:12576
s_waitcnt lgkmcnt(0)
s_waitcnt vmcnt(5)
s_barrier
ds_read_b64_tr_b16 v[56:57], v8 offset:0
ds_read_b64_tr_b16 v[60:61], v8 offset:32
ds_read_b64_tr_b16 v[64:65], v8 offset:64
ds_read_b64_tr_b16 v[68:69], v8 offset:96
ds_read_b64_tr_b16 v[72:73], v8 offset:128
ds_read_b64_tr_b16 v[76:77], v8 offset:160
ds_read_b64_tr_b16 v[80:81], v8 offset:192
ds_read_b64_tr_b16 v[84:85], v8 offset:224
ds_read_b64_tr_b16 v[88:89], v8 offset:256
ds_read_b64_tr_b16 v[92:93], v8 offset:288
s_waitcnt lgkmcnt(0)
s_waitcnt vmcnt(0)
s_barrier
ds_read_b64_tr_b16 v[58:59], v8 offset:20480
ds_read_b64_tr_b16 v[62:63], v8 offset:20512
ds_read_b64_tr_b16 v[66:67], v8 offset:20544
ds_read_b64_tr_b16 v[70:71], v8 offset:20576
ds_read_b64_tr_b16 v[74:75], v8 offset:20608
ds_read_b64_tr_b16 v[78:79], v8 offset:20640
ds_read_b64_tr_b16 v[82:83], v8 offset:20672
ds_read_b64_tr_b16 v[86:87], v8 offset:20704
ds_read_b64_tr_b16 v[90:91], v8 offset:20736
ds_read_b64_tr_b16 v[94:95], v8 offset:20768
s_waitcnt lgkmcnt(0)
s_barrier
s_mul_i32 s28, s24, 20480
v_add_u32 v5, s28, v1
ds_write_b128 v5, v[16:19] offset:0
ds_write_b128 v5, v[20:23] offset:1024
ds_write_b128 v5, v[24:27] offset:2048
ds_write_b128 v5, v[28:31] offset:3072
ds_write_b128 v5, v[32:35] offset:4096
ds_write_b128 v5, v[36:39] offset:5120
ds_write_b128 v5, v[40:43] offset:6144
ds_write_b128 v5, v[44:47] offset:7168
ds_write_b128 v5, v[48:51] offset:8192
ds_write_b128 v5, v[52:55] offset:9216
ds_write_b128 v5, v[56:59] offset:10240
ds_write_b128 v5, v[60:63] offset:11264
ds_write_b128 v5, v[64:67] offset:12288
ds_write_b128 v5, v[68:71] offset:13312
ds_write_b128 v5, v[72:75] offset:14336
ds_write_b128 v5, v[76:79] offset:15360
ds_write_b128 v5, v[80:83] offset:16384
ds_write_b128 v5, v[84:87] offset:17408
ds_write_b128 v5, v[88:91] offset:18432
ds_write_b128 v5, v[92:95] offset:19456
s_waitcnt lgkmcnt(0)
s_mov_b32 s62, 0
v_mov_b32 v15, 128
XVwn:
s_add_u32 s62, s62, 1
s_mov_b32 s63, 9
s_cmp_gt_u32 s62, 400000
s_cbranch_scc1 L_err
buffer_load_dwordx3 v[12:14], v15, s[20:23], 0 offen sc1
s_waitcnt vmcnt(0)
v_readfirstlane_b32 s3, v12
v_readfirstlane_b32 s57, v14
s_cmp_eq_u32 s57, 0
s_cselect_b32 s3, 0, s3
s_bitcmp1_b32 s3, 8
s_cbranch_scc0 XVwn
s_bfe_u32 s3, s3, 0x10001
v_lshrrev_b32 v8, 3, v0
s_lshl_b32 s35, s24, 3
v_add_u32 v7, s35, v8
v_mul_u32_u24 v7, 1280, v7
v_and_b32 v9, 7, v0
v_xor_b32 v9, v9, v8
v_lshl_add_u32 v7, v9, 4, v7
v_and_b32 v8, 7, v2
v_xor_b32 v9, v3, v8
v_lshlrev_b32 v9, 4, v9
v_lshl_add_u32 v9, v8, 7, v9
v_lshrrev_b32 v8, 3, v2
v_mul_u32_u24 v8, 10240, v8
v_add_u32 v10, v8, v9
v_xor_b32 v11, 64, v10
v_add_u32 v4, 81920, v10
v_add_u32 v8, 81920, v11
v_add_u32 v9, 122880, v1
s_mul_i32 s41, s24, 3
s_add_u32 s41, s41, 0
s_lshr_b32 s42, s41, 1
s_lshl_b32 s42, s42, 10
s_and_b32 s41, s41, 1
s_lshl_b32 s41, s41, 3
s_add_u32 s41, s41, s42
v_add_u32 v10, s41, v9
s_mul_i32 s41, s24, 3
s_add_u32 s41, s41, 1
s_lshr_b32 s42, s41, 1
s_lshl_b32 s42, s42, 10
s_and_b32 s41, s41, 1
s_lshl_b32 s41, s41, 3
s_add_u32 s41, s41, s42
v_add_u32 v11, s41, v9
s_mul_i32 s41, s24, 3
s_add_u32 s41, s41, 2
s_lshr_b32 s42, s41, 1
s_lshl_b32 s42, s42, 10
s_and_b32 s41, s41, 1
s_lshl_b32 s41, s41, 3
s_add_u32 s41, s41, s42
v_add_u32 v12, s41, v9
s_mul_i32 s45, s24, 40
s_lshr_b32 s41, s25, 3
s_add_u32 s45, s45, s41
s_and_b32 s47, s25, 7
s_lshl_b32 s47, s47, 10
s_lshl_b32 s45, s45, 14
s_add_u32 s45, s45, 5177344
s_add_u32 s45, s45, s47
s_lshl_b32 s41, s3, 13
s_add_u32 s45, s45, s41
s_mul_i32 s41, s24, 10240
v_lshlrev_b32 v13, 7, v0
v_add_u32 v13, s41, v13
s_add_u32 s46, s39, 2
s_min_u32 s46, s46, 63
s_mul_i32 s41, s46, 40960
s_sub_u32 s41, s41, 128
s_mul_i32 s42, s24, 10240
s_add_u32 m0, s42, 80896
s_mul_i32 s44, s39, 2621440
s_add_u32 s44, s44, s45
s_add_u32 s44, s44, 65536
s_lshr_b32 s43, s44, 8
s_and_b32 s43, s43, 0x2000
s_xor_b32 s43, s43, s44
s_branch XVmid
XVloop:
s_waitcnt lgkmcnt(2)
v_mfma_f32_16x16x32_bf16 v[16:19], a[0:3], v[48:51], 0
v_mfma_f32_16x16x32_bf16 v[20:23], a[0:3], v[52:55], 0
v_mfma_f32_16x16x32_bf16 v[24:27], a[8:11], v[48:51], 0
ds_read_b128 v[40:43], v4 offset:1024
v_mfma_f32_16x16x32_bf16 v[28:31], a[8:11], v[52:55], 0
ds_read_b128 v[44:47], v4 offset:21504
v_mfma_f32_16x16x32_bf16 v[32:35], a[16:19], v[48:51], 0
v_mfma_f32_16x16x32_bf16 v[36:39], a[16:19], v[52:55], 0
s_waitcnt lgkmcnt(2)
v_mfma_f32_16x16x32_bf16 v[16:19], a[4:7], v[56:59], v[16:19]
v_mfma_f32_16x16x32_bf16 v[20:23], a[4:7], v[60:63], v[20:23]
v_mfma_f32_16x16x32_bf16 v[24:27], a[12:15], v[56:59], v[24:27]
ds_read_b128 v[48:51], v8 offset:1024
v_mfma_f32_16x16x32_bf16 v[28:31], a[12:15], v[60:63], v[28:31]
ds_read_b128 v[52:55], v8 offset:21504
v_mfma_f32_16x16x32_bf16 v[32:35], a[20:23], v[56:59], v[32:35]
v_mfma_f32_16x16x32_bf16 v[36:39], a[20:23], v[60:63], v[36:39]
s_waitcnt lgkmcnt(2)
v_mfma_f32_16x16x32_bf16 v[16:19], a[24:27], v[40:43], v[16:19]
s_add_u32 s46, s39, 2
s_min_u32 s46, s46, 63
v_mfma_f32_16x16x32_bf16 v[20:23], a[24:27], v[44:47], v[20:23]
s_mul_i32 s41, s46, 40960
s_sub_u32 s41, s41, 128
v_mfma_f32_16x16x32_bf16 v[24:27], a[32:35], v[40:43], v[24:27]
ds_read_b128 v[56:59], v4 offset:2048
v_mfma_f32_16x16x32_bf16 v[28:31], a[32:35], v[44:47], v[28:31]
ds_read_b128 v[60:63], v4 offset:22528
v_mfma_f32_16x16x32_bf16 v[32:35], a[40:43], v[40:43], v[32:35]
s_mul_i32 s42, s24, 10240
s_add_u32 m0, s42, 80896
v_mfma_f32_16x16x32_bf16 v[36:39], a[40:43], v[44:47], v[36:39]
s_mul_i32 s44, s39, 2621440
s_add_u32 s44, s44, s45
s_waitcnt lgkmcnt(2)
v_mfma_f32_16x16x32_bf16 v[16:19], a[28:31], v[48:51], v[16:19]
s_add_u32 s44, s44, 65536
s_lshr_b32 s43, s44, 8
v_mfma_f32_16x16x32_bf16 v[20:23], a[28:31], v[52:55], v[20:23]
s_and_b32 s43, s43, 0x2000
s_xor_b32 s43, s43, s44
v_mfma_f32_16x16x32_bf16 v[24:27], a[36:39], v[48:51], v[24:27]
ds_read_b128 v[40:43], v8 offset:2048
v_mfma_f32_16x16x32_bf16 v[28:31], a[36:39], v[52:55], v[28:31]
ds_read_b128 v[44:47], v8 offset:22528
v_mfma_f32_16x16x32_bf16 v[32:35], a[44:47], v[48:51], v[32:35]
v_mfma_f32_16x16x32_bf16 v[36:39], a[44:47], v[52:55], v[36:39]
s_waitcnt lgkmcnt(2)
v_mfma_f32_16x16x32_bf16 v[16:19], a[48:51], v[56:59], v[16:19]
v_mfma_f32_16x16x32_bf16 v[20:23], a[48:51], v[60:63], v[20:23]
v_mfma_f32_16x16x32_bf16 v[24:27], a[56:59], v[56:59], v[24:27]
ds_read_b128 v[48:51], v4 offset:3072
v_mfma_f32_16x16x32_bf16 v[28:31], a[56:59], v[60:63], v[28:31]
ds_read_b128 v[52:55], v4 offset:23552
v_mfma_f32_16x16x32_bf16 v[32:35], a[64:67], v[56:59], v[32:35]
v_mfma_f32_16x16x32_bf16 v[36:39], a[64:67], v[60:63], v[36:39]
s_waitcnt lgkmcnt(2)
v_mfma_f32_16x16x32_bf16 v[16:19], a[52:55], v[40:43], v[16:19]
v_mfma_f32_16x16x32_bf16 v[20:23], a[52:55], v[44:47], v[20:23]
v_mfma_f32_16x16x32_bf16 v[24:27], a[60:63], v[40:43], v[24:27]
ds_read_b128 v[56:59], v8 offset:3072
v_mfma_f32_16x16x32_bf16 v[28:31], a[60:63], v[44:47], v[28:31]
ds_read_b128 v[60:63], v8 offset:23552
v_mfma_f32_16x16x32_bf16 v[32:35], a[68:71], v[40:43], v[32:35]
v_mfma_f32_16x16x32_bf16 v[36:39], a[68:71], v[44:47], v[36:39]
s_waitcnt lgkmcnt(2)
v_mfma_f32_16x16x32_bf16 v[16:19], a[72:75], v[48:51], v[16:19]
v_mfma_f32_16x16x32_bf16 v[20:23], a[72:75], v[52:55], v[20:23]
v_mfma_f32_16x16x32_bf16 v[24:27], a[80:83], v[48:51], v[24:27]
ds_read_b128 v[40:43], v4 offset:4096
v_mfma_f32_16x16x32_bf16 v[28:31], a[80:83], v[52:55], v[28:31]
ds_read_b128 v[44:47], v4 offset:24576
v_mfma_f32_16x16x32_bf16 v[32:35], a[88:91], v[48:51], v[32:35]
v_mfma_f32_16x16x32_bf16 v[36:39], a[88:91], v[52:55], v[36:39]
s_waitcnt lgkmcnt(2)
v_mfma_f32_16x16x32_bf16 v[16:19], a[76:79], v[56:59], v[16:19]
v_mfma_f32_16x16x32_bf16 v[20:23], a[76:79], v[60:63], v[20:23]
v_mfma_f32_16x16x32_bf16 v[24:27], a[84:87], v[56:59], v[24:27]
ds_read_b128 v[48:51], v8 offset:4096
v_mfma_f32_16x16x32_bf16 v[28:31], a[84:87], v[60:63], v[28:31]
ds_read_b128 v[52:55], v8 offset:24576
v_mfma_f32_16x16x32_bf16 v[32:35], a[92:95], v[56:59], v[32:35]
v_mfma_f32_16x16x32_bf16 v[36:39], a[92:95], v[60:63], v[36:39]
s_waitcnt lgkmcnt(2)
v_mfma_f32_16x16x32_bf16 v[16:19], a[96:99], v[40:43], v[16:19]
v_mfma_f32_16x16x32_bf16 v[20:23], a[96:99], v[44:47], v[20:23]
v_mfma_f32_16x16x32_bf16 v[24:27], a[104:107], v[40:43], v[24:27]
ds_read_b128 v[56:59], v4 offset:5120
v_mfma_f32_16x16x32_bf16 v[28:31], a[104:107], v[44:47], v[28:31]
ds_read_b128 v[60:63], v4 offset:25600
v_mfma_f32_16x16x32_bf16 v[32:35], a[112:115], v[40:43], v[32:35]
v_mfma_f32_16x16x32_bf16 v[36:39], a[112:115], v[44:47], v[36:39]
s_waitcnt lgkmcnt(2)
v_mfma_f32_16x16x32_bf16 v[16:19], a[100:103], v[48:51], v[16:19]
v_mfma_f32_16x16x32_bf16 v[20:23], a[100:103], v[52:55], v[20:23]
v_mfma_f32_16x16x32_bf16 v[24:27], a[108:111], v[48:51], v[24:27]
ds_read_b128 v[40:43], v8 offset:5120
v_mfma_f32_16x16x32_bf16 v[28:31], a[108:111], v[52:55], v[28:31]
ds_read_b128 v[44:47], v8 offset:25600
v_mfma_f32_16x16x32_bf16 v[32:35], a[116:119], v[48:51], v[32:35]
v_mfma_f32_16x16x32_bf16 v[36:39], a[116:119], v[52:55], v[36:39]
s_waitcnt lgkmcnt(2)
v_mfma_f32_16x16x32_bf16 v[16:19], a[120:123], v[56:59], v[16:19]
v_mfma_f32_16x16x32_bf16 v[20:23], a[120:123], v[60:63], v[20:23]
v_mfma_f32_16x16x32_bf16 v[24:27], a[128:131], v[56:59], v[24:27]
ds_read_b128 v[48:51], v4 offset:6144
v_mfma_f32_16x16x32_bf16 v[28:31], a[128:131], v[60:63], v[28:31]
ds_read_b128 v[52:55], v4 offset:26624
v_mfma_f32_16x16x32_bf16 v[32:35], a[136:139], v[56:59], v[32:35]
v_mfma_f32_16x16x32_bf16 v[36:39], a[136:139], v[60:63], v[36:39]
s_waitcnt lgkmcnt(2)
v_mfma_f32_16x16x32_bf16 v[16:19], a[124:127], v[40:43], v[16:19]
v_mfma_f32_16x16x32_bf16 v[20:23], a[124:127], v[44:47], v[20:23]
v_mfma_f32_16x16x32_bf16 v[24:27], a[132:135], v[40:43], v[24:27]
ds_read_b128 v[56:59], v8 offset:6144
v_mfma_f32_16x16x32_bf16 v[28:31], a[132:135], v[44:47], v[28:31]
ds_read_b128 v[60:63], v8 offset:26624
v_mfma_f32_16x16x32_bf16 v[32:35], a[140:143], v[40:43], v[32:35]
v_mfma_f32_16x16x32_bf16 v[36:39], a[140:143], v[44:47], v[36:39]
s_waitcnt lgkmcnt(2)
v_mfma_f32_16x16x32_bf16 v[16:19], a[144:147], v[48:51], v[16:19]
v_mfma_f32_16x16x32_bf16 v[20:23], a[144:147], v[52:55], v[20:23]
v_mfma_f32_16x16x32_bf16 v[24:27], a[152:155], v[48:51], v[24:27]
ds_read_b128 v[40:43], v4 offset:7168
v_mfma_f32_16x16x32_bf16 v[28:31], a[152:155], v[52:55], v[28:31]
ds_read_b128 v[44:47], v4 offset:27648
v_mfma_f32_16x16x32_bf16 v[32:35], a[160:163], v[48:51], v[32:35]
v_mfma_f32_16x16x32_bf16 v[36:39], a[160:163], v[52:55], v[36:39]
s_waitcnt lgkmcnt(2)
v_mfma_f32_16x16x32_bf16 v[16:19], a[148:151], v[56:59], v[16:19]
v_mfma_f32_16x16x32_bf16 v[20:23], a[148:151], v[60:63], v[20:23]
v_mfma_f32_16x16x32_bf16 v[24:27], a[156:159], v[56:59], v[24:27]
ds_read_b128 v[48:51], v8 offset:7168
v_mfma_f32_16x16x32_bf16 v[28:31], a[156:159], v[60:63], v[28:31]
ds_read_b128 v[52:55], v8 offset:27648
v_mfma_f32_16x16x32_bf16 v[32:35], a[164:167], v[56:59], v[32:35]
v_mfma_f32_16x16x32_bf16 v[36:39], a[164:167], v[60:63], v[36:39]
s_waitcnt lgkmcnt(2)
v_mfma_f32_16x16x32_bf16 v[16:19], a[168:171], v[40:43], v[16:19]
v_mfma_f32_16x16x32_bf16 v[20:23], a[168:171], v[44:47], v[20:23]
v_mfma_f32_16x16x32_bf16 v[24:27], a[176:179], v[40:43], v[24:27]
ds_read_b128 v[56:59], v4 offset:8192
v_mfma_f32_16x16x32_bf16 v[28:31], a[176:179], v[44:47], v[28:31]
ds_read_b128 v[60:63], v4 offset:28672
v_mfma_f32_16x16x32_bf16 v[32:35], a[184:187], v[40:43], v[32:35]
v_mfma_f32_16x16x32_bf16 v[36:39], a[184:187], v[44:47], v[36:39]
s_waitcnt lgkmcnt(2)
v_mfma_f32_16x16x32_bf16 v[16:19], a[172:175], v[48:51], v[16:19]
v_mfma_f32_16x16x32_bf16 v[20:23], a[172:175], v[52:55], v[20:23]
v_mfma_f32_16x16x32_bf16 v[24:27], a[180:183], v[48:51], v[24:27]
ds_read_b128 v[40:43], v8 offset:8192
v_mfma_f32_16x16x32_bf16 v[28:31], a[180:183], v[52:55], v[28:31]
ds_read_b128 v[44:47], v8 offset:28672
v_mfma_f32_16x16x32_bf16 v[32:35], a[188:191], v[48:51], v[32:35]
v_mfma_f32_16x16x32_bf16 v[36:39], a[188:191], v[52:55], v[36:39]
s_waitcnt lgkmcnt(2)
v_mfma_f32_16x16x32_bf16 v[16:19], a[192:195], v[56:59], v[16:19]
v_mfma_f32_16x16x32_bf16 v[20:23], a[192:195], v[60:63], v[20:23]
v_mfma_f32_16x16x32_bf16 v[24:27], a[200:203], v[56:59], v[24:27]
ds_read_b128 v[48:51], v4 offset:9216
v_mfma_f32_16x16x32_bf16 v[28:31], a[200:203], v[60:63], v[28:31]
ds_read_b128 v[52:55], v4 offset:29696
v_mfma_f32_16x16x32_bf16 v[32:35], a[208:211], v[56:59], v[32:35]
v_mfma_f32_16x16x32_bf16 v[36:39], a[208:211], v[60:63], v[36:39]
s_waitcnt lgkmcnt(2)
v_mfma_f32_16x16x32_bf16 v[16:19], a[196:199], v[40:43], v[16:19]
v_mfma_f32_16x16x32_bf16 v[20:23], a[196:199], v[44:47], v[20:23]
v_mfma_f32_16x16x32_bf16 v[24:27], a[204:207], v[40:43], v[24:27]
ds_read_b128 v[56:59], v8 offset:9216
v_mfma_f32_16x16x32_bf16 v[28:31], a[204:207], v[44:47], v[28:31]
ds_read_b128 v[60:63], v8 offset:29696
v_mfma_f32_16x16x32_bf16 v[32:35], a[212:215], v[40:43], v[32:35]
v_mfma_f32_16x16x32_bf16 v[36:39], a[212:215], v[44:47], v[36:39]
s_waitcnt lgkmcnt(2)
v_mfma_f32_16x16x32_bf16 v[16:19], a[216:219], v[48:51], v[16:19]
v_mfma_f32_16x16x32_bf16 v[20:23], a[216:219], v[52:55], v[20:23]
s_waitcnt lgkmcnt(0)
v_mfma_f32_16x16x32_bf16 v[16:19], a[220:223], v[56:59], v[16:19]
v_mfma_f32_16x16x32_bf16 v[20:23], a[220:223], v[60:63], v[20:23]
v_mfma_f32_16x16x32_bf16 v[24:27], a[224:227], v[48:51], v[24:27]
v_mfma_f32_16x16x32_bf16 v[28:31], a[224:227], v[52:55], v[28:31]
v_mfma_f32_16x16x32_bf16 v[24:27], a[228:231], v[56:59], v[24:27]
v_mfma_f32_16x16x32_bf16 v[28:31], a[228:231], v[60:63], v[28:31]
v_mfma_f32_16x16x32_bf16 v[32:35], a[232:235], v[48:51], v[32:35]
v_mfma_f32_16x16x32_bf16 v[36:39], a[232:235], v[52:55], v[36:39]
v_mfma_f32_16x16x32_bf16 v[32:35], a[236:239], v[56:59], v[32:35]
v_mfma_f32_16x16x32_bf16 v[36:39], a[236:239], v[60:63], v[36:39]
v_cvt_pk_bf16_f32 v64, v16, v17
v_cvt_pk_bf16_f32 v65, v18, v19
ds_write_b64 v10, v[64:65] offset:0
v_cvt_pk_bf16_f32 v66, v20, v21
v_cvt_pk_bf16_f32 v67, v22, v23
ds_write_b64 v10, v[66:67] offset:6144
v_cvt_pk_bf16_f32 v68, v24, v25
v_cvt_pk_bf16_f32 v69, v26, v27
ds_write_b64 v11, v[68:69] offset:0
v_cvt_pk_bf16_f32 v70, v28, v29
v_cvt_pk_bf16_f32 v71, v30, v31
ds_write_b64 v11, v[70:71] offset:6144
v_cvt_pk_bf16_f32 v72, v32, v33
v_cvt_pk_bf16_f32 v73, v34, v35
ds_write_b64 v12, v[72:73] offset:0
v_cvt_pk_bf16_f32 v74, v36, v37
v_cvt_pk_bf16_f32 v75, v38, v39
ds_write_b64 v12, v[74:75] offset:6144
s_waitcnt vmcnt(0)
s_waitcnt lgkmcnt(0)
s_barrier
XVmid:
ds_read_b128 v[64:67], v9 offset:0
ds_read_b128 v[88:91], v9 offset:6144
ds_read_b128 v[68:71], v9 offset:1024
ds_read_b128 v[92:95], v9 offset:7168
ds_read_b128 v[72:75], v9 offset:2048
ds_read_b128 v[96:99], v9 offset:8192
ds_read_b128 v[76:79], v9 offset:3072
ds_read_b128 v[100:103], v9 offset:9216
ds_read_b128 v[80:83], v9 offset:4096
ds_read_b128 v[104:107], v9 offset:10240
ds_read_b128 v[84:87], v9 offset:5120
ds_read_b128 v[108:111], v9 offset:11264
ds_read_b128 v[40:43], v5 offset:0
ds_read_b128 v[44:47], v5 offset:10240
ds_read_b128 v[48:51], v5 offset:1024
ds_read_b128 v[52:55], v5 offset:11264
s_waitcnt lgkmcnt(14)
v_mfma_f32_16x16x32_bf16 v[24:27], v[64:67], a[240:243], 0
ds_read_b128 v[56:59], v5 offset:2048
s_add_u32 m0, m0, 1024
v_mfma_f32_16x16x32_bf16 v[28:31], v[88:91], a[240:243], 0
ds_read_b128 v[60:63], v5 offset:12288
s_add_u32 s41, s41, 128
s_waitcnt lgkmcnt(14)
v_mfma_f32_16x16x32_bf16 v[24:27], v[68:71], a[244:247], v[24:27]
buffer_load_dwordx4 v7, s[8:11], s41 offen lds
s_add_u32 m0, m0, 1024
v_mfma_f32_16x16x32_bf16 v[28:31], v[92:95], a[244:247], v[28:31]
s_add_u32 s41, s41, 128
buffer_load_dwordx4 v7, s[8:11], s41 offen lds
s_waitcnt lgkmcnt(12)
v_mfma_f32_16x16x32_bf16 v[24:27], v[72:75], v[176:179], v[24:27]
s_add_u32 m0, m0, 1024
s_add_u32 s41, s41, 128
v_mfma_f32_16x16x32_bf16 v[28:31], v[96:99], v[176:179], v[28:31]
buffer_load_dwordx4 v7, s[8:11], s41 offen lds
s_add_u32 m0, m0, 1024
s_waitcnt lgkmcnt(10)
v_mfma_f32_16x16x32_bf16 v[24:27], v[76:79], v[180:183], v[24:27]
s_add_u32 s41, s41, 128
buffer_load_dwordx4 v7, s[8:11], s41 offen lds
v_mfma_f32_16x16x32_bf16 v[28:31], v[100:103], v[180:183], v[28:31]
s_add_u32 m0, m0, 1024
s_add_u32 s41, s41, 128
s_waitcnt lgkmcnt(5)
v_mfma_f32_16x16x32_bf16 v[24:27], v[80:83], v[40:43], v[24:27]
buffer_load_dwordx4 v7, s[8:11], s41 offen lds
s_add_u32 m0, m0, 1024
v_mfma_f32_16x16x32_bf16 v[28:31], v[104:107], v[40:43], v[28:31]
s_add_u32 s41, s41, 128
buffer_load_dwordx4 v7, s[8:11], s41 offen lds
s_waitcnt lgkmcnt(4)
v_mfma_f32_16x16x32_bf16 v[24:27], v[84:87], v[44:47], v[24:27]
s_add_u32 m0, m0, 1024
s_add_u32 s41, s41, 128
v_mfma_f32_16x16x32_bf16 v[28:31], v[108:111], v[44:47], v[28:31]
buffer_load_dwordx4 v7, s[8:11], s41 offen lds
v_mfma_f32_16x16x32_bf16 v[32:35], v[64:67], a[248:251], 0
ds_read_b128 v[40:43], v5 offset:3072
s_add_u32 m0, m0, 1024
v_mfma_f32_16x16x32_bf16 v[36:39], v[88:91], a[248:251], 0
ds_read_b128 v[44:47], v5 offset:13312
s_add_u32 s41, s41, 128
v_mfma_f32_16x16x32_bf16 v[32:35], v[68:71], a[252:255], v[32:35]
buffer_load_dwordx4 v7, s[8:11], s41 offen lds
s_add_u32 m0, m0, 1024
v_mfma_f32_16x16x32_bf16 v[36:39], v[92:95], a[252:255], v[36:39]
s_add_u32 s41, s41, 128
buffer_load_dwordx4 v7, s[8:11], s41 offen lds
v_mfma_f32_16x16x32_bf16 v[32:35], v[72:75], v[184:187], v[32:35]
s_add_u32 m0, m0, 1024
s_add_u32 s41, s41, 128
v_mfma_f32_16x16x32_bf16 v[36:39], v[96:99], v[184:187], v[36:39]
buffer_load_dwordx4 v7, s[8:11], s41 offen lds
v_mfma_f32_16x16x32_bf16 v[32:35], v[76:79], v[188:191], v[32:35]
v_mfma_f32_16x16x32_bf16 v[36:39], v[100:103], v[188:191], v[36:39]
s_waitcnt lgkmcnt(5)
v_mfma_f32_16x16x32_bf16 v[32:35], v[80:83], v[48:51], v[32:35]
v_cvt_pk_bf16_f32 v16, v24, v25
v_cvt_pk_bf16_f32 v17, v26, v27
v_mfma_f32_16x16x32_bf16 v[36:39], v[104:107], v[48:51], v[36:39]
v_cvt_pk_bf16_f32 v18, v28, v29
v_cvt_pk_bf16_f32 v19, v30, v31
s_waitcnt lgkmcnt(4)
v_mfma_f32_16x16x32_bf16 v[32:35], v[84:87], v[52:55], v[32:35]
buffer_store_dwordx4 v[16:19], v1, s[4:7], s43 offen sc1
s_add_u32 s44, s44, 65536
v_mfma_f32_16x16x32_bf16 v[36:39], v[108:111], v[52:55], v[36:39]
s_lshr_b32 s43, s44, 8
s_and_b32 s43, s43, 0x2000
v_mfma_f32_16x16x32_bf16 v[24:27], v[64:67], v[112:115], 0
ds_read_b128 v[48:51], v5 offset:4096
s_xor_b32 s43, s43, s44
v_mfma_f32_16x16x32_bf16 v[28:31], v[88:91], v[112:115], 0
ds_read_b128 v[52:55], v5 offset:14336
s_add_u32 s61, s57, s40
v_mfma_f32_16x16x32_bf16 v[24:27], v[68:71], v[116:119], v[24:27]
v_mov_b32 v14, s61
v_mov_b32 v15, 0
v_mfma_f32_16x16x32_bf16 v[28:31], v[92:95], v[116:119], v[28:31]
s_mov_b64 exec, 1
buffer_store_dword v14, v15, s[4:7], s34 offen sc1
s_mov_b64 exec, -1
v_mfma_f32_16x16x32_bf16 v[24:27], v[72:75], v[192:195], v[24:27]
v_mfma_f32_16x16x32_bf16 v[28:31], v[96:99], v[192:195], v[28:31]
v_mfma_f32_16x16x32_bf16 v[24:27], v[76:79], v[196:199], v[24:27]
v_mfma_f32_16x16x32_bf16 v[28:31], v[100:103], v[196:199], v[28:31]
s_waitcnt lgkmcnt(5)
v_mfma_f32_16x16x32_bf16 v[24:27], v[80:83], v[56:59], v[24:27]
v_cvt_pk_bf16_f32 v20, v32, v33
v_cvt_pk_bf16_f32 v21, v34, v35
v_mfma_f32_16x16x32_bf16 v[28:31], v[104:107], v[56:59], v[28:31]
v_cvt_pk_bf16_f32 v22, v36, v37
v_cvt_pk_bf16_f32 v23, v38, v39
s_waitcnt lgkmcnt(4)
v_mfma_f32_16x16x32_bf16 v[24:27], v[84:87], v[60:63], v[24:27]
buffer_store_dwordx4 v[20:23], v1, s[4:7], s43 offen sc1
s_add_u32 s44, s44, 65536
v_mfma_f32_16x16x32_bf16 v[28:31], v[108:111], v[60:63], v[28:31]
s_lshr_b32 s43, s44, 8
s_and_b32 s43, s43, 0x2000
v_mfma_f32_16x16x32_bf16 v[32:35], v[64:67], v[120:123], 0
ds_read_b128 v[56:59], v5 offset:5120
s_xor_b32 s43, s43, s44
v_mfma_f32_16x16x32_bf16 v[36:39], v[88:91], v[120:123], 0
ds_read_b128 v[60:63], v5 offset:15360
v_mfma_f32_16x16x32_bf16 v[32:35], v[68:71], v[124:127], v[32:35]
v_mfma_f32_16x16x32_bf16 v[36:39], v[92:95], v[124:127], v[36:39]
v_mfma_f32_16x16x32_bf16 v[32:35], v[72:75], v[200:203], v[32:35]
v_mfma_f32_16x16x32_bf16 v[36:39], v[96:99], v[200:203], v[36:39]
v_mfma_f32_16x16x32_bf16 v[32:35], v[76:79], v[204:207], v[32:35]
v_mfma_f32_16x16x32_bf16 v[36:39], v[100:103], v[204:207], v[36:39]
s_waitcnt lgkmcnt(5)
v_mfma_f32_16x16x32_bf16 v[32:35], v[80:83], v[40:43], v[32:35]
v_cvt_pk_bf16_f32 v16, v24, v25
v_cvt_pk_bf16_f32 v17, v26, v27
v_mfma_f32_16x16x32_bf16 v[36:39], v[104:107], v[40:43], v[36:39]
v_cvt_pk_bf16_f32 v18, v28, v29
v_cvt_pk_bf16_f32 v19, v30, v31
s_waitcnt lgkmcnt(4)
v_mfma_f32_16x16x32_bf16 v[32:35], v[84:87], v[44:47], v[32:35]
buffer_store_dwordx4 v[16:19], v1, s[4:7], s43 offen sc1
s_add_u32 s44, s44, 65536
v_mfma_f32_16x16x32_bf16 v[36:39], v[108:111], v[44:47], v[36:39]
s_lshr_b32 s43, s44, 8
s_and_b32 s43, s43, 0x2000
v_mfma_f32_16x16x32_bf16 v[24:27], v[64:67], v[128:131], 0
ds_read_b128 v[40:43], v5 offset:6144
s_xor_b32 s43, s43, s44
v_mfma_f32_16x16x32_bf16 v[28:31], v[88:91], v[128:131], 0
ds_read_b128 v[44:47], v5 offset:16384
v_mfma_f32_16x16x32_bf16 v[24:27], v[68:71], v[132:135], v[24:27]
v_mfma_f32_16x16x32_bf16 v[28:31], v[92:95], v[132:135], v[28:31]
v_mfma_f32_16x16x32_bf16 v[24:27], v[72:75], v[208:211], v[24:27]
v_mfma_f32_16x16x32_bf16 v[28:31], v[96:99], v[208:211], v[28:31]
v_mfma_f32_16x16x32_bf16 v[24:27], v[76:79], v[212:215], v[24:27]
v_mfma_f32_16x16x32_bf16 v[28:31], v[100:103], v[212:215], v[28:31]
s_waitcnt lgkmcnt(5)
v_mfma_f32_16x16x32_bf16 v[24:27], v[80:83], v[48:51], v[24:27]
v_cvt_pk_bf16_f32 v20, v32, v33
v_cvt_pk_bf16_f32 v21, v34, v35
v_mfma_f32_16x16x32_bf16 v[28:31], v[104:107], v[48:51], v[28:31]
v_cvt_pk_bf16_f32 v22, v36, v37
v_cvt_pk_bf16_f32 v23, v38, v39
s_waitcnt lgkmcnt(4)
v_mfma_f32_16x16x32_bf16 v[24:27], v[84:87], v[52:55], v[24:27]
buffer_store_dwordx4 v[20:23], v1, s[4:7], s43 offen sc1
s_add_u32 s44, s44, 65536
v_mfma_f32_16x16x32_bf16 v[28:31], v[108:111], v[52:55], v[28:31]
s_lshr_b32 s43, s44, 8
s_and_b32 s43, s43, 0x2000
v_mfma_f32_16x16x32_bf16 v[32:35], v[64:67], v[136:139], 0
ds_read_b128 v[48:51], v5 offset:7168
s_xor_b32 s43, s43, s44
v_mfma_f32_16x16x32_bf16 v[36:39], v[88:91], v[136:139], 0
ds_read_b128 v[52:55], v5 offset:17408
v_mfma_f32_16x16x32_bf16 v[32:35], v[68:71], v[140:143], v[32:35]
v_mfma_f32_16x16x32_bf16 v[36:39], v[92:95], v[140:143], v[36:39]
v_mfma_f32_16x16x32_bf16 v[32:35], v[72:75], v[216:219], v[32:35]
v_mfma_f32_16x16x32_bf16 v[36:39], v[96:99], v[216:219], v[36:39]
v_mfma_f32_16x16x32_bf16 v[32:35], v[76:79], v[220:223], v[32:35]
v_mfma_f32_16x16x32_bf16 v[36:39], v[100:103], v[220:223], v[36:39]
s_waitcnt lgkmcnt(5)
v_mfma_f32_16x16x32_bf16 v[32:35], v[80:83], v[56:59], v[32:35]
v_cvt_pk_bf16_f32 v16, v24, v25
v_cvt_pk_bf16_f32 v17, v26, v27
v_mfma_f32_16x16x32_bf16 v[36:39], v[104:107], v[56:59], v[36:39]
v_cvt_pk_bf16_f32 v18, v28, v29
v_cvt_pk_bf16_f32 v19, v30, v31
s_waitcnt lgkmcnt(4)
v_mfma_f32_16x16x32_bf16 v[32:35], v[84:87], v[60:63], v[32:35]
buffer_store_dwordx4 v[16:19], v1, s[4:7], s43 offen sc1
s_add_u32 s44, s44, 65536
v_mfma_f32_16x16x32_bf16 v[36:39], v[108:111], v[60:63], v[36:39]
s_lshr_b32 s43, s44, 8
s_and_b32 s43, s43, 0x2000
v_mfma_f32_16x16x32_bf16 v[24:27], v[64:67], v[144:147], 0
ds_read_b128 v[56:59], v5 offset:8192
s_xor_b32 s43, s43, s44
v_mfma_f32_16x16x32_bf16 v[28:31], v[88:91], v[144:147], 0
ds_read_b128 v[60:63], v5 offset:18432
v_mfma_f32_16x16x32_bf16 v[24:27], v[68:71], v[148:151], v[24:27]
v_mfma_f32_16x16x32_bf16 v[28:31], v[92:95], v[148:151], v[28:31]
v_mfma_f32_16x16x32_bf16 v[24:27], v[72:75], v[224:227], v[24:27]
v_mfma_f32_16x16x32_bf16 v[28:31], v[96:99], v[224:227], v[28:31]
v_mfma_f32_16x16x32_bf16 v[24:27], v[76:79], v[228:231], v[24:27]
v_mfma_f32_16x16x32_bf16 v[28:31], v[100:103], v[228:231], v[28:31]
s_waitcnt lgkmcnt(5)
v_mfma_f32_16x16x32_bf16 v[24:27], v[80:83], v[40:43], v[24:27]
v_cvt_pk_bf16_f32 v20, v32, v33
v_cvt_pk_bf16_f32 v21, v34, v35
v_mfma_f32_16x16x32_bf16 v[28:31], v[104:107], v[40:43], v[28:31]
v_cvt_pk_bf16_f32 v22, v36, v37
v_cvt_pk_bf16_f32 v23, v38, v39
s_waitcnt lgkmcnt(4)
v_mfma_f32_16x16x32_bf16 v[24:27], v[84:87], v[44:47], v[24:27]
buffer_store_dwordx4 v[20:23], v1, s[4:7], s43 offen sc1
s_add_u32 s44, s44, 65536
v_mfma_f32_16x16x32_bf16 v[28:31], v[108:111], v[44:47], v[28:31]
s_lshr_b32 s43, s44, 8
s_and_b32 s43, s43, 0x2000
v_mfma_f32_16x16x32_bf16 v[32:35], v[64:67], v[152:155], 0
ds_read_b128 v[40:43], v5 offset:9216
s_xor_b32 s43, s43, s44
v_mfma_f32_16x16x32_bf16 v[36:39], v[88:91], v[152:155], 0
ds_read_b128 v[44:47], v5 offset:19456
v_mfma_f32_16x16x32_bf16 v[32:35], v[68:71], v[156:159], v[32:35]
v_mfma_f32_16x16x32_bf16 v[36:39], v[92:95], v[156:159], v[36:39]
v_mfma_f32_16x16x32_bf16 v[32:35], v[72:75], v[232:235], v[32:35]
v_mfma_f32_16x16x32_bf16 v[36:39], v[96:99], v[232:235], v[36:39]
v_mfma_f32_16x16x32_bf16 v[32:35], v[76:79], v[236:239], v[32:35]
v_mfma_f32_16x16x32_bf16 v[36:39], v[100:103], v[236:239], v[36:39]
s_waitcnt lgkmcnt(5)
v_mfma_f32_16x16x32_bf16 v[32:35], v[80:83], v[48:51], v[32:35]
v_cvt_pk_bf16_f32 v16, v24, v25
v_cvt_pk_bf16_f32 v17, v26, v27
v_mfma_f32_16x16x32_bf16 v[36:39], v[104:107], v[48:51], v[36:39]
v_cvt_pk_bf16_f32 v18, v28, v29
v_cvt_pk_bf16_f32 v19, v30, v31
s_waitcnt lgkmcnt(4)
v_mfma_f32_16x16x32_bf16 v[32:35], v[84:87], v[52:55], v[32:35]
buffer_store_dwordx4 v[16:19], v1, s[4:7], s43 offen sc1
s_add_u32 s44, s44, 65536
v_mfma_f32_16x16x32_bf16 v[36:39], v[108:111], v[52:55], v[36:39]
s_lshr_b32 s43, s44, 8
s_and_b32 s43, s43, 0x2000
s_waitcnt vmcnt(8)
s_barrier
v_mfma_f32_16x16x32_bf16 v[24:27], v[64:67], v[160:163], 0
ds_read_b128 v[48:51], v4 offset:0
s_xor_b32 s43, s43, s44
v_mfma_f32_16x16x32_bf16 v[28:31], v[88:91], v[160:163], 0
ds_read_b128 v[52:55], v4 offset:20480
v_mfma_f32_16x16x32_bf16 v[24:27], v[68:71], v[164:167], v[24:27]
v_mfma_f32_16x16x32_bf16 v[28:31], v[92:95], v[164:167], v[28:31]
v_mfma_f32_16x16x32_bf16 v[24:27], v[72:75], v[240:243], v[24:27]
v_mfma_f32_16x16x32_bf16 v[28:31], v[96:99], v[240:243], v[28:31]
v_mfma_f32_16x16x32_bf16 v[24:27], v[76:79], v[244:247], v[24:27]
v_mfma_f32_16x16x32_bf16 v[28:31], v[100:103], v[244:247], v[28:31]
s_waitcnt lgkmcnt(5)
v_mfma_f32_16x16x32_bf16 v[24:27], v[80:83], v[56:59], v[24:27]
v_cvt_pk_bf16_f32 v20, v32, v33
v_cvt_pk_bf16_f32 v21, v34, v35
v_mfma_f32_16x16x32_bf16 v[28:31], v[104:107], v[56:59], v[28:31]
v_cvt_pk_bf16_f32 v22, v36, v37
v_cvt_pk_bf16_f32 v23, v38, v39
s_waitcnt lgkmcnt(4)
v_mfma_f32_16x16x32_bf16 v[24:27], v[84:87], v[60:63], v[24:27]
buffer_store_dwordx4 v[20:23], v1, s[4:7], s43 offen sc1
s_add_u32 s44, s44, 65536
v_mfma_f32_16x16x32_bf16 v[28:31], v[108:111], v[60:63], v[28:31]
s_lshr_b32 s43, s44, 8
s_and_b32 s43, s43, 0x2000
v_mfma_f32_16x16x32_bf16 v[32:35], v[64:67], v[168:171], 0
ds_read_b128 v[56:59], v8 offset:0
s_xor_b32 s43, s43, s44
v_mfma_f32_16x16x32_bf16 v[36:39], v[88:91], v[168:171], 0
ds_read_b128 v[60:63], v8 offset:20480
v_mfma_f32_16x16x32_bf16 v[32:35], v[68:71], v[172:175], v[32:35]
v_mfma_f32_16x16x32_bf16 v[36:39], v[92:95], v[172:175], v[36:39]
v_mfma_f32_16x16x32_bf16 v[32:35], v[72:75], v[248:251], v[32:35]
v_mfma_f32_16x16x32_bf16 v[36:39], v[96:99], v[248:251], v[36:39]
v_mfma_f32_16x16x32_bf16 v[32:35], v[76:79], v[252:255], v[32:35]
v_mfma_f32_16x16x32_bf16 v[36:39], v[100:103], v[252:255], v[36:39]
s_waitcnt lgkmcnt(5)
v_mfma_f32_16x16x32_bf16 v[32:35], v[80:83], v[40:43], v[32:35]
v_cvt_pk_bf16_f32 v16, v24, v25
v_cvt_pk_bf16_f32 v17, v26, v27
v_mfma_f32_16x16x32_bf16 v[36:39], v[104:107], v[40:43], v[36:39]
v_cvt_pk_bf16_f32 v18, v28, v29
v_cvt_pk_bf16_f32 v19, v30, v31
s_waitcnt lgkmcnt(4)
v_mfma_f32_16x16x32_bf16 v[32:35], v[84:87], v[44:47], v[32:35]
buffer_store_dwordx4 v[16:19], v1, s[4:7], s43 offen sc1
s_add_u32 s44, s44, 65536
v_mfma_f32_16x16x32_bf16 v[36:39], v[108:111], v[44:47], v[36:39]
s_lshr_b32 s43, s44, 8
s_and_b32 s43, s43, 0x2000
s_xor_b32 s43, s43, s44
s_nop 1
v_cvt_pk_bf16_f32 v20, v32, v33
v_cvt_pk_bf16_f32 v21, v34, v35
s_nop 0
v_cvt_pk_bf16_f32 v22, v36, v37
v_cvt_pk_bf16_f32 v23, v38, v39
buffer_store_dwordx4 v[20:23], v1, s[4:7], s43 offen sc1
s_add_u32 s40, s40, 1
s_add_u32 s39, s39, 2
s_cmp_le_u32 s40, 1
s_cselect_b32 s41, 1, 0
s_cmp_eq_u32 s40, 32
s_cselect_b32 s41, 1, s41
s_cmp_eq_u32 s41, 0
s_cbranch_scc1 xe_4
s_waitcnt vmcnt(0)
s_barrier
s_add_u32 s61, s57, s40
v_mov_b32 v14, s61
v_mov_b32 v15, 0
s_mov_b64 exec, 1
buffer_store_dword v14, v15, s[4:7], s34 offen sc1
s_mov_b64 exec, -1
xe_4:
s_cmp_lt_u32 s40, 32
s_cbranch_scc1 XVloop
s_waitcnt lgkmcnt(0)
s_waitcnt vmcnt(0)
s_branch L_T
L_A:
s_mov_b32 s12, s68
s_and_b32 s13, s69, 0xffff
s_mov_b32 s14, 0x780000
s_mov_b32 s15, 0x20000
s_mov_b32 s16, s70
s_and_b32 s17, s71, 0xffff
s_mov_b32 s18, 0x780000
s_mov_b32 s19, 0x20000
s_mul_i32 s29, s25, 384
s_mov_b32 s30, 0
s_mul_i32 s61, s24, 192
v_add_u32 v15, s61, v0
v_add_u32 v10, 0, v15
v_mul_u32_u24 v11, 43691, v10
v_lshrrev_b32 v11, 20, v11
v_mul_u32_u24 v13, 24, v11
v_sub_u32 v12, v10, v13
v_mul_u32_u24 v11, 12288, v11
v_lshlrev_b32 v12, 4, v12
v_add3_u32 v112, v11, v12, s29
v_add_u32 v10, 64, v15
v_mul_u32_u24 v11, 43691, v10
v_lshrrev_b32 v11, 20, v11
v_mul_u32_u24 v13, 24, v11
v_sub_u32 v12, v10, v13
v_mul_u32_u24 v11, 12288, v11
v_lshlrev_b32 v12, 4, v12
v_add3_u32 v113, v11, v12, s29
v_add_u32 v10, 128, v15
v_mul_u32_u24 v11, 43691, v10
v_lshrrev_b32 v11, 20, v11
v_mul_u32_u24 v13, 24, v11
v_sub_u32 v12, v10, v13
v_mul_u32_u24 v11, 12288, v11
v_lshlrev_b32 v12, 4, v12
v_add3_u32 v114, v11, v12, s29
s_mul_i32 s29, s24, 96
v_bfe_u32 v10, v0, 2, 1
v_lshl_add_u32 v10, v3, 2, v10
v_bfe_u32 v11, v0, 3, 1
v_mul_u32_u24 v11, 12288, v11
v_mul_u32_u24 v10, 384, v10
v_and_b32 v12, 3, v0
v_lshl_add_u32 v11, v12, 3, v11
v_add3_u32 v6, v10, v11, s29
v_add_u32 v7, 49152, v6
s_add_u32 s60, s30, 3932160
s_mul_i32 s61, s24, 3072
s_add_u32 s61, s61, 0
s_add_u32 m0, s61, 0
s_nop 0
buffer_load_dwordx4 v112, s[12:15], s60 offen lds
s_add_u32 m0, s61, 1024
s_nop 0
buffer_load_dwordx4 v113, s[12:15], s60 offen lds
s_add_u32 m0, s61, 2048
s_nop 0
buffer_load_dwordx4 v114, s[12:15], s60 offen lds
s_add_u32 s60, s30, 3932160
s_mul_i32 s61, s24, 3072
s_add_u32 s61, s61, 12288
s_add_u32 m0, s61, 0
s_nop 0
buffer_load_dwordx4 v112, s[16:19], s60 offen lds
s_add_u32 m0, s61, 1024
s_nop 0
buffer_load_dwordx4 v113, s[16:19], s60 offen lds
s_add_u32 m0, s61, 2048
s_nop 0
buffer_load_dwordx4 v114, s[16:19], s60 offen lds
s_add_u32 s60, s30, 4325376
s_mul_i32 s61, s24, 3072
s_add_u32 s61, s61, 24576
s_add_u32 m0, s61, 0
s_nop 0
buffer_load_dwordx4 v112, s[12:15], s60 offen lds
s_add_u32 m0, s61, 1024
s_nop 0
buffer_load_dwordx4 v113, s[12:15], s60 offen lds
s_add_u32 m0, s61, 2048
s_nop 0
buffer_load_dwordx4 v114, s[12:15], s60 offen lds
s_add_u32 s60, s30, 4325376
s_mul_i32 s61, s24, 3072
s_add_u32 s61, s61, 36864
s_add_u32 m0, s61, 0
s_nop 0
buffer_load_dwordx4 v112, s[16:19], s60 offen lds
s_add_u32 m0, s61, 1024
s_nop 0
buffer_load_dwordx4 v113, s[16:19], s60 offen lds
s_add_u32 m0, s61, 2048
s_nop 0
buffer_load_dwordx4 v114, s[16:19], s60 offen lds
s_add_u32 s60, s30, 4718592
s_mul_i32 s61, s24, 3072
s_add_u32 s61, s61, 49152
s_add_u32 m0, s61, 0
s_nop 0
buffer_load_dwordx4 v112, s[12:15], s60 offen lds
s_add_u32 m0, s61, 1024
s_nop 0
buffer_load_dwordx4 v113, s[12:15], s60 offen lds
s_add_u32 m0, s61, 2048
s_nop 0
buffer_load_dwordx4 v114, s[12:15], s60 offen lds
s_add_u32 s60, s30, 4718592
s_mul_i32 s61, s24, 3072
s_add_u32 s61, s61, 61440
s_add_u32 m0, s61, 0
s_nop 0
buffer_load_dwordx4 v112, s[16:19], s60 offen lds
s_add_u32 m0, s61, 1024
s_nop 0
buffer_load_dwordx4 v113, s[16:19], s60 offen lds
s_add_u32 m0, s61, 2048
s_nop 0
buffer_load_dwordx4 v114, s[16:19], s60 offen lds
s_add_u32 s60, s30, 5111808
s_mul_i32 s61, s24, 3072
s_add_u32 s61, s61, 73728
s_add_u32 m0, s61, 0
s_nop 0
buffer_load_dwordx4 v112, s[12:15], s60 offen lds
s_add_u32 m0, s61, 1024
s_nop 0
buffer_load_dwordx4 v113, s[12:15], s60 offen lds
s_add_u32 m0, s61, 2048
s_nop 0
buffer_load_dwordx4 v114, s[12:15], s60 offen lds
s_add_u32 s60, s30, 5111808
s_mul_i32 s61, s24, 3072
s_add_u32 s61, s61, 86016
s_add_u32 m0, s61, 0
s_nop 0
buffer_load_dwordx4 v112, s[16:19], s60 offen lds
s_add_u32 m0, s61, 1024
s_nop 0
buffer_load_dwordx4 v113, s[16:19], s60 offen lds
s_add_u32 m0, s61, 2048
s_nop 0
buffer_load_dwordx4 v114, s[16:19], s60 offen lds
s_waitcnt vmcnt(18)
s_barrier
ds_read_b64_tr_b16 a[240:241], v6 offset:0
ds_read_b64_tr_b16 a[242:243], v6 offset:768
ds_read_b64_tr_b16 a[244:245], v6 offset:6144
ds_read_b64_tr_b16 a[246:247], v6 offset:6912
ds_read_b64_tr_b16 a[248:249], v6 offset:32
ds_read_b64_tr_b16 a[250:251], v6 offset:800
ds_read_b64_tr_b16 a[252:253], v6 offset:6176
ds_read_b64_tr_b16 a[254:255], v6 offset:6944
ds_read_b64_tr_b16 v[128:129], v6 offset:64
ds_read_b64_tr_b16 v[130:131], v6 offset:832
ds_read_b64_tr_b16 v[132:133], v6 offset:6208
ds_read_b64_tr_b16 v[134:135], v6 offset:6976
s_waitcnt lgkmcnt(0)
s_waitcnt vmcnt(12)
s_barrier
s_add_u32 s60, s30, 5505024
s_mul_i32 s61, s24, 3072
s_add_u32 s61, s61, 0
s_add_u32 m0, s61, 0
s_nop 0
buffer_load_dwordx4 v112, s[12:15], s60 offen lds
s_add_u32 m0, s61, 1024
s_nop 0
buffer_load_dwordx4 v113, s[12:15], s60 offen lds
s_add_u32 m0, s61, 2048
s_nop 0
buffer_load_dwordx4 v114, s[12:15], s60 offen lds
s_add_u32 s60, s30, 5505024
s_mul_i32 s61, s24, 3072
s_add_u32 s61, s61, 12288
s_add_u32 m0, s61, 0
s_nop 0
buffer_load_dwordx4 v112, s[16:19], s60 offen lds
s_add_u32 m0, s61, 1024
s_nop 0
buffer_load_dwordx4 v113, s[16:19], s60 offen lds
s_add_u32 m0, s61, 2048
s_nop 0
buffer_load_dwordx4 v114, s[16:19], s60 offen lds
ds_read_b64_tr_b16 v[136:137], v6 offset:24576
ds_read_b64_tr_b16 v[138:139], v6 offset:25344
ds_read_b64_tr_b16 v[140:141], v6 offset:30720
ds_read_b64_tr_b16 v[142:143], v6 offset:31488
ds_read_b64_tr_b16 v[144:145], v6 offset:24608
ds_read_b64_tr_b16 v[146:147], v6 offset:25376
ds_read_b64_tr_b16 v[148:149], v6 offset:30752
ds_read_b64_tr_b16 v[150:151], v6 offset:31520
ds_read_b64_tr_b16 v[152:153], v6 offset:24640
ds_read_b64_tr_b16 v[154:155], v6 offset:25408
ds_read_b64_tr_b16 v[156:157], v6 offset:30784
ds_read_b64_tr_b16 v[158:159], v6 offset:31552
s_waitcnt lgkmcnt(0)
s_waitcnt vmcnt(12)
s_barrier
s_add_u32 s60, s30, 5898240
s_mul_i32 s61, s24, 3072
s_add_u32 s61, s61, 24576
s_add_u32 m0, s61, 0
s_nop 0
buffer_load_dwordx4 v112, s[12:15], s60 offen lds
s_add_u32 m0, s61, 1024
s_nop 0
buffer_load_dwordx4 v113, s[12:15], s60 offen lds
s_add_u32 m0, s61, 2048
s_nop 0
buffer_load_dwordx4 v114, s[12:15], s60 offen lds
s_add_u32 s60, s30, 5898240
s_mul_i32 s61, s24, 3072
s_add_u32 s61, s61, 36864
s_add_u32 m0, s61, 0
s_nop 0
buffer_load_dwordx4 v112, s[16:19], s60 offen lds
s_add_u32 m0, s61, 1024
s_nop 0
buffer_load_dwordx4 v113, s[16:19], s60 offen lds
s_add_u32 m0, s61, 2048
s_nop 0
buffer_load_dwordx4 v114, s[16:19], s60 offen lds
ds_read_b64_tr_b16 v[160:161], v7 offset:0
ds_read_b64_tr_b16 v[162:163], v7 offset:768
ds_read_b64_tr_b16 v[164:165], v7 offset:6144
ds_read_b64_tr_b16 v[166:167], v7 offset:6912
ds_read_b64_tr_b16 v[168:169], v7 offset:32
ds_read_b64_tr_b16 v[170:171], v7 offset:800
ds_read_b64_tr_b16 v[172:173], v7 offset:6176
ds_read_b64_tr_b16 v[174:175], v7 offset:6944
ds_read_b64_tr_b16 v[176:177], v7 offset:64
ds_read_b64_tr_b16 v[178:179], v7 offset:832
ds_read_b64_tr_b16 v[180:181], v7 offset:6208
ds_read_b64_tr_b16 v[182:183], v7 offset:6976
s_waitcnt lgkmcnt(0)
s_waitcnt vmcnt(12)
s_barrier
s_add_u32 s60, s30, 6291456
s_mul_i32 s61, s24, 3072
s_add_u32 s61, s61, 49152
s_add_u32 m0, s61, 0
s_nop 0
buffer_load_dwordx4 v112, s[12:15], s60 offen lds
s_add_u32 m0, s61, 1024
s_nop 0
buffer_load_dwordx4 v113, s[12:15], s60 offen lds
s_add_u32 m0, s61, 2048
s_nop 0
buffer_load_dwordx4 v114, s[12:15], s60 offen lds
s_add_u32 s60, s30, 6291456
s_mul_i32 s61, s24, 3072
s_add_u32 s61, s61, 61440
s_add_u32 m0, s61, 0
s_nop 0
buffer_load_dwordx4 v112, s[16:19], s60 offen lds
s_add_u32 m0, s61, 1024
s_nop 0
buffer_load_dwordx4 v113, s[16:19], s60 offen lds
s_add_u32 m0, s61, 2048
s_nop 0
buffer_load_dwordx4 v114, s[16:19], s60 offen lds
ds_read_b64_tr_b16 v[184:185], v7 offset:24576
ds_read_b64_tr_b16 v[186:187], v7 offset:25344
ds_read_b64_tr_b16 v[188:189], v7 offset:30720
ds_read_b64_tr_b16 v[190:191], v7 offset:31488
ds_read_b64_tr_b16 v[192:193], v7 offset:24608
ds_read_b64_tr_b16 v[194:195], v7 offset:25376
ds_read_b64_tr_b16 v[196:197], v7 offset:30752
ds_read_b64_tr_b16 v[198:199], v7 offset:31520
ds_read_b64_tr_b16 v[200:201], v7 offset:24640
ds_read_b64_tr_b16 v[202:203], v7 offset:25408
ds_read_b64_tr_b16 v[204:205], v7 offset:30784
ds_read_b64_tr_b16 v[206:207], v7 offset:31552
s_waitcnt lgkmcnt(0)
s_waitcnt vmcnt(12)
s_barrier
s_add_u32 s60, s30, 6684672
s_mul_i32 s61, s24, 3072
s_add_u32 s61, s61, 73728
s_add_u32 m0, s61, 0
s_nop 0
buffer_load_dwordx4 v112, s[12:15], s60 offen lds
s_add_u32 m0, s61, 1024
s_nop 0
buffer_load_dwordx4 v113, s[12:15], s60 offen lds
s_add_u32 m0, s61, 2048
s_nop 0
buffer_load_dwordx4 v114, s[12:15], s60 offen lds
s_add_u32 s60, s30, 6684672
s_mul_i32 s61, s24, 3072
s_add_u32 s61, s61, 86016
s_add_u32 m0, s61, 0
s_nop 0
buffer_load_dwordx4 v112, s[16:19], s60 offen lds
s_add_u32 m0, s61, 1024
s_nop 0
buffer_load_dwordx4 v113, s[16:19], s60 offen lds
s_add_u32 m0, s61, 2048
s_nop 0
buffer_load_dwordx4 v114, s[16:19], s60 offen lds
ds_read_b64_tr_b16 v[208:209], v6 offset:0
ds_read_b64_tr_b16 v[210:211], v6 offset:768
ds_read_b64_tr_b16 v[212:213], v6 offset:6144
ds_read_b64_tr_b16 v[214:215], v6 offset:6912
ds_read_b64_tr_b16 v[216:217], v6 offset:32
ds_read_b64_tr_b16 v[218:219], v6 offset:800
ds_read_b64_tr_b16 v[220:221], v6 offset:6176
ds_read_b64_tr_b16 v[222:223], v6 offset:6944
ds_read_b64_tr_b16 v[224:225], v6 offset:64
ds_read_b64_tr_b16 v[226:227], v6 offset:832
ds_read_b64_tr_b16 v[228:229], v6 offset:6208
ds_read_b64_tr_b16 v[230:231], v6 offset:6976
s_waitcnt lgkmcnt(0)
s_waitcnt vmcnt(12)
s_barrier
s_add_u32 s60, s30, 7077888
s_mul_i32 s61, s24, 3072
s_add_u32 s61, s61, 0
s_add_u32 m0, s61, 0
s_nop 0
buffer_load_dwordx4 v112, s[12:15], s60 offen lds
s_add_u32 m0, s61, 1024
s_nop 0
buffer_load_dwordx4 v113, s[12:15], s60 offen lds
s_add_u32 m0, s61, 2048
s_nop 0
buffer_load_dwordx4 v114, s[12:15], s60 offen lds
s_add_u32 s60, s30, 7077888
s_mul_i32 s61, s24, 3072
s_add_u32 s61, s61, 12288
s_add_u32 m0, s61, 0
s_nop 0
buffer_load_dwordx4 v112, s[16:19], s60 offen lds
s_add_u32 m0, s61, 1024
s_nop 0
buffer_load_dwordx4 v113, s[16:19], s60 offen lds
s_add_u32 m0, s61, 2048
s_nop 0
buffer_load_dwordx4 v114, s[16:19], s60 offen lds
ds_read_b64_tr_b16 v[232:233], v6 offset:24576
ds_read_b64_tr_b16 v[234:235], v6 offset:25344
ds_read_b64_tr_b16 v[236:237], v6 offset:30720
ds_read_b64_tr_b16 v[238:239], v6 offset:31488
ds_read_b64_tr_b16 v[240:241], v6 offset:24608
ds_read_b64_tr_b16 v[242:243], v6 offset:25376
ds_read_b64_tr_b16 v[244:245], v6 offset:30752
ds_read_b64_tr_b16 v[246:247], v6 offset:31520
ds_read_b64_tr_b16 v[248:249], v6 offset:24640
ds_read_b64_tr_b16 v[250:251], v6 offset:25408
ds_read_b64_tr_b16 v[252:253], v6 offset:30784
ds_read_b64_tr_b16 v[254:255], v6 offset:31552
s_waitcnt lgkmcnt(0)
s_waitcnt vmcnt(12)
s_barrier
s_add_u32 s60, s30, 7471104
s_mul_i32 s61, s24, 3072
s_add_u32 s61, s61, 24576
s_add_u32 m0, s61, 0
s_nop 0
buffer_load_dwordx4 v112, s[12:15], s60 offen lds
s_add_u32 m0, s61, 1024
s_nop 0
buffer_load_dwordx4 v113, s[12:15], s60 offen lds
s_add_u32 m0, s61, 2048
s_nop 0
buffer_load_dwordx4 v114, s[12:15], s60 offen lds
s_add_u32 s60, s30, 7471104
s_mul_i32 s61, s24, 3072
s_add_u32 s61, s61, 36864
s_add_u32 m0, s61, 0
s_nop 0
buffer_load_dwordx4 v112, s[16:19], s60 offen lds
s_add_u32 m0, s61, 1024
s_nop 0
buffer_load_dwordx4 v113, s[16:19], s60 offen lds
s_add_u32 m0, s61, 2048
s_nop 0
buffer_load_dwordx4 v114, s[16:19], s60 offen lds
ds_read_b64_tr_b16 v[16:17], v7 offset:0
ds_read_b64_tr_b16 v[18:19], v7 offset:768
ds_read_b64_tr_b16 v[20:21], v7 offset:6144
ds_read_b64_tr_b16 v[22:23], v7 offset:6912
ds_read_b64_tr_b16 v[24:25], v7 offset:32
ds_read_b64_tr_b16 v[26:27], v7 offset:800
ds_read_b64_tr_b16 v[28:29], v7 offset:6176
ds_read_b64_tr_b16 v[30:31], v7 offset:6944
ds_read_b64_tr_b16 v[32:33], v7 offset:64
ds_read_b64_tr_b16 v[34:35], v7 offset:832
ds_read_b64_tr_b16 v[36:37], v7 offset:6208
ds_read_b64_tr_b16 v[38:39], v7 offset:6976
s_waitcnt lgkmcnt(0)
s_waitcnt vmcnt(12)
s_barrier
s_add_u32 s60, s30, 0
s_mul_i32 s61, s24, 3072
s_add_u32 s61, s61, 49152
s_add_u32 m0, s61, 0
s_nop 0
buffer_load_dwordx4 v112, s[12:15], s60 offen lds
s_add_u32 m0, s61, 1024
s_nop 0
buffer_load_dwordx4 v113, s[12:15], s60 offen lds
s_add_u32 m0, s61, 2048
s_nop 0
buffer_load_dwordx4 v114, s[12:15], s60 offen lds
s_add_u32 s60, s30, 0
s_mul_i32 s61, s24, 3072
s_add_u32 s61, s61, 61440
s_add_u32 m0, s61, 0
s_nop 0
buffer_load_dwordx4 v112, s[16:19], s60 offen lds
s_add_u32 m0, s61, 1024
s_nop 0
buffer_load_dwordx4 v113, s[16:19], s60 offen lds
s_add_u32 m0, s61, 2048
s_nop 0
buffer_load_dwordx4 v114, s[16:19], s60 offen lds
ds_read_b64_tr_b16 v[40:41], v7 offset:24576
ds_read_b64_tr_b16 v[42:43], v7 offset:25344
ds_read_b64_tr_b16 v[44:45], v7 offset:30720
ds_read_b64_tr_b16 v[46:47], v7 offset:31488
ds_read_b64_tr_b16 v[48:49], v7 offset:24608
ds_read_b64_tr_b16 v[50:51], v7 offset:25376
ds_read_b64_tr_b16 v[52:53], v7 offset:30752
ds_read_b64_tr_b16 v[54:55], v7 offset:31520
ds_read_b64_tr_b16 v[56:57], v7 offset:24640
ds_read_b64_tr_b16 v[58:59], v7 offset:25408
ds_read_b64_tr_b16 v[60:61], v7 offset:30784
ds_read_b64_tr_b16 v[62:63], v7 offset:31552
s_waitcnt lgkmcnt(0)
s_waitcnt vmcnt(12)
s_barrier
s_add_u32 s60, s30, 393216
s_mul_i32 s61, s24, 3072
s_add_u32 s61, s61, 73728
s_add_u32 m0, s61, 0
s_nop 0
buffer_load_dwordx4 v112, s[12:15], s60 offen lds
s_add_u32 m0, s61, 1024
s_nop 0
buffer_load_dwordx4 v113, s[12:15], s60 offen lds
s_add_u32 m0, s61, 2048
s_nop 0
buffer_load_dwordx4 v114, s[12:15], s60 offen lds
s_add_u32 s60, s30, 393216
s_mul_i32 s61, s24, 3072
s_add_u32 s61, s61, 86016
s_add_u32 m0, s61, 0
s_nop 0
buffer_load_dwordx4 v112, s[16:19], s60 offen lds
s_add_u32 m0, s61, 1024
s_nop 0
buffer_load_dwordx4 v113, s[16:19], s60 offen lds
s_add_u32 m0, s61, 2048
s_nop 0
buffer_load_dwordx4 v114, s[16:19], s60 offen lds
ds_read_b64_tr_b16 v[64:65], v6 offset:0
ds_read_b64_tr_b16 v[66:67], v6 offset:768
ds_read_b64_tr_b16 v[68:69], v6 offset:6144
ds_read_b64_tr_b16 v[70:71], v6 offset:6912
ds_read_b64_tr_b16 v[72:73], v6 offset:32
ds_read_b64_tr_b16 v[74:75], v6 offset:800
ds_read_b64_tr_b16 v[76:77], v6 offset:6176
ds_read_b64_tr_b16 v[78:79], v6 offset:6944
ds_read_b64_tr_b16 v[80:81], v6 offset:64
ds_read_b64_tr_b16 v[82:83], v6 offset:832
ds_read_b64_tr_b16 v[84:85], v6 offset:6208
ds_read_b64_tr_b16 v[86:87], v6 offset:6976
s_waitcnt lgkmcnt(0)
s_waitcnt vmcnt(12)
s_barrier
s_add_u32 s60, s30, 786432
s_mul_i32 s61, s24, 3072
s_add_u32 s61, s61, 0
s_add_u32 m0, s61, 0
s_nop 0
buffer_load_dwordx4 v112, s[12:15], s60 offen lds
s_add_u32 m0, s61, 1024
s_nop 0
buffer_load_dwordx4 v113, s[12:15], s60 offen lds
s_add_u32 m0, s61, 2048
s_nop 0
buffer_load_dwordx4 v114, s[12:15], s60 offen lds
s_add_u32 s60, s30, 786432
s_mul_i32 s61, s24, 3072
s_add_u32 s61, s61, 12288
s_add_u32 m0, s61, 0
s_nop 0
buffer_load_dwordx4 v112, s[16:19], s60 offen lds
s_add_u32 m0, s61, 1024
s_nop 0
buffer_load_dwordx4 v113, s[16:19], s60 offen lds
s_add_u32 m0, s61, 2048
s_nop 0
buffer_load_dwordx4 v114, s[16:19], s60 offen lds
ds_read_b64_tr_b16 v[88:89], v6 offset:24576
ds_read_b64_tr_b16 v[90:91], v6 offset:25344
ds_read_b64_tr_b16 v[92:93], v6 offset:30720
ds_read_b64_tr_b16 v[94:95], v6 offset:31488
ds_read_b64_tr_b16 v[96:97], v6 offset:24608
ds_read_b64_tr_b16 v[98:99], v6 offset:25376
ds_read_b64_tr_b16 v[100:101], v6 offset:30752
ds_read_b64_tr_b16 v[102:103], v6 offset:31520
ds_read_b64_tr_b16 v[104:105], v6 offset:24640
ds_read_b64_tr_b16 v[106:107], v6 offset:25408
ds_read_b64_tr_b16 v[108:109], v6 offset:30784
ds_read_b64_tr_b16 v[110:111], v6 offset:31552
s_waitcnt lgkmcnt(0)
s_waitcnt vmcnt(12)
s_barrier
s_add_u32 s60, s30, 1179648
s_mul_i32 s61, s24, 3072
s_add_u32 s61, s61, 24576
s_add_u32 m0, s61, 0
s_nop 0
buffer_load_dwordx4 v112, s[12:15], s60 offen lds
s_add_u32 m0, s61, 1024
s_nop 0
buffer_load_dwordx4 v113, s[12:15], s60 offen lds
s_add_u32 m0, s61, 2048
s_nop 0
buffer_load_dwordx4 v114, s[12:15], s60 offen lds
s_add_u32 s60, s30, 1179648
s_mul_i32 s61, s24, 3072
s_add_u32 s61, s61, 36864
s_add_u32 m0, s61, 0
s_nop 0
buffer_load_dwordx4 v112, s[16:19], s60 offen lds
s_add_u32 m0, s61, 1024
s_nop 0
buffer_load_dwordx4 v113, s[16:19], s60 offen lds
s_add_u32 m0, s61, 2048
s_nop 0
buffer_load_dwordx4 v114, s[16:19], s60 offen lds
ds_read_b64_tr_b16 a[0:1], v7 offset:0
ds_read_b64_tr_b16 a[2:3], v7 offset:768
ds_read_b64_tr_b16 a[4:5], v7 offset:6144
ds_read_b64_tr_b16 a[6:7], v7 offset:6912
ds_read_b64_tr_b16 a[8:9], v7 offset:32
ds_read_b64_tr_b16 a[10:11], v7 offset:800
ds_read_b64_tr_b16 a[12:13], v7 offset:6176
ds_read_b64_tr_b16 a[14:15], v7 offset:6944
ds_read_b64_tr_b16 a[16:17], v7 offset:64
ds_read_b64_tr_b16 a[18:19], v7 offset:832
ds_read_b64_tr_b16 a[20:21], v7 offset:6208
ds_read_b64_tr_b16 a[22:23], v7 offset:6976
s_waitcnt lgkmcnt(0)
s_waitcnt vmcnt(12)
s_barrier
s_add_u32 s60, s30, 1572864
s_mul_i32 s61, s24, 3072
s_add_u32 s61, s61, 49152
s_add_u32 m0, s61, 0
s_nop 0
buffer_load_dwordx4 v112, s[12:15], s60 offen lds
s_add_u32 m0, s61, 1024
s_nop 0
buffer_load_dwordx4 v113, s[12:15], s60 offen lds
s_add_u32 m0, s61, 2048
s_nop 0
buffer_load_dwordx4 v114, s[12:15], s60 offen lds
s_add_u32 s60, s30, 1572864
s_mul_i32 s61, s24, 3072
s_add_u32 s61, s61, 61440
s_add_u32 m0, s61, 0
s_nop 0
buffer_load_dwordx4 v112, s[16:19], s60 offen lds
s_add_u32 m0, s61, 1024
s_nop 0
buffer_load_dwordx4 v113, s[16:19], s60 offen lds
s_add_u32 m0, s61, 2048
s_nop 0
buffer_load_dwordx4 v114, s[16:19], s60 offen lds
ds_read_b64_tr_b16 a[24:25], v7 offset:24576
ds_read_b64_tr_b16 a[26:27], v7 offset:25344
ds_read_b64_tr_b16 a[28:29], v7 offset:30720
ds_read_b64_tr_b16 a[30:31], v7 offset:31488
ds_read_b64_tr_b16 a[32:33], v7 offset:24608
ds_read_b64_tr_b16 a[34:35], v7 offset:25376
ds_read_b64_tr_b16 a[36:37], v7 offset:30752
ds_read_b64_tr_b16 a[38:39], v7 offset:31520
ds_read_b64_tr_b16 a[40:41], v7 offset:24640
ds_read_b64_tr_b16 a[42:43], v7 offset:25408
ds_read_b64_tr_b16 a[44:45], v7 offset:30784
ds_read_b64_tr_b16 a[46:47], v7 offset:31552
s_waitcnt lgkmcnt(0)
s_waitcnt vmcnt(12)
s_barrier
s_add_u32 s60, s30, 1966080
s_mul_i32 s61, s24, 3072
s_add_u32 s61, s61, 73728
s_add_u32 m0, s61, 0
s_nop 0
buffer_load_dwordx4 v112, s[12:15], s60 offen lds
s_add_u32 m0, s61, 1024
s_nop 0
buffer_load_dwordx4 v113, s[12:15], s60 offen lds
s_add_u32 m0, s61, 2048
s_nop 0
buffer_load_dwordx4 v114, s[12:15], s60 offen lds
s_add_u32 s60, s30, 1966080
s_mul_i32 s61, s24, 3072
s_add_u32 s61, s61, 86016
s_add_u32 m0, s61, 0
s_nop 0
buffer_load_dwordx4 v112, s[16:19], s60 offen lds
s_add_u32 m0, s61, 1024
s_nop 0
buffer_load_dwordx4 v113, s[16:19], s60 offen lds
s_add_u32 m0, s61, 2048
s_nop 0
buffer_load_dwordx4 v114, s[16:19], s60 offen lds
ds_read_b64_tr_b16 a[48:49], v6 offset:0
ds_read_b64_tr_b16 a[50:51], v6 offset:768
ds_read_b64_tr_b16 a[52:53], v6 offset:6144
ds_read_b64_tr_b16 a[54:55], v6 offset:6912
ds_read_b64_tr_b16 a[56:57], v6 offset:32
ds_read_b64_tr_b16 a[58:59], v6 offset:800
ds_read_b64_tr_b16 a[60:61], v6 offset:6176
ds_read_b64_tr_b16 a[62:63], v6 offset:6944
ds_read_b64_tr_b16 a[64:65], v6 offset:64
ds_read_b64_tr_b16 a[66:67], v6 offset:832
ds_read_b64_tr_b16 a[68:69], v6 offset:6208
ds_read_b64_tr_b16 a[70:71], v6 offset:6976
s_waitcnt lgkmcnt(0)
s_waitcnt vmcnt(12)
s_barrier
s_add_u32 s60, s30, 2359296
s_mul_i32 s61, s24, 3072
s_add_u32 s61, s61, 0
s_add_u32 m0, s61, 0
s_nop 0
buffer_load_dwordx4 v112, s[12:15], s60 offen lds
s_add_u32 m0, s61, 1024
s_nop 0
buffer_load_dwordx4 v113, s[12:15], s60 offen lds
s_add_u32 m0, s61, 2048
s_nop 0
buffer_load_dwordx4 v114, s[12:15], s60 offen lds
s_add_u32 s60, s30, 2359296
s_mul_i32 s61, s24, 3072
s_add_u32 s61, s61, 12288
s_add_u32 m0, s61, 0
s_nop 0
buffer_load_dwordx4 v112, s[16:19], s60 offen lds
s_add_u32 m0, s61, 1024
s_nop 0
buffer_load_dwordx4 v113, s[16:19], s60 offen lds
s_add_u32 m0, s61, 2048
s_nop 0
buffer_load_dwordx4 v114, s[16:19], s60 offen lds
ds_read_b64_tr_b16 a[72:73], v6 offset:24576
ds_read_b64_tr_b16 a[74:75], v6 offset:25344
ds_read_b64_tr_b16 a[76:77], v6 offset:30720
ds_read_b64_tr_b16 a[78:79], v6 offset:31488
ds_read_b64_tr_b16 a[80:81], v6 offset:24608
ds_read_b64_tr_b16 a[82:83], v6 offset:25376
ds_read_b64_tr_b16 a[84:85], v6 offset:30752
ds_read_b64_tr_b16 a[86:87], v6 offset:31520
ds_read_b64_tr_b16 a[88:89], v6 offset:24640
ds_read_b64_tr_b16 a[90:91], v6 offset:25408
ds_read_b64_tr_b16 a[92:93], v6 offset:30784
ds_read_b64_tr_b16 a[94:95], v6 offset:31552
s_waitcnt lgkmcnt(0)
s_waitcnt vmcnt(12)
s_barrier
s_add_u32 s60, s30, 2752512
s_mul_i32 s61, s24, 3072
s_add_u32 s61, s61, 24576
s_add_u32 m0, s61, 0
s_nop 0
buffer_load_dwordx4 v112, s[12:15], s60 offen lds
s_add_u32 m0, s61, 1024
s_nop 0
buffer_load_dwordx4 v113, s[12:15], s60 offen lds
s_add_u32 m0, s61, 2048
s_nop 0
buffer_load_dwordx4 v114, s[12:15], s60 offen lds
s_add_u32 s60, s30, 2752512
s_mul_i32 s61, s24, 3072
s_add_u32 s61, s61, 36864
s_add_u32 m0, s61, 0
s_nop 0
buffer_load_dwordx4 v112, s[16:19], s60 offen lds
s_add_u32 m0, s61, 1024
s_nop 0
buffer_load_dwordx4 v113, s[16:19], s60 offen lds
s_add_u32 m0, s61, 2048
s_nop 0
buffer_load_dwordx4 v114, s[16:19], s60 offen lds
ds_read_b64_tr_b16 a[96:97], v7 offset:0
ds_read_b64_tr_b16 a[98:99], v7 offset:768
ds_read_b64_tr_b16 a[100:101], v7 offset:6144
ds_read_b64_tr_b16 a[102:103], v7 offset:6912
ds_read_b64_tr_b16 a[104:105], v7 offset:32
ds_read_b64_tr_b16 a[106:107], v7 offset:800
ds_read_b64_tr_b16 a[108:109], v7 offset:6176
ds_read_b64_tr_b16 a[110:111], v7 offset:6944
ds_read_b64_tr_b16 a[112:113], v7 offset:64
ds_read_b64_tr_b16 a[114:115], v7 offset:832
ds_read_b64_tr_b16 a[116:117], v7 offset:6208
ds_read_b64_tr_b16 a[118:119], v7 offset:6976
s_waitcnt lgkmcnt(0)
s_waitcnt vmcnt(12)
s_barrier
s_add_u32 s60, s30, 3145728
s_mul_i32 s61, s24, 3072
s_add_u32 s61, s61, 49152
s_add_u32 m0, s61, 0
s_nop 0
buffer_load_dwordx4 v112, s[12:15], s60 offen lds
s_add_u32 m0, s61, 1024
s_nop 0
buffer_load_dwordx4 v113, s[12:15], s60 offen lds
s_add_u32 m0, s61, 2048
s_nop 0
buffer_load_dwordx4 v114, s[12:15], s60 offen lds
s_add_u32 s60, s30, 3145728
s_mul_i32 s61, s24, 3072
s_add_u32 s61, s61, 61440
s_add_u32 m0, s61, 0
s_nop 0
buffer_load_dwordx4 v112, s[16:19], s60 offen lds
s_add_u32 m0, s61, 1024
s_nop 0
buffer_load_dwordx4 v113, s[16:19], s60 offen lds
s_add_u32 m0, s61, 2048
s_nop 0
buffer_load_dwordx4 v114, s[16:19], s60 offen lds
ds_read_b64_tr_b16 a[120:121], v7 offset:24576
ds_read_b64_tr_b16 a[122:123], v7 offset:25344
ds_read_b64_tr_b16 a[124:125], v7 offset:30720
ds_read_b64_tr_b16 a[126:127], v7 offset:31488
ds_read_b64_tr_b16 a[128:129], v7 offset:24608
ds_read_b64_tr_b16 a[130:131], v7 offset:25376
ds_read_b64_tr_b16 a[132:133], v7 offset:30752
ds_read_b64_tr_b16 a[134:135], v7 offset:31520
ds_read_b64_tr_b16 a[136:137], v7 offset:24640
ds_read_b64_tr_b16 a[138:139], v7 offset:25408
ds_read_b64_tr_b16 a[140:141], v7 offset:30784
ds_read_b64_tr_b16 a[142:143], v7 offset:31552
s_waitcnt lgkmcnt(0)
s_waitcnt vmcnt(12)
s_barrier
s_add_u32 s60, s30, 3538944
s_mul_i32 s61, s24, 3072
s_add_u32 s61, s61, 73728
s_add_u32 m0, s61, 0
s_nop 0
buffer_load_dwordx4 v112, s[12:15], s60 offen lds
s_add_u32 m0, s61, 1024
s_nop 0
buffer_load_dwordx4 v113, s[12:15], s60 offen lds
s_add_u32 m0, s61, 2048
s_nop 0
buffer_load_dwordx4 v114, s[12:15], s60 offen lds
s_add_u32 s60, s30, 3538944
s_mul_i32 s61, s24, 3072
s_add_u32 s61, s61, 86016
s_add_u32 m0, s61, 0
s_nop 0
buffer_load_dwordx4 v112, s[16:19], s60 offen lds
s_add_u32 m0, s61, 1024
s_nop 0
buffer_load_dwordx4 v113, s[16:19], s60 offen lds
s_add_u32 m0, s61, 2048
s_nop 0
buffer_load_dwordx4 v114, s[16:19], s60 offen lds
ds_read_b64_tr_b16 a[144:145], v6 offset:0
ds_read_b64_tr_b16 a[146:147], v6 offset:768
ds_read_b64_tr_b16 a[148:149], v6 offset:6144
ds_read_b64_tr_b16 a[150:151], v6 offset:6912
ds_read_b64_tr_b16 a[152:153], v6 offset:32
ds_read_b64_tr_b16 a[154:155], v6 offset:800
ds_read_b64_tr_b16 a[156:157], v6 offset:6176
ds_read_b64_tr_b16 a[158:159], v6 offset:6944
ds_read_b64_tr_b16 a[160:161], v6 offset:64
ds_read_b64_tr_b16 a[162:163], v6 offset:832
ds_read_b64_tr_b16 a[164:165], v6 offset:6208
ds_read_b64_tr_b16 a[166:167], v6 offset:6976
s_waitcnt lgkmcnt(0)
s_waitcnt vmcnt(12)
s_barrier
ds_read_b64_tr_b16 a[168:169], v6 offset:24576
ds_read_b64_tr_b16 a[170:171], v6 offset:25344
ds_read_b64_tr_b16 a[172:173], v6 offset:30720
ds_read_b64_tr_b16 a[174:175], v6 offset:31488
ds_read_b64_tr_b16 a[176:177], v6 offset:24608
ds_read_b64_tr_b16 a[178:179], v6 offset:25376
ds_read_b64_tr_b16 a[180:181], v6 offset:30752
ds_read_b64_tr_b16 a[182:183], v6 offset:31520
ds_read_b64_tr_b16 a[184:185], v6 offset:24640
ds_read_b64_tr_b16 a[186:187], v6 offset:25408
ds_read_b64_tr_b16 a[188:189], v6 offset:30784
ds_read_b64_tr_b16 a[190:191], v6 offset:31552
s_waitcnt lgkmcnt(0)
s_waitcnt vmcnt(6)
s_barrier
ds_read_b64_tr_b16 a[192:193], v7 offset:0
ds_read_b64_tr_b16 a[194:195], v7 offset:768
ds_read_b64_tr_b16 a[196:197], v7 offset:6144
ds_read_b64_tr_b16 a[198:199], v7 offset:6912
ds_read_b64_tr_b16 a[200:201], v7 offset:32
ds_read_b64_tr_b16 a[202:203], v7 offset:800
ds_read_b64_tr_b16 a[204:205], v7 offset:6176
ds_read_b64_tr_b16 a[206:207], v7 offset:6944
ds_read_b64_tr_b16 a[208:209], v7 offset:64
ds_read_b64_tr_b16 a[210:211], v7 offset:832
ds_read_b64_tr_b16 a[212:213], v7 offset:6208
ds_read_b64_tr_b16 a[214:215], v7 offset:6976
s_waitcnt lgkmcnt(0)
s_waitcnt vmcnt(0)
s_barrier
ds_read_b64_tr_b16 a[216:217], v7 offset:24576
ds_read_b64_tr_b16 a[218:219], v7 offset:25344
ds_read_b64_tr_b16 a[220:221], v7 offset:30720
ds_read_b64_tr_b16 a[222:223], v7 offset:31488
ds_read_b64_tr_b16 a[224:225], v7 offset:24608
ds_read_b64_tr_b16 a[226:227], v7 offset:25376
ds_read_b64_tr_b16 a[228:229], v7 offset:30752
ds_read_b64_tr_b16 a[230:231], v7 offset:31520
ds_read_b64_tr_b16 a[232:233], v7 offset:24640
ds_read_b64_tr_b16 a[234:235], v7 offset:25408
ds_read_b64_tr_b16 a[236:237], v7 offset:30784
ds_read_b64_tr_b16 a[238:239], v7 offset:31552
s_waitcnt lgkmcnt(0)
s_barrier
s_mul_i32 s28, s24, 24576
v_add_u32 v5, s28, v1
ds_write_b128 v5, v[16:19] offset:0
ds_write_b128 v5, v[20:23] offset:1024
ds_write_b128 v5, v[24:27] offset:2048
ds_write_b128 v5, v[28:31] offset:3072
ds_write_b128 v5, v[32:35] offset:4096
ds_write_b128 v5, v[36:39] offset:5120
ds_write_b128 v5, v[40:43] offset:6144
ds_write_b128 v5, v[44:47] offset:7168
ds_write_b128 v5, v[48:51] offset:8192
ds_write_b128 v5, v[52:55] offset:9216
ds_write_b128 v5, v[56:59] offset:10240
ds_write_b128 v5, v[60:63] offset:11264
ds_write_b128 v5, v[64:67] offset:12288
ds_write_b128 v5, v[68:71] offset:13312
ds_write_b128 v5, v[72:75] offset:14336
ds_write_b128 v5, v[76:79] offset:15360
ds_write_b128 v5, v[80:83] offset:16384
ds_write_b128 v5, v[84:87] offset:17408
ds_write_b128 v5, v[88:91] offset:18432
ds_write_b128 v5, v[92:95] offset:19456
ds_write_b128 v5, v[96:99] offset:20480
ds_write_b128 v5, v[100:103] offset:21504
ds_write_b128 v5, v[104:107] offset:22528
ds_write_b128 v5, v[108:111] offset:23552
s_waitcnt lgkmcnt(0)
s_mov_b32 s62, 0
v_mov_b32 v15, 128
Awc:
s_add_u32 s62, s62, 1
s_mov_b32 s63, 1
s_cmp_gt_u32 s62, 400000
s_cbranch_scc1 L_err
buffer_load_dwordx3 v[12:14], v15, s[20:23], 0 offen sc1
s_waitcnt vmcnt(0)
v_readfirstlane_b32 s41, v12
v_readfirstlane_b32 s42, v13
v_readfirstlane_b32 s57, v14
s_and_b32 s43, s41, s42
s_cmp_eq_u32 s57, 0
s_cselect_b32 s43, 0, s43
s_bitcmp1_b32 s43, 8
s_cbranch_scc0 Awc
s_bfe_u32 s3, s41, 0x10001
s_and_b32 s41, s41, 7
s_and_b32 s42, s42, 7
s_xor_b32 s52, s41, 7
s_lshl_b32 s52, s52, 12
s_xor_b32 s44, s42, 7
s_lshl_b32 s44, s44, 12
s_xor_b32 s53, s41, 3
s_lshl_b32 s53, s53, 12
s_xor_b32 s45, s42, 3
s_lshl_b32 s45, s45, 12
s_xor_b32 s54, s41, 6
s_lshl_b32 s54, s54, 12
s_xor_b32 s46, s42, 6
s_lshl_b32 s46, s46, 12
s_xor_b32 s55, s41, 2
s_lshl_b32 s55, s55, 12
s_xor_b32 s47, s42, 2
s_lshl_b32 s47, s47, 12
s_and_b32 s41, s27, 3
s_mov_b32 s35, s52
s_cmp_eq_u32 s41, 1
s_cselect_b32 s35, s53, s35
s_cmp_eq_u32 s41, 2
s_cselect_b32 s35, s54, s35
s_cmp_eq_u32 s41, 3
s_cselect_b32 s35, s55, s35
v_mov_b32 v7, 0x4444
v_mov_b32 v12, 0xeeee
v_cmp_gt_u32 vcc, 8, v2
s_nop 1
v_cndmask_b32 v7, v12, v7, vcc
s_cmp_eq_u32 s24, 0
s_cselect_b32 s41, 2, 0
s_cselect_b32 s44, 0, -1
s_mov_b32 s45, -1
v_mov_b32 v12, 0xf149f2ca
v_cmp_gt_u32 vcc, s41, v3
s_nop 1
v_cndmask_b32 v6, 0, v12, vcc
s_mul_i32 s41, s24, 2560
s_add_u32 s41, s41, 98304
v_add_u32 v4, s41, v1
v_and_b32 v12, 1, v3
v_lshrrev_b32 v13, 3, v2
v_lshl_or_b32 v12, v12, 1, v13
s_cmp_eq_u32 s24, 3
s_cselect_b64 vcc, -1, 0
v_cndmask_b32 v12, v12, v3, vcc
v_mov_b32 v9, s52
v_mov_b32 v13, s53
v_cmp_eq_u32 vcc, 1, v12
s_nop 1
v_cndmask_b32 v9, v9, v13, vcc
v_mov_b32 v13, s54
v_cmp_eq_u32 vcc, 2, v12
s_nop 1
v_cndmask_b32 v9, v9, v13, vcc
v_mov_b32 v13, s55
v_cmp_eq_u32 vcc, 3, v12
s_nop 1
v_cndmask_b32 v9, v9, v13, vcc
s_sub_u32 s41, s24, 1
s_lshl_b32 s41, s41, 8
v_lshrrev_b32 v12, 1, v3
v_lshlrev_b32 v12, 7, v12
v_add_u32 v12, s41, v12
s_cmp_eq_u32 s24, 0
s_cselect_b64 vcc, -1, 0
v_mov_b32 v13, 512
v_cndmask_b32 v12, v12, v13, vcc
v_and_b32 v13, 7, v2
v_lshl_add_u32 v10, v13, 4, v12
v_lshlrev_b32 v12, 4, v2
s_cmp_eq_u32 s24, 3
s_cselect_b64 vcc, -1, 0
s_and_b32 s41, s25, 3
s_mul_i32 s41, s41, 640
v_cndmask_b32 v10, v10, v12, vcc
v_add_u32 v10, s41, v10
v_bfe_u32 v12, v2, 2, 1
v_mul_u32_u24 v12, 6144, v12
v_lshrrev_b32 v13, 3, v2
v_lshlrev_b32 v13, 2, v13
v_and_b32 v14, 3, v2
v_add_u32 v13, v13, v14
s_sub_u32 s41, s24, 1
s_and_b32 s41, s41, 1
s_lshl_b32 s41, s41, 3
v_add_u32 v13, s41, v13
v_sub_u32 v13, v13, v2
v_lshl_add_u32 v11, v13, 4, v12
s_lshl_b32 s34, s25, 1
s_add_u32 s34, s34, s24
s_sub_u32 s34, s34, 1
s_lshl_b32 s34, s34, 7
s_add_u32 s34, s34, 4210688
s_cmp_lg_u32 s24, 1
s_cbranch_scc1 A_c0
s_add_u32 s61, s57, 0
v_mov_b32 v14, s61
v_mov_b32 v15, 0
s_mov_b64 exec, 1
buffer_store_dword v14, v15, s[4:7], s34 offen sc1
s_mov_b64 exec, -1
A_c0:
s_mul_i32 s41, s24, 1536
s_add_u32 s41, s41, 108544
v_lshrrev_b32 v12, 2, v2
v_xor_b32 v12, v12, v3
v_lshlrev_b32 v12, 3, v12
v_lshl_add_u32 v12, v2, 5, v12
v_add_u32 v120, s41, v12
v_bfe_u32 v12, v0, 2, 2
v_lshl_add_u32 v12, v3, 2, v12
v_and_b32 v13, 3, v0
v_xor_b32 v13, v13, v3
v_lshlrev_b32 v13, 3, v13
v_lshl_add_u32 v121, v12, 5, v13
v_lshlrev_b32 v13, 3, v2
s_lshl_b32 s41, s24, 7
s_add_u32 s41, s41, 98304
v_mul_u32_u24 v14, 2560, v3
v_add3_u32 v96, v13, v14, s41
s_mul_i32 s41, s24, 2560
s_add_u32 s41, s41, 98304
s_cmp_eq_u32 s24, 0
s_cselect_b32 s42, 128, 0
s_add_u32 s42, s42, s41
v_add_u32 v97, s42, v13
s_cmp_eq_u32 s24, 2
s_cselect_b32 s42, 1, 2
s_lshl_b32 s42, s42, 7
s_add_u32 s42, s42, s41
v_add_u32 v98, s42, v13
v_add_u32 v121, 108544, v121
v_and_b32 v12, 7, v2
v_lshlrev_b32 v12, 4, v12
v_lshl_add_u32 v12, v3, 7, v12
v_add_u32 v123, 98304, v12
s_mov_b32 s36, 2
s_mov_b32 s37, 0
s_mov_b32 s38, 1
s_mov_b32 s40, 0
s_mov_b32 s48, 0
s_mov_b32 s49, 0
s_mov_b32 s30, 0x3dd53b95
s_mov_b32 s16, 0
s_mov_b32 s17, 0
s_mov_b32 s18, 125
s_mov_b32 s19, 54
s_mov_b32 s26, 1
s_mov_b32 s56, 1
v_min_u32 v13, 39, v0
v_lshlrev_b32 v13, 7, v13
s_mov_b32 s41, 4222976
s_mov_b32 s62, 0
s_add_u32 s61, s57, 0
A_rr:
s_add_u32 s62, s62, 1
s_mov_b32 s63, 2
s_cmp_gt_u32 s62, 400000
s_cbranch_scc1 L_err
buffer_load_dword v14, v13, s[4:7], s41 offen sc1
s_waitcnt vmcnt(0)
v_subrev_u32 v14, s61, v14
v_cmp_lt_u32 vcc, 64, v14
s_cbranch_vccnz A_rr
s_add_u32 s41, s24, 0
s_bfe_u32 s60, s41, 0x10004
s_lshl_b32 s60, s60, 14
s_bfe_u32 s61, s41, 0x10005
s_lshl_b32 s61, s61, 12
s_xor_b32 s60, s60, s61
s_xor_b32 s60, s60, s35
s_lshl_b32 s64, s41, 15
s_add_u32 s64, s64, s60
s_cmp_eq_u32 s24, 3
s_cselect_b32 s41, 28, 12
s_lshr_b32 s42, s25, 2
s_add_u32 s41, s41, s42
s_bfe_u32 s65, s41, 0x10004
s_lshl_b32 s65, s65, 14
s_bfe_u32 s61, s41, 0x10005
s_lshl_b32 s61, s61, 12
s_xor_b32 s65, s65, s61
s_lshl_b32 s66, s41, 15
s_add_u32 s41, s24, 4
s_bfe_u32 s60, s41, 0x10004
s_lshl_b32 s60, s60, 14
s_bfe_u32 s61, s41, 0x10005
s_lshl_b32 s61, s61, 12
s_xor_b32 s60, s60, s61
s_xor_b32 s60, s60, s35
s_lshl_b32 s67, s41, 15
s_add_u32 s67, s67, s60
s_cmp_eq_u32 s24, 3
s_cselect_b32 s41, 12, 20
s_lshr_b32 s42, s25, 2
s_add_u32 s41, s41, s42
s_bfe_u32 s68, s41, 0x10004
s_lshl_b32 s68, s68, 14
s_bfe_u32 s61, s41, 0x10005
s_lshl_b32 s61, s61, 12
s_xor_b32 s68, s68, s61
s_lshl_b32 s69, s41, 15
s_add_u32 s41, s24, 8
s_bfe_u32 s60, s41, 0x10004
s_lshl_b32 s60, s60, 14
s_bfe_u32 s61, s41, 0x10005
s_lshl_b32 s61, s61, 12
s_xor_b32 s60, s60, s61
s_xor_b32 s60, s60, s35
s_lshl_b32 s70, s41, 15
s_add_u32 s70, s70, s60
s_cmp_eq_u32 s24, 3
s_cselect_b32 s41, 20, 28
s_lshr_b32 s42, s25, 2
s_add_u32 s41, s41, s42
s_bfe_u32 s71, s41, 0x10004
s_lshl_b32 s71, s71, 14
s_bfe_u32 s61, s41, 0x10005
s_lshl_b32 s61, s61, 12
s_xor_b32 s71, s71, s61
s_lshl_b32 s72, s41, 15
s_mov_b32 s73, 0x21800000
s_mov_b32 s74, 0x3c000000
s_mov_b32 s76, 0x00ff00ff
s_mov_b32 s77, 0x00ff00ff
s_cmp_eq_u32 s24, 2
s_cselect_b32 s75, 1, 2
s_lshl_b32 s75, s75, 7
s_lshl_b32 s51, s25, 2
s_add_u32 s51, s51, s24
s_mul_i32 s33, s24, 6144
s_lshl_b32 s47, s33, 1
s_add_u32 s47, s47, 253952
s_add_u32 s33, s33, 114688
s_lshl_b32 s32, s51, 14
s_add_u32 s32, s32, 5242880
s_bfe_u32 s61, s32, 0x10015
s_xor_b32 s61, s61, s3
s_xor_b32 s61, s61, 1
s_lshl_b32 s61, s61, 13
s_add_u32 s32, s32, s61
s_add_u32 s29, s32, 4096
s_add_u32 s28, s33, 4096
A_loop:
s_mov_b32 s39, s64
v_xor_b32 v8, s65, v9
v_add3_u32 v8, v8, s66, v10
s_mov_b32 s41, s64
s_mov_b32 s42, s65
s_mov_b32 s43, s66
s_mov_b32 s64, s67
s_mov_b32 s65, s68
s_mov_b32 s66, s69
s_mov_b32 s67, s70
s_mov_b32 s68, s71
s_mov_b32 s69, s72
s_mov_b32 s70, s41
s_mov_b32 s71, s42
s_mov_b32 s72, s43
s_mov_b32 s46, 0
s_mul_i32 s41, s24, 6144
s_sub_u32 s41, s33, s41
v_add_u32 v122, s41, v1
s_sub_u32 s33, s47, s33
s_add_u32 s28, s33, 4096
s_add_u32 s50, s40, 1
s_cmp_ge_u32 s50, 64
s_cbranch_scc1 Ak1ok
s_add_u32 s32, s32, 0x200000
s_xor_b32 s32, s32, 0x2000
s_add_u32 s29, s32, 4096
s_cmp_eq_u32 s40, 0
s_cbranch_scc1 Ak1ok
s_and_b32 s41, s50, 1
s_lshr_b32 s42, s50, 1
s_cmp_eq_u32 s41, 0
s_cselect_b32 s43, s48, s49
s_cmp_gt_u32 s43, s42
s_cbranch_scc1 Ak1ok
s_lshl_b32 s51, s41, 6
s_add_u32 s51, s51, s25
s_lshl_b32 s51, s51, 7
s_add_u32 s51, s51, 4194304
v_mov_b32 v13, 0
s_add_u32 s42, s42, 1
s_add_u32 s61, s57, s42
buffer_load_dword v14, v13, s[4:7], s51 offen sc1
s_waitcnt vmcnt(0)
v_subrev_u32 v14, s61, v14
v_cmp_lt_u32 vcc, 64, v14
s_mov_b32 s46, 1
s_cbranch_vccnz Ak1ok
s_mov_b32 s46, 0
v_readfirstlane_b32 s43, v14
s_add_u32 s43, s43, s42
s_cmp_eq_u32 s41, 0
s_cselect_b32 s48, s43, s48
s_cselect_b32 s49, s49, s43
Ak1ok:
v_mov_b64 v[32:33], 0
v_mov_b64 v[34:35], 0
v_mov_b64 v[36:37], 0
v_mov_b64 v[38:39], 0
v_mov_b64 v[40:41], 0
v_mov_b64 v[42:43], 0
v_mov_b64 v[24:25], 0
v_mov_b64 v[26:27], 0
v_add_u32 v99, v122, v11
v_mov_b32 v44, v6
v_mov_b32 v45, v6
v_mov_b32 v46, v6
v_mov_b32 v47, v6
ds_read_b128 v[104:107], v5 offset:0
ds_read_b128 v[108:111], v5 offset:1024
ds_read_b128 v[112:115], v5 offset:2048
ds_read_b128 v[116:119], v5 offset:3072
ds_read_b128 v[48:51], v5 offset:4096
ds_read_b128 v[52:55], v5 offset:5120
s_cmp_eq_u32 s40, 0
s_cbranch_scc1 A_tm
s_add_u32 s50, s57, s40
s_cmp_lg_u32 s24, 0
s_cbranch_scc1 A_t1
s_sub_u32 s50, s40, 1
s_sleep 0
s_xor_b32 s43, s35, 0x1000
s_add_u32 s43, s43, 1179648
s_and_b32 s41, s50, 3
s_mul_i32 s41, s41, 98304
s_add_u32 s41, s41, s43
s_and_b32 s42, s50, 3
s_mul_i32 s42, s42, 98304
s_add_u32 s42, s42, s43
s_add_u32 s42, s42, 65536
v_min_u32 v12, 39, v0
v_lshrrev_b32 v13, 5, v12
v_mul_u32_u24 v13, 28672, v13
v_lshl_add_u32 v12, v12, 7, v13
v_and_b32 v13, 31, v0
v_lshlrev_b32 v13, 7, v13
buffer_load_dwordx2 v[14:15], v12, s[4:7], s41 offen sc1
buffer_load_dwordx2 v[18:19], v13, s[4:7], s42 offen sc1
s_mov_b32 s62, 0
s_add_u32 s60, s57, s50
s_add_u32 s61, s57, s50
s_waitcnt vmcnt(0)
s_branch A_stc
A_st:
s_add_u32 s62, s62, 1
s_mov_b32 s63, 16
s_cmp_gt_u32 s62, 400000
s_cbranch_scc1 L_err
buffer_load_dwordx2 v[14:15], v12, s[4:7], s41 offen sc1
buffer_load_dwordx2 v[18:19], v13, s[4:7], s42 offen sc1
s_waitcnt vmcnt(0)
A_stc:
v_xor_b32 v15, s60, v15
v_xor_b32 v19, s61, v19
v_or_b32 v15, v15, v19
v_cmp_ne_u32 vcc, 0, v15
s_cbranch_vccnz A_st
v_max_i32_dpp v14, v14, v14 quad_perm:[1,0,3,2] row_mask:0xf bank_mask:0xf
v_max_i32_dpp v18, v18, v18 quad_perm:[1,0,3,2] row_mask:0xf bank_mask:0xf
s_nop 0
v_max_i32_dpp v14, v14, v14 quad_perm:[2,3,0,1] row_mask:0xf bank_mask:0xf
v_max_i32_dpp v18, v18, v18 quad_perm:[2,3,0,1] row_mask:0xf bank_mask:0xf
s_nop 0
v_max_i32_dpp v14, v14, v14 row_ror:4 row_mask:0xf bank_mask:0xf
v_max_i32_dpp v18, v18, v18 row_ror:4 row_mask:0xf bank_mask:0xf
s_nop 0
v_max_i32_dpp v14, v14, v14 row_ror:8 row_mask:0xf bank_mask:0xf
v_max_i32_dpp v18, v18, v18 row_ror:8 row_mask:0xf bank_mask:0xf
v_readlane_b32 s42, v14, 0
v_readlane_b32 s41, v14, 16
v_readlane_b32 s60, v14, 32
v_readlane_b32 s43, v18, 0
v_readlane_b32 s61, v18, 16
s_max_i32 s42, s42, s41
s_max_i32 s42, s42, s60
s_max_i32 s43, s43, s61
s_sub_u32 s41, s42, s17
s_sub_u32 s60, s19, 2
s_max_i32 s60, s60, s41
s_add_u32 s61, s19, 2
s_min_i32 s60, s60, s61
s_cmp_lg_u32 s26, 0
s_cselect_b32 s19, s19, s60
s_add_u32 s41, s42, 5
s_cmp_gt_i32 s41, s16
s_cselect_b32 s56, 1, 0
s_add_u32 s41, s42, 28
s_cmp_lg_u32 s56, 0
s_cselect_b32 s41, s41, s16
s_add_u32 s17, s41, s18
s_add_u32 s17, s17, 15
s_sub_u32 s41, s43, s16
s_sub_u32 s60, s18, 2
s_max_i32 s60, s60, s41
s_add_u32 s61, s18, 2
s_min_i32 s60, s60, s61
s_cmp_lg_u32 s56, 0
s_cselect_b32 s18, s18, s60
s_add_u32 s41, s43, 10
s_cmp_gt_i32 s41, s17
s_cselect_b32 s26, 1, 0
s_add_u32 s41, s43, 28
s_cmp_lg_u32 s26, 0
s_cselect_b32 s41, s41, s17
s_add_u32 s16, s41, s19
s_add_u32 s16, s16, 8
s_add_u32 s50, s57, s40
v_mov_b32 v14, s16
v_mov_b32 v15, s50
v_mul_u32_u24 v13, 2560, v3
v_add_u32 v13, 98304, v13
ds_write_b64 v13, v[14:15] offset:512
s_branch A_t2
A_t1:
s_mul_i32 s41, s24, 2560
s_add_u32 s41, s41, 98304
v_mov_b32 v13, s41
s_mov_b32 s62, 0
A_t3:
s_add_u32 s62, s62, 1
s_mov_b32 s63, 17
s_cmp_gt_u32 s62, 400000
s_cbranch_scc1 L_err
ds_read_b64 v[14:15], v13 offset:512
s_waitcnt lgkmcnt(0)
v_readfirstlane_b32 s41, v15
v_readfirstlane_b32 s16, v14
s_cmp_lg_u32 s41, s50
s_cbranch_scc1 A_t3
A_t2:
s_add_u32 s43, s16, s57
s_add_u32 s43, s43, 0
A_wu:
s_memrealtime s[58:59]
s_waitcnt lgkmcnt(0)
s_sub_u32 s59, s58, s43
s_cmp_lt_i32 s59, 0
s_cbranch_scc1 A_wu
A_tm:
s_mov_b32 s62, -1
Agm:
buffer_load_dwordx4 v[16:19], v1, s[4:7], s39 offen sc1
buffer_load_dwordx4 v[20:23], v1, s[4:7], s39 offen offset:1024 sc1
s_mov_b32 exec_hi, 0
buffer_load_dwordx4 v[24:27], v1, s[4:7], s39 offen offset:2048 sc1
s_mov_b32 exec_hi, -1
s_add_u32 s62, s62, 1
s_add_u32 s62, s62, 1
s_mov_b32 s63, 4
s_cmp_gt_u32 s62, 400000
s_cbranch_scc1 L_err
s_waitcnt vmcnt(2)
ds_write_b128 v4, v[16:19]
s_waitcnt vmcnt(1)
ds_write_b128 v4, v[20:23] offset:1024
s_mov_b32 exec_hi, 0
s_waitcnt vmcnt(0)
ds_write_b128 v4, v[24:27] offset:2048
s_mov_b32 exec_hi, -1
v_max3_u32 v14, v16, v20, v24
v_cmp_eq_u32 vcc, -1, v14
s_cbranch_vccnz Agm
s_waitcnt lgkmcnt(0)
s_barrier
ds_read_b128 v[16:19], v123 offset:0
ds_read_b128 v[124:127], v123 offset:8192
ds_read_b128 v[20:23], v123 offset:512
ds_read_b128 v[24:27], v123 offset:1024
ds_read_b128 v[28:31], v123 offset:1536
ds_read_b128 v[100:103], v123 offset:2048
s_waitcnt lgkmcnt(5)
v_smfmac_f32_16x16x64_bf16 v[32:35], v[16:19], a[0:7], v7
s_mov_b32 m0, s33
v_smfmac_f32_16x16x64_bf16 v[36:39], v[16:19], a[8:15], v7
buffer_load_dwordx4 v1, s[4:7], s32 offen offset:0 sc1 lds
v_smfmac_f32_16x16x64_bf16 v[40:43], v[16:19], a[16:23], v7
s_waitcnt lgkmcnt(4)
v_smfmac_f32_16x16x64_bf16 v[32:35], v[124:127], v[104:111], v7
s_waitcnt lgkmcnt(2)
v_smfmac_f32_16x16x64_bf16 v[32:35], v[20:23], a[24:31], v7
ds_read_b128 v[16:19], v123 offset:2560
v_smfmac_f32_16x16x64_bf16 v[36:39], v[20:23], a[32:39], v7
ds_read_b128 v[104:107], v5 offset:6144
v_smfmac_f32_16x16x64_bf16 v[40:43], v[20:23], a[40:47], v7
ds_read_b128 v[20:23], v123 offset:3072
v_smfmac_f32_16x16x64_bf16 v[36:39], v[124:127], v[112:119], v7
ds_read_b128 v[108:111], v5 offset:7168
v_smfmac_f32_16x16x64_bf16 v[32:35], v[24:27], a[48:55], v7
ds_read_b128 v[112:115], v5 offset:8192
v_smfmac_f32_16x16x64_bf16 v[36:39], v[24:27], a[56:63], v7
ds_read_b128 v[116:119], v5 offset:9216
v_smfmac_f32_16x16x64_bf16 v[40:43], v[24:27], a[64:71], v7
ds_read_b128 v[24:27], v123 offset:3584
v_smfmac_f32_16x16x64_bf16 v[40:43], v[124:127], v[48:55], v7
s_waitcnt lgkmcnt(7)
v_smfmac_f32_16x16x64_bf16 v[32:35], v[28:31], a[72:79], v7
ds_read_b128 v[124:127], v123 offset:8704
v_smfmac_f32_16x16x64_bf16 v[36:39], v[28:31], a[80:87], v7
ds_read_b128 v[48:51], v5 offset:10240
v_smfmac_f32_16x16x64_bf16 v[40:43], v[28:31], a[88:95], v7
ds_read_b128 v[28:31], v123 offset:4096
v_smfmac_f32_16x16x64_bf16 v[32:35], v[100:103], a[96:103], v7
ds_read_b128 v[52:55], v5 offset:11264
v_smfmac_f32_16x16x64_bf16 v[36:39], v[100:103], a[104:111], v7
buffer_load_dwordx4 v1, s[4:7], s32 offen offset:1024 sc1 lds
v_smfmac_f32_16x16x64_bf16 v[40:43], v[100:103], a[112:119], v7
s_waitcnt lgkmcnt(3)
v_smfmac_f32_16x16x64_bf16 v[32:35], v[124:127], v[104:111], v7
ds_read_b128 v[100:103], v123 offset:4608
v_smfmac_f32_16x16x64_bf16 v[32:35], v[16:19], a[120:127], v7
ds_read_b128 v[104:107], v5 offset:12288
v_smfmac_f32_16x16x64_bf16 v[36:39], v[16:19], a[128:135], v7
ds_read_b128 v[108:111], v5 offset:13312
v_smfmac_f32_16x16x64_bf16 v[40:43], v[16:19], a[136:143], v7
ds_read_b128 v[16:19], v123 offset:5120
v_smfmac_f32_16x16x64_bf16 v[36:39], v[124:127], v[112:119], v7
ds_read_b128 v[112:115], v5 offset:14336
v_smfmac_f32_16x16x64_bf16 v[32:35], v[20:23], a[144:151], v7
ds_read_b128 v[116:119], v5 offset:15360
v_smfmac_f32_16x16x64_bf16 v[36:39], v[20:23], a[152:159], v7
buffer_load_dwordx4 v1, s[4:7], s32 offen offset:2048 sc1 lds
v_smfmac_f32_16x16x64_bf16 v[40:43], v[20:23], a[160:167], v7
s_waitcnt lgkmcnt(6)
v_smfmac_f32_16x16x64_bf16 v[40:43], v[124:127], v[48:55], v7
ds_read_b128 v[124:127], v123 offset:9216
v_smfmac_f32_16x16x64_bf16 v[32:35], v[24:27], a[168:175], v7
ds_read_b128 v[20:23], v123 offset:5632
v_smfmac_f32_16x16x64_bf16 v[36:39], v[24:27], a[176:183], v7
ds_read_b128 v[48:51], v5 offset:16384
v_smfmac_f32_16x16x64_bf16 v[40:43], v[24:27], a[184:191], v7
ds_read_b128 v[24:27], v123 offset:6144
v_smfmac_f32_16x16x64_bf16 v[32:35], v[28:31], a[192:199], v7
ds_read_b128 v[52:55], v5 offset:17408
v_smfmac_f32_16x16x64_bf16 v[36:39], v[28:31], a[200:207], v7
buffer_load_dwordx4 v1, s[4:7], s32 offen offset:3072 sc1 lds
v_smfmac_f32_16x16x64_bf16 v[40:43], v[28:31], a[208:215], v7
s_waitcnt lgkmcnt(4)
v_smfmac_f32_16x16x64_bf16 v[32:35], v[124:127], v[104:111], v7
ds_read_b128 v[28:31], v123 offset:6656
v_smfmac_f32_16x16x64_bf16 v[32:35], v[100:103], a[216:223], v7
ds_read_b128 v[104:107], v5 offset:18432
v_smfmac_f32_16x16x64_bf16 v[36:39], v[100:103], a[224:231], v7
ds_read_b128 v[108:111], v5 offset:19456
v_smfmac_f32_16x16x64_bf16 v[40:43], v[100:103], a[232:239], v7
ds_read_b128 v[100:103], v123 offset:7168
v_smfmac_f32_16x16x64_bf16 v[36:39], v[124:127], v[112:119], v7
ds_read_b128 v[112:115], v5 offset:20480
v_smfmac_f32_16x16x64_bf16 v[32:35], v[16:19], a[240:247], v7
ds_read_b128 v[116:119], v5 offset:21504
v_smfmac_f32_16x16x64_bf16 v[36:39], v[16:19], a[248:255], v7
s_mov_b32 m0, s28
v_smfmac_f32_16x16x64_bf16 v[40:43], v[16:19], v[128:135], v7
s_waitcnt lgkmcnt(6)
v_smfmac_f32_16x16x64_bf16 v[40:43], v[124:127], v[48:55], v7
ds_read_b128 v[124:127], v123 offset:9728
v_smfmac_f32_16x16x64_bf16 v[32:35], v[20:23], v[136:143], v7
ds_read_b128 v[16:19], v123 offset:7680
v_smfmac_f32_16x16x64_bf16 v[36:39], v[20:23], v[144:151], v7
ds_read_b128 v[48:51], v5 offset:22528
v_smfmac_f32_16x16x64_bf16 v[40:43], v[20:23], v[152:159], v7
ds_read_b128 v[52:55], v5 offset:23552
v_smfmac_f32_16x16x64_bf16 v[32:35], v[24:27], v[160:167], v7
ds_read_b128 v[56:59], v99 offset:0
v_smfmac_f32_16x16x64_bf16 v[36:39], v[24:27], v[168:175], v7
ds_read_b128 v[60:63], v99 offset:1024
v_smfmac_f32_16x16x64_bf16 v[40:43], v[24:27], v[176:183], v7
s_waitcnt lgkmcnt(5)
v_smfmac_f32_16x16x64_bf16 v[32:35], v[124:127], v[104:111], v7
ds_read_b128 v[64:67], v99 offset:2048
v_smfmac_f32_16x16x64_bf16 v[32:35], v[28:31], v[184:191], v7
ds_read_b128 v[68:71], v99 offset:3072
v_smfmac_f32_16x16x64_bf16 v[36:39], v[28:31], v[192:199], v7
ds_read_b128 v[72:75], v99 offset:4096
v_smfmac_f32_16x16x64_bf16 v[40:43], v[28:31], v[200:207], v7
ds_read_b128 v[76:79], v99 offset:5120
v_smfmac_f32_16x16x64_bf16 v[36:39], v[124:127], v[112:119], v7
buffer_load_dwordx4 v1, s[4:7], s29 offen offset:0 sc1 lds
v_smfmac_f32_16x16x64_bf16 v[32:35], v[100:103], v[208:215], v7
buffer_load_dwordx4 v1, s[4:7], s29 offen offset:1024 sc1 lds
v_smfmac_f32_16x16x64_bf16 v[36:39], v[100:103], v[216:223], v7
v_smfmac_f32_16x16x64_bf16 v[40:43], v[100:103], v[224:231], v7
s_waitcnt lgkmcnt(6)
v_smfmac_f32_16x16x64_bf16 v[40:43], v[124:127], v[48:55], v7
v_smfmac_f32_16x16x64_bf16 v[32:35], v[16:19], v[232:239], v7
v_smfmac_f32_16x16x64_bf16 v[36:39], v[16:19], v[240:247], v7
v_smfmac_f32_16x16x64_bf16 v[40:43], v[16:19], v[248:255], v7
s_nop 5
v_cvt_pk_bf16_f32 v32, v32, v33
v_cvt_pk_bf16_f32 v33, v34, v35
ds_write_b64 v120, v[32:33] offset:0
v_cvt_pk_bf16_f32 v36, v36, v37
v_cvt_pk_bf16_f32 v37, v38, v39
ds_write_b64 v120, v[36:37] offset:512
v_cvt_pk_bf16_f32 v40, v40, v41
v_cvt_pk_bf16_f32 v41, v42, v43
ds_write_b64 v120, v[40:41] offset:1024
s_waitcnt lgkmcnt(0)
s_barrier
s_cmp_eq_u32 s40, 0
s_cbranch_scc1 A_first
A_cont:
s_cmp_eq_u32 s24, 3
s_cbranch_scc1 A_w3
ds_read_b64_tr_b16 v[104:105], v121 offset:0
ds_read_b64_tr_b16 v[106:107], v121 offset:512
ds_read_b64_tr_b16 v[108:109], v121 offset:1024
ds_read_b64_tr_b16 v[110:111], v121 offset:1536
ds_read_b64_tr_b16 v[112:113], v121 offset:2048
ds_read_b64_tr_b16 v[114:115], v121 offset:2560
ds_read_b64_tr_b16 v[116:117], v121 offset:3072
ds_read_b64_tr_b16 v[118:119], v121 offset:3584
ds_read_b64_tr_b16 v[124:125], v121 offset:4096
ds_read_b64_tr_b16 v[126:127], v121 offset:4608
ds_read_b64_tr_b16 v[28:29], v121 offset:5120
ds_read_b64_tr_b16 v[30:31], v121 offset:5632
s_cmp_eq_u32 s40, 63
s_cbranch_scc1 A_last
s_cmp_lg_u32 s24, 0
s_cbranch_scc1 A_s12
s_waitcnt lgkmcnt(10)
v_mfma_f32_16x16x32_bf16 v[44:47], v[104:107], v[104:107], v[44:47]
s_waitcnt lgkmcnt(8)
v_mfma_f32_16x16x32_bf16 v[44:47], v[108:111], v[108:111], v[44:47]
s_waitcnt lgkmcnt(6)
v_mfma_f32_16x16x32_bf16 v[44:47], v[112:115], v[112:115], v[44:47]
s_waitcnt lgkmcnt(4)
v_mfma_f32_16x16x32_bf16 v[44:47], v[116:119], v[116:119], v[44:47]
s_waitcnt lgkmcnt(2)
v_mfma_f32_16x16x32_bf16 v[44:47], v[124:127], v[124:127], v[44:47]
s_waitcnt lgkmcnt(0)
v_mfma_f32_16x16x32_bf16 v[44:47], v[28:31], v[28:31], v[44:47]
s_branch A_sj
A_s12:
s_waitcnt lgkmcnt(10)
v_mfma_f32_16x16x32_bf16 v[44:47], v[56:59], v[104:107], v[44:47]
s_waitcnt lgkmcnt(8)
v_mfma_f32_16x16x32_bf16 v[44:47], v[60:63], v[108:111], v[44:47]
s_waitcnt lgkmcnt(6)
v_mfma_f32_16x16x32_bf16 v[44:47], v[64:67], v[112:115], v[44:47]
s_waitcnt lgkmcnt(4)
v_mfma_f32_16x16x32_bf16 v[44:47], v[68:71], v[116:119], v[44:47]
s_waitcnt lgkmcnt(2)
v_mfma_f32_16x16x32_bf16 v[44:47], v[72:75], v[124:127], v[44:47]
s_waitcnt lgkmcnt(0)
v_mfma_f32_16x16x32_bf16 v[44:47], v[76:79], v[28:31], v[44:47]
A_sj:
v_subrev_u32 v99, s75, v98
s_nop 6
v_pk_mul_f32 v[88:89], v[44:45], s[30:31] op_sel_hi:[1,0]
v_pk_mul_f32 v[90:91], v[46:47], s[30:31] op_sel_hi:[1,0]
v_exp_f32 v88, v88
v_exp_f32 v89, v89
v_exp_f32 v90, v90
v_exp_f32 v91, v91
v_add_f32 v81, v88, v89
v_add_f32 v82, v90, v91
v_add_f32 v81, v81, v82
v_mov_b32 v82, v81
s_nop 1
v_permlane32_swap_b32 v81, v82
v_add_f32 v81, v81, v82
v_mov_b32 v82, v81
s_nop 1
v_permlane16_swap_b32 v81, v82
v_add_f32 v81, v81, v82
ds_write_b32 v96, v81 offset:1024
s_waitcnt lgkmcnt(0)
s_barrier
ds_read_b32 v81, v99 offset:1024
ds_read_b32 v82, v99 offset:1152
ds_read_b32 v83, v99 offset:1280
s_waitcnt lgkmcnt(0)
v_add_f32 v81, v81, v82
v_add_f32 v81, v81, v83
v_rcp_f32 v80, v81
v_subrev_u32 v87, s73, v81
v_cmp_lt_u32 vcc, s74, v87
s_and_b64 vcc, vcc, s[76:77]
s_cbranch_vccnz A_sx
v_pk_mul_f32 v[44:45], v[88:89], v[80:81] op_sel_hi:[1,0]
v_pk_mul_f32 v[46:47], v[90:91], v[80:81] op_sel_hi:[1,0]
A_sf:
v_cvt_pk_bf16_f32 v84, v44, v45
v_cvt_pk_bf16_f32 v86, v44, v45
v_cvt_pk_bf16_f32 v85, v46, v47
v_cvt_pk_bf16_f32 v87, v46, v47
v_permlane16_swap_b32 v84, v86
s_nop 0
v_permlane16_swap_b32 v85, v87
v_min_u32 v84, -2, v84
v_mov_b32_dpp v86, v86 row_ror:8 row_mask:0xf bank_mask:0xc
v_mov_b32_dpp v85, v85 row_ror:8 row_mask:0xf bank_mask:0xc
v_mov_b32_dpp v87, v87 row_ror:8 row_mask:0xf bank_mask:0xc
v_mov_b32_dpp v84, v84 row_ror:8 row_mask:0xf bank_mask:0xc
s_mov_b64 exec, s[44:45]
buffer_store_dwordx4 v[84:87], v8, s[4:7], 0 offen sc1
s_mov_b64 exec, -1
s_cmp_lg_u32 s24, 0
s_cbranch_scc1 A_w12
s_memrealtime s[58:59]
s_and_b32 s41, s40, 3
s_mul_i32 s41, s41, 3
s_add_u32 s41, s41, 38
s_lshr_b32 s42, s25, 5
s_add_u32 s41, s41, s42
s_lshl_b32 s41, s41, 15
s_and_b32 s42, s25, 31
s_lshl_b32 s42, s42, 7
s_add_u32 s41, s41, s42
s_add_u32 s42, s57, s40
v_mov_b32 v15, s42
v_mov_b32 v13, s52
v_writelane_b32 v13, s53, 1
v_writelane_b32 v13, s54, 2
v_writelane_b32 v13, s55, 3
v_xor_b32 v13, 0x1000, v13
s_waitcnt lgkmcnt(0)
s_sub_u32 s58, s58, s57
v_mov_b32 v14, s58
s_mov_b64 exec, 15
buffer_store_dwordx2 v[14:15], v13, s[4:7], s41 offen sc1
s_mov_b64 exec, -1
s_branch A_next
A_w12:
s_sub_u32 s41, s24, 1
s_mul_i32 s42, s41, 6144
s_add_u32 s42, s42, 12288
v_add_u32 v13, s42, v122
ds_read_b128 v[16:19], v13 offset:0
ds_read_b128 v[20:23], v13 offset:1024
ds_read_b128 v[24:27], v13 offset:2048
ds_read_b128 v[32:35], v13 offset:3072
ds_read_b128 v[36:39], v13 offset:4096
ds_read_b128 v[40:43], v13 offset:5120
ds_read_b128 v[56:59], v122 offset:0
ds_read_b128 v[80:83], v122 offset:6144
ds_read_b128 v[60:63], v122 offset:1024
ds_read_b128 v[84:87], v122 offset:7168
ds_read_b128 v[64:67], v122 offset:2048
ds_read_b128 v[88:91], v122 offset:8192
ds_read_b128 v[68:71], v122 offset:3072
ds_read_b128 v[92:95], v122 offset:9216
ds_read_b128 v[72:75], v122 offset:4096
ds_read_b128 v[96:99], v122 offset:10240
ds_read_b128 v[76:79], v122 offset:5120
ds_read_b128 v[100:103], v122 offset:11264
s_add_u32 s61, s57, s40
v_mov_b32 v14, s61
v_mov_b32 v15, 0
s_mov_b64 exec, 1
buffer_store_dword v14, v15, s[4:7], s34 offen sc1
s_mov_b64 exec, -1
v_mov_b32 v12, 0xf149f2ca
v_cmp_gt_u32 vcc, 2, v3
s_sub_u32 s41, s24, 1
s_nop 0
v_cndmask_b32 v44, 0, v12, vcc
v_cndmask_b32 v45, 0, v12, vcc
v_cndmask_b32 v46, 0, v12, vcc
v_cndmask_b32 v47, 0, v12, vcc
s_lshl_b32 s41, s41, 4
v_lshlrev_b32 v14, 2, v3
v_sub_u32 v14, v2, v14
v_add_u32 v14, s41, v14
v_cmp_gt_i32 vcc, 0, v14
s_nop 1
v_cndmask_b32 v48, 0, v12, vcc
v_cmp_gt_i32 vcc, 1, v14
s_nop 1
v_cndmask_b32 v49, 0, v12, vcc
v_cmp_gt_i32 vcc, 2, v14
s_nop 1
v_cndmask_b32 v50, 0, v12, vcc
v_cmp_gt_i32 vcc, 3, v14
s_nop 1
v_cndmask_b32 v51, 0, v12, vcc
v_cmp_gt_i32 vcc, 16, v14
s_nop 1
v_cndmask_b32 v52, 0, v12, vcc
v_cmp_gt_i32 vcc, 17, v14
s_nop 1
v_cndmask_b32 v53, 0, v12, vcc
v_cmp_gt_i32 vcc, 18, v14
s_nop 1
v_cndmask_b32 v54, 0, v12, vcc
v_cmp_gt_i32 vcc, 19, v14
s_nop 1
v_cndmask_b32 v55, 0, v12, vcc
s_waitcnt lgkmcnt(10)
v_mfma_f32_16x16x32_bf16 v[48:51], v[56:59], v[16:19], v[48:51]
v_mfma_f32_16x16x32_bf16 v[52:55], v[80:83], v[16:19], v[52:55]
v_mfma_f32_16x16x32_bf16 v[44:47], v[104:107], v[16:19], v[44:47]
s_waitcnt lgkmcnt(8)
v_mfma_f32_16x16x32_bf16 v[48:51], v[60:63], v[20:23], v[48:51]
v_mfma_f32_16x16x32_bf16 v[52:55], v[84:87], v[20:23], v[52:55]
v_mfma_f32_16x16x32_bf16 v[44:47], v[108:111], v[20:23], v[44:47]
s_waitcnt lgkmcnt(6)
v_mfma_f32_16x16x32_bf16 v[48:51], v[64:67], v[24:27], v[48:51]
v_mfma_f32_16x16x32_bf16 v[52:55], v[88:91], v[24:27], v[52:55]
v_mfma_f32_16x16x32_bf16 v[44:47], v[112:115], v[24:27], v[44:47]
s_waitcnt lgkmcnt(4)
v_mfma_f32_16x16x32_bf16 v[48:51], v[68:71], v[32:35], v[48:51]
v_mfma_f32_16x16x32_bf16 v[52:55], v[92:95], v[32:35], v[52:55]
v_mfma_f32_16x16x32_bf16 v[44:47], v[116:119], v[32:35], v[44:47]
s_waitcnt lgkmcnt(2)
v_mfma_f32_16x16x32_bf16 v[48:51], v[72:75], v[36:39], v[48:51]
v_mfma_f32_16x16x32_bf16 v[52:55], v[96:99], v[36:39], v[52:55]
v_mfma_f32_16x16x32_bf16 v[44:47], v[124:127], v[36:39], v[44:47]
s_waitcnt lgkmcnt(0)
v_mfma_f32_16x16x32_bf16 v[48:51], v[76:79], v[40:43], v[48:51]
v_mfma_f32_16x16x32_bf16 v[52:55], v[100:103], v[40:43], v[52:55]
v_mfma_f32_16x16x32_bf16 v[44:47], v[28:31], v[40:43], v[44:47]
v_lshlrev_b32 v13, 3, v2
s_lshl_b32 s41, s24, 7
s_add_u32 s41, s41, 98304
v_mul_u32_u24 v14, 2560, v3
v_add3_u32 v96, v13, v14, s41
s_mul_i32 s41, s24, 2560
s_add_u32 s41, s41, 98304
s_cmp_eq_u32 s24, 0
s_cselect_b32 s42, 128, 0
s_add_u32 s42, s42, s41
v_add_u32 v97, s42, v13
s_cmp_eq_u32 s24, 2
s_cselect_b32 s42, 1, 2
s_lshl_b32 s42, s42, 7
s_add_u32 s42, s42, s41
v_add_u32 v98, s42, v13
v_max3_f32 v56, v48, v49, v50
v_max3_f32 v57, v51, v52, v53
v_max3_f32 v56, v56, v54, v55
v_max3_f32 v57, v57, v44, v45
v_max3_f32 v56, v56, v46, v47
v_max_f32 v56, v56, v57
v_mov_b32 v57, v56
s_nop 1
v_permlane32_swap_b32 v56, v57
v_max_f32 v56, v56, v57
v_mov_b32 v57, v56
s_nop 1
v_permlane16_swap_b32 v56, v57
v_max_f32 v56, v56, v57
v_mul_f32 v56, s30, v56
v_pk_fma_f32 v[44:45], v[44:45], s[30:31], v[56:57] op_sel_hi:[1,0,0] neg_lo:[0,0,1] neg_hi:[0,0,1]
v_pk_fma_f32 v[46:47], v[46:47], s[30:31], v[56:57] op_sel_hi:[1,0,0] neg_lo:[0,0,1] neg_hi:[0,0,1]
v_pk_fma_f32 v[48:49], v[48:49], s[30:31], v[56:57] op_sel_hi:[1,0,0] neg_lo:[0,0,1] neg_hi:[0,0,1]
v_pk_fma_f32 v[50:51], v[50:51], s[30:31], v[56:57] op_sel_hi:[1,0,0] neg_lo:[0,0,1] neg_hi:[0,0,1]
v_pk_fma_f32 v[52:53], v[52:53], s[30:31], v[56:57] op_sel_hi:[1,0,0] neg_lo:[0,0,1] neg_hi:[0,0,1]
v_pk_fma_f32 v[54:55], v[54:55], s[30:31], v[56:57] op_sel_hi:[1,0,0] neg_lo:[0,0,1] neg_hi:[0,0,1]
v_exp_f32 v44, v44
v_exp_f32 v45, v45
v_exp_f32 v46, v46
v_exp_f32 v47, v47
v_exp_f32 v48, v48
v_exp_f32 v49, v49
v_exp_f32 v50, v50
v_exp_f32 v51, v51
v_exp_f32 v52, v52
v_exp_f32 v53, v53
v_exp_f32 v54, v54
v_exp_f32 v55, v55
v_pk_add_f32 v[56:57], v[44:45], v[46:47]
v_pk_add_f32 v[58:59], v[48:49], v[50:51]
v_pk_add_f32 v[56:57], v[56:57], v[52:53]
v_pk_add_f32 v[58:59], v[58:59], v[54:55]
v_pk_add_f32 v[56:57], v[56:57], v[58:59]
v_add_f32 v56, v56, v57
v_mov_b32 v57, v56
s_nop 1
v_permlane32_swap_b32 v56, v57
v_add_f32 v56, v56, v57
v_mov_b32 v57, v56
s_nop 1
v_permlane16_swap_b32 v56, v57
v_add_f32 v56, v56, v57
v_rcp_f32 v56, v56
s_nop 0
v_pk_mul_f32 v[48:49], v[48:49], v[56:57] op_sel_hi:[1,0]
v_pk_mul_f32 v[50:51], v[50:51], v[56:57] op_sel_hi:[1,0]
v_pk_mul_f32 v[52:53], v[52:53], v[56:57] op_sel_hi:[1,0]
v_pk_mul_f32 v[54:55], v[54:55], v[56:57] op_sel_hi:[1,0]
v_pk_mul_f32 v[44:45], v[44:45], v[56:57] op_sel_hi:[1,0]
v_pk_mul_f32 v[46:47], v[46:47], v[56:57] op_sel_hi:[1,0]
v_cvt_pk_bf16_f32 v60, v48, v49
v_cvt_pk_bf16_f32 v61, v50, v51
v_cvt_pk_bf16_f32 v62, v52, v53
v_cvt_pk_bf16_f32 v63, v54, v55
v_cvt_pk_bf16_f32 v64, v44, v45
v_cvt_pk_bf16_f32 v65, v46, v47
s_lshl_b32 s41, s40, 5
s_add_u32 s41, s41, s25
s_lshl_b32 s41, s41, 1
s_add_u32 s41, s41, s24
s_sub_u32 s41, s41, 1
s_mul_i32 s41, s41, 1280
s_add_u32 s41, s41, 216006656
v_lshlrev_b32 v12, 4, v2
v_and_b32 v13, 1, v3
v_lshl_add_u32 v12, v13, 3, v12
buffer_store_dwordx4 v[60:63], v1, s[4:7], s41 offen sc1
s_mov_b32 exec_lo, 0
buffer_store_dwordx2 v[64:65], v12, s[4:7], s41 offen offset:1024 sc1
s_mov_b32 exec_lo, -1
s_branch A_next
A_sx:
v_max3_f32 v56, v44, v45, v46
v_max_f32 v56, v56, v47
v_mov_b32 v57, v56
s_nop 1
v_permlane32_swap_b32 v56, v57
v_max_f32 v56, v56, v57
v_mov_b32 v57, v56
s_nop 1
v_permlane16_swap_b32 v56, v57
v_max_f32 v56, v56, v57
v_mul_f32 v56, s30, v56
v_pk_fma_f32 v[44:45], v[44:45], s[30:31], v[56:57] op_sel_hi:[1,0,0] neg_lo:[0,0,1] neg_hi:[0,0,1]
v_pk_fma_f32 v[46:47], v[46:47], s[30:31], v[56:57] op_sel_hi:[1,0,0] neg_lo:[0,0,1] neg_hi:[0,0,1]
v_exp_f32 v44, v44
v_exp_f32 v45, v45
v_exp_f32 v46, v46
v_exp_f32 v47, v47
v_add_f32 v57, v44, v45
v_add_f32 v58, v46, v47
v_add_f32 v57, v57, v58
v_mov_b32 v58, v57
s_nop 1
v_permlane32_swap_b32 v57, v58
v_add_f32 v57, v57, v58
v_mov_b32 v58, v57
s_nop 1
v_permlane16_swap_b32 v57, v58
v_add_f32 v57, v57, v58
s_mov_b32 exec_hi, 0xffff
ds_write_b64 v96, v[56:57]
s_mov_b32 exec_hi, -1
s_waitcnt lgkmcnt(0)
s_barrier
ds_read_b64 v[58:59], v97
ds_read_b64 v[60:61], v98
s_waitcnt lgkmcnt(0)
v_max3_f32 v62, v56, v58, v60
v_sub_f32 v58, v58, v62
v_sub_f32 v60, v60, v62
v_sub_f32 v56, v56, v62
v_exp_f32 v58, v58
v_exp_f32 v60, v60
v_exp_f32 v56, v56
v_mul_f32 v62, v58, v59
v_fmac_f32 v62, v60, v61
v_fmac_f32 v62, v56, v57
v_rcp_f32 v62, v62
s_nop 0
v_mul_f32 v56, v56, v62
v_pk_mul_f32 v[44:45], v[44:45], v[56:57] op_sel_hi:[1,0]
v_pk_mul_f32 v[46:47], v[46:47], v[56:57] op_sel_hi:[1,0]
s_branch A_sf
A_first:
s_mov_b32 s50, 1
s_and_b32 s41, s50, 1
s_lshr_b32 s42, s50, 1
s_cmp_eq_u32 s41, 0
s_cselect_b32 s43, s48, s49
s_cmp_gt_u32 s43, s42
s_cbranch_scc1 Ak2ok
s_lshl_b32 s51, s41, 6
s_add_u32 s51, s51, s25
s_lshl_b32 s51, s51, 7
s_add_u32 s51, s51, 4194304
v_mov_b32 v13, 0
s_add_u32 s42, s42, 1
s_mov_b32 s62, 0
s_add_u32 s61, s57, s42
Ak2w:
s_add_u32 s62, s62, 1
s_mov_b32 s63, 3
s_cmp_gt_u32 s62, 400000
s_cbranch_scc1 L_err
buffer_load_dword v14, v13, s[4:7], s51 offen sc1
s_waitcnt vmcnt(0)
v_subrev_u32 v14, s61, v14
v_cmp_lt_u32 vcc, 64, v14
s_cbranch_vccnz Ak2w
v_readfirstlane_b32 s43, v14
s_add_u32 s43, s43, s42
s_cmp_eq_u32 s41, 0
s_cselect_b32 s48, s43, s48
s_cselect_b32 s49, s49, s43
Ak2ok:
s_mov_b32 s50, 0
s_and_b32 s41, s50, 1
s_lshr_b32 s42, s50, 1
s_cmp_eq_u32 s41, 0
s_cselect_b32 s43, s48, s49
s_cmp_gt_u32 s43, s42
s_cbranch_scc1 Ak3ok
s_lshl_b32 s51, s41, 6
s_add_u32 s51, s51, s25
s_lshl_b32 s51, s51, 7
s_add_u32 s51, s51, 4194304
v_mov_b32 v13, 0
s_add_u32 s42, s42, 1
s_mov_b32 s62, 0
s_add_u32 s61, s57, s42
Ak3w:
s_add_u32 s62, s62, 1
s_mov_b32 s63, 3
s_cmp_gt_u32 s62, 400000
s_cbranch_scc1 L_err
buffer_load_dword v14, v13, s[4:7], s51 offen sc1
s_waitcnt vmcnt(0)
v_subrev_u32 v14, s61, v14
v_cmp_lt_u32 vcc, 64, v14
s_cbranch_vccnz Ak3w
v_readfirstlane_b32 s43, v14
s_add_u32 s43, s43, s42
s_cmp_eq_u32 s41, 0
s_cselect_b32 s48, s43, s48
s_cselect_b32 s49, s49, s43
Ak3ok:
s_xor_b32 s41, s32, 0x2000
s_sub_u32 s41, s41, 0x200000
s_sub_u32 s42, s47, s33
s_mov_b32 m0, s42
s_add_u32 s43, s41, 4096
buffer_load_dwordx4 v1, s[4:7], s41 offen offset:0 sc1 lds
buffer_load_dwordx4 v1, s[4:7], s41 offen offset:1024 sc1 lds
buffer_load_dwordx4 v1, s[4:7], s41 offen offset:2048 sc1 lds
buffer_load_dwordx4 v1, s[4:7], s41 offen offset:3072 sc1 lds
s_add_u32 m0, s42, 4096
s_nop 0
buffer_load_dwordx4 v1, s[4:7], s43 offen offset:0 sc1 lds
buffer_load_dwordx4 v1, s[4:7], s43 offen offset:1024 sc1 lds
s_mov_b32 m0, s33
s_nop 0
buffer_load_dwordx4 v1, s[4:7], s32 offen offset:0 sc1 lds
buffer_load_dwordx4 v1, s[4:7], s32 offen offset:1024 sc1 lds
buffer_load_dwordx4 v1, s[4:7], s32 offen offset:2048 sc1 lds
buffer_load_dwordx4 v1, s[4:7], s32 offen offset:3072 sc1 lds
s_mov_b32 m0, s28
s_nop 0
buffer_load_dwordx4 v1, s[4:7], s29 offen offset:0 sc1 lds
buffer_load_dwordx4 v1, s[4:7], s29 offen offset:1024 sc1 lds
s_waitcnt vmcnt(6)
s_barrier
ds_read_b128 v[56:59], v99 offset:0
ds_read_b128 v[60:63], v99 offset:1024
ds_read_b128 v[64:67], v99 offset:2048
ds_read_b128 v[68:71], v99 offset:3072
ds_read_b128 v[72:75], v99 offset:4096
ds_read_b128 v[76:79], v99 offset:5120
s_waitcnt lgkmcnt(0)
s_branch A_cont
A_last:
s_waitcnt lgkmcnt(0)
s_cmp_eq_u32 s24, 0
s_cbranch_scc1 A_next
s_branch A_w12
A_w3:
s_cmp_eq_u32 s40, 63
s_cbranch_scc1 A_next
s_barrier
ds_read_b32 v57, v97 offset:1024
ds_read_b32 v58, v97 offset:1152
ds_read_b32 v59, v97 offset:1280
s_waitcnt lgkmcnt(0)
v_add_f32 v57, v57, v58
v_add_f32 v57, v57, v59
v_subrev_u32 v63, s73, v57
v_cmp_lt_u32 vcc, s74, v63
s_and_b64 vcc, vcc, s[76:77]
s_cbranch_vccnz A_w3x
s_branch A_w3y
A_w3x:
s_barrier
A_w3y:
v_mov_b32 v20, -1
v_mov_b32 v21, -1
v_mov_b32 v22, -1
v_mov_b32 v23, -1
buffer_store_dwordx4 v[20:23], v8, s[4:7], 0 offen offset:0 sc1
buffer_store_dwordx4 v[20:23], v8, s[4:7], 0 offen offset:256 sc1
buffer_store_dwordx4 v[20:23], v8, s[4:7], 0 offen offset:384 sc1
A_next:
s_cmp_eq_u32 s46, 0
s_cbranch_scc1 A_nx
s_add_u32 s50, s40, 1
s_and_b32 s41, s50, 1
s_lshr_b32 s42, s50, 1
s_cmp_eq_u32 s41, 0
s_cselect_b32 s43, s48, s49
s_cmp_gt_u32 s43, s42
s_cbranch_scc1 Ak4ok
s_lshl_b32 s51, s41, 6
s_add_u32 s51, s51, s25
s_lshl_b32 s51, s51, 7
s_add_u32 s51, s51, 4194304
v_mov_b32 v13, 0
s_add_u32 s42, s42, 1
s_mov_b32 s62, 0
s_add_u32 s61, s57, s42
Ak4w:
s_add_u32 s62, s62, 1
s_mov_b32 s63, 3
s_cmp_gt_u32 s62, 400000
s_cbranch_scc1 L_err
buffer_load_dword v14, v13, s[4:7], s51 offen sc1
s_waitcnt vmcnt(0)
v_subrev_u32 v14, s61, v14
v_cmp_lt_u32 vcc, 64, v14
s_cbranch_vccnz Ak4w
v_readfirstlane_b32 s43, v14
s_add_u32 s43, s43, s42
s_cmp_eq_u32 s41, 0
s_cselect_b32 s48, s43, s48
s_cselect_b32 s49, s49, s43
Ak4ok:
s_mov_b32 m0, s33
s_nop 0
buffer_load_dwordx4 v1, s[4:7], s32 offen offset:0 sc1 lds
buffer_load_dwordx4 v1, s[4:7], s32 offen offset:1024 sc1 lds
buffer_load_dwordx4 v1, s[4:7], s32 offen offset:2048 sc1 lds
buffer_load_dwordx4 v1, s[4:7], s32 offen offset:3072 sc1 lds
s_mov_b32 m0, s28
s_nop 0
buffer_load_dwordx4 v1, s[4:7], s29 offen offset:0 sc1 lds
buffer_load_dwordx4 v1, s[4:7], s29 offen offset:1024 sc1 lds
A_nx:
s_add_u32 s40, s40, 1
s_cmp_lt_u32 s40, 64
s_cbranch_scc1 A_loop
s_waitcnt vmcnt(0)
s_cmp_eq_u32 s24, 0
s_cbranch_scc1 L_fin
s_cmp_eq_u32 s24, 3
s_cbranch_scc1 L_fin
s_add_u32 s61, s57, s40
v_mov_b32 v14, s61
v_mov_b32 v15, 0
s_mov_b64 exec, 1
buffer_store_dword v14, v15, s[4:7], s34 offen sc1
s_mov_b64 exec, -1
s_branch L_fin
L_B:
s_mov_b32 s12, s72
s_and_b32 s13, s73, 0xffff
s_mov_b32 s14, 0x780000
s_mov_b32 s15, 0x20000
s_mov_b32 s16, s74
s_and_b32 s17, s75, 0xffff
s_mov_b32 s18, 0x780000
s_mov_b32 s19, 0x20000
s_mul_i32 s29, s25, 384
s_mov_b32 s30, 0
s_mul_i32 s31, s25, 245760
s_mul_i32 s61, s24, 192
v_add_u32 v15, s61, v0
v_add_u32 v10, 0, v15
v_mul_u32_u24 v11, 43691, v10
v_lshrrev_b32 v11, 20, v11
v_mul_u32_u24 v13, 24, v11
v_sub_u32 v12, v10, v13
v_and_b32 v13, 17, v11
v_bfe_u32 v10, v11, 1, 1
v_lshl_or_b32 v13, v10, 3, v13
v_bfe_u32 v10, v11, 2, 2
v_lshl_or_b32 v11, v10, 1, v13
v_mul_u32_u24 v11, 12288, v11
v_lshlrev_b32 v12, 4, v12
v_add3_u32 v100, v11, v12, s29
v_add_u32 v10, 64, v15
v_mul_u32_u24 v11, 43691, v10
v_lshrrev_b32 v11, 20, v11
v_mul_u32_u24 v13, 24, v11
v_sub_u32 v12, v10, v13
v_and_b32 v13, 17, v11
v_bfe_u32 v10, v11, 1, 1
v_lshl_or_b32 v13, v10, 3, v13
v_bfe_u32 v10, v11, 2, 2
v_lshl_or_b32 v11, v10, 1, v13
v_mul_u32_u24 v11, 12288, v11
v_lshlrev_b32 v12, 4, v12
v_add3_u32 v101, v11, v12, s29
v_add_u32 v10, 128, v15
v_mul_u32_u24 v11, 43691, v10
v_lshrrev_b32 v11, 20, v11
v_mul_u32_u24 v13, 24, v11
v_sub_u32 v12, v10, v13
v_and_b32 v13, 17, v11
v_bfe_u32 v10, v11, 1, 1
v_lshl_or_b32 v13, v10, 3, v13
v_bfe_u32 v10, v11, 2, 2
v_lshl_or_b32 v11, v10, 1, v13
v_mul_u32_u24 v11, 12288, v11
v_lshlrev_b32 v12, 4, v12
v_add3_u32 v102, v11, v12, s29
s_mul_i32 s61, s24, 320
v_add_u32 v15, s61, v0
v_add_u32 v10, 0, v15
v_mul_u32_u24 v11, 13108, v10
v_lshrrev_b32 v11, 20, v11
v_mul_u32_u24 v13, 80, v11
v_sub_u32 v12, v10, v13
v_mul_u32_u24 v11, 1280, v11
v_lshlrev_b32 v12, 4, v12
v_add3_u32 v104, v11, v12, s30
v_add_u32 v10, 64, v15
v_mul_u32_u24 v11, 13108, v10
v_lshrrev_b32 v11, 20, v11
v_mul_u32_u24 v13, 80, v11
v_sub_u32 v12, v10, v13
v_mul_u32_u24 v11, 1280, v11
v_lshlrev_b32 v12, 4, v12
v_add3_u32 v105, v11, v12, s30
v_add_u32 v10, 128, v15
v_mul_u32_u24 v11, 13108, v10
v_lshrrev_b32 v11, 20, v11
v_mul_u32_u24 v13, 80, v11
v_sub_u32 v12, v10, v13
v_mul_u32_u24 v11, 1280, v11
v_lshlrev_b32 v12, 4, v12
v_add3_u32 v106, v11, v12, s30
v_add_u32 v10, 192, v15
v_mul_u32_u24 v11, 13108, v10
v_lshrrev_b32 v11, 20, v11
v_mul_u32_u24 v13, 80, v11
v_sub_u32 v12, v10, v13
v_mul_u32_u24 v11, 1280, v11
v_lshlrev_b32 v12, 4, v12
v_add3_u32 v107, v11, v12, s30
v_add_u32 v10, 256, v15
v_mul_u32_u24 v11, 13108, v10
v_lshrrev_b32 v11, 20, v11
v_mul_u32_u24 v13, 80, v11
v_sub_u32 v12, v10, v13
v_mul_u32_u24 v11, 1280, v11
v_lshlrev_b32 v12, 4, v12
v_add3_u32 v108, v11, v12, s30
s_mul_i32 s29, s24, 96
v_bfe_u32 v10, v0, 2, 2
v_lshl_add_u32 v10, v3, 3, v10
v_mov_b32 v11, 0
v_mul_u32_u24 v10, 384, v10
v_and_b32 v12, 3, v0
v_lshl_add_u32 v11, v12, 3, v11
v_add3_u32 v6, v10, v11, s29
v_add_u32 v7, 49152, v6
s_mul_i32 s29, s24, 320
v_bfe_u32 v10, v0, 2, 1
v_lshl_add_u32 v10, v3, 2, v10
v_bfe_u32 v11, v0, 3, 1
v_lshlrev_b32 v11, 5, v11
v_mul_u32_u24 v10, 1280, v10
v_and_b32 v12, 3, v0
v_lshl_add_u32 v11, v12, 3, v11
v_add3_u32 v8, v10, v11, s29
v_add_u32 v9, 49152, v8
s_add_u32 s60, s31, 0
s_mul_i32 s61, s24, 5120
s_add_u32 s61, s61, 0
s_add_u32 m0, s61, 0
s_nop 0
buffer_load_dwordx4 v104, s[16:19], s60 offen lds
s_add_u32 m0, s61, 1024
s_nop 0
buffer_load_dwordx4 v105, s[16:19], s60 offen lds
s_add_u32 m0, s61, 2048
s_nop 0
buffer_load_dwordx4 v106, s[16:19], s60 offen lds
s_add_u32 m0, s61, 3072
s_nop 0
buffer_load_dwordx4 v107, s[16:19], s60 offen lds
s_add_u32 m0, s61, 4096
s_nop 0
buffer_load_dwordx4 v108, s[16:19], s60 offen lds
s_add_u32 s60, s31, 20480
s_mul_i32 s61, s24, 5120
s_add_u32 s61, s61, 20480
s_add_u32 m0, s61, 0
s_nop 0
buffer_load_dwordx4 v104, s[16:19], s60 offen lds
s_add_u32 m0, s61, 1024
s_nop 0
buffer_load_dwordx4 v105, s[16:19], s60 offen lds
s_add_u32 m0, s61, 2048
s_nop 0
buffer_load_dwordx4 v106, s[16:19], s60 offen lds
s_add_u32 m0, s61, 3072
s_nop 0
buffer_load_dwordx4 v107, s[16:19], s60 offen lds
s_add_u32 m0, s61, 4096
s_nop 0
buffer_load_dwordx4 v108, s[16:19], s60 offen lds
s_add_u32 s60, s31, 40960
s_mul_i32 s61, s24, 5120
s_add_u32 s61, s61, 40960
s_add_u32 m0, s61, 0
s_nop 0
buffer_load_dwordx4 v104, s[16:19], s60 offen lds
s_add_u32 m0, s61, 1024
s_nop 0
buffer_load_dwordx4 v105, s[16:19], s60 offen lds
s_add_u32 m0, s61, 2048
s_nop 0
buffer_load_dwordx4 v106, s[16:19], s60 offen lds
s_add_u32 m0, s61, 3072
s_nop 0
buffer_load_dwordx4 v107, s[16:19], s60 offen lds
s_add_u32 m0, s61, 4096
s_nop 0
buffer_load_dwordx4 v108, s[16:19], s60 offen lds
s_add_u32 s60, s31, 61440
s_mul_i32 s61, s24, 5120
s_add_u32 s61, s61, 61440
s_add_u32 m0, s61, 0
s_nop 0
buffer_load_dwordx4 v104, s[16:19], s60 offen lds
s_add_u32 m0, s61, 1024
s_nop 0
buffer_load_dwordx4 v105, s[16:19], s60 offen lds
s_add_u32 m0, s61, 2048
s_nop 0
buffer_load_dwordx4 v106, s[16:19], s60 offen lds
s_add_u32 m0, s61, 3072
s_nop 0
buffer_load_dwordx4 v107, s[16:19], s60 offen lds
s_add_u32 m0, s61, 4096
s_nop 0
buffer_load_dwordx4 v108, s[16:19], s60 offen lds
s_waitcnt vmcnt(15)
s_barrier
ds_read_b64_tr_b16 a[240:241], v8 offset:0
ds_read_b64_tr_b16 a[242:243], v8 offset:2560
ds_read_b64_tr_b16 a[248:249], v8 offset:64
ds_read_b64_tr_b16 a[250:251], v8 offset:2624
ds_read_b64_tr_b16 v[112:113], v8 offset:128
ds_read_b64_tr_b16 v[114:115], v8 offset:2688
ds_read_b64_tr_b16 v[120:121], v8 offset:192
ds_read_b64_tr_b16 v[122:123], v8 offset:2752
ds_read_b64_tr_b16 v[128:129], v8 offset:256
ds_read_b64_tr_b16 v[130:131], v8 offset:2816
s_waitcnt lgkmcnt(0)
s_waitcnt vmcnt(10)
s_barrier
s_add_u32 s60, s31, 81920
s_mul_i32 s61, s24, 5120
s_add_u32 s61, s61, 0
s_add_u32 m0, s61, 0
s_nop 0
buffer_load_dwordx4 v104, s[16:19], s60 offen lds
s_add_u32 m0, s61, 1024
s_nop 0
buffer_load_dwordx4 v105, s[16:19], s60 offen lds
s_add_u32 m0, s61, 2048
s_nop 0
buffer_load_dwordx4 v106, s[16:19], s60 offen lds
s_add_u32 m0, s61, 3072
s_nop 0
buffer_load_dwordx4 v107, s[16:19], s60 offen lds
s_add_u32 m0, s61, 4096
s_nop 0
buffer_load_dwordx4 v108, s[16:19], s60 offen lds
ds_read_b64_tr_b16 a[244:245], v8 offset:20480
ds_read_b64_tr_b16 a[246:247], v8 offset:23040
ds_read_b64_tr_b16 a[252:253], v8 offset:20544
ds_read_b64_tr_b16 a[254:255], v8 offset:23104
ds_read_b64_tr_b16 v[116:117], v8 offset:20608
ds_read_b64_tr_b16 v[118:119], v8 offset:23168
ds_read_b64_tr_b16 v[124:125], v8 offset:20672
ds_read_b64_tr_b16 v[126:127], v8 offset:23232
ds_read_b64_tr_b16 v[132:133], v8 offset:20736
ds_read_b64_tr_b16 v[134:135], v8 offset:23296
s_waitcnt lgkmcnt(0)
s_waitcnt vmcnt(10)
s_barrier
s_add_u32 s60, s31, 102400
s_mul_i32 s61, s24, 5120
s_add_u32 s61, s61, 20480
s_add_u32 m0, s61, 0
s_nop 0
buffer_load_dwordx4 v104, s[16:19], s60 offen lds
s_add_u32 m0, s61, 1024
s_nop 0
buffer_load_dwordx4 v105, s[16:19], s60 offen lds
s_add_u32 m0, s61, 2048
s_nop 0
buffer_load_dwordx4 v106, s[16:19], s60 offen lds
s_add_u32 m0, s61, 3072
s_nop 0
buffer_load_dwordx4 v107, s[16:19], s60 offen lds
s_add_u32 m0, s61, 4096
s_nop 0
buffer_load_dwordx4 v108, s[16:19], s60 offen lds
ds_read_b64_tr_b16 v[136:137], v8 offset:40960
ds_read_b64_tr_b16 v[138:139], v8 offset:43520
ds_read_b64_tr_b16 v[144:145], v8 offset:41024
ds_read_b64_tr_b16 v[146:147], v8 offset:43584
ds_read_b64_tr_b16 v[152:153], v8 offset:41088
ds_read_b64_tr_b16 v[154:155], v8 offset:43648
ds_read_b64_tr_b16 v[160:161], v8 offset:41152
ds_read_b64_tr_b16 v[162:163], v8 offset:43712
ds_read_b64_tr_b16 v[168:169], v8 offset:41216
ds_read_b64_tr_b16 v[170:171], v8 offset:43776
s_waitcnt lgkmcnt(0)
s_waitcnt vmcnt(10)
s_barrier
s_add_u32 s60, s31, 122880
s_mul_i32 s61, s24, 5120
s_add_u32 s61, s61, 40960
s_add_u32 m0, s61, 0
s_nop 0
buffer_load_dwordx4 v104, s[16:19], s60 offen lds
s_add_u32 m0, s61, 1024
s_nop 0
buffer_load_dwordx4 v105, s[16:19], s60 offen lds
s_add_u32 m0, s61, 2048
s_nop 0
buffer_load_dwordx4 v106, s[16:19], s60 offen lds
s_add_u32 m0, s61, 3072
s_nop 0
buffer_load_dwordx4 v107, s[16:19], s60 offen lds
s_add_u32 m0, s61, 4096
s_nop 0
buffer_load_dwordx4 v108, s[16:19], s60 offen lds
ds_read_b64_tr_b16 v[140:141], v9 offset:12288
ds_read_b64_tr_b16 v[142:143], v9 offset:14848
ds_read_b64_tr_b16 v[148:149], v9 offset:12352
ds_read_b64_tr_b16 v[150:151], v9 offset:14912
ds_read_b64_tr_b16 v[156:157], v9 offset:12416
ds_read_b64_tr_b16 v[158:159], v9 offset:14976
ds_read_b64_tr_b16 v[164:165], v9 offset:12480
ds_read_b64_tr_b16 v[166:167], v9 offset:15040
ds_read_b64_tr_b16 v[172:173], v9 offset:12544
ds_read_b64_tr_b16 v[174:175], v9 offset:15104
s_waitcnt lgkmcnt(0)
s_waitcnt vmcnt(10)
s_barrier
s_add_u32 s60, s31, 143360
s_mul_i32 s61, s24, 5120
s_add_u32 s61, s61, 61440
s_add_u32 m0, s61, 0
s_nop 0
buffer_load_dwordx4 v104, s[16:19], s60 offen lds
s_add_u32 m0, s61, 1024
s_nop 0
buffer_load_dwordx4 v105, s[16:19], s60 offen lds
s_add_u32 m0, s61, 2048
s_nop 0
buffer_load_dwordx4 v106, s[16:19], s60 offen lds
s_add_u32 m0, s61, 3072
s_nop 0
buffer_load_dwordx4 v107, s[16:19], s60 offen lds
s_add_u32 m0, s61, 4096
s_nop 0
buffer_load_dwordx4 v108, s[16:19], s60 offen lds
ds_read_b64_tr_b16 v[176:177], v8 offset:0
ds_read_b64_tr_b16 v[178:179], v8 offset:2560
ds_read_b64_tr_b16 v[184:185], v8 offset:64
ds_read_b64_tr_b16 v[186:187], v8 offset:2624
ds_read_b64_tr_b16 v[192:193], v8 offset:128
ds_read_b64_tr_b16 v[194:195], v8 offset:2688
ds_read_b64_tr_b16 v[200:201], v8 offset:192
ds_read_b64_tr_b16 v[202:203], v8 offset:2752
ds_read_b64_tr_b16 v[208:209], v8 offset:256
ds_read_b64_tr_b16 v[210:211], v8 offset:2816
s_waitcnt lgkmcnt(0)
s_waitcnt vmcnt(10)
s_barrier
s_add_u32 s60, s31, 163840
s_mul_i32 s61, s24, 5120
s_add_u32 s61, s61, 0
s_add_u32 m0, s61, 0
s_nop 0
buffer_load_dwordx4 v104, s[16:19], s60 offen lds
s_add_u32 m0, s61, 1024
s_nop 0
buffer_load_dwordx4 v105, s[16:19], s60 offen lds
s_add_u32 m0, s61, 2048
s_nop 0
buffer_load_dwordx4 v106, s[16:19], s60 offen lds
s_add_u32 m0, s61, 3072
s_nop 0
buffer_load_dwordx4 v107, s[16:19], s60 offen lds
s_add_u32 m0, s61, 4096
s_nop 0
buffer_load_dwordx4 v108, s[16:19], s60 offen lds
ds_read_b64_tr_b16 v[180:181], v8 offset:20480
ds_read_b64_tr_b16 v[182:183], v8 offset:23040
ds_read_b64_tr_b16 v[188:189], v8 offset:20544
ds_read_b64_tr_b16 v[190:191], v8 offset:23104
ds_read_b64_tr_b16 v[196:197], v8 offset:20608
ds_read_b64_tr_b16 v[198:199], v8 offset:23168
ds_read_b64_tr_b16 v[204:205], v8 offset:20672
ds_read_b64_tr_b16 v[206:207], v8 offset:23232
ds_read_b64_tr_b16 v[212:213], v8 offset:20736
ds_read_b64_tr_b16 v[214:215], v8 offset:23296
s_waitcnt lgkmcnt(0)
s_waitcnt vmcnt(10)
s_barrier
s_add_u32 s60, s31, 184320
s_mul_i32 s61, s24, 5120
s_add_u32 s61, s61, 20480
s_add_u32 m0, s61, 0
s_nop 0
buffer_load_dwordx4 v104, s[16:19], s60 offen lds
s_add_u32 m0, s61, 1024
s_nop 0
buffer_load_dwordx4 v105, s[16:19], s60 offen lds
s_add_u32 m0, s61, 2048
s_nop 0
buffer_load_dwordx4 v106, s[16:19], s60 offen lds
s_add_u32 m0, s61, 3072
s_nop 0
buffer_load_dwordx4 v107, s[16:19], s60 offen lds
s_add_u32 m0, s61, 4096
s_nop 0
buffer_load_dwordx4 v108, s[16:19], s60 offen lds
ds_read_b64_tr_b16 v[216:217], v8 offset:40960
ds_read_b64_tr_b16 v[218:219], v8 offset:43520
ds_read_b64_tr_b16 v[224:225], v8 offset:41024
ds_read_b64_tr_b16 v[226:227], v8 offset:43584
ds_read_b64_tr_b16 v[232:233], v8 offset:41088
ds_read_b64_tr_b16 v[234:235], v8 offset:43648
ds_read_b64_tr_b16 v[240:241], v8 offset:41152
ds_read_b64_tr_b16 v[242:243], v8 offset:43712
ds_read_b64_tr_b16 v[248:249], v8 offset:41216
ds_read_b64_tr_b16 v[250:251], v8 offset:43776
s_waitcnt lgkmcnt(0)
s_waitcnt vmcnt(10)
s_barrier
s_add_u32 s60, s31, 204800
s_mul_i32 s61, s24, 5120
s_add_u32 s61, s61, 40960
s_add_u32 m0, s61, 0
s_nop 0
buffer_load_dwordx4 v104, s[16:19], s60 offen lds
s_add_u32 m0, s61, 1024
s_nop 0
buffer_load_dwordx4 v105, s[16:19], s60 offen lds
s_add_u32 m0, s61, 2048
s_nop 0
buffer_load_dwordx4 v106, s[16:19], s60 offen lds
s_add_u32 m0, s61, 3072
s_nop 0
buffer_load_dwordx4 v107, s[16:19], s60 offen lds
s_add_u32 m0, s61, 4096
s_nop 0
buffer_load_dwordx4 v108, s[16:19], s60 offen lds
ds_read_b64_tr_b16 v[220:221], v9 offset:12288
ds_read_b64_tr_b16 v[222:223], v9 offset:14848
ds_read_b64_tr_b16 v[228:229], v9 offset:12352
ds_read_b64_tr_b16 v[230:231], v9 offset:14912
ds_read_b64_tr_b16 v[236:237], v9 offset:12416
ds_read_b64_tr_b16 v[238:239], v9 offset:14976
ds_read_b64_tr_b16 v[244:245], v9 offset:12480
ds_read_b64_tr_b16 v[246:247], v9 offset:15040
ds_read_b64_tr_b16 v[252:253], v9 offset:12544
ds_read_b64_tr_b16 v[254:255], v9 offset:15104
s_waitcnt lgkmcnt(0)
s_waitcnt vmcnt(10)
s_barrier
s_add_u32 s60, s31, 225280
s_mul_i32 s61, s24, 5120
s_add_u32 s61, s61, 61440
s_add_u32 m0, s61, 0
s_nop 0
buffer_load_dwordx4 v104, s[16:19], s60 offen lds
s_add_u32 m0, s61, 1024
s_nop 0
buffer_load_dwordx4 v105, s[16:19], s60 offen lds
s_add_u32 m0, s61, 2048
s_nop 0
buffer_load_dwordx4 v106, s[16:19], s60 offen lds
s_add_u32 m0, s61, 3072
s_nop 0
buffer_load_dwordx4 v107, s[16:19], s60 offen lds
s_add_u32 m0, s61, 4096
s_nop 0
buffer_load_dwordx4 v108, s[16:19], s60 offen lds
ds_read_b64_tr_b16 v[16:17], v8 offset:0
ds_read_b64_tr_b16 v[18:19], v8 offset:2560
ds_read_b64_tr_b16 v[24:25], v8 offset:64
ds_read_b64_tr_b16 v[26:27], v8 offset:2624
ds_read_b64_tr_b16 v[32:33], v8 offset:128
ds_read_b64_tr_b16 v[34:35], v8 offset:2688
ds_read_b64_tr_b16 v[40:41], v8 offset:192
ds_read_b64_tr_b16 v[42:43], v8 offset:2752
ds_read_b64_tr_b16 v[48:49], v8 offset:256
ds_read_b64_tr_b16 v[50:51], v8 offset:2816
s_waitcnt lgkmcnt(0)
s_waitcnt vmcnt(10)
s_barrier
s_add_u32 s60, s30, 0
s_mul_i32 s61, s24, 3072
s_add_u32 s61, s61, 0
s_add_u32 m0, s61, 0
s_nop 0
buffer_load_dwordx4 v100, s[12:15], s60 offen lds
s_add_u32 m0, s61, 1024
s_nop 0
buffer_load_dwordx4 v101, s[12:15], s60 offen lds
s_add_u32 m0, s61, 2048
s_nop 0
buffer_load_dwordx4 v102, s[12:15], s60 offen lds
ds_read_b64_tr_b16 v[20:21], v8 offset:20480
ds_read_b64_tr_b16 v[22:23], v8 offset:23040
ds_read_b64_tr_b16 v[28:29], v8 offset:20544
ds_read_b64_tr_b16 v[30:31], v8 offset:23104
ds_read_b64_tr_b16 v[36:37], v8 offset:20608
ds_read_b64_tr_b16 v[38:39], v8 offset:23168
ds_read_b64_tr_b16 v[44:45], v8 offset:20672
ds_read_b64_tr_b16 v[46:47], v8 offset:23232
ds_read_b64_tr_b16 v[52:53], v8 offset:20736
ds_read_b64_tr_b16 v[54:55], v8 offset:23296
s_waitcnt lgkmcnt(0)
s_waitcnt vmcnt(8)
s_barrier
s_add_u32 s60, s30, 393216
s_mul_i32 s61, s24, 3072
s_add_u32 s61, s61, 12288
s_add_u32 m0, s61, 0
s_nop 0
buffer_load_dwordx4 v100, s[12:15], s60 offen lds
s_add_u32 m0, s61, 1024
s_nop 0
buffer_load_dwordx4 v101, s[12:15], s60 offen lds
s_add_u32 m0, s61, 2048
s_nop 0
buffer_load_dwordx4 v102, s[12:15], s60 offen lds
s_add_u32 s60, s30, 786432
s_mul_i32 s61, s24, 3072
s_add_u32 s61, s61, 24576
s_add_u32 m0, s61, 0
s_nop 0
buffer_load_dwordx4 v100, s[12:15], s60 offen lds
s_add_u32 m0, s61, 1024
s_nop 0
buffer_load_dwordx4 v101, s[12:15], s60 offen lds
s_add_u32 m0, s61, 2048
s_nop 0
buffer_load_dwordx4 v102, s[12:15], s60 offen lds
ds_read_b64_tr_b16 v[56:57], v8 offset:40960
ds_read_b64_tr_b16 v[58:59], v8 offset:43520
ds_read_b64_tr_b16 v[64:65], v8 offset:41024
ds_read_b64_tr_b16 v[66:67], v8 offset:43584
ds_read_b64_tr_b16 v[72:73], v8 offset:41088
ds_read_b64_tr_b16 v[74:75], v8 offset:43648
ds_read_b64_tr_b16 v[80:81], v8 offset:41152
ds_read_b64_tr_b16 v[82:83], v8 offset:43712
ds_read_b64_tr_b16 v[88:89], v8 offset:41216
ds_read_b64_tr_b16 v[90:91], v8 offset:43776
s_waitcnt lgkmcnt(0)
s_waitcnt vmcnt(9)
s_barrier
s_add_u32 s60, s30, 1179648
s_mul_i32 s61, s24, 3072
s_add_u32 s61, s61, 36864
s_add_u32 m0, s61, 0
s_nop 0
buffer_load_dwordx4 v100, s[12:15], s60 offen lds
s_add_u32 m0, s61, 1024
s_nop 0
buffer_load_dwordx4 v101, s[12:15], s60 offen lds
s_add_u32 m0, s61, 2048
s_nop 0
buffer_load_dwordx4 v102, s[12:15], s60 offen lds
s_add_u32 s60, s30, 1572864
s_mul_i32 s61, s24, 3072
s_add_u32 s61, s61, 49152
s_add_u32 m0, s61, 0
s_nop 0
buffer_load_dwordx4 v100, s[12:15], s60 offen lds
s_add_u32 m0, s61, 1024
s_nop 0
buffer_load_dwordx4 v101, s[12:15], s60 offen lds
s_add_u32 m0, s61, 2048
s_nop 0
buffer_load_dwordx4 v102, s[12:15], s60 offen lds
ds_read_b64_tr_b16 v[60:61], v9 offset:12288
ds_read_b64_tr_b16 v[62:63], v9 offset:14848
ds_read_b64_tr_b16 v[68:69], v9 offset:12352
ds_read_b64_tr_b16 v[70:71], v9 offset:14912
ds_read_b64_tr_b16 v[76:77], v9 offset:12416
ds_read_b64_tr_b16 v[78:79], v9 offset:14976
ds_read_b64_tr_b16 v[84:85], v9 offset:12480
ds_read_b64_tr_b16 v[86:87], v9 offset:15040
ds_read_b64_tr_b16 v[92:93], v9 offset:12544
ds_read_b64_tr_b16 v[94:95], v9 offset:15104
s_waitcnt lgkmcnt(0)
s_waitcnt vmcnt(12)
s_barrier
s_add_u32 s60, s30, 1966080
s_mul_i32 s61, s24, 3072
s_add_u32 s61, s61, 61440
s_add_u32 m0, s61, 0
s_nop 0
buffer_load_dwordx4 v100, s[12:15], s60 offen lds
s_add_u32 m0, s61, 1024
s_nop 0
buffer_load_dwordx4 v101, s[12:15], s60 offen lds
s_add_u32 m0, s61, 2048
s_nop 0
buffer_load_dwordx4 v102, s[12:15], s60 offen lds
ds_read_b64_tr_b16 a[0:1], v6 offset:0
ds_read_b64_tr_b16 a[2:3], v6 offset:1536
ds_read_b64_tr_b16 a[8:9], v6 offset:32
ds_read_b64_tr_b16 a[10:11], v6 offset:1568
ds_read_b64_tr_b16 a[16:17], v6 offset:64
ds_read_b64_tr_b16 a[18:19], v6 offset:1600
s_waitcnt lgkmcnt(0)
s_waitcnt vmcnt(12)
s_barrier
s_add_u32 s60, s30, 2359296
s_mul_i32 s61, s24, 3072
s_add_u32 s61, s61, 0
s_add_u32 m0, s61, 0
s_nop 0
buffer_load_dwordx4 v100, s[12:15], s60 offen lds
s_add_u32 m0, s61, 1024
s_nop 0
buffer_load_dwordx4 v101, s[12:15], s60 offen lds
s_add_u32 m0, s61, 2048
s_nop 0
buffer_load_dwordx4 v102, s[12:15], s60 offen lds
ds_read_b64_tr_b16 a[4:5], v6 offset:12288
ds_read_b64_tr_b16 a[6:7], v6 offset:13824
ds_read_b64_tr_b16 a[12:13], v6 offset:12320
ds_read_b64_tr_b16 a[14:15], v6 offset:13856
ds_read_b64_tr_b16 a[20:21], v6 offset:12352
ds_read_b64_tr_b16 a[22:23], v6 offset:13888
s_waitcnt lgkmcnt(0)
s_waitcnt vmcnt(12)
s_barrier
s_add_u32 s60, s30, 2752512
s_mul_i32 s61, s24, 3072
s_add_u32 s61, s61, 12288
s_add_u32 m0, s61, 0
s_nop 0
buffer_load_dwordx4 v100, s[12:15], s60 offen lds
s_add_u32 m0, s61, 1024
s_nop 0
buffer_load_dwordx4 v101, s[12:15], s60 offen lds
s_add_u32 m0, s61, 2048
s_nop 0
buffer_load_dwordx4 v102, s[12:15], s60 offen lds
ds_read_b64_tr_b16 a[24:25], v6 offset:24576
ds_read_b64_tr_b16 a[26:27], v6 offset:26112
ds_read_b64_tr_b16 a[32:33], v6 offset:24608
ds_read_b64_tr_b16 a[34:35], v6 offset:26144
ds_read_b64_tr_b16 a[40:41], v6 offset:24640
ds_read_b64_tr_b16 a[42:43], v6 offset:26176
s_waitcnt lgkmcnt(0)
s_waitcnt vmcnt(12)
s_barrier
s_add_u32 s60, s30, 3145728
s_mul_i32 s61, s24, 3072
s_add_u32 s61, s61, 24576
s_add_u32 m0, s61, 0
s_nop 0
buffer_load_dwordx4 v100, s[12:15], s60 offen lds
s_add_u32 m0, s61, 1024
s_nop 0
buffer_load_dwordx4 v101, s[12:15], s60 offen lds
s_add_u32 m0, s61, 2048
s_nop 0
buffer_load_dwordx4 v102, s[12:15], s60 offen lds
ds_read_b64_tr_b16 a[28:29], v6 offset:36864
ds_read_b64_tr_b16 a[30:31], v6 offset:38400
ds_read_b64_tr_b16 a[36:37], v6 offset:36896
ds_read_b64_tr_b16 a[38:39], v6 offset:38432
ds_read_b64_tr_b16 a[44:45], v6 offset:36928
ds_read_b64_tr_b16 a[46:47], v6 offset:38464
s_waitcnt lgkmcnt(0)
s_waitcnt vmcnt(12)
s_barrier
s_add_u32 s60, s30, 3538944
s_mul_i32 s61, s24, 3072
s_add_u32 s61, s61, 36864
s_add_u32 m0, s61, 0
s_nop 0
buffer_load_dwordx4 v100, s[12:15], s60 offen lds
s_add_u32 m0, s61, 1024
s_nop 0
buffer_load_dwordx4 v101, s[12:15], s60 offen lds
s_add_u32 m0, s61, 2048
s_nop 0
buffer_load_dwordx4 v102, s[12:15], s60 offen lds
ds_read_b64_tr_b16 a[48:49], v7 offset:0
ds_read_b64_tr_b16 a[50:51], v7 offset:1536
ds_read_b64_tr_b16 a[56:57], v7 offset:32
ds_read_b64_tr_b16 a[58:59], v7 offset:1568
ds_read_b64_tr_b16 a[64:65], v7 offset:64
ds_read_b64_tr_b16 a[66:67], v7 offset:1600
s_waitcnt lgkmcnt(0)
s_waitcnt vmcnt(12)
s_barrier
s_add_u32 s60, s30, 3932160
s_mul_i32 s61, s24, 3072
s_add_u32 s61, s61, 49152
s_add_u32 m0, s61, 0
s_nop 0
buffer_load_dwordx4 v100, s[12:15], s60 offen lds
s_add_u32 m0, s61, 1024
s_nop 0
buffer_load_dwordx4 v101, s[12:15], s60 offen lds
s_add_u32 m0, s61, 2048
s_nop 0
buffer_load_dwordx4 v102, s[12:15], s60 offen lds
ds_read_b64_tr_b16 a[52:53], v7 offset:12288
ds_read_b64_tr_b16 a[54:55], v7 offset:13824
ds_read_b64_tr_b16 a[60:61], v7 offset:12320
ds_read_b64_tr_b16 a[62:63], v7 offset:13856
ds_read_b64_tr_b16 a[68:69], v7 offset:12352
ds_read_b64_tr_b16 a[70:71], v7 offset:13888
s_waitcnt lgkmcnt(0)
s_waitcnt vmcnt(12)
s_barrier
s_add_u32 s60, s30, 4325376
s_mul_i32 s61, s24, 3072
s_add_u32 s61, s61, 61440
s_add_u32 m0, s61, 0
s_nop 0
buffer_load_dwordx4 v100, s[12:15], s60 offen lds
s_add_u32 m0, s61, 1024
s_nop 0
buffer_load_dwordx4 v101, s[12:15], s60 offen lds
s_add_u32 m0, s61, 2048
s_nop 0
buffer_load_dwordx4 v102, s[12:15], s60 offen lds
ds_read_b64_tr_b16 a[72:73], v6 offset:0
ds_read_b64_tr_b16 a[74:75], v6 offset:1536
ds_read_b64_tr_b16 a[80:81], v6 offset:32
ds_read_b64_tr_b16 a[82:83], v6 offset:1568
ds_read_b64_tr_b16 a[88:89], v6 offset:64
ds_read_b64_tr_b16 a[90:91], v6 offset:1600
s_waitcnt lgkmcnt(0)
s_waitcnt vmcnt(12)
s_barrier
s_add_u32 s60, s30, 4718592
s_mul_i32 s61, s24, 3072
s_add_u32 s61, s61, 0
s_add_u32 m0, s61, 0
s_nop 0
buffer_load_dwordx4 v100, s[12:15], s60 offen lds
s_add_u32 m0, s61, 1024
s_nop 0
buffer_load_dwordx4 v101, s[12:15], s60 offen lds
s_add_u32 m0, s61, 2048
s_nop 0
buffer_load_dwordx4 v102, s[12:15], s60 offen lds
ds_read_b64_tr_b16 a[76:77], v6 offset:12288
ds_read_b64_tr_b16 a[78:79], v6 offset:13824
ds_read_b64_tr_b16 a[84:85], v6 offset:12320
ds_read_b64_tr_b16 a[86:87], v6 offset:13856
ds_read_b64_tr_b16 a[92:93], v6 offset:12352
ds_read_b64_tr_b16 a[94:95], v6 offset:13888
s_waitcnt lgkmcnt(0)
s_waitcnt vmcnt(12)
s_barrier
s_add_u32 s60, s30, 5111808
s_mul_i32 s61, s24, 3072
s_add_u32 s61, s61, 12288
s_add_u32 m0, s61, 0
s_nop 0
buffer_load_dwordx4 v100, s[12:15], s60 offen lds
s_add_u32 m0, s61, 1024
s_nop 0
buffer_load_dwordx4 v101, s[12:15], s60 offen lds
s_add_u32 m0, s61, 2048
s_nop 0
buffer_load_dwordx4 v102, s[12:15], s60 offen lds
ds_read_b64_tr_b16 a[96:97], v6 offset:24576
ds_read_b64_tr_b16 a[98:99], v6 offset:26112
ds_read_b64_tr_b16 a[104:105], v6 offset:24608
ds_read_b64_tr_b16 a[106:107], v6 offset:26144
ds_read_b64_tr_b16 a[112:113], v6 offset:24640
ds_read_b64_tr_b16 a[114:115], v6 offset:26176
s_waitcnt lgkmcnt(0)
s_waitcnt vmcnt(12)
s_barrier
s_add_u32 s60, s30, 5505024
s_mul_i32 s61, s24, 3072
s_add_u32 s61, s61, 24576
s_add_u32 m0, s61, 0
s_nop 0
buffer_load_dwordx4 v100, s[12:15], s60 offen lds
s_add_u32 m0, s61, 1024
s_nop 0
buffer_load_dwordx4 v101, s[12:15], s60 offen lds
s_add_u32 m0, s61, 2048
s_nop 0
buffer_load_dwordx4 v102, s[12:15], s60 offen lds
ds_read_b64_tr_b16 a[100:101], v6 offset:36864
ds_read_b64_tr_b16 a[102:103], v6 offset:38400
ds_read_b64_tr_b16 a[108:109], v6 offset:36896
ds_read_b64_tr_b16 a[110:111], v6 offset:38432
ds_read_b64_tr_b16 a[116:117], v6 offset:36928
ds_read_b64_tr_b16 a[118:119], v6 offset:38464
s_waitcnt lgkmcnt(0)
s_waitcnt vmcnt(12)
s_barrier
s_add_u32 s60, s30, 5898240
s_mul_i32 s61, s24, 3072
s_add_u32 s61, s61, 36864
s_add_u32 m0, s61, 0
s_nop 0
buffer_load_dwordx4 v100, s[12:15], s60 offen lds
s_add_u32 m0, s61, 1024
s_nop 0
buffer_load_dwordx4 v101, s[12:15], s60 offen lds
s_add_u32 m0, s61, 2048
s_nop 0
buffer_load_dwordx4 v102, s[12:15], s60 offen lds
ds_read_b64_tr_b16 a[120:121], v7 offset:0
ds_read_b64_tr_b16 a[122:123], v7 offset:1536
ds_read_b64_tr_b16 a[128:129], v7 offset:32
ds_read_b64_tr_b16 a[130:131], v7 offset:1568
ds_read_b64_tr_b16 a[136:137], v7 offset:64
ds_read_b64_tr_b16 a[138:139], v7 offset:1600
s_waitcnt lgkmcnt(0)
s_waitcnt vmcnt(12)
s_barrier
s_add_u32 s60, s30, 6291456
s_mul_i32 s61, s24, 3072
s_add_u32 s61, s61, 49152
s_add_u32 m0, s61, 0
s_nop 0
buffer_load_dwordx4 v100, s[12:15], s60 offen lds
s_add_u32 m0, s61, 1024
s_nop 0
buffer_load_dwordx4 v101, s[12:15], s60 offen lds
s_add_u32 m0, s61, 2048
s_nop 0
buffer_load_dwordx4 v102, s[12:15], s60 offen lds
ds_read_b64_tr_b16 a[124:125], v7 offset:12288
ds_read_b64_tr_b16 a[126:127], v7 offset:13824
ds_read_b64_tr_b16 a[132:133], v7 offset:12320
ds_read_b64_tr_b16 a[134:135], v7 offset:13856
ds_read_b64_tr_b16 a[140:141], v7 offset:12352
ds_read_b64_tr_b16 a[142:143], v7 offset:13888
s_waitcnt lgkmcnt(0)
s_waitcnt vmcnt(12)
s_barrier
s_add_u32 s60, s30, 6684672
s_mul_i32 s61, s24, 3072
s_add_u32 s61, s61, 61440
s_add_u32 m0, s61, 0
s_nop 0
buffer_load_dwordx4 v100, s[12:15], s60 offen lds
s_add_u32 m0, s61, 1024
s_nop 0
buffer_load_dwordx4 v101, s[12:15], s60 offen lds
s_add_u32 m0, s61, 2048
s_nop 0
buffer_load_dwordx4 v102, s[12:15], s60 offen lds
ds_read_b64_tr_b16 a[144:145], v6 offset:0
ds_read_b64_tr_b16 a[146:147], v6 offset:1536
ds_read_b64_tr_b16 a[152:153], v6 offset:32
ds_read_b64_tr_b16 a[154:155], v6 offset:1568
ds_read_b64_tr_b16 a[160:161], v6 offset:64
ds_read_b64_tr_b16 a[162:163], v6 offset:1600
s_waitcnt lgkmcnt(0)
s_waitcnt vmcnt(12)
s_barrier
s_add_u32 s60, s30, 7077888
s_mul_i32 s61, s24, 3072
s_add_u32 s61, s61, 0
s_add_u32 m0, s61, 0
s_nop 0
buffer_load_dwordx4 v100, s[12:15], s60 offen lds
s_add_u32 m0, s61, 1024
s_nop 0
buffer_load_dwordx4 v101, s[12:15], s60 offen lds
s_add_u32 m0, s61, 2048
s_nop 0
buffer_load_dwordx4 v102, s[12:15], s60 offen lds
ds_read_b64_tr_b16 a[148:149], v6 offset:12288
ds_read_b64_tr_b16 a[150:151], v6 offset:13824
ds_read_b64_tr_b16 a[156:157], v6 offset:12320
ds_read_b64_tr_b16 a[158:159], v6 offset:13856
ds_read_b64_tr_b16 a[164:165], v6 offset:12352
ds_read_b64_tr_b16 a[166:167], v6 offset:13888
s_waitcnt lgkmcnt(0)
s_waitcnt vmcnt(12)
s_barrier
s_add_u32 s60, s30, 7471104
s_mul_i32 s61, s24, 3072
s_add_u32 s61, s61, 12288
s_add_u32 m0, s61, 0
s_nop 0
buffer_load_dwordx4 v100, s[12:15], s60 offen lds
s_add_u32 m0, s61, 1024
s_nop 0
buffer_load_dwordx4 v101, s[12:15], s60 offen lds
s_add_u32 m0, s61, 2048
s_nop 0
buffer_load_dwordx4 v102, s[12:15], s60 offen lds
ds_read_b64_tr_b16 a[168:169], v6 offset:24576
ds_read_b64_tr_b16 a[170:171], v6 offset:26112
ds_read_b64_tr_b16 a[176:177], v6 offset:24608
ds_read_b64_tr_b16 a[178:179], v6 offset:26144
ds_read_b64_tr_b16 a[184:185], v6 offset:24640
ds_read_b64_tr_b16 a[186:187], v6 offset:26176
s_waitcnt lgkmcnt(0)
s_waitcnt vmcnt(12)
s_barrier
ds_read_b64_tr_b16 a[172:173], v6 offset:36864
ds_read_b64_tr_b16 a[174:175], v6 offset:38400
ds_read_b64_tr_b16 a[180:181], v6 offset:36896
ds_read_b64_tr_b16 a[182:183], v6 offset:38432
ds_read_b64_tr_b16 a[188:189], v6 offset:36928
ds_read_b64_tr_b16 a[190:191], v6 offset:38464
s_waitcnt lgkmcnt(0)
s_waitcnt vmcnt(9)
s_barrier
ds_read_b64_tr_b16 a[192:193], v7 offset:0
ds_read_b64_tr_b16 a[194:195], v7 offset:1536
ds_read_b64_tr_b16 a[200:201], v7 offset:32
ds_read_b64_tr_b16 a[202:203], v7 offset:1568
ds_read_b64_tr_b16 a[208:209], v7 offset:64
ds_read_b64_tr_b16 a[210:211], v7 offset:1600
s_waitcnt lgkmcnt(0)
s_waitcnt vmcnt(6)
s_barrier
ds_read_b64_tr_b16 a[196:197], v7 offset:12288
ds_read_b64_tr_b16 a[198:199], v7 offset:13824
ds_read_b64_tr_b16 a[204:205], v7 offset:12320
ds_read_b64_tr_b16 a[206:207], v7 offset:13856
ds_read_b64_tr_b16 a[212:213], v7 offset:12352
ds_read_b64_tr_b16 a[214:215], v7 offset:13888
s_waitcnt lgkmcnt(0)
s_waitcnt vmcnt(3)
s_barrier
ds_read_b64_tr_b16 a[216:217], v6 offset:0
ds_read_b64_tr_b16 a[218:219], v6 offset:1536
ds_read_b64_tr_b16 a[224:225], v6 offset:32
ds_read_b64_tr_b16 a[226:227], v6 offset:1568
ds_read_b64_tr_b16 a[232:233], v6 offset:64
ds_read_b64_tr_b16 a[234:235], v6 offset:1600
s_waitcnt lgkmcnt(0)
s_waitcnt vmcnt(0)
s_barrier
ds_read_b64_tr_b16 a[220:221], v6 offset:12288
ds_read_b64_tr_b16 a[222:223], v6 offset:13824
ds_read_b64_tr_b16 a[228:229], v6 offset:12320
ds_read_b64_tr_b16 a[230:231], v6 offset:13856
ds_read_b64_tr_b16 a[236:237], v6 offset:12352
ds_read_b64_tr_b16 a[238:239], v6 offset:13888
s_waitcnt lgkmcnt(0)
s_barrier
s_mul_i32 s28, s24, 20480
v_add_u32 v5, s28, v1
ds_write_b128 v5, v[16:19] offset:0
ds_write_b128 v5, v[20:23] offset:1024
ds_write_b128 v5, v[24:27] offset:2048
ds_write_b128 v5, v[28:31] offset:3072
ds_write_b128 v5, v[32:35] offset:4096
ds_write_b128 v5, v[36:39] offset:5120
ds_write_b128 v5, v[40:43] offset:6144
ds_write_b128 v5, v[44:47] offset:7168
ds_write_b128 v5, v[48:51] offset:8192
ds_write_b128 v5, v[52:55] offset:9216
ds_write_b128 v5, v[56:59] offset:10240
ds_write_b128 v5, v[60:63] offset:11264
ds_write_b128 v5, v[64:67] offset:12288
ds_write_b128 v5, v[68:71] offset:13312
ds_write_b128 v5, v[72:75] offset:14336
ds_write_b128 v5, v[76:79] offset:15360
ds_write_b128 v5, v[80:83] offset:16384
ds_write_b128 v5, v[84:87] offset:17408
ds_write_b128 v5, v[88:91] offset:18432
ds_write_b128 v5, v[92:95] offset:19456
s_waitcnt lgkmcnt(0)
s_mov_b32 s62, 0
v_mov_b32 v15, 128
Bwc:
s_add_u32 s62, s62, 1
s_mov_b32 s63, 1
s_cmp_gt_u32 s62, 400000
s_cbranch_scc1 L_err
buffer_load_dwordx3 v[12:14], v15, s[20:23], 0 offen sc1
s_waitcnt vmcnt(0)
v_readfirstlane_b32 s41, v12
v_readfirstlane_b32 s42, v13
v_readfirstlane_b32 s57, v14
s_and_b32 s43, s41, s42
s_cmp_eq_u32 s57, 0
s_cselect_b32 s43, 0, s43
s_bitcmp1_b32 s43, 8
s_cbranch_scc0 Bwc
s_bfe_u32 s3, s41, 0x10001
s_and_b32 s41, s41, 7
s_and_b32 s42, s42, 7
s_xor_b32 s52, s41, 7
s_lshl_b32 s52, s52, 12
s_xor_b32 s44, s42, 7
s_lshl_b32 s44, s44, 12
s_xor_b32 s53, s41, 3
s_lshl_b32 s53, s53, 12
s_xor_b32 s45, s42, 3
s_lshl_b32 s45, s45, 12
s_xor_b32 s54, s41, 6
s_lshl_b32 s54, s54, 12
s_xor_b32 s46, s42, 6
s_lshl_b32 s46, s46, 12
s_xor_b32 s55, s41, 2
s_lshl_b32 s55, s55, 12
s_xor_b32 s47, s42, 2
s_lshl_b32 s47, s47, 12
s_and_b32 s41, s27, 3
s_mov_b32 s35, s52
s_cmp_eq_u32 s41, 1
s_cselect_b32 s35, s53, s35
s_cmp_eq_u32 s41, 2
s_cselect_b32 s35, s54, s35
s_cmp_eq_u32 s41, 3
s_cselect_b32 s35, s55, s35
s_mov_b32 s33, s44
s_cmp_eq_u32 s24, 1
s_cselect_b32 s33, s45, s33
s_cmp_eq_u32 s24, 2
s_cselect_b32 s33, s46, s33
s_cmp_eq_u32 s24, 3
s_cselect_b32 s33, s47, s33
v_mov_b32 v7, 0x4444
v_mov_b32 v12, 0xeeee
v_cmp_gt_u32 vcc, 8, v2
s_nop 1
v_cndmask_b32 v7, v12, v7, vcc
s_mul_i32 s41, s24, 2560
s_add_u32 s41, s41, 81920
v_add_u32 v4, s41, v1
s_mov_b32 s32, 2097152
s_lshl_b32 s34, s25, 7
s_add_u32 s34, s34, 4218880
s_add_u32 s61, s57, 0
v_mov_b32 v14, s61
v_mov_b32 v15, 0
s_mov_b64 exec, 1
buffer_store_dword v14, v15, s[4:7], s34 offen sc1
s_mov_b64 exec, -1
s_mul_i32 s41, s24, 10
s_add_u32 s41, s41, 10560
v_lshrrev_b32 v12, 1, v3
v_and_b32 v13, 1, v3
v_lshl_or_b32 v13, v13, 1, v12
v_add_u32 v10, s41, v13
s_add_u32 s41, s41, 8
v_add_u32 v11, s41, v12
s_lshl_b32 s41, s25, 8
s_lshl_b32 s42, s3, 13
s_add_u32 s41, s41, s42
v_lshl_add_u32 v12, v2, 4, s41
v_lshl_add_u32 v10, v10, 14, v12
v_lshl_add_u32 v11, v11, 14, v12
s_mul_i32 s41, s24, 3072
s_add_u32 s41, s41, 96256
v_add_u32 v111, s41, v1
s_mov_b32 s43, 0
s_mul_i32 s41, s43, 20
s_lshr_b32 s42, s25, 4
s_add_u32 s41, s41, s42
s_and_b32 s42, s25, 15
s_lshl_b32 s42, s42, 8
v_lshlrev_b32 v15, 4, v2
v_add_u32 v15, s42, v15
v_lshrrev_b32 v12, 1, v3
v_and_b32 v13, 1, v3
v_lshl_or_b32 v12, v13, 1, v12
v_add_u32 v12, 0, v12
v_lshl_add_u32 v12, v12, 1, s41
v_bfe_u32 v13, v12, 4, 1
v_lshlrev_b32 v13, 14, v13
v_bfe_u32 v14, v12, 5, 1
v_lshlrev_b32 v14, 12, v14
v_xor_b32 v13, v13, v14
v_xor_b32 v13, s33, v13
v_lshlrev_b32 v12, 15, v12
v_add3_u32 v16, v12, v13, v15
v_lshrrev_b32 v12, 1, v3
v_and_b32 v13, 1, v3
v_lshl_or_b32 v12, v13, 1, v12
v_add_u32 v12, 4, v12
v_lshl_add_u32 v12, v12, 1, s41
v_bfe_u32 v13, v12, 4, 1
v_lshlrev_b32 v13, 14, v13
v_bfe_u32 v14, v12, 5, 1
v_lshlrev_b32 v14, 12, v14
v_xor_b32 v13, v13, v14
v_xor_b32 v13, s33, v13
v_lshlrev_b32 v12, 15, v12
v_add3_u32 v17, v12, v13, v15
v_lshrrev_b32 v12, 1, v3
v_add_u32 v12, 8, v12
v_lshl_add_u32 v12, v12, 1, s41
v_bfe_u32 v13, v12, 4, 1
v_lshlrev_b32 v13, 14, v13
v_bfe_u32 v14, v12, 5, 1
v_lshlrev_b32 v14, 12, v14
v_xor_b32 v13, v13, v14
v_xor_b32 v13, s33, v13
v_lshlrev_b32 v12, 15, v12
v_add3_u32 v18, v12, v13, v15
ds_write_b128 v111, v[16:19] offset:0
s_add_u32 s41, s24, 0
s_bfe_u32 s60, s41, 0x10004
s_lshl_b32 s60, s60, 14
s_bfe_u32 s61, s41, 0x10005
s_lshl_b32 s61, s61, 12
s_xor_b32 s60, s60, s61
s_xor_b32 s60, s60, s35
s_lshl_b32 s64, s41, 15
s_add_u32 s64, s64, s60
s_mov_b32 s43, 1
s_mul_i32 s41, s43, 20
s_lshr_b32 s42, s25, 4
s_add_u32 s41, s41, s42
s_and_b32 s42, s25, 15
s_lshl_b32 s42, s42, 8
v_lshlrev_b32 v15, 4, v2
v_add_u32 v15, s42, v15
v_lshrrev_b32 v12, 1, v3
v_and_b32 v13, 1, v3
v_lshl_or_b32 v12, v13, 1, v12
v_add_u32 v12, 0, v12
v_lshl_add_u32 v12, v12, 1, s41
v_bfe_u32 v13, v12, 4, 1
v_lshlrev_b32 v13, 14, v13
v_bfe_u32 v14, v12, 5, 1
v_lshlrev_b32 v14, 12, v14
v_xor_b32 v13, v13, v14
v_xor_b32 v13, s33, v13
v_lshlrev_b32 v12, 15, v12
v_add3_u32 v16, v12, v13, v15
v_lshrrev_b32 v12, 1, v3
v_and_b32 v13, 1, v3
v_lshl_or_b32 v12, v13, 1, v12
v_add_u32 v12, 4, v12
v_lshl_add_u32 v12, v12, 1, s41
v_bfe_u32 v13, v12, 4, 1
v_lshlrev_b32 v13, 14, v13
v_bfe_u32 v14, v12, 5, 1
v_lshlrev_b32 v14, 12, v14
v_xor_b32 v13, v13, v14
v_xor_b32 v13, s33, v13
v_lshlrev_b32 v12, 15, v12
v_add3_u32 v17, v12, v13, v15
v_lshrrev_b32 v12, 1, v3
v_add_u32 v12, 8, v12
v_lshl_add_u32 v12, v12, 1, s41
v_bfe_u32 v13, v12, 4, 1
v_lshlrev_b32 v13, 14, v13
v_bfe_u32 v14, v12, 5, 1
v_lshlrev_b32 v14, 12, v14
v_xor_b32 v13, v13, v14
v_xor_b32 v13, s33, v13
v_lshlrev_b32 v12, 15, v12
v_add3_u32 v18, v12, v13, v15
ds_write_b128 v111, v[16:19] offset:1024
s_add_u32 s41, s24, 4
s_bfe_u32 s60, s41, 0x10004
s_lshl_b32 s60, s60, 14
s_bfe_u32 s61, s41, 0x10005
s_lshl_b32 s61, s61, 12
s_xor_b32 s60, s60, s61
s_xor_b32 s60, s60, s35
s_lshl_b32 s65, s41, 15
s_add_u32 s65, s65, s60
s_mov_b32 s43, 2
s_mul_i32 s41, s43, 20
s_lshr_b32 s42, s25, 4
s_add_u32 s41, s41, s42
s_and_b32 s42, s25, 15
s_lshl_b32 s42, s42, 8
v_lshlrev_b32 v15, 4, v2
v_add_u32 v15, s42, v15
v_lshrrev_b32 v12, 1, v3
v_and_b32 v13, 1, v3
v_lshl_or_b32 v12, v13, 1, v12
v_add_u32 v12, 0, v12
v_lshl_add_u32 v12, v12, 1, s41
v_bfe_u32 v13, v12, 4, 1
v_lshlrev_b32 v13, 14, v13
v_bfe_u32 v14, v12, 5, 1
v_lshlrev_b32 v14, 12, v14
v_xor_b32 v13, v13, v14
v_xor_b32 v13, s33, v13
v_lshlrev_b32 v12, 15, v12
v_add3_u32 v16, v12, v13, v15
v_lshrrev_b32 v12, 1, v3
v_and_b32 v13, 1, v3
v_lshl_or_b32 v12, v13, 1, v12
v_add_u32 v12, 4, v12
v_lshl_add_u32 v12, v12, 1, s41
v_bfe_u32 v13, v12, 4, 1
v_lshlrev_b32 v13, 14, v13
v_bfe_u32 v14, v12, 5, 1
v_lshlrev_b32 v14, 12, v14
v_xor_b32 v13, v13, v14
v_xor_b32 v13, s33, v13
v_lshlrev_b32 v12, 15, v12
v_add3_u32 v17, v12, v13, v15
v_lshrrev_b32 v12, 1, v3
v_add_u32 v12, 8, v12
v_lshl_add_u32 v12, v12, 1, s41
v_bfe_u32 v13, v12, 4, 1
v_lshlrev_b32 v13, 14, v13
v_bfe_u32 v14, v12, 5, 1
v_lshlrev_b32 v14, 12, v14
v_xor_b32 v13, v13, v14
v_xor_b32 v13, s33, v13
v_lshlrev_b32 v12, 15, v12
v_add3_u32 v18, v12, v13, v15
ds_write_b128 v111, v[16:19] offset:2048
s_add_u32 s41, s24, 8
s_bfe_u32 s60, s41, 0x10004
s_lshl_b32 s60, s60, 14
s_bfe_u32 s61, s41, 0x10005
s_lshl_b32 s61, s61, 12
s_xor_b32 s60, s60, s61
s_xor_b32 s60, s60, s35
s_lshl_b32 s66, s41, 15
s_add_u32 s66, s66, s60
s_waitcnt lgkmcnt(0)
v_lshrrev_b32 v12, 1, v3
v_lshl_add_u32 v12, v12, 4, v2
v_lshlrev_b32 v12, 4, v12
v_and_b32 v13, 1, v3
v_lshl_add_u32 v12, v13, 3, v12
s_mul_i32 s41, s24, 768
s_add_u32 s41, s41, 92160
v_add_u32 v8, s41, v12
v_bfe_u32 v12, v0, 2, 2
v_lshl_add_u32 v12, v3, 3, v12
v_lshlrev_b32 v12, 4, v12
v_and_b32 v13, 1, v0
v_lshl_add_u32 v12, v13, 3, v12
v_add_u32 v9, 92160, v12
v_add_u32 v6, 81920, v1
s_mov_b32 s36, 2
s_mov_b32 s37, 0
s_mov_b32 s38, 1
s_mov_b32 s40, 0
s_mov_b32 s16, 0
s_mov_b32 s17, 0
s_mov_b32 s18, 125
s_mov_b32 s19, 54
s_mov_b32 s26, 1
s_mov_b32 s56, 1
v_min_u32 v13, 39, v0
v_lshlrev_b32 v13, 7, v13
s_mov_b32 s41, 4222976
s_mov_b32 s62, 0
s_add_u32 s61, s57, 0
B_rr:
s_add_u32 s62, s62, 1
s_mov_b32 s63, 2
s_cmp_gt_u32 s62, 400000
s_cbranch_scc1 L_err
buffer_load_dword v14, v13, s[4:7], s41 offen sc1
s_waitcnt vmcnt(0)
v_subrev_u32 v14, s61, v14
v_cmp_lt_u32 vcc, 64, v14
s_cbranch_vccnz B_rr
s_mov_b32 s47, 0
v_add_u32 v12, s47, v111
s_add_u32 s47, s47, 1024
s_cmp_eq_u32 s47, 3072
s_cselect_b32 s47, 0, s47
s_mov_b32 s39, s64
s_mov_b32 s64, s65
s_mov_b32 s65, s66
s_mov_b32 s66, s39
ds_read_b96 v[108:110], v12
s_add_u32 s41, s47, 1024
s_cmp_eq_u32 s41, 3072
s_cselect_b32 s41, 0, s41
v_add_u32 v12, s41, v111
ds_read_b96 v[104:106], v12
B_loop:
v_mov_b64 v[24:25], 0
v_mov_b64 v[26:27], 0
v_mov_b64 v[56:57], 0
v_mov_b64 v[58:59], 0
v_mov_b64 v[60:61], 0
v_mov_b64 v[62:63], 0
v_mov_b64 v[64:65], 0
v_mov_b64 v[66:67], 0
v_mov_b64 v[68:69], 0
v_mov_b64 v[70:71], 0
v_mov_b64 v[72:73], 0
v_mov_b64 v[74:75], 0
v_mov_b64 v[76:77], 0
v_mov_b64 v[78:79], 0
v_mov_b64 v[80:81], 0
v_mov_b64 v[82:83], 0
v_mov_b64 v[84:85], 0
v_mov_b64 v[86:87], 0
ds_read_b128 v[88:91], v5 offset:0
ds_read_b128 v[92:95], v5 offset:1024
ds_read_b128 v[96:99], v5 offset:10240
ds_read_b128 v[100:103], v5 offset:11264
s_cmp_eq_u32 s40, 0
s_cbranch_scc1 B_tm
s_add_u32 s50, s57, s40
v_mov_b32 v13, 95744
s_cmp_lg_u32 s24, 3
s_cbranch_scc1 B_t1
s_sub_u32 s50, s40, 1
s_sleep 10
s_xor_b32 s43, s35, 0x1000
s_add_u32 s43, s43, 1179648
s_and_b32 s44, s50, 3
s_mul_i32 s44, s44, 98304
s_add_u32 s44, s44, s43
s_and_b32 s45, s50, 3
s_mul_i32 s45, s45, 98304
s_add_u32 s45, s45, s43
s_add_u32 s45, s45, 65536
v_min_u32 v32, 39, v0
v_lshrrev_b32 v33, 5, v32
v_mul_u32_u24 v33, 28672, v33
v_lshl_add_u32 v32, v32, 7, v33
v_and_b32 v33, 31, v0
v_lshlrev_b32 v33, 7, v33
buffer_load_dwordx2 v[30:31], v32, s[4:7], s44 offen sc1
buffer_load_dwordx2 v[28:29], v33, s[4:7], s45 offen sc1
s_mov_b32 s62, 0
s_add_u32 s60, s57, s50
s_add_u32 s61, s57, s50
s_waitcnt vmcnt(0)
s_branch B_stc
B_st:
s_add_u32 s62, s62, 1
s_mov_b32 s63, 16
s_cmp_gt_u32 s62, 400000
s_cbranch_scc1 L_err
buffer_load_dwordx2 v[30:31], v32, s[4:7], s44 offen sc1
buffer_load_dwordx2 v[28:29], v33, s[4:7], s45 offen sc1
s_waitcnt vmcnt(0)
B_stc:
v_xor_b32 v31, s60, v31
v_xor_b32 v29, s61, v29
v_or_b32 v31, v31, v29
v_cmp_ne_u32 vcc, 0, v31
s_cbranch_vccnz B_st
v_max_i32_dpp v30, v30, v30 quad_perm:[1,0,3,2] row_mask:0xf bank_mask:0xf
v_max_i32_dpp v28, v28, v28 quad_perm:[1,0,3,2] row_mask:0xf bank_mask:0xf
s_nop 0
v_max_i32_dpp v30, v30, v30 quad_perm:[2,3,0,1] row_mask:0xf bank_mask:0xf
v_max_i32_dpp v28, v28, v28 quad_perm:[2,3,0,1] row_mask:0xf bank_mask:0xf
s_nop 0
v_max_i32_dpp v30, v30, v30 row_ror:4 row_mask:0xf bank_mask:0xf
v_max_i32_dpp v28, v28, v28 row_ror:4 row_mask:0xf bank_mask:0xf
s_nop 0
v_max_i32_dpp v30, v30, v30 row_ror:8 row_mask:0xf bank_mask:0xf
v_max_i32_dpp v28, v28, v28 row_ror:8 row_mask:0xf bank_mask:0xf
v_readlane_b32 s42, v30, 0
v_readlane_b32 s41, v30, 16
v_readlane_b32 s60, v30, 32
v_readlane_b32 s43, v28, 0
v_readlane_b32 s61, v28, 16
s_max_i32 s42, s42, s41
s_max_i32 s42, s42, s60
s_max_i32 s43, s43, s61
s_sub_u32 s41, s42, s17
s_sub_u32 s60, s19, 2
s_max_i32 s60, s60, s41
s_add_u32 s61, s19, 2
s_min_i32 s60, s60, s61
s_cmp_lg_u32 s26, 0
s_cselect_b32 s19, s19, s60
s_add_u32 s41, s42, 5
s_cmp_gt_i32 s41, s16
s_cselect_b32 s56, 1, 0
s_add_u32 s41, s42, 28
s_cmp_lg_u32 s56, 0
s_cselect_b32 s41, s41, s16
s_add_u32 s17, s41, s18
s_add_u32 s17, s17, 15
s_sub_u32 s41, s43, s16
s_sub_u32 s60, s18, 2
s_max_i32 s60, s60, s41
s_add_u32 s61, s18, 2
s_min_i32 s60, s60, s61
s_cmp_lg_u32 s56, 0
s_cselect_b32 s18, s18, s60
s_add_u32 s41, s43, 10
s_cmp_gt_i32 s41, s17
s_cselect_b32 s26, 1, 0
s_add_u32 s41, s43, 28
s_cmp_lg_u32 s26, 0
s_cselect_b32 s41, s41, s17
s_add_u32 s16, s41, s19
s_add_u32 s16, s16, 8
s_add_u32 s50, s57, s40
v_mov_b32 v14, s16
v_mov_b32 v15, s50
v_mov_b32 v13, 95744
ds_write_b64 v13, v[14:15]
s_branch B_t2
B_t1:
s_mov_b32 s62, 0
B_t3:
s_add_u32 s62, s62, 1
s_mov_b32 s63, 17
s_cmp_gt_u32 s62, 400000
s_cbranch_scc1 L_err
ds_read_b64 v[14:15], v13
s_waitcnt lgkmcnt(0)
v_readfirstlane_b32 s41, v15
v_readfirstlane_b32 s16, v14
s_cmp_lg_u32 s41, s50
s_cbranch_scc1 B_t3
B_t2:
s_add_u32 s43, s16, s57
s_add_u32 s43, s43, 0
B_wu:
s_memrealtime s[58:59]
s_waitcnt lgkmcnt(0)
s_sub_u32 s59, s58, s43
s_cmp_lt_i32 s59, 0
s_cbranch_scc1 B_wu
B_tm:
s_mov_b32 s62, -1
Bgm:
buffer_load_dwordx4 v[16:19], v1, s[4:7], s39 offen sc1
buffer_load_dwordx4 v[20:23], v1, s[4:7], s39 offen offset:1024 sc1
s_mov_b32 exec_hi, 0
buffer_load_dwordx4 v[24:27], v1, s[4:7], s39 offen offset:2048 sc1
s_mov_b32 exec_hi, -1
s_add_u32 s62, s62, 1
s_add_u32 s62, s62, 1
s_mov_b32 s63, 5
s_cmp_gt_u32 s62, 400000
s_cbranch_scc1 L_err
s_waitcnt vmcnt(2)
ds_write_b128 v4, v[16:19]
s_waitcnt vmcnt(1)
ds_write_b128 v4, v[20:23] offset:1024
s_mov_b32 exec_hi, 0
s_waitcnt vmcnt(0)
ds_write_b128 v4, v[24:27] offset:2048
s_mov_b32 exec_hi, -1
v_max3_u32 v14, v16, v20, v24
v_cmp_eq_u32 vcc, -1, v14
s_cbranch_vccnz Bgm
s_waitcnt lgkmcnt(0)
s_barrier
ds_read_b128 v[16:19], v6 offset:0
ds_read_b128 v[20:23], v6 offset:1024
ds_read_b128 v[24:27], v6 offset:2048
ds_read_b128 v[28:31], v6 offset:3072
ds_read_b128 v[32:35], v6 offset:4096
ds_read_b128 v[36:39], v6 offset:5120
ds_read_b128 v[40:43], v6 offset:6144
ds_read_b128 v[44:47], v6 offset:7168
ds_read_b128 v[48:51], v6 offset:8192
ds_read_b128 v[52:55], v6 offset:9216
s_waitcnt lgkmcnt(9)
v_smfmac_f32_16x16x64_bf16 v[56:59], v[16:19], a[0:7], v7
s_waitcnt lgkmcnt(7)
v_smfmac_f32_16x16x64_bf16 v[56:59], v[20:23], a[24:31], v7
v_smfmac_f32_16x16x64_bf16 v[56:59], v[24:27], a[48:55], v7
s_waitcnt lgkmcnt(4)
v_smfmac_f32_16x16x64_bf16 v[56:59], v[28:31], a[72:79], v7
v_smfmac_f32_16x16x64_bf16 v[56:59], v[32:35], a[96:103], v7
v_smfmac_f32_16x16x64_bf16 v[56:59], v[36:39], a[120:127], v7
s_waitcnt lgkmcnt(0)
v_smfmac_f32_16x16x64_bf16 v[56:59], v[40:43], a[144:151], v7
v_smfmac_f32_16x16x64_bf16 v[56:59], v[44:47], a[168:175], v7
v_smfmac_f32_16x16x64_bf16 v[56:59], v[48:51], a[192:199], v7
v_smfmac_f32_16x16x64_bf16 v[56:59], v[52:55], a[216:223], v7
v_smfmac_f32_16x16x64_bf16 v[60:63], v[16:19], a[8:15], v7
v_mov_b64 v[12:13], -1
v_smfmac_f32_16x16x64_bf16 v[60:63], v[20:23], a[32:39], v7
v_mov_b64 v[14:15], -1
v_smfmac_f32_16x16x64_bf16 v[60:63], v[24:27], a[56:63], v7
v_smfmac_f32_16x16x64_bf16 v[60:63], v[28:31], a[80:87], v7
buffer_store_dwordx4 v[12:15], v104, s[4:7], s32 offen sc1
v_smfmac_f32_16x16x64_bf16 v[60:63], v[32:35], a[104:111], v7
v_smfmac_f32_16x16x64_bf16 v[60:63], v[36:39], a[128:135], v7
buffer_store_dwordx4 v[12:15], v105, s[4:7], s32 offen sc1
v_smfmac_f32_16x16x64_bf16 v[60:63], v[40:43], a[152:159], v7
v_smfmac_f32_16x16x64_bf16 v[60:63], v[44:47], a[176:183], v7
buffer_store_dwordx4 v[12:15], v106, s[4:7], s32 offen sc1
v_smfmac_f32_16x16x64_bf16 v[60:63], v[48:51], a[200:207], v7
v_smfmac_f32_16x16x64_bf16 v[60:63], v[52:55], a[224:231], v7
v_smfmac_f32_16x16x64_bf16 v[64:67], v[16:19], a[16:23], v7
v_smfmac_f32_16x16x64_bf16 v[64:67], v[20:23], a[40:47], v7
v_smfmac_f32_16x16x64_bf16 v[64:67], v[24:27], a[64:71], v7
v_smfmac_f32_16x16x64_bf16 v[64:67], v[28:31], a[88:95], v7
v_smfmac_f32_16x16x64_bf16 v[64:67], v[32:35], a[112:119], v7
v_smfmac_f32_16x16x64_bf16 v[64:67], v[36:39], a[136:143], v7
v_smfmac_f32_16x16x64_bf16 v[64:67], v[40:43], a[160:167], v7
s_nop 0
v_permlane32_swap_b32 v56, v60
v_smfmac_f32_16x16x64_bf16 v[64:67], v[44:47], a[184:191], v7
v_permlane32_swap_b32 v57, v61
v_smfmac_f32_16x16x64_bf16 v[64:67], v[48:51], a[208:215], v7
v_permlane32_swap_b32 v58, v62
v_smfmac_f32_16x16x64_bf16 v[64:67], v[52:55], a[232:239], v7
v_permlane32_swap_b32 v59, v63
v_pk_add_f32 v[56:57], v[56:57], v[60:61]
v_pk_add_f32 v[58:59], v[58:59], v[62:63]
v_cvt_pk_bf16_f32 v60, v56, v57
v_cvt_pk_bf16_f32 v61, v58, v59
ds_write_b64 v8, v[60:61]
s_nop 1
v_permlane32_swap_b32 v64, v16
v_permlane32_swap_b32 v65, v17
v_permlane32_swap_b32 v66, v18
v_permlane32_swap_b32 v67, v19
v_pk_add_f32 v[64:65], v[64:65], v[16:17]
v_pk_add_f32 v[66:67], v[66:67], v[18:19]
v_cvt_pk_bf16_f32 v56, v64, v65
v_cvt_pk_bf16_f32 v57, v66, v67
s_mov_b32 exec_hi, 0
ds_write_b64 v8, v[56:57] offset:512
s_mov_b32 exec_hi, -1
s_waitcnt lgkmcnt(0)
s_barrier
ds_read_b64_tr_b16 v[16:17], v9 offset:0
ds_read_b64_tr_b16 v[18:19], v9 offset:64
ds_read_b64_tr_b16 v[20:21], v9 offset:512
ds_read_b64_tr_b16 v[22:23], v9 offset:576
ds_read_b64_tr_b16 v[24:25], v9 offset:1024
ds_read_b64_tr_b16 v[26:27], v9 offset:1088
ds_read_b64_tr_b16 v[28:29], v9 offset:1536
ds_read_b64_tr_b16 v[30:31], v9 offset:1600
ds_read_b64_tr_b16 v[32:33], v9 offset:2048
ds_read_b64_tr_b16 v[34:35], v9 offset:2112
ds_read_b64_tr_b16 v[36:37], v9 offset:2560
ds_read_b64_tr_b16 v[38:39], v9 offset:2624
ds_read_b128 v[40:43], v5 offset:2048
ds_read_b128 v[44:47], v5 offset:3072
s_waitcnt lgkmcnt(10)
v_smfmac_f32_16x16x64_bf16 v[68:71], v[16:19], a[240:247], v7
v_smfmac_f32_16x16x64_bf16 v[68:71], v[20:23], v[136:143], v7
s_waitcnt lgkmcnt(6)
v_smfmac_f32_16x16x64_bf16 v[68:71], v[24:27], v[176:183], v7
v_smfmac_f32_16x16x64_bf16 v[68:71], v[28:31], v[216:223], v7
s_waitcnt lgkmcnt(2)
v_smfmac_f32_16x16x64_bf16 v[68:71], v[32:35], v[88:95], v7
ds_read_b128 v[88:91], v5 offset:12288
v_smfmac_f32_16x16x64_bf16 v[68:71], v[36:39], v[96:103], v7
ds_read_b128 v[92:95], v5 offset:13312
v_smfmac_f32_16x16x64_bf16 v[72:75], v[16:19], a[248:255], v7
ds_read_b128 v[96:99], v5 offset:4096
v_smfmac_f32_16x16x64_bf16 v[72:75], v[20:23], v[144:151], v7
ds_read_b128 v[100:103], v5 offset:5120
v_smfmac_f32_16x16x64_bf16 v[72:75], v[24:27], v[184:191], v7
v_smfmac_f32_16x16x64_bf16 v[72:75], v[28:31], v[224:231], v7
s_waitcnt lgkmcnt(4)
v_smfmac_f32_16x16x64_bf16 v[72:75], v[32:35], v[40:47], v7
ds_read_b128 v[40:43], v5 offset:14336
s_waitcnt lgkmcnt(3)
v_smfmac_f32_16x16x64_bf16 v[72:75], v[36:39], v[88:95], v7
ds_read_b128 v[44:47], v5 offset:15360
v_smfmac_f32_16x16x64_bf16 v[76:79], v[16:19], v[112:119], v7
ds_read_b128 v[88:91], v5 offset:6144
v_smfmac_f32_16x16x64_bf16 v[76:79], v[20:23], v[152:159], v7
ds_read_b128 v[92:95], v5 offset:7168
v_smfmac_f32_16x16x64_bf16 v[76:79], v[24:27], v[192:199], v7
v_cvt_pk_bf16_f32 v48, v68, v69
v_smfmac_f32_16x16x64_bf16 v[76:79], v[28:31], v[232:239], v7
v_cvt_pk_bf16_f32 v50, v72, v73
s_waitcnt lgkmcnt(4)
v_smfmac_f32_16x16x64_bf16 v[76:79], v[32:35], v[96:103], v7
ds_read_b128 v[96:99], v5 offset:16384
s_waitcnt lgkmcnt(3)
v_smfmac_f32_16x16x64_bf16 v[76:79], v[36:39], v[40:47], v7
ds_read_b128 v[100:103], v5 offset:17408
v_smfmac_f32_16x16x64_bf16 v[80:83], v[16:19], v[120:127], v7
ds_read_b128 v[40:43], v5 offset:8192
v_smfmac_f32_16x16x64_bf16 v[80:83], v[20:23], v[160:167], v7
ds_read_b128 v[44:47], v5 offset:9216
v_smfmac_f32_16x16x64_bf16 v[80:83], v[24:27], v[200:207], v7
v_cvt_pk_bf16_f32 v49, v70, v71
v_smfmac_f32_16x16x64_bf16 v[80:83], v[28:31], v[240:247], v7
v_cvt_pk_bf16_f32 v51, v74, v75
s_waitcnt lgkmcnt(4)
v_smfmac_f32_16x16x64_bf16 v[80:83], v[32:35], v[88:95], v7
ds_read_b128 v[88:91], v5 offset:18432
s_waitcnt lgkmcnt(3)
v_smfmac_f32_16x16x64_bf16 v[80:83], v[36:39], v[96:103], v7
ds_read_b128 v[92:95], v5 offset:19456
v_smfmac_f32_16x16x64_bf16 v[84:87], v[16:19], v[128:135], v7
v_permlane16_swap_b32 v48, v50
v_smfmac_f32_16x16x64_bf16 v[84:87], v[20:23], v[168:175], v7
v_permlane16_swap_b32 v49, v51
v_smfmac_f32_16x16x64_bf16 v[84:87], v[24:27], v[208:215], v7
v_min_u32 v48, -2, v48
v_smfmac_f32_16x16x64_bf16 v[84:87], v[28:31], v[248:255], v7
buffer_store_dwordx4 v[48:51], v108, s[4:7], s32 offen sc1
s_waitcnt lgkmcnt(2)
v_smfmac_f32_16x16x64_bf16 v[84:87], v[32:35], v[40:47], v7
v_cvt_pk_bf16_f32 v52, v76, v77
s_waitcnt lgkmcnt(0)
v_smfmac_f32_16x16x64_bf16 v[84:87], v[36:39], v[88:95], v7
v_cvt_pk_bf16_f32 v54, v80, v81
v_cvt_pk_bf16_f32 v53, v78, v79
v_cvt_pk_bf16_f32 v55, v82, v83
v_permlane16_swap_b32 v52, v54
s_nop 0
v_permlane16_swap_b32 v53, v55
v_min_u32 v52, -2, v52
buffer_store_dwordx4 v[52:55], v109, s[4:7], s32 offen sc1
v_cvt_pk_bf16_f32 v56, v84, v85
v_cvt_pk_bf16_f32 v58, v84, v85
v_cvt_pk_bf16_f32 v57, v86, v87
v_cvt_pk_bf16_f32 v59, v86, v87
v_permlane16_swap_b32 v56, v58
s_nop 0
v_permlane16_swap_b32 v57, v59
v_min_u32 v56, -2, v56
buffer_store_dwordx4 v[56:59], v110, s[4:7], s32 offen sc1
v_lshrrev_b32 v12, 8, v10
v_and_b32 v12, 0x2000, v12
v_xor_b32 v12, v12, v10
buffer_store_dwordx4 v[48:51], v12, s[4:7], 0 offen sc1
v_add_u32 v13, 65536, v10
v_lshrrev_b32 v12, 8, v13
v_and_b32 v12, 0x2000, v12
v_xor_b32 v12, v12, v13
buffer_store_dwordx4 v[52:55], v12, s[4:7], 0 offen sc1
v_lshrrev_b32 v12, 8, v11
v_and_b32 v12, 0x2000, v12
v_xor_b32 v12, v12, v11
buffer_store_dwordx4 v[56:59], v12, s[4:7], 0 offen sc1
v_add_u32 v10, 655360, v10
v_add_u32 v11, 655360, v11
s_add_u32 s61, s57, s40
v_mov_b32 v14, s61
v_mov_b32 v15, 0
s_mov_b64 exec, 1
buffer_store_dword v14, v15, s[4:7], s34 offen sc1
s_mov_b64 exec, -1
v_add_u32 v12, s47, v111
s_add_u32 s47, s47, 1024
s_cmp_eq_u32 s47, 3072
s_cselect_b32 s47, 0, s47
s_mov_b32 s39, s64
s_mov_b32 s64, s65
s_mov_b32 s65, s66
s_mov_b32 s66, s39
ds_read_b96 v[108:110], v12
s_add_u32 s41, s47, 1024
s_cmp_eq_u32 s41, 3072
s_cselect_b32 s41, 0, s41
v_add_u32 v12, s41, v111
ds_read_b96 v[104:106], v12
s_add_u32 s40, s40, 1
s_cmp_lt_u32 s40, 64
s_cbranch_scc1 B_loop
s_waitcnt vmcnt(0)
s_barrier
s_add_u32 s61, s57, s40
v_mov_b32 v14, s61
v_mov_b32 v15, 0
s_mov_b64 exec, 1
buffer_store_dword v14, v15, s[4:7], s34 offen sc1
s_mov_b64 exec, -1
s_branch L_fin
L_R:
s_cmp_ge_u32 s25, 2
s_cbranch_scc1 R_np
v_mov_b32 v15, 0
s_cmp_lg_u32 s25, 0
s_cbranch_scc1 R_nn
s_cmp_lg_u32 s24, 0
s_cbranch_scc1 R_nn
s_memrealtime s[44:45]
s_waitcnt lgkmcnt(0)
s_or_b32 s44, s44, 1
v_mov_b32 v14, s44
s_mov_b64 exec, 1
buffer_store_dword v14, v15, s[20:23], 0 offen offset:136 sc1
s_mov_b64 exec, -1
R_nn:
s_mul_i32 s30, s25, 2293760
s_add_u32 s30, s30, 1835008
s_lshl_b32 s42, s24, 7
s_add_u32 s30, s30, s42
v_mov_b32 v16, -1
v_lshlrev_b32 v17, 2, v0
ds_write_b32 v17, v16
s_waitcnt lgkmcnt(0)
s_barrier
s_mov_b64 exec, 1
s_mov_b32 s31, 0
R_pe:
s_bitcmp1_b32 s24, 0
s_cselect_b32 s42, -1, 1
s_mul_i32 s42, s42, s31
s_lshl_b32 s43, s24, 1
s_add_u32 s42, s42, s43
s_and_b32 s42, s42, 7
s_lshl_b32 s43, s42, 12
s_add_u32 s41, s30, s43
s_lshl_b32 s42, s42, 2
v_mov_b32 v17, s42
s_memtime s[44:45]
s_waitcnt lgkmcnt(0)
buffer_store_dword v15, v15, s[4:7], s41 offen sc1
s_waitcnt vmcnt(0)
s_memtime s[46:47]
s_waitcnt lgkmcnt(0)
s_sub_u32 s42, s46, s44
v_mov_b32 v16, s42
ds_min_u32 v17, v16
s_add_u32 s31, s31, 1
s_cmp_lt_u32 s31, 12
s_cbranch_scc1 R_pe
s_waitcnt lgkmcnt(0)
s_barrier
ds_read_b128 v[16:19], v15
ds_read_b128 v[20:23], v15 offset:16
s_waitcnt lgkmcnt(0)
v_add_u32 v24, v16, v17
v_add_u32 v25, v18, v19
v_add_u32 v26, v20, v21
v_add_u32 v27, v22, v23
v_add_u32 v28, v24, v26
v_add_u32 v29, v25, v27
v_cmp_gt_u32 vcc, v28, v29
s_nop 1
v_cndmask_b32_e64 v30, 0, 2, vcc
v_cndmask_b32 v24, v24, v25, vcc
v_cndmask_b32 v26, v26, v27, vcc
v_cndmask_b32 v16, v16, v18, vcc
v_cndmask_b32 v17, v17, v19, vcc
v_cndmask_b32 v20, v20, v22, vcc
v_cndmask_b32 v21, v21, v23, vcc
v_cmp_gt_u32 vcc, v24, v26
s_nop 1
v_cndmask_b32_e64 v31, 0, 4, vcc
v_cndmask_b32 v16, v16, v20, vcc
v_cndmask_b32 v17, v17, v21, vcc
v_cmp_gt_u32 vcc, v16, v17
s_nop 1
v_cndmask_b32_e64 v16, 0, 1, vcc
v_or3_b32 v16, v16, v30, v31
s_mov_b32 s42, 0x4152637
s_lshl_b32 s43, s27, 2
s_lshr_b32 s42, s42, s43
s_and_b32 s42, s42, 7
s_xor_b32 s42, s42, 0x105
v_xor_b32 v16, s42, v16
s_lshl_b32 s42, s25, 2
s_add_u32 s42, s42, 128
s_cmp_lg_u32 s24, 0
s_cbranch_scc1 R_pq
buffer_store_dword v16, v15, s[20:23], s42 offen sc1
R_pq:
s_mov_b64 exec, -1
R_np:
s_mov_b32 s62, 0
v_mov_b32 v15, 128
Rwc:
s_add_u32 s62, s62, 1
s_mov_b32 s63, 1
s_cmp_gt_u32 s62, 400000
s_cbranch_scc1 L_err
buffer_load_dwordx3 v[12:14], v15, s[20:23], 0 offen sc1
s_waitcnt vmcnt(0)
v_readfirstlane_b32 s41, v12
v_readfirstlane_b32 s42, v13
v_readfirstlane_b32 s57, v14
s_and_b32 s43, s41, s42
s_cmp_eq_u32 s57, 0
s_cselect_b32 s43, 0, s43
s_bitcmp1_b32 s43, 8
s_cbranch_scc0 Rwc
s_bfe_u32 s3, s41, 0x10001
s_and_b32 s41, s41, 7
s_and_b32 s42, s42, 7
s_xor_b32 s52, s41, 7
s_lshl_b32 s52, s52, 12
s_xor_b32 s44, s42, 7
s_lshl_b32 s44, s44, 12
s_xor_b32 s53, s41, 3
s_lshl_b32 s53, s53, 12
s_xor_b32 s45, s42, 3
s_lshl_b32 s45, s45, 12
s_xor_b32 s54, s41, 6
s_lshl_b32 s54, s54, 12
s_xor_b32 s46, s42, 6
s_lshl_b32 s46, s46, 12
s_xor_b32 s55, s41, 2
s_lshl_b32 s55, s55, 12
s_xor_b32 s47, s42, 2
s_lshl_b32 s47, s47, 12
s_and_b32 s41, s27, 3
s_mov_b32 s35, s52
s_cmp_eq_u32 s41, 1
s_cselect_b32 s35, s53, s35
s_cmp_eq_u32 s41, 2
s_cselect_b32 s35, s54, s35
s_cmp_eq_u32 s41, 3
s_cselect_b32 s35, s55, s35
s_mul_i32 s30, s25, 205
s_lshr_b32 s30, s30, 11
s_mul_i32 s31, s30, 10
s_sub_u32 s31, s25, s31
s_mov_b32 s33, s44
s_cmp_eq_u32 s30, 1
s_cselect_b32 s33, s45, s33
s_cmp_eq_u32 s30, 2
s_cselect_b32 s33, s46, s33
s_cmp_eq_u32 s30, 3
s_cselect_b32 s33, s47, s33
v_bfe_u32 v12, v0, 3, 1
v_lshrrev_b32 v14, 5, v0
v_lshl_or_b32 v12, v14, 1, v12
v_mov_b32 v8, s52
v_mov_b32 v13, s53
v_cmp_eq_u32 vcc, 1, v12
s_nop 1
v_cndmask_b32 v8, v8, v13, vcc
v_mov_b32 v13, s54
v_cmp_eq_u32 vcc, 2, v12
s_nop 1
v_cndmask_b32 v8, v8, v13, vcc
v_mov_b32 v13, s55
v_cmp_eq_u32 vcc, 3, v12
s_nop 1
v_cndmask_b32 v8, v8, v13, vcc
s_lshl_b32 s41, s31, 8
v_and_b32 v9, 7, v0
v_lshlrev_b32 v9, 4, v9
v_bfe_u32 v12, v0, 4, 1
v_lshl_add_u32 v9, v12, 7, v9
v_add_u32 v9, s41, v9
s_cmp_eq_u32 s24, 3
s_cbranch_scc1 R_c0
s_lshl_b32 s41, s24, 2
s_add_u32 s41, s41, s30
s_bfe_u32 s60, s41, 0x10004
s_lshl_b32 s60, s60, 14
s_bfe_u32 s61, s41, 0x10005
s_lshl_b32 s61, s61, 12
s_xor_b32 s60, s60, s61
v_xor_b32 v16, s60, v8
s_lshl_b32 s60, s41, 15
v_add3_u32 v16, v16, s60, v9
v_mov_b32 v20, -1
v_mov_b32 v21, -1
v_mov_b32 v22, -1
v_mov_b32 v23, -1
s_cmp_lg_u32 s24, 0
s_cbranch_scc1 R_c2
s_mov_b32 s12, s66
s_and_b32 s13, s67, 0xffff
s_mov_b32 s14, 0x2800
s_mov_b32 s15, 0x20000
v_and_b32 v12, 7, v0
v_mul_u32_u24 v12, 1280, v12
v_bfe_u32 v13, v0, 4, 1
v_lshl_add_u32 v12, v13, 4, v12
s_lshl_b32 s41, s25, 5
buffer_load_dwordx4 v[20:23], v12, s[12:15], s41 offen
s_waitcnt vmcnt(0)
v_min_u32 v20, -2, v20
s_mov_b32 s40, 0
s_memrealtime s[58:59]
s_and_b32 s41, s40, 3
s_mul_i32 s41, s41, 3
s_add_u32 s41, s41, 36
s_lshr_b32 s42, s25, 5
s_add_u32 s41, s41, s42
s_lshl_b32 s41, s41, 15
s_and_b32 s42, s25, 31
s_lshl_b32 s42, s42, 7
s_add_u32 s41, s41, s42
s_add_u32 s42, s57, s40
v_mov_b32 v15, s42
v_mov_b32 v13, s52
v_writelane_b32 v13, s53, 1
v_writelane_b32 v13, s54, 2
v_writelane_b32 v13, s55, 3
v_xor_b32 v13, 0x1000, v13
s_waitcnt lgkmcnt(0)
s_sub_u32 s58, s58, s57
v_mov_b32 v14, s58
s_mov_b64 exec, 15
buffer_store_dwordx2 v[14:15], v13, s[4:7], s41 offen sc1
s_mov_b64 exec, -1
R_c2:
buffer_store_dwordx4 v[20:23], v16, s[4:7], 0 offen sc1
R_c0:
v_mov_b32 v24, -1
v_mov_b32 v25, -1
v_mov_b32 v26, -1
v_mov_b32 v27, -1
s_lshl_b32 s41, s31, 1
s_add_u32 s41, s41, 0
s_lshr_b32 s42, s24, 1
s_add_u32 s41, s41, s42
s_bfe_u32 s60, s41, 0x10004
s_lshl_b32 s60, s60, 14
s_bfe_u32 s61, s41, 0x10005
s_lshl_b32 s61, s61, 12
s_xor_b32 s60, s60, s61
s_xor_b32 s60, s60, s33
s_lshl_b32 s39, s41, 15
s_add_u32 s39, s39, s60
s_and_b32 s41, s24, 1
s_lshl_b32 s41, s41, 11
s_add_u32 s39, s39, s41
s_add_u32 s39, s39, 2097152
buffer_store_dwordx4 v[24:27], v1, s[4:7], s39 offen sc1
buffer_store_dwordx4 v[24:27], v1, s[4:7], s39 offen offset:1024 sc1
s_lshl_b32 s41, s31, 1
s_add_u32 s41, s41, 20
s_lshr_b32 s42, s24, 1
s_add_u32 s41, s41, s42
s_bfe_u32 s60, s41, 0x10004
s_lshl_b32 s60, s60, 14
s_bfe_u32 s61, s41, 0x10005
s_lshl_b32 s61, s61, 12
s_xor_b32 s60, s60, s61
s_xor_b32 s60, s60, s33
s_lshl_b32 s39, s41, 15
s_add_u32 s39, s39, s60
s_and_b32 s41, s24, 1
s_lshl_b32 s41, s41, 11
s_add_u32 s39, s39, s41
s_add_u32 s39, s39, 2097152
buffer_store_dwordx4 v[24:27], v1, s[4:7], s39 offen sc1
buffer_store_dwordx4 v[24:27], v1, s[4:7], s39 offen offset:1024 sc1
s_lshl_b32 s41, s31, 1
s_add_u32 s41, s41, 40
s_lshr_b32 s42, s24, 1
s_add_u32 s41, s41, s42
s_bfe_u32 s60, s41, 0x10004
s_lshl_b32 s60, s60, 14
s_bfe_u32 s61, s41, 0x10005
s_lshl_b32 s61, s61, 12
s_xor_b32 s60, s60, s61
s_xor_b32 s60, s60, s33
s_lshl_b32 s39, s41, 15
s_add_u32 s39, s39, s60
s_and_b32 s41, s24, 1
s_lshl_b32 s41, s41, 11
s_add_u32 s39, s39, s41
s_add_u32 s39, s39, 2097152
buffer_store_dwordx4 v[24:27], v1, s[4:7], s39 offen sc1
buffer_store_dwordx4 v[24:27], v1, s[4:7], s39 offen offset:1024 sc1
s_lshl_b32 s41, s31, 2
s_add_u32 s41, s41, s24
s_cmp_ge_u32 s41, 24
s_cbranch_scc1 R_c3
s_add_u32 s41, s41, 12
s_mov_b32 s42, s52
s_cmp_eq_u32 s30, 1
s_cselect_b32 s42, s53, s42
s_cmp_eq_u32 s30, 2
s_cselect_b32 s42, s54, s42
s_cmp_eq_u32 s30, 3
s_cselect_b32 s42, s55, s42
s_bfe_u32 s60, s41, 0x10004
s_lshl_b32 s60, s60, 14
s_bfe_u32 s61, s41, 0x10005
s_lshl_b32 s61, s61, 12
s_xor_b32 s60, s60, s61
s_xor_b32 s60, s60, s42
s_lshl_b32 s39, s41, 15
s_add_u32 s39, s39, s60
buffer_store_dwordx4 v[24:27], v1, s[4:7], s39 offen offset:0 sc1
buffer_store_dwordx4 v[24:27], v1, s[4:7], s39 offen offset:1024 sc1
buffer_store_dwordx4 v[24:27], v1, s[4:7], s39 offen offset:2048 sc1
R_c3:
s_waitcnt vmcnt(0)
s_barrier
s_lshl_b32 s34, s25, 7
s_add_u32 s34, s34, 4222976
s_add_u32 s61, s57, 0
v_mov_b32 v14, s61
v_mov_b32 v15, 0
s_mov_b64 exec, 1
buffer_store_dword v14, v15, s[4:7], s34 offen sc1
s_mov_b64 exec, -1
v_lshrrev_b32 v12, 3, v2
v_mul_u32_u24 v12, 640, v12
v_and_b32 v13, 7, v2
v_lshlrev_b32 v13, 4, v13
v_lshl_add_u32 v10, v3, 7, v13
v_add_u32 v10, v10, v12
v_mul_u32_u24 v11, 640, v3
v_add_u32 v11, v11, v13
v_add_u32 v11, 512, v11
v_bfe_u32 v12, v0, 3, 2
v_lshlrev_b32 v12, 8, v12
v_add_u32 v5, v12, v13
s_lshl_b32 s41, s24, 10
v_add_u32 v4, s41, v1
v_and_b32 v6, 7, v0
s_lshl_b32 s41, s24, 3
s_add_u32 s41, s41, 32
v_add_u32 v6, s41, v6
v_lshlrev_b32 v6, 7, v6
s_mov_b32 s36, 2
s_mov_b32 s37, 0
s_mov_b32 s38, 1
s_mov_b32 s40, 0
s_mov_b32 s48, 0
s_mov_b32 s49, 0
v_min_u32 v13, 39, v0
v_lshlrev_b32 v13, 7, v13
s_mov_b32 s41, 4222976
s_mov_b32 s62, 0
s_add_u32 s61, s57, 0
R_rr:
s_add_u32 s62, s62, 1
s_mov_b32 s63, 2
s_cmp_gt_u32 s62, 400000
s_cbranch_scc1 L_err
buffer_load_dword v14, v13, s[4:7], s41 offen sc1
s_waitcnt vmcnt(0)
v_subrev_u32 v14, s61, v14
v_cmp_lt_u32 vcc, 64, v14
s_cbranch_vccnz R_rr
s_mov_b32 s12, s80
s_and_b32 s13, s81, 0xffff
s_mov_b32 s14, 0x258000
s_mov_b32 s15, 0x20000
s_mov_b32 s16, s82
s_and_b32 s17, s83, 0xffff
s_mov_b32 s18, 0xc8000
s_mov_b32 s19, 0x20000
s_lshl_b32 s41, s25, 2
s_add_u32 s41, s41, s24
s_lshl_b32 s42, s41, 14
s_lshl_b32 s41, s41, 13
v_lshlrev_b32 v12, 7, v0
s_add_u32 s43, s42, 8192
buffer_load_dword v20, v12, s[12:15], s42 offen
buffer_load_dword v21, v12, s[12:15], s43 offen
buffer_load_dword v22, v12, s[16:19], s41 offen
s_mov_b32 s50, 0
s_mov_b32 s16, 0
s_mov_b32 s17, 0
s_mov_b32 s18, 125
s_mov_b32 s19, 54
s_mov_b32 s26, 1
s_mov_b32 s56, 1
s_and_b32 s41, s50, 1
s_lshr_b32 s42, s50, 1
s_cmp_eq_u32 s41, 0
s_cselect_b32 s43, s48, s49
s_cmp_gt_u32 s43, s42
s_cbranch_scc1 Ru0ok
s_lshl_b32 s51, s41, 13
s_add_u32 s51, s51, 4194304
s_add_u32 s42, s42, 1
s_mov_b32 s62, 0
s_add_u32 s61, s57, s42
Ru0w:
s_add_u32 s62, s62, 1
s_mov_b32 s63, 6
s_cmp_gt_u32 s62, 400000
s_cbranch_scc1 L_err
buffer_load_dword v14, v6, s[4:7], s51 offen sc1
s_waitcnt vmcnt(0)
v_subrev_u32 v14, s61, v14
v_cmp_lt_u32 vcc, 64, v14
s_cbranch_vccnz Ru0w
v_min_u32_dpp v14, v14, v14 quad_perm:[1,0,3,2] row_mask:0xf bank_mask:0xf
s_nop 1
v_min_u32_dpp v14, v14, v14 quad_perm:[2,3,0,1] row_mask:0xf bank_mask:0xf
s_nop 1
v_min_u32_dpp v14, v14, v14 row_ror:4 row_mask:0xf bank_mask:0xf
s_nop 0
v_readfirstlane_b32 s43, v14
s_add_u32 s43, s43, s42
s_cmp_eq_u32 s41, 0
s_cselect_b32 s48, s43, s48
s_cselect_b32 s49, s49, s43
Ru0ok:
s_mul_i32 s43, s50, 40
s_add_u32 s43, s43, s25
s_lshl_b32 s43, s43, 2
s_add_u32 s43, s43, s24
s_lshl_b32 s42, s43, 14
s_add_u32 s42, s42, 5242880
s_bfe_u32 s61, s42, 0x10015
s_xor_b32 s61, s61, s3
s_lshl_b32 s61, s61, 13
s_add_u32 s42, s42, s61
s_add_u32 s43, s42, 4096
buffer_load_dwordx4 v[32:35], v1, s[4:7], s42 offen offset:0 sc1
buffer_load_dwordx4 v[36:39], v1, s[4:7], s42 offen offset:1024 sc1
buffer_load_dwordx4 v[40:43], v1, s[4:7], s42 offen offset:2048 sc1
buffer_load_dwordx4 v[44:47], v1, s[4:7], s42 offen offset:3072 sc1
buffer_load_dwordx4 v[48:51], v1, s[4:7], s43 offen offset:0 sc1
buffer_load_dwordx4 v[52:55], v1, s[4:7], s43 offen offset:1024 sc1
buffer_load_dwordx4 v[56:59], v1, s[4:7], s43 offen offset:2048 sc1
buffer_load_dwordx4 v[60:63], v1, s[4:7], s43 offen offset:3072 sc1
s_lshl_b32 s41, s31, 1
s_add_u32 s41, s41, 0
s_lshr_b32 s42, s24, 1
s_add_u32 s41, s41, s42
s_bfe_u32 s60, s41, 0x10004
s_lshl_b32 s60, s60, 14
s_bfe_u32 s61, s41, 0x10005
s_lshl_b32 s61, s61, 12
s_xor_b32 s60, s60, s61
s_xor_b32 s60, s60, s33
s_lshl_b32 s64, s41, 15
s_add_u32 s64, s64, s60
s_and_b32 s41, s24, 1
s_lshl_b32 s41, s41, 11
s_add_u32 s64, s64, s41
s_add_u32 s64, s64, 2097152
s_lshl_b32 s41, s24, 1
s_add_u32 s41, s41, 12
s_bfe_u32 s60, s41, 0x10004
s_lshl_b32 s60, s60, 14
s_bfe_u32 s61, s41, 0x10005
s_lshl_b32 s61, s61, 12
s_xor_b32 s60, s60, s61
s_xor_b32 s60, s60, s35
s_lshl_b32 s65, s41, 15
s_add_u32 s65, s65, s60
s_add_u32 s41, s41, 1
s_bfe_u32 s60, s41, 0x10004
s_lshl_b32 s60, s60, 14
s_bfe_u32 s61, s41, 0x10005
s_lshl_b32 s61, s61, 12
s_xor_b32 s60, s60, s61
s_xor_b32 s60, s60, s35
s_lshl_b32 s66, s41, 15
s_add_u32 s66, s66, s60
v_mov_b32 v12, s65
v_mov_b32 v13, s66
v_cmp_gt_u32 vcc, 8, v2
s_nop 1
v_cndmask_b32 v12, v13, v12, vcc
v_add_u32 v120, v12, v11
s_cmp_eq_u32 s24, 0
s_cselect_b32 s50, 1, 0
s_lshl_b32 s41, s50, 2
s_add_u32 s41, s41, s30
s_bfe_u32 s60, s41, 0x10004
s_lshl_b32 s60, s60, 14
s_bfe_u32 s61, s41, 0x10005
s_lshl_b32 s61, s61, 12
s_xor_b32 s60, s60, s61
v_xor_b32 v124, s60, v8
s_lshl_b32 s60, s41, 15
v_add3_u32 v124, v124, s60, v9
s_lshl_b32 s41, s31, 1
s_add_u32 s41, s41, 20
s_lshr_b32 s42, s24, 1
s_add_u32 s41, s41, s42
s_bfe_u32 s60, s41, 0x10004
s_lshl_b32 s60, s60, 14
s_bfe_u32 s61, s41, 0x10005
s_lshl_b32 s61, s61, 12
s_xor_b32 s60, s60, s61
s_xor_b32 s60, s60, s33
s_lshl_b32 s67, s41, 15
s_add_u32 s67, s67, s60
s_and_b32 s41, s24, 1
s_lshl_b32 s41, s41, 11
s_add_u32 s67, s67, s41
s_add_u32 s67, s67, 2097152
s_lshl_b32 s41, s24, 1
s_add_u32 s41, s41, 20
s_bfe_u32 s60, s41, 0x10004
s_lshl_b32 s60, s60, 14
s_bfe_u32 s61, s41, 0x10005
s_lshl_b32 s61, s61, 12
s_xor_b32 s60, s60, s61
s_xor_b32 s60, s60, s35
s_lshl_b32 s68, s41, 15
s_add_u32 s68, s68, s60
s_add_u32 s41, s41, 1
s_bfe_u32 s60, s41, 0x10004
s_lshl_b32 s60, s60, 14
s_bfe_u32 s61, s41, 0x10005
s_lshl_b32 s61, s61, 12
s_xor_b32 s60, s60, s61
s_xor_b32 s60, s60, s35
s_lshl_b32 s69, s41, 15
s_add_u32 s69, s69, s60
v_mov_b32 v12, s68
v_mov_b32 v13, s69
v_cmp_gt_u32 vcc, 8, v2
s_nop 1
v_cndmask_b32 v12, v13, v12, vcc
v_add_u32 v121, v12, v11
s_cmp_eq_u32 s24, 0
s_cselect_b32 s50, 2, 1
s_lshl_b32 s41, s50, 2
s_add_u32 s41, s41, s30
s_bfe_u32 s60, s41, 0x10004
s_lshl_b32 s60, s60, 14
s_bfe_u32 s61, s41, 0x10005
s_lshl_b32 s61, s61, 12
s_xor_b32 s60, s60, s61
v_xor_b32 v125, s60, v8
s_lshl_b32 s60, s41, 15
v_add3_u32 v125, v125, s60, v9
s_lshl_b32 s41, s31, 1
s_add_u32 s41, s41, 40
s_lshr_b32 s42, s24, 1
s_add_u32 s41, s41, s42
s_bfe_u32 s60, s41, 0x10004
s_lshl_b32 s60, s60, 14
s_bfe_u32 s61, s41, 0x10005
s_lshl_b32 s61, s61, 12
s_xor_b32 s60, s60, s61
s_xor_b32 s60, s60, s33
s_lshl_b32 s70, s41, 15
s_add_u32 s70, s70, s60
s_and_b32 s41, s24, 1
s_lshl_b32 s41, s41, 11
s_add_u32 s70, s70, s41
s_add_u32 s70, s70, 2097152
s_lshl_b32 s41, s24, 1
s_add_u32 s41, s41, 28
s_bfe_u32 s60, s41, 0x10004
s_lshl_b32 s60, s60, 14
s_bfe_u32 s61, s41, 0x10005
s_lshl_b32 s61, s61, 12
s_xor_b32 s60, s60, s61
s_xor_b32 s60, s60, s35
s_lshl_b32 s71, s41, 15
s_add_u32 s71, s71, s60
s_add_u32 s41, s41, 1
s_bfe_u32 s60, s41, 0x10004
s_lshl_b32 s60, s60, 14
s_bfe_u32 s61, s41, 0x10005
s_lshl_b32 s61, s61, 12
s_xor_b32 s60, s60, s61
s_xor_b32 s60, s60, s35
s_lshl_b32 s72, s41, 15
s_add_u32 s72, s72, s60
v_mov_b32 v12, s71
v_mov_b32 v13, s72
v_cmp_gt_u32 vcc, 8, v2
s_nop 1
v_cndmask_b32 v12, v13, v12, vcc
v_add_u32 v122, v12, v11
s_cmp_eq_u32 s24, 0
s_cselect_b32 s50, 0, 2
s_lshl_b32 s41, s50, 2
s_add_u32 s41, s41, s30
s_bfe_u32 s60, s41, 0x10004
s_lshl_b32 s60, s60, 14
s_bfe_u32 s61, s41, 0x10005
s_lshl_b32 s61, s61, 12
s_xor_b32 s60, s60, s61
v_xor_b32 v126, s60, v8
s_lshl_b32 s60, s41, 15
v_add3_u32 v126, v126, s60, v9
v_min_u32 v24, 39, v0
v_lshrrev_b32 v25, 5, v24
v_mul_u32_u24 v25, 28672, v25
v_lshl_add_u32 v24, v24, 7, v25
v_and_b32 v25, 31, v0
v_lshlrev_b32 v25, 7, v25
R_loop:
s_mov_b32 s39, s64
s_mov_b32 s28, s65
s_mov_b32 s29, s66
s_mov_b32 s64, s67
s_mov_b32 s65, s68
s_mov_b32 s66, s69
s_mov_b32 s67, s70
s_mov_b32 s68, s71
s_mov_b32 s69, s72
s_mov_b32 s70, s39
s_mov_b32 s71, s28
s_mov_b32 s72, s29
v_mov_b32 v7, v120
v_mov_b32 v120, v121
v_mov_b32 v121, v122
v_mov_b32 v122, v7
v_mov_b32 v16, v124
v_mov_b32 v124, v125
v_mov_b32 v125, v126
v_mov_b32 v126, v16
s_add_u32 s50, s57, s40
v_mov_b32 v13, 8192
s_cmp_lg_u32 s24, 3
s_cbranch_scc1 R_t1
s_cmp_eq_u32 s40, 0
s_cbranch_scc1 R_s0
s_sub_u32 s50, s40, 1
s_mov_b32 s62, 0
s_add_u32 s60, s57, s40
s_add_u32 s61, s57, s50
s_waitcnt vmcnt(8)
s_branch R_stc
R_st:
s_add_u32 s62, s62, 1
s_mov_b32 s63, 16
s_cmp_gt_u32 s62, 400000
s_cbranch_scc1 L_err
buffer_load_dwordx2 v[26:27], v24, s[4:7], s44 offen sc1
buffer_load_dwordx2 v[28:29], v25, s[4:7], s45 offen sc1
s_waitcnt vmcnt(0)
R_stc:
v_xor_b32 v27, s60, v27
v_xor_b32 v29, s61, v29
v_or_b32 v27, v27, v29
v_cmp_ne_u32 vcc, 0, v27
s_cbranch_vccnz R_st
v_max_i32_dpp v26, v26, v26 quad_perm:[1,0,3,2] row_mask:0xf bank_mask:0xf
v_max_i32_dpp v28, v28, v28 quad_perm:[1,0,3,2] row_mask:0xf bank_mask:0xf
s_nop 0
v_max_i32_dpp v26, v26, v26 quad_perm:[2,3,0,1] row_mask:0xf bank_mask:0xf
v_max_i32_dpp v28, v28, v28 quad_perm:[2,3,0,1] row_mask:0xf bank_mask:0xf
s_nop 0
v_max_i32_dpp v26, v26, v26 row_ror:4 row_mask:0xf bank_mask:0xf
v_max_i32_dpp v28, v28, v28 row_ror:4 row_mask:0xf bank_mask:0xf
s_nop 0
v_max_i32_dpp v26, v26, v26 row_ror:8 row_mask:0xf bank_mask:0xf
v_max_i32_dpp v28, v28, v28 row_ror:8 row_mask:0xf bank_mask:0xf
v_readlane_b32 s42, v26, 0
v_readlane_b32 s41, v26, 16
v_readlane_b32 s60, v26, 32
v_readlane_b32 s43, v28, 0
v_readlane_b32 s61, v28, 16
s_max_i32 s42, s42, s41
s_max_i32 s42, s42, s60
s_max_i32 s43, s43, s61
s_sub_u32 s41, s43, s16
s_sub_u32 s60, s18, 2
s_max_i32 s60, s60, s41
s_add_u32 s61, s18, 2
s_min_i32 s60, s60, s61
s_cmp_lg_u32 s56, 0
s_cselect_b32 s18, s18, s60
s_add_u32 s41, s43, 10
s_cmp_gt_i32 s41, s17
s_cselect_b32 s26, 1, 0
s_add_u32 s41, s43, 28
s_cmp_lg_u32 s26, 0
s_cselect_b32 s41, s41, s17
s_add_u32 s16, s41, s19
s_add_u32 s16, s16, 8
s_branch R_s1
R_s0:
s_mov_b32 s42, 0
R_s1:
s_sub_u32 s41, s42, s17
s_sub_u32 s60, s19, 2
s_max_i32 s60, s60, s41
s_add_u32 s61, s19, 2
s_min_i32 s60, s60, s61
s_cmp_lg_u32 s26, 0
s_cselect_b32 s19, s19, s60
s_add_u32 s41, s42, 5
s_cmp_gt_i32 s41, s16
s_cselect_b32 s56, 1, 0
s_add_u32 s41, s42, 28
s_cmp_lg_u32 s56, 0
s_cselect_b32 s41, s41, s16
s_add_u32 s17, s41, s18
s_add_u32 s17, s17, 15
s_add_u32 s50, s57, s40
v_mov_b32 v14, s17
v_mov_b32 v15, s50
v_mov_b32 v13, 8192
ds_write_b64 v13, v[14:15]
s_branch R_t2
R_t1:
s_mov_b32 s62, 0
R_t3:
s_add_u32 s62, s62, 1
s_mov_b32 s63, 17
s_cmp_gt_u32 s62, 400000
s_cbranch_scc1 L_err
ds_read_b64 v[14:15], v13
s_waitcnt lgkmcnt(0)
v_readfirstlane_b32 s41, v15
v_readfirstlane_b32 s17, v14
s_cmp_lg_u32 s41, s50
s_cbranch_scc1 R_t3
R_t2:
s_add_u32 s43, s17, s57
s_add_u32 s43, s43, -12
R_wu:
s_memrealtime s[58:59]
s_waitcnt lgkmcnt(0)
s_sub_u32 s59, s58, s43
s_cmp_lt_i32 s59, 0
s_cbranch_scc1 R_wu
s_mov_b32 s62, 0
R_p:
buffer_load_dwordx4 v[64:67], v1, s[4:7], s39 offen sc1
buffer_load_dwordx4 v[68:71], v1, s[4:7], s39 offen offset:1024 sc1
s_add_u32 s43, s17, s57
s_add_u32 s43, s43, 0
R_wp:
s_memrealtime s[58:59]
s_waitcnt lgkmcnt(0)
s_sub_u32 s59, s58, s43
s_cmp_lt_i32 s59, 0
s_cbranch_scc1 R_wp
buffer_load_dwordx4 v[72:75], v10, s[4:7], s28 offen offset:0 sc1
buffer_load_dwordx4 v[76:79], v10, s[4:7], s28 offen offset:1280 sc1
buffer_load_dwordx4 v[80:83], v10, s[4:7], s29 offen offset:0 sc1
buffer_load_dwordx4 v[84:87], v10, s[4:7], s29 offen offset:1280 sc1
buffer_load_dwordx4 v[88:91], v7, s[4:7], 0 offen sc1
s_add_u32 s62, s62, 1
s_mov_b32 s63, 8
s_cmp_gt_u32 s62, 400000
s_cbranch_scc1 L_err
s_waitcnt vmcnt(4)
v_mfma_f32_16x16x32_bf16 v[92:95], v[32:35], v[72:75], 0
v_mfma_f32_16x16x32_bf16 v[96:99], v[36:39], v[72:75], 0
s_waitcnt vmcnt(3)
v_mfma_f32_16x16x32_bf16 v[92:95], v[40:43], v[76:79], v[92:95]
v_mfma_f32_16x16x32_bf16 v[96:99], v[44:47], v[76:79], v[96:99]
s_waitcnt vmcnt(2)
v_mfma_f32_16x16x32_bf16 v[92:95], v[48:51], v[80:83], v[92:95]
v_mfma_f32_16x16x32_bf16 v[96:99], v[52:55], v[80:83], v[96:99]
s_waitcnt vmcnt(1)
v_mfma_f32_16x16x32_bf16 v[92:95], v[56:59], v[84:87], v[92:95]
v_mfma_f32_16x16x32_bf16 v[96:99], v[60:63], v[84:87], v[96:99]
v_max3_u32 v14, v72, v76, v80
s_waitcnt vmcnt(0)
v_mfma_f32_16x16x32_bf16 v[96:99], v[68:71], v[88:91], v[96:99]
v_mfma_f32_16x16x32_bf16 v[92:95], v[64:67], v[88:91], v[92:95]
v_max3_u32 v14, v14, v84, v88
v_max3_u32 v14, v14, v90, v64
v_max_u32 v14, v14, v68
v_cmp_eq_u32 vcc, -1, v14
s_cbranch_vccnz R_p
s_nop 2
v_add_f32_dpp v92, v96, v92 row_ror:8 row_mask:0xf bank_mask:0xf
v_add_f32_dpp v93, v97, v93 row_ror:8 row_mask:0xf bank_mask:0xf
v_add_f32_dpp v94, v98, v94 row_ror:8 row_mask:0xf bank_mask:0xf
v_add_f32_dpp v95, v99, v95 row_ror:8 row_mask:0xf bank_mask:0xf
ds_write_b128 v4, v[92:95]
s_waitcnt lgkmcnt(0)
s_barrier
s_cmp_lg_u32 s24, 0
s_cbranch_scc1 R_n0
ds_read_b128 v[100:103], v5 offset:0
ds_read_b128 v[104:107], v5 offset:1024
ds_read_b128 v[108:111], v5 offset:2048
ds_read_b128 v[112:115], v5 offset:3072
s_waitcnt lgkmcnt(2)
v_pk_add_f32 v[100:101], v[100:101], v[104:105]
v_pk_add_f32 v[102:103], v[102:103], v[106:107]
s_waitcnt lgkmcnt(0)
v_pk_add_f32 v[108:109], v[108:109], v[112:113]
v_pk_add_f32 v[110:111], v[110:111], v[114:115]
v_pk_add_f32 v[100:101], v[100:101], v[108:109]
v_pk_add_f32 v[102:103], v[102:103], v[110:111]
v_cvt_pk_bf16_f32 v108, v100, v101
v_cvt_pk_bf16_f32 v110, v100, v101
v_cvt_pk_bf16_f32 v109, v102, v103
v_cvt_pk_bf16_f32 v111, v102, v103
v_min_u32 v108, -2, v108
v_mov_b32_dpp v110, v110 row_ror:8 row_mask:0xf bank_mask:0x3
v_mov_b32_dpp v109, v109 row_ror:8 row_mask:0xf bank_mask:0xc
v_mov_b32_dpp v111, v111 row_ror:8 row_mask:0xf bank_mask:0x3
v_mov_b32_dpp v108, v108 row_ror:8 row_mask:0xf bank_mask:0xc
buffer_store_dwordx4 v[108:111], v16, s[4:7], 0 offen sc1
s_add_u32 s50, s40, 1
s_memrealtime s[58:59]
s_and_b32 s41, s50, 3
s_mul_i32 s41, s41, 3
s_add_u32 s41, s41, 36
s_lshr_b32 s42, s25, 5
s_add_u32 s41, s41, s42
s_lshl_b32 s41, s41, 15
s_and_b32 s42, s25, 31
s_lshl_b32 s42, s42, 7
s_add_u32 s41, s41, s42
s_add_u32 s42, s57, s50
v_mov_b32 v15, s42
v_mov_b32 v13, s52
v_writelane_b32 v13, s53, 1
v_writelane_b32 v13, s54, 2
v_writelane_b32 v13, s55, 3
v_xor_b32 v13, 0x1000, v13
s_waitcnt lgkmcnt(0)
s_sub_u32 s58, s58, s57
v_mov_b32 v14, s58
s_mov_b64 exec, 15
buffer_store_dwordx2 v[14:15], v13, s[4:7], s41 offen sc1
s_mov_b64 exec, -1
R_n0:
s_cmp_lg_u32 s24, 1
s_cbranch_scc1 R_n1
v_mov_b32 v20, -1
v_mov_b32 v21, -1
v_mov_b32 v22, -1
v_mov_b32 v23, -1
buffer_store_dwordx4 v[20:23], v16, s[4:7], 0 offen sc1
R_n1:
s_add_u32 s40, s40, 1
s_cmp_ge_u32 s40, 63
s_cbranch_scc1 L_fin
s_mov_b32 s50, s40
s_sleep 10
s_cmp_lg_u32 s24, 3
s_cbranch_scc1 R_ns
s_sub_u32 s51, s40, 1
s_xor_b32 s43, s35, 0x1000
s_add_u32 s43, s43, 1179648
s_and_b32 s44, s40, 3
s_mul_i32 s44, s44, 98304
s_add_u32 s44, s44, s43
s_and_b32 s45, s51, 3
s_mul_i32 s45, s45, 98304
s_add_u32 s45, s45, s43
s_add_u32 s45, s45, 65536
buffer_load_dwordx2 v[26:27], v24, s[4:7], s44 offen sc1
buffer_load_dwordx2 v[28:29], v25, s[4:7], s45 offen sc1
R_ns:
s_and_b32 s41, s50, 1
s_lshr_b32 s42, s50, 1
s_cmp_eq_u32 s41, 0
s_cselect_b32 s43, s48, s49
s_cmp_gt_u32 s43, s42
s_cbranch_scc1 Ru1ok
s_lshl_b32 s51, s41, 13
s_add_u32 s51, s51, 4194304
s_add_u32 s42, s42, 1
s_mov_b32 s62, 0
s_add_u32 s61, s57, s42
Ru1w:
s_add_u32 s62, s62, 1
s_mov_b32 s63, 6
s_cmp_gt_u32 s62, 400000
s_cbranch_scc1 L_err
buffer_load_dword v14, v6, s[4:7], s51 offen sc1
s_waitcnt vmcnt(0)
v_subrev_u32 v14, s61, v14
v_cmp_lt_u32 vcc, 64, v14
s_cbranch_vccnz Ru1w
v_min_u32_dpp v14, v14, v14 quad_perm:[1,0,3,2] row_mask:0xf bank_mask:0xf
s_nop 1
v_min_u32_dpp v14, v14, v14 quad_perm:[2,3,0,1] row_mask:0xf bank_mask:0xf
s_nop 1
v_min_u32_dpp v14, v14, v14 row_ror:4 row_mask:0xf bank_mask:0xf
s_nop 0
v_readfirstlane_b32 s43, v14
s_add_u32 s43, s43, s42
s_cmp_eq_u32 s41, 0
s_cselect_b32 s48, s43, s48
s_cselect_b32 s49, s49, s43
Ru1ok:
s_mul_i32 s43, s50, 40
s_add_u32 s43, s43, s25
s_lshl_b32 s43, s43, 2
s_add_u32 s43, s43, s24
s_lshl_b32 s42, s43, 14
s_add_u32 s42, s42, 5242880
s_bfe_u32 s61, s42, 0x10015
s_xor_b32 s61, s61, s3
s_lshl_b32 s61, s61, 13
s_add_u32 s42, s42, s61
s_add_u32 s43, s42, 4096
buffer_load_dwordx4 v[32:35], v1, s[4:7], s42 offen offset:0 sc1
buffer_load_dwordx4 v[36:39], v1, s[4:7], s42 offen offset:1024 sc1
buffer_load_dwordx4 v[40:43], v1, s[4:7], s42 offen offset:2048 sc1
buffer_load_dwordx4 v[44:47], v1, s[4:7], s42 offen offset:3072 sc1
buffer_load_dwordx4 v[48:51], v1, s[4:7], s43 offen offset:0 sc1
buffer_load_dwordx4 v[52:55], v1, s[4:7], s43 offen offset:1024 sc1
buffer_load_dwordx4 v[56:59], v1, s[4:7], s43 offen offset:2048 sc1
buffer_load_dwordx4 v[60:63], v1, s[4:7], s43 offen offset:3072 sc1
s_branch R_loop
L_B1:
s_mov_b32 s62, 0
v_mov_b32 v15, 128
B1wn:
s_add_u32 s62, s62, 1
s_mov_b32 s63, 9
s_cmp_gt_u32 s62, 400000
s_cbranch_scc1 L_err
buffer_load_dwordx3 v[12:14], v15, s[20:23], 0 offen sc1
s_waitcnt vmcnt(0)
v_readfirstlane_b32 s3, v12
v_readfirstlane_b32 s57, v14
s_cmp_eq_u32 s57, 0
s_cselect_b32 s3, 0, s3
s_bitcmp1_b32 s3, 8
s_cbranch_scc0 B1wn
s_bfe_u32 s3, s3, 0x10001
s_mul_i32 s29, s25, 43
s_lshr_b32 s29, s29, 8
s_lshr_b32 s26, s25, 2
s_lshl_b32 s41, s29, 3
v_and_b32 v12, 7, v0
v_add_u32 v12, s41, v12
v_lshlrev_b32 v13, 8, v12
v_add_u32 v12, 64, v12
v_lshlrev_b32 v12, 7, v12
v_cmp_gt_u32 vcc, 8, v0
s_nop 1
v_cndmask_b32 v13, v12, v13, vcc
s_mov_b32 s41, 4210688
s_mov_b32 s62, 0
s_add_u32 s61, s57, 0
s_branch B1_w_go
B1_w:
v_readfirstlane_b32 s60, v14
s_sleep 8
s_cmp_ge_i32 s60, -1
s_cbranch_scc1 B1_w_go
s_sleep 48
B1_w_go:
s_add_u32 s62, s62, 1
s_mov_b32 s63, 10
s_cmp_gt_u32 s62, 400000
s_cbranch_scc1 L_err
buffer_load_dword v14, v13, s[4:7], s41 offen sc1
s_waitcnt vmcnt(0)
v_subrev_u32 v14, s61, v14
v_cmp_lt_u32 vcc, 64, v14
s_cbranch_vccnz B1_w
s_mov_b32 s12, s80
s_and_b32 s13, s81, 0xffff
s_mov_b32 s14, 0x258000
s_mov_b32 s15, 0x20000
s_mul_i32 s30, s26, 640
s_mov_b32 s31, 0
s_mul_i32 s61, s24, 320
v_add_u32 v15, s61, v0
v_add_u32 v10, 0, v15
v_mul_u32_u24 v11, 26215, v10
v_lshrrev_b32 v11, 20, v11
v_mul_u32_u24 v13, 40, v11
v_sub_u32 v12, v10, v13
v_mul_u32_u24 v11, 3840, v11
v_lshlrev_b32 v12, 4, v12
v_add3_u32 v16, v11, v12, s30
v_add_u32 v10, 64, v15
v_mul_u32_u24 v11, 26215, v10
v_lshrrev_b32 v11, 20, v11
v_mul_u32_u24 v13, 40, v11
v_sub_u32 v12, v10, v13
v_mul_u32_u24 v11, 3840, v11
v_lshlrev_b32 v12, 4, v12
v_add3_u32 v17, v11, v12, s30
v_add_u32 v10, 128, v15
v_mul_u32_u24 v11, 26215, v10
v_lshrrev_b32 v11, 20, v11
v_mul_u32_u24 v13, 40, v11
v_sub_u32 v12, v10, v13
v_mul_u32_u24 v11, 3840, v11
v_lshlrev_b32 v12, 4, v12
v_add3_u32 v18, v11, v12, s30
v_add_u32 v10, 192, v15
v_mul_u32_u24 v11, 26215, v10
v_lshrrev_b32 v11, 20, v11
v_mul_u32_u24 v13, 40, v11
v_sub_u32 v12, v10, v13
v_mul_u32_u24 v11, 3840, v11
v_lshlrev_b32 v12, 4, v12
v_add3_u32 v19, v11, v12, s30
v_add_u32 v10, 256, v15
v_mul_u32_u24 v11, 26215, v10
v_lshrrev_b32 v11, 20, v11
v_mul_u32_u24 v13, 40, v11
v_sub_u32 v12, v10, v13
v_mul_u32_u24 v11, 3840, v11
v_lshlrev_b32 v12, 4, v12
v_add3_u32 v20, v11, v12, s30
s_mul_i32 s30, s24, 160
v_bfe_u32 v10, v0, 2, 2
v_lshl_add_u32 v10, v3, 3, v10
v_mov_b32 v11, 0
v_mul_u32_u24 v10, 640, v10
v_and_b32 v12, 3, v0
v_lshl_add_u32 v11, v12, 3, v11
v_add3_u32 v6, v10, v11, s30
v_add_u32 v7, 49152, v6
s_add_u32 s60, s31, 0
s_mul_i32 s61, s24, 5120
s_add_u32 s61, s61, 0
s_add_u32 m0, s61, 0
s_nop 0
buffer_load_dwordx4 v16, s[12:15], s60 offen lds
s_add_u32 m0, s61, 1024
s_nop 0
buffer_load_dwordx4 v17, s[12:15], s60 offen lds
s_add_u32 m0, s61, 2048
s_nop 0
buffer_load_dwordx4 v18, s[12:15], s60 offen lds
s_add_u32 m0, s61, 3072
s_nop 0
buffer_load_dwordx4 v19, s[12:15], s60 offen lds
s_add_u32 m0, s61, 4096
s_nop 0
buffer_load_dwordx4 v20, s[12:15], s60 offen lds
s_add_u32 s60, s31, 122880
s_mul_i32 s61, s24, 5120
s_add_u32 s61, s61, 20480
s_add_u32 m0, s61, 0
s_nop 0
buffer_load_dwordx4 v16, s[12:15], s60 offen lds
s_add_u32 m0, s61, 1024
s_nop 0
buffer_load_dwordx4 v17, s[12:15], s60 offen lds
s_add_u32 m0, s61, 2048
s_nop 0
buffer_load_dwordx4 v18, s[12:15], s60 offen lds
s_add_u32 m0, s61, 3072
s_nop 0
buffer_load_dwordx4 v19, s[12:15], s60 offen lds
s_add_u32 m0, s61, 4096
s_nop 0
buffer_load_dwordx4 v20, s[12:15], s60 offen lds
s_add_u32 s60, s31, 245760
s_mul_i32 s61, s24, 5120
s_add_u32 s61, s61, 40960
s_add_u32 m0, s61, 0
s_nop 0
buffer_load_dwordx4 v16, s[12:15], s60 offen lds
s_add_u32 m0, s61, 1024
s_nop 0
buffer_load_dwordx4 v17, s[12:15], s60 offen lds
s_add_u32 m0, s61, 2048
s_nop 0
buffer_load_dwordx4 v18, s[12:15], s60 offen lds
s_add_u32 m0, s61, 3072
s_nop 0
buffer_load_dwordx4 v19, s[12:15], s60 offen lds
s_add_u32 m0, s61, 4096
s_nop 0
buffer_load_dwordx4 v20, s[12:15], s60 offen lds
s_add_u32 s60, s31, 368640
s_mul_i32 s61, s24, 5120
s_add_u32 s61, s61, 61440
s_add_u32 m0, s61, 0
s_nop 0
buffer_load_dwordx4 v16, s[12:15], s60 offen lds
s_add_u32 m0, s61, 1024
s_nop 0
buffer_load_dwordx4 v17, s[12:15], s60 offen lds
s_add_u32 m0, s61, 2048
s_nop 0
buffer_load_dwordx4 v18, s[12:15], s60 offen lds
s_add_u32 m0, s61, 3072
s_nop 0
buffer_load_dwordx4 v19, s[12:15], s60 offen lds
s_add_u32 m0, s61, 4096
s_nop 0
buffer_load_dwordx4 v20, s[12:15], s60 offen lds
s_waitcnt vmcnt(15)
s_barrier
ds_read_b64_tr_b16 a[0:1], v6 offset:0
ds_read_b64_tr_b16 a[2:3], v6 offset:2560
ds_read_b64_tr_b16 a[4:5], v6 offset:32
ds_read_b64_tr_b16 a[6:7], v6 offset:2592
ds_read_b64_tr_b16 a[8:9], v6 offset:64
ds_read_b64_tr_b16 a[10:11], v6 offset:2624
ds_read_b64_tr_b16 a[12:13], v6 offset:96
ds_read_b64_tr_b16 a[14:15], v6 offset:2656
ds_read_b64_tr_b16 a[16:17], v6 offset:128
ds_read_b64_tr_b16 a[18:19], v6 offset:2688
s_waitcnt lgkmcnt(0)
s_waitcnt vmcnt(10)
s_barrier
s_add_u32 s60, s31, 491520
s_mul_i32 s61, s24, 5120
s_add_u32 s61, s61, 0
s_add_u32 m0, s61, 0
s_nop 0
buffer_load_dwordx4 v16, s[12:15], s60 offen lds
s_add_u32 m0, s61, 1024
s_nop 0
buffer_load_dwordx4 v17, s[12:15], s60 offen lds
s_add_u32 m0, s61, 2048
s_nop 0
buffer_load_dwordx4 v18, s[12:15], s60 offen lds
s_add_u32 m0, s61, 3072
s_nop 0
buffer_load_dwordx4 v19, s[12:15], s60 offen lds
s_add_u32 m0, s61, 4096
s_nop 0
buffer_load_dwordx4 v20, s[12:15], s60 offen lds
ds_read_b64_tr_b16 a[20:21], v6 offset:20480
ds_read_b64_tr_b16 a[22:23], v6 offset:23040
ds_read_b64_tr_b16 a[24:25], v6 offset:20512
ds_read_b64_tr_b16 a[26:27], v6 offset:23072
ds_read_b64_tr_b16 a[28:29], v6 offset:20544
ds_read_b64_tr_b16 a[30:31], v6 offset:23104
ds_read_b64_tr_b16 a[32:33], v6 offset:20576
ds_read_b64_tr_b16 a[34:35], v6 offset:23136
ds_read_b64_tr_b16 a[36:37], v6 offset:20608
ds_read_b64_tr_b16 a[38:39], v6 offset:23168
s_waitcnt lgkmcnt(0)
s_waitcnt vmcnt(10)
s_barrier
s_add_u32 s60, s31, 614400
s_mul_i32 s61, s24, 5120
s_add_u32 s61, s61, 20480
s_add_u32 m0, s61, 0
s_nop 0
buffer_load_dwordx4 v16, s[12:15], s60 offen lds
s_add_u32 m0, s61, 1024
s_nop 0
buffer_load_dwordx4 v17, s[12:15], s60 offen lds
s_add_u32 m0, s61, 2048
s_nop 0
buffer_load_dwordx4 v18, s[12:15], s60 offen lds
s_add_u32 m0, s61, 3072
s_nop 0
buffer_load_dwordx4 v19, s[12:15], s60 offen lds
s_add_u32 m0, s61, 4096
s_nop 0
buffer_load_dwordx4 v20, s[12:15], s60 offen lds
ds_read_b64_tr_b16 a[40:41], v6 offset:40960
ds_read_b64_tr_b16 a[42:43], v6 offset:43520
ds_read_b64_tr_b16 a[44:45], v6 offset:40992
ds_read_b64_tr_b16 a[46:47], v6 offset:43552
ds_read_b64_tr_b16 a[48:49], v6 offset:41024
ds_read_b64_tr_b16 a[50:51], v6 offset:43584
ds_read_b64_tr_b16 a[52:53], v6 offset:41056
ds_read_b64_tr_b16 a[54:55], v6 offset:43616
ds_read_b64_tr_b16 a[56:57], v6 offset:41088
ds_read_b64_tr_b16 a[58:59], v6 offset:43648
s_waitcnt lgkmcnt(0)
s_waitcnt vmcnt(10)
s_barrier
s_add_u32 s60, s31, 737280
s_mul_i32 s61, s24, 5120
s_add_u32 s61, s61, 40960
s_add_u32 m0, s61, 0
s_nop 0
buffer_load_dwordx4 v16, s[12:15], s60 offen lds
s_add_u32 m0, s61, 1024
s_nop 0
buffer_load_dwordx4 v17, s[12:15], s60 offen lds
s_add_u32 m0, s61, 2048
s_nop 0
buffer_load_dwordx4 v18, s[12:15], s60 offen lds
s_add_u32 m0, s61, 3072
s_nop 0
buffer_load_dwordx4 v19, s[12:15], s60 offen lds
s_add_u32 m0, s61, 4096
s_nop 0
buffer_load_dwordx4 v20, s[12:15], s60 offen lds
ds_read_b64_tr_b16 a[60:61], v7 offset:12288
ds_read_b64_tr_b16 a[62:63], v7 offset:14848
ds_read_b64_tr_b16 a[64:65], v7 offset:12320
ds_read_b64_tr_b16 a[66:67], v7 offset:14880
ds_read_b64_tr_b16 a[68:69], v7 offset:12352
ds_read_b64_tr_b16 a[70:71], v7 offset:14912
ds_read_b64_tr_b16 a[72:73], v7 offset:12384
ds_read_b64_tr_b16 a[74:75], v7 offset:14944
ds_read_b64_tr_b16 a[76:77], v7 offset:12416
ds_read_b64_tr_b16 a[78:79], v7 offset:14976
s_waitcnt lgkmcnt(0)
s_waitcnt vmcnt(10)
s_barrier
s_add_u32 s60, s31, 860160
s_mul_i32 s61, s24, 5120
s_add_u32 s61, s61, 61440
s_add_u32 m0, s61, 0
s_nop 0
buffer_load_dwordx4 v16, s[12:15], s60 offen lds
s_add_u32 m0, s61, 1024
s_nop 0
buffer_load_dwordx4 v17, s[12:15], s60 offen lds
s_add_u32 m0, s61, 2048
s_nop 0
buffer_load_dwordx4 v18, s[12:15], s60 offen lds
s_add_u32 m0, s61, 3072
s_nop 0
buffer_load_dwordx4 v19, s[12:15], s60 offen lds
s_add_u32 m0, s61, 4096
s_nop 0
buffer_load_dwordx4 v20, s[12:15], s60 offen lds
ds_read_b64_tr_b16 a[80:81], v6 offset:0
ds_read_b64_tr_b16 a[82:83], v6 offset:2560
ds_read_b64_tr_b16 a[84:85], v6 offset:32
ds_read_b64_tr_b16 a[86:87], v6 offset:2592
ds_read_b64_tr_b16 a[88:89], v6 offset:64
ds_read_b64_tr_b16 a[90:91], v6 offset:2624
ds_read_b64_tr_b16 a[92:93], v6 offset:96
ds_read_b64_tr_b16 a[94:95], v6 offset:2656
ds_read_b64_tr_b16 a[96:97], v6 offset:128
ds_read_b64_tr_b16 a[98:99], v6 offset:2688
s_waitcnt lgkmcnt(0)
s_waitcnt vmcnt(10)
s_barrier
s_add_u32 s60, s31, 983040
s_mul_i32 s61, s24, 5120
s_add_u32 s61, s61, 0
s_add_u32 m0, s61, 0
s_nop 0
buffer_load_dwordx4 v16, s[12:15], s60 offen lds
s_add_u32 m0, s61, 1024
s_nop 0
buffer_load_dwordx4 v17, s[12:15], s60 offen lds
s_add_u32 m0, s61, 2048
s_nop 0
buffer_load_dwordx4 v18, s[12:15], s60 offen lds
s_add_u32 m0, s61, 3072
s_nop 0
buffer_load_dwordx4 v19, s[12:15], s60 offen lds
s_add_u32 m0, s61, 4096
s_nop 0
buffer_load_dwordx4 v20, s[12:15], s60 offen lds
ds_read_b64_tr_b16 a[100:101], v6 offset:20480
ds_read_b64_tr_b16 a[102:103], v6 offset:23040
ds_read_b64_tr_b16 a[104:105], v6 offset:20512
ds_read_b64_tr_b16 a[106:107], v6 offset:23072
ds_read_b64_tr_b16 a[108:109], v6 offset:20544
ds_read_b64_tr_b16 a[110:111], v6 offset:23104
ds_read_b64_tr_b16 a[112:113], v6 offset:20576
ds_read_b64_tr_b16 a[114:115], v6 offset:23136
ds_read_b64_tr_b16 a[116:117], v6 offset:20608
ds_read_b64_tr_b16 a[118:119], v6 offset:23168
s_waitcnt lgkmcnt(0)
s_waitcnt vmcnt(10)
s_barrier
s_add_u32 s60, s31, 1105920
s_mul_i32 s61, s24, 5120
s_add_u32 s61, s61, 20480
s_add_u32 m0, s61, 0
s_nop 0
buffer_load_dwordx4 v16, s[12:15], s60 offen lds
s_add_u32 m0, s61, 1024
s_nop 0
buffer_load_dwordx4 v17, s[12:15], s60 offen lds
s_add_u32 m0, s61, 2048
s_nop 0
buffer_load_dwordx4 v18, s[12:15], s60 offen lds
s_add_u32 m0, s61, 3072
s_nop 0
buffer_load_dwordx4 v19, s[12:15], s60 offen lds
s_add_u32 m0, s61, 4096
s_nop 0
buffer_load_dwordx4 v20, s[12:15], s60 offen lds
ds_read_b64_tr_b16 a[120:121], v6 offset:40960
ds_read_b64_tr_b16 a[122:123], v6 offset:43520
ds_read_b64_tr_b16 a[124:125], v6 offset:40992
ds_read_b64_tr_b16 a[126:127], v6 offset:43552
ds_read_b64_tr_b16 a[128:129], v6 offset:41024
ds_read_b64_tr_b16 a[130:131], v6 offset:43584
ds_read_b64_tr_b16 a[132:133], v6 offset:41056
ds_read_b64_tr_b16 a[134:135], v6 offset:43616
ds_read_b64_tr_b16 a[136:137], v6 offset:41088
ds_read_b64_tr_b16 a[138:139], v6 offset:43648
s_waitcnt lgkmcnt(0)
s_waitcnt vmcnt(10)
s_barrier
s_add_u32 s60, s31, 1228800
s_mul_i32 s61, s24, 5120
s_add_u32 s61, s61, 40960
s_add_u32 m0, s61, 0
s_nop 0
buffer_load_dwordx4 v16, s[12:15], s60 offen lds
s_add_u32 m0, s61, 1024
s_nop 0
buffer_load_dwordx4 v17, s[12:15], s60 offen lds
s_add_u32 m0, s61, 2048
s_nop 0
buffer_load_dwordx4 v18, s[12:15], s60 offen lds
s_add_u32 m0, s61, 3072
s_nop 0
buffer_load_dwordx4 v19, s[12:15], s60 offen lds
s_add_u32 m0, s61, 4096
s_nop 0
buffer_load_dwordx4 v20, s[12:15], s60 offen lds
ds_read_b64_tr_b16 a[140:141], v7 offset:12288
ds_read_b64_tr_b16 a[142:143], v7 offset:14848
ds_read_b64_tr_b16 a[144:145], v7 offset:12320
ds_read_b64_tr_b16 a[146:147], v7 offset:14880
ds_read_b64_tr_b16 a[148:149], v7 offset:12352
ds_read_b64_tr_b16 a[150:151], v7 offset:14912
ds_read_b64_tr_b16 a[152:153], v7 offset:12384
ds_read_b64_tr_b16 a[154:155], v7 offset:14944
ds_read_b64_tr_b16 a[156:157], v7 offset:12416
ds_read_b64_tr_b16 a[158:159], v7 offset:14976
s_waitcnt lgkmcnt(0)
s_waitcnt vmcnt(10)
s_barrier
s_add_u32 s60, s31, 1351680
s_mul_i32 s61, s24, 5120
s_add_u32 s61, s61, 61440
s_add_u32 m0, s61, 0
s_nop 0
buffer_load_dwordx4 v16, s[12:15], s60 offen lds
s_add_u32 m0, s61, 1024
s_nop 0
buffer_load_dwordx4 v17, s[12:15], s60 offen lds
s_add_u32 m0, s61, 2048
s_nop 0
buffer_load_dwordx4 v18, s[12:15], s60 offen lds
s_add_u32 m0, s61, 3072
s_nop 0
buffer_load_dwordx4 v19, s[12:15], s60 offen lds
s_add_u32 m0, s61, 4096
s_nop 0
buffer_load_dwordx4 v20, s[12:15], s60 offen lds
ds_read_b64_tr_b16 a[160:161], v6 offset:0
ds_read_b64_tr_b16 a[162:163], v6 offset:2560
ds_read_b64_tr_b16 a[164:165], v6 offset:32
ds_read_b64_tr_b16 a[166:167], v6 offset:2592
ds_read_b64_tr_b16 a[168:169], v6 offset:64
ds_read_b64_tr_b16 a[170:171], v6 offset:2624
ds_read_b64_tr_b16 a[172:173], v6 offset:96
ds_read_b64_tr_b16 a[174:175], v6 offset:2656
ds_read_b64_tr_b16 a[176:177], v6 offset:128
ds_read_b64_tr_b16 a[178:179], v6 offset:2688
s_waitcnt lgkmcnt(0)
s_waitcnt vmcnt(10)
s_barrier
s_add_u32 s60, s31, 1474560
s_mul_i32 s61, s24, 5120
s_add_u32 s61, s61, 0
s_add_u32 m0, s61, 0
s_nop 0
buffer_load_dwordx4 v16, s[12:15], s60 offen lds
s_add_u32 m0, s61, 1024
s_nop 0
buffer_load_dwordx4 v17, s[12:15], s60 offen lds
s_add_u32 m0, s61, 2048
s_nop 0
buffer_load_dwordx4 v18, s[12:15], s60 offen lds
s_add_u32 m0, s61, 3072
s_nop 0
buffer_load_dwordx4 v19, s[12:15], s60 offen lds
s_add_u32 m0, s61, 4096
s_nop 0
buffer_load_dwordx4 v20, s[12:15], s60 offen lds
ds_read_b64_tr_b16 a[180:181], v6 offset:20480
ds_read_b64_tr_b16 a[182:183], v6 offset:23040
ds_read_b64_tr_b16 a[184:185], v6 offset:20512
ds_read_b64_tr_b16 a[186:187], v6 offset:23072
ds_read_b64_tr_b16 a[188:189], v6 offset:20544
ds_read_b64_tr_b16 a[190:191], v6 offset:23104
ds_read_b64_tr_b16 a[192:193], v6 offset:20576
ds_read_b64_tr_b16 a[194:195], v6 offset:23136
ds_read_b64_tr_b16 a[196:197], v6 offset:20608
ds_read_b64_tr_b16 a[198:199], v6 offset:23168
s_waitcnt lgkmcnt(0)
s_waitcnt vmcnt(10)
s_barrier
s_add_u32 s60, s31, 1597440
s_mul_i32 s61, s24, 5120
s_add_u32 s61, s61, 20480
s_add_u32 m0, s61, 0
s_nop 0
buffer_load_dwordx4 v16, s[12:15], s60 offen lds
s_add_u32 m0, s61, 1024
s_nop 0
buffer_load_dwordx4 v17, s[12:15], s60 offen lds
s_add_u32 m0, s61, 2048
s_nop 0
buffer_load_dwordx4 v18, s[12:15], s60 offen lds
s_add_u32 m0, s61, 3072
s_nop 0
buffer_load_dwordx4 v19, s[12:15], s60 offen lds
s_add_u32 m0, s61, 4096
s_nop 0
buffer_load_dwordx4 v20, s[12:15], s60 offen lds
ds_read_b64_tr_b16 a[200:201], v6 offset:40960
ds_read_b64_tr_b16 a[202:203], v6 offset:43520
ds_read_b64_tr_b16 a[204:205], v6 offset:40992
ds_read_b64_tr_b16 a[206:207], v6 offset:43552
ds_read_b64_tr_b16 a[208:209], v6 offset:41024
ds_read_b64_tr_b16 a[210:211], v6 offset:43584
ds_read_b64_tr_b16 a[212:213], v6 offset:41056
ds_read_b64_tr_b16 a[214:215], v6 offset:43616
ds_read_b64_tr_b16 a[216:217], v6 offset:41088
ds_read_b64_tr_b16 a[218:219], v6 offset:43648
s_waitcnt lgkmcnt(0)
s_waitcnt vmcnt(10)
s_barrier
s_add_u32 s60, s31, 1720320
s_mul_i32 s61, s24, 5120
s_add_u32 s61, s61, 40960
s_add_u32 m0, s61, 0
s_nop 0
buffer_load_dwordx4 v16, s[12:15], s60 offen lds
s_add_u32 m0, s61, 1024
s_nop 0
buffer_load_dwordx4 v17, s[12:15], s60 offen lds
s_add_u32 m0, s61, 2048
s_nop 0
buffer_load_dwordx4 v18, s[12:15], s60 offen lds
s_add_u32 m0, s61, 3072
s_nop 0
buffer_load_dwordx4 v19, s[12:15], s60 offen lds
s_add_u32 m0, s61, 4096
s_nop 0
buffer_load_dwordx4 v20, s[12:15], s60 offen lds
ds_read_b64_tr_b16 a[220:221], v7 offset:12288
ds_read_b64_tr_b16 a[222:223], v7 offset:14848
ds_read_b64_tr_b16 a[224:225], v7 offset:12320
ds_read_b64_tr_b16 a[226:227], v7 offset:14880
ds_read_b64_tr_b16 a[228:229], v7 offset:12352
ds_read_b64_tr_b16 a[230:231], v7 offset:14912
ds_read_b64_tr_b16 a[232:233], v7 offset:12384
ds_read_b64_tr_b16 a[234:235], v7 offset:14944
ds_read_b64_tr_b16 a[236:237], v7 offset:12416
ds_read_b64_tr_b16 a[238:239], v7 offset:14976
s_waitcnt lgkmcnt(0)
s_waitcnt vmcnt(10)
s_barrier
s_add_u32 s60, s31, 1843200
s_mul_i32 s61, s24, 5120
s_add_u32 s61, s61, 61440
s_add_u32 m0, s61, 0
s_nop 0
buffer_load_dwordx4 v16, s[12:15], s60 offen lds
s_add_u32 m0, s61, 1024
s_nop 0
buffer_load_dwordx4 v17, s[12:15], s60 offen lds
s_add_u32 m0, s61, 2048
s_nop 0
buffer_load_dwordx4 v18, s[12:15], s60 offen lds
s_add_u32 m0, s61, 3072
s_nop 0
buffer_load_dwordx4 v19, s[12:15], s60 offen lds
s_add_u32 m0, s61, 4096
s_nop 0
buffer_load_dwordx4 v20, s[12:15], s60 offen lds
ds_read_b64_tr_b16 a[240:241], v6 offset:0
ds_read_b64_tr_b16 a[242:243], v6 offset:2560
ds_read_b64_tr_b16 a[244:245], v6 offset:32
ds_read_b64_tr_b16 a[246:247], v6 offset:2592
ds_read_b64_tr_b16 a[248:249], v6 offset:64
ds_read_b64_tr_b16 a[250:251], v6 offset:2624
ds_read_b64_tr_b16 a[252:253], v6 offset:96
ds_read_b64_tr_b16 a[254:255], v6 offset:2656
ds_read_b64_tr_b16 v[112:113], v6 offset:128
ds_read_b64_tr_b16 v[114:115], v6 offset:2688
s_waitcnt lgkmcnt(0)
s_waitcnt vmcnt(10)
s_barrier
s_add_u32 s60, s31, 1966080
s_mul_i32 s61, s24, 5120
s_add_u32 s61, s61, 0
s_add_u32 m0, s61, 0
s_nop 0
buffer_load_dwordx4 v16, s[12:15], s60 offen lds
s_add_u32 m0, s61, 1024
s_nop 0
buffer_load_dwordx4 v17, s[12:15], s60 offen lds
s_add_u32 m0, s61, 2048
s_nop 0
buffer_load_dwordx4 v18, s[12:15], s60 offen lds
s_add_u32 m0, s61, 3072
s_nop 0
buffer_load_dwordx4 v19, s[12:15], s60 offen lds
s_add_u32 m0, s61, 4096
s_nop 0
buffer_load_dwordx4 v20, s[12:15], s60 offen lds
ds_read_b64_tr_b16 v[116:117], v6 offset:20480
ds_read_b64_tr_b16 v[118:119], v6 offset:23040
ds_read_b64_tr_b16 v[120:121], v6 offset:20512
ds_read_b64_tr_b16 v[122:123], v6 offset:23072
ds_read_b64_tr_b16 v[124:125], v6 offset:20544
ds_read_b64_tr_b16 v[126:127], v6 offset:23104
ds_read_b64_tr_b16 v[128:129], v6 offset:20576
ds_read_b64_tr_b16 v[130:131], v6 offset:23136
ds_read_b64_tr_b16 v[132:133], v6 offset:20608
ds_read_b64_tr_b16 v[134:135], v6 offset:23168
s_waitcnt lgkmcnt(0)
s_waitcnt vmcnt(10)
s_barrier
s_add_u32 s60, s31, 2088960
s_mul_i32 s61, s24, 5120
s_add_u32 s61, s61, 20480
s_add_u32 m0, s61, 0
s_nop 0
buffer_load_dwordx4 v16, s[12:15], s60 offen lds
s_add_u32 m0, s61, 1024
s_nop 0
buffer_load_dwordx4 v17, s[12:15], s60 offen lds
s_add_u32 m0, s61, 2048
s_nop 0
buffer_load_dwordx4 v18, s[12:15], s60 offen lds
s_add_u32 m0, s61, 3072
s_nop 0
buffer_load_dwordx4 v19, s[12:15], s60 offen lds
s_add_u32 m0, s61, 4096
s_nop 0
buffer_load_dwordx4 v20, s[12:15], s60 offen lds
ds_read_b64_tr_b16 v[136:137], v6 offset:40960
ds_read_b64_tr_b16 v[138:139], v6 offset:43520
ds_read_b64_tr_b16 v[140:141], v6 offset:40992
ds_read_b64_tr_b16 v[142:143], v6 offset:43552
ds_read_b64_tr_b16 v[144:145], v6 offset:41024
ds_read_b64_tr_b16 v[146:147], v6 offset:43584
ds_read_b64_tr_b16 v[148:149], v6 offset:41056
ds_read_b64_tr_b16 v[150:151], v6 offset:43616
ds_read_b64_tr_b16 v[152:153], v6 offset:41088
ds_read_b64_tr_b16 v[154:155], v6 offset:43648
s_waitcnt lgkmcnt(0)
s_waitcnt vmcnt(10)
s_barrier
s_add_u32 s60, s31, 2211840
s_mul_i32 s61, s24, 5120
s_add_u32 s61, s61, 40960
s_add_u32 m0, s61, 0
s_nop 0
buffer_load_dwordx4 v16, s[12:15], s60 offen lds
s_add_u32 m0, s61, 1024
s_nop 0
buffer_load_dwordx4 v17, s[12:15], s60 offen lds
s_add_u32 m0, s61, 2048
s_nop 0
buffer_load_dwordx4 v18, s[12:15], s60 offen lds
s_add_u32 m0, s61, 3072
s_nop 0
buffer_load_dwordx4 v19, s[12:15], s60 offen lds
s_add_u32 m0, s61, 4096
s_nop 0
buffer_load_dwordx4 v20, s[12:15], s60 offen lds
ds_read_b64_tr_b16 v[156:157], v7 offset:12288
ds_read_b64_tr_b16 v[158:159], v7 offset:14848
ds_read_b64_tr_b16 v[160:161], v7 offset:12320
ds_read_b64_tr_b16 v[162:163], v7 offset:14880
ds_read_b64_tr_b16 v[164:165], v7 offset:12352
ds_read_b64_tr_b16 v[166:167], v7 offset:14912
ds_read_b64_tr_b16 v[168:169], v7 offset:12384
ds_read_b64_tr_b16 v[170:171], v7 offset:14944
ds_read_b64_tr_b16 v[172:173], v7 offset:12416
ds_read_b64_tr_b16 v[174:175], v7 offset:14976
s_waitcnt lgkmcnt(0)
s_waitcnt vmcnt(10)
s_barrier
s_add_u32 s60, s31, 2334720
s_mul_i32 s61, s24, 5120
s_add_u32 s61, s61, 61440
s_add_u32 m0, s61, 0
s_nop 0
buffer_load_dwordx4 v16, s[12:15], s60 offen lds
s_add_u32 m0, s61, 1024
s_nop 0
buffer_load_dwordx4 v17, s[12:15], s60 offen lds
s_add_u32 m0, s61, 2048
s_nop 0
buffer_load_dwordx4 v18, s[12:15], s60 offen lds
s_add_u32 m0, s61, 3072
s_nop 0
buffer_load_dwordx4 v19, s[12:15], s60 offen lds
s_add_u32 m0, s61, 4096
s_nop 0
buffer_load_dwordx4 v20, s[12:15], s60 offen lds
ds_read_b64_tr_b16 v[176:177], v6 offset:0
ds_read_b64_tr_b16 v[178:179], v6 offset:2560
ds_read_b64_tr_b16 v[180:181], v6 offset:32
ds_read_b64_tr_b16 v[182:183], v6 offset:2592
ds_read_b64_tr_b16 v[184:185], v6 offset:64
ds_read_b64_tr_b16 v[186:187], v6 offset:2624
ds_read_b64_tr_b16 v[188:189], v6 offset:96
ds_read_b64_tr_b16 v[190:191], v6 offset:2656
ds_read_b64_tr_b16 v[192:193], v6 offset:128
ds_read_b64_tr_b16 v[194:195], v6 offset:2688
s_waitcnt lgkmcnt(0)
s_waitcnt vmcnt(10)
s_barrier
ds_read_b64_tr_b16 v[196:197], v6 offset:20480
ds_read_b64_tr_b16 v[198:199], v6 offset:23040
ds_read_b64_tr_b16 v[200:201], v6 offset:20512
ds_read_b64_tr_b16 v[202:203], v6 offset:23072
ds_read_b64_tr_b16 v[204:205], v6 offset:20544
ds_read_b64_tr_b16 v[206:207], v6 offset:23104
ds_read_b64_tr_b16 v[208:209], v6 offset:20576
ds_read_b64_tr_b16 v[210:211], v6 offset:23136
ds_read_b64_tr_b16 v[212:213], v6 offset:20608
ds_read_b64_tr_b16 v[214:215], v6 offset:23168
s_waitcnt lgkmcnt(0)
s_waitcnt vmcnt(5)
s_barrier
ds_read_b64_tr_b16 v[216:217], v6 offset:40960
ds_read_b64_tr_b16 v[218:219], v6 offset:43520
ds_read_b64_tr_b16 v[220:221], v6 offset:40992
ds_read_b64_tr_b16 v[222:223], v6 offset:43552
ds_read_b64_tr_b16 v[224:225], v6 offset:41024
ds_read_b64_tr_b16 v[226:227], v6 offset:43584
ds_read_b64_tr_b16 v[228:229], v6 offset:41056
ds_read_b64_tr_b16 v[230:231], v6 offset:43616
ds_read_b64_tr_b16 v[232:233], v6 offset:41088
ds_read_b64_tr_b16 v[234:235], v6 offset:43648
s_waitcnt lgkmcnt(0)
s_waitcnt vmcnt(0)
s_barrier
ds_read_b64_tr_b16 v[236:237], v7 offset:12288
ds_read_b64_tr_b16 v[238:239], v7 offset:14848
ds_read_b64_tr_b16 v[240:241], v7 offset:12320
ds_read_b64_tr_b16 v[242:243], v7 offset:14880
ds_read_b64_tr_b16 v[244:245], v7 offset:12352
ds_read_b64_tr_b16 v[246:247], v7 offset:14912
ds_read_b64_tr_b16 v[248:249], v7 offset:12384
ds_read_b64_tr_b16 v[250:251], v7 offset:14944
ds_read_b64_tr_b16 v[252:253], v7 offset:12416
ds_read_b64_tr_b16 v[254:255], v7 offset:14976
s_waitcnt lgkmcnt(0)
s_barrier
s_lshl_b32 s30, s25, 2
s_add_u32 s30, s30, s24
B1_g:
s_mov_b32 s41, s30
s_mov_b32 s12, s84
s_and_b32 s13, s85, 0xffff
s_mov_b32 s14, 0x500
s_mov_b32 s15, 0x20000
s_mul_i32 s42, s41, 20480
v_lshrrev_b32 v12, 2, v0
v_mul_u32_u24 v12, 1280, v12
v_and_b32 v13, 3, v0
v_lshlrev_b32 v13, 4, v13
v_add_u32 v12, v12, v13
v_mov_b32 v16, 0
v_mov_b32 v17, 0
s_mov_b32 s43, 0xffff0000
buffer_load_dwordx4 v[24:27], v12, s[8:11], s42 offen offset:0
buffer_load_dwordx4 v[28:31], v13, s[12:15], 0 offen offset:0
buffer_load_dwordx4 v[32:35], v12, s[8:11], s42 offen offset:64
buffer_load_dwordx4 v[36:39], v13, s[12:15], 0 offen offset:64
buffer_load_dwordx4 v[40:43], v12, s[8:11], s42 offen offset:128
buffer_load_dwordx4 v[44:47], v13, s[12:15], 0 offen offset:128
buffer_load_dwordx4 v[48:51], v12, s[8:11], s42 offen offset:192
buffer_load_dwordx4 v[52:55], v13, s[12:15], 0 offen offset:192
buffer_load_dwordx4 v[56:59], v12, s[8:11], s42 offen offset:256
buffer_load_dwordx4 v[60:63], v13, s[12:15], 0 offen offset:256
buffer_load_dwordx4 v[64:67], v12, s[8:11], s42 offen offset:320
buffer_load_dwordx4 v[68:71], v13, s[12:15], 0 offen offset:320
buffer_load_dwordx4 v[72:75], v12, s[8:11], s42 offen offset:384
buffer_load_dwordx4 v[76:79], v13, s[12:15], 0 offen offset:384
buffer_load_dwordx4 v[80:83], v12, s[8:11], s42 offen offset:448
buffer_load_dwordx4 v[84:87], v13, s[12:15], 0 offen offset:448
buffer_load_dwordx4 v[88:91], v12, s[8:11], s42 offen offset:512
buffer_load_dwordx4 v[92:95], v13, s[12:15], 0 offen offset:512
buffer_load_dwordx4 v[96:99], v12, s[8:11], s42 offen offset:576
buffer_load_dwordx4 v[100:103], v13, s[12:15], 0 offen offset:576
s_waitcnt vmcnt(18)
v_lshlrev_b32 v18, 16, v24
v_lshlrev_b32 v19, 16, v28
v_and_b32 v20, s43, v24
v_and_b32 v21, s43, v28
v_mul_f32 v18, v18, v19
v_mul_f32 v20, v20, v21
v_cvt_pk_bf16_f32 v18, v18, v20
v_lshlrev_b32 v19, 16, v18
v_and_b32 v20, s43, v18
v_add_f32 v16, v16, v19
v_add_f32 v17, v17, v20
v_lshlrev_b32 v18, 16, v25
v_lshlrev_b32 v19, 16, v29
v_and_b32 v20, s43, v25
v_and_b32 v21, s43, v29
v_mul_f32 v18, v18, v19
v_mul_f32 v20, v20, v21
v_cvt_pk_bf16_f32 v18, v18, v20
v_lshlrev_b32 v19, 16, v18
v_and_b32 v20, s43, v18
v_add_f32 v16, v16, v19
v_add_f32 v17, v17, v20
v_lshlrev_b32 v18, 16, v26
v_lshlrev_b32 v19, 16, v30
v_and_b32 v20, s43, v26
v_and_b32 v21, s43, v30
v_mul_f32 v18, v18, v19
v_mul_f32 v20, v20, v21
v_cvt_pk_bf16_f32 v18, v18, v20
v_lshlrev_b32 v19, 16, v18
v_and_b32 v20, s43, v18
v_add_f32 v16, v16, v19
v_add_f32 v17, v17, v20
v_lshlrev_b32 v18, 16, v27
v_lshlrev_b32 v19, 16, v31
v_and_b32 v20, s43, v27
v_and_b32 v21, s43, v31
v_mul_f32 v18, v18, v19
v_mul_f32 v20, v20, v21
v_cvt_pk_bf16_f32 v18, v18, v20
v_lshlrev_b32 v19, 16, v18
v_and_b32 v20, s43, v18
v_add_f32 v16, v16, v19
v_add_f32 v17, v17, v20
s_waitcnt vmcnt(16)
v_lshlrev_b32 v18, 16, v32
v_lshlrev_b32 v19, 16, v36
v_and_b32 v20, s43, v32
v_and_b32 v21, s43, v36
v_mul_f32 v18, v18, v19
v_mul_f32 v20, v20, v21
v_cvt_pk_bf16_f32 v18, v18, v20
v_lshlrev_b32 v19, 16, v18
v_and_b32 v20, s43, v18
v_add_f32 v16, v16, v19
v_add_f32 v17, v17, v20
v_lshlrev_b32 v18, 16, v33
v_lshlrev_b32 v19, 16, v37
v_and_b32 v20, s43, v33
v_and_b32 v21, s43, v37
v_mul_f32 v18, v18, v19
v_mul_f32 v20, v20, v21
v_cvt_pk_bf16_f32 v18, v18, v20
v_lshlrev_b32 v19, 16, v18
v_and_b32 v20, s43, v18
v_add_f32 v16, v16, v19
v_add_f32 v17, v17, v20
v_lshlrev_b32 v18, 16, v34
v_lshlrev_b32 v19, 16, v38
v_and_b32 v20, s43, v34
v_and_b32 v21, s43, v38
v_mul_f32 v18, v18, v19
v_mul_f32 v20, v20, v21
v_cvt_pk_bf16_f32 v18, v18, v20
v_lshlrev_b32 v19, 16, v18
v_and_b32 v20, s43, v18
v_add_f32 v16, v16, v19
v_add_f32 v17, v17, v20
v_lshlrev_b32 v18, 16, v35
v_lshlrev_b32 v19, 16, v39
v_and_b32 v20, s43, v35
v_and_b32 v21, s43, v39
v_mul_f32 v18, v18, v19
v_mul_f32 v20, v20, v21
v_cvt_pk_bf16_f32 v18, v18, v20
v_lshlrev_b32 v19, 16, v18
v_and_b32 v20, s43, v18
v_add_f32 v16, v16, v19
v_add_f32 v17, v17, v20
s_waitcnt vmcnt(14)
v_lshlrev_b32 v18, 16, v40
v_lshlrev_b32 v19, 16, v44
v_and_b32 v20, s43, v40
v_and_b32 v21, s43, v44
v_mul_f32 v18, v18, v19
v_mul_f32 v20, v20, v21
v_cvt_pk_bf16_f32 v18, v18, v20
v_lshlrev_b32 v19, 16, v18
v_and_b32 v20, s43, v18
v_add_f32 v16, v16, v19
v_add_f32 v17, v17, v20
v_lshlrev_b32 v18, 16, v41
v_lshlrev_b32 v19, 16, v45
v_and_b32 v20, s43, v41
v_and_b32 v21, s43, v45
v_mul_f32 v18, v18, v19
v_mul_f32 v20, v20, v21
v_cvt_pk_bf16_f32 v18, v18, v20
v_lshlrev_b32 v19, 16, v18
v_and_b32 v20, s43, v18
v_add_f32 v16, v16, v19
v_add_f32 v17, v17, v20
v_lshlrev_b32 v18, 16, v42
v_lshlrev_b32 v19, 16, v46
v_and_b32 v20, s43, v42
v_and_b32 v21, s43, v46
v_mul_f32 v18, v18, v19
v_mul_f32 v20, v20, v21
v_cvt_pk_bf16_f32 v18, v18, v20
v_lshlrev_b32 v19, 16, v18
v_and_b32 v20, s43, v18
v_add_f32 v16, v16, v19
v_add_f32 v17, v17, v20
v_lshlrev_b32 v18, 16, v43
v_lshlrev_b32 v19, 16, v47
v_and_b32 v20, s43, v43
v_and_b32 v21, s43, v47
v_mul_f32 v18, v18, v19
v_mul_f32 v20, v20, v21
v_cvt_pk_bf16_f32 v18, v18, v20
v_lshlrev_b32 v19, 16, v18
v_and_b32 v20, s43, v18
v_add_f32 v16, v16, v19
v_add_f32 v17, v17, v20
s_waitcnt vmcnt(12)
v_lshlrev_b32 v18, 16, v48
v_lshlrev_b32 v19, 16, v52
v_and_b32 v20, s43, v48
v_and_b32 v21, s43, v52
v_mul_f32 v18, v18, v19
v_mul_f32 v20, v20, v21
v_cvt_pk_bf16_f32 v18, v18, v20
v_lshlrev_b32 v19, 16, v18
v_and_b32 v20, s43, v18
v_add_f32 v16, v16, v19
v_add_f32 v17, v17, v20
v_lshlrev_b32 v18, 16, v49
v_lshlrev_b32 v19, 16, v53
v_and_b32 v20, s43, v49
v_and_b32 v21, s43, v53
v_mul_f32 v18, v18, v19
v_mul_f32 v20, v20, v21
v_cvt_pk_bf16_f32 v18, v18, v20
v_lshlrev_b32 v19, 16, v18
v_and_b32 v20, s43, v18
v_add_f32 v16, v16, v19
v_add_f32 v17, v17, v20
v_lshlrev_b32 v18, 16, v50
v_lshlrev_b32 v19, 16, v54
v_and_b32 v20, s43, v50
v_and_b32 v21, s43, v54
v_mul_f32 v18, v18, v19
v_mul_f32 v20, v20, v21
v_cvt_pk_bf16_f32 v18, v18, v20
v_lshlrev_b32 v19, 16, v18
v_and_b32 v20, s43, v18
v_add_f32 v16, v16, v19
v_add_f32 v17, v17, v20
v_lshlrev_b32 v18, 16, v51
v_lshlrev_b32 v19, 16, v55
v_and_b32 v20, s43, v51
v_and_b32 v21, s43, v55
v_mul_f32 v18, v18, v19
v_mul_f32 v20, v20, v21
v_cvt_pk_bf16_f32 v18, v18, v20
v_lshlrev_b32 v19, 16, v18
v_and_b32 v20, s43, v18
v_add_f32 v16, v16, v19
v_add_f32 v17, v17, v20
s_waitcnt vmcnt(10)
v_lshlrev_b32 v18, 16, v56
v_lshlrev_b32 v19, 16, v60
v_and_b32 v20, s43, v56
v_and_b32 v21, s43, v60
v_mul_f32 v18, v18, v19
v_mul_f32 v20, v20, v21
v_cvt_pk_bf16_f32 v18, v18, v20
v_lshlrev_b32 v19, 16, v18
v_and_b32 v20, s43, v18
v_add_f32 v16, v16, v19
v_add_f32 v17, v17, v20
v_lshlrev_b32 v18, 16, v57
v_lshlrev_b32 v19, 16, v61
v_and_b32 v20, s43, v57
v_and_b32 v21, s43, v61
v_mul_f32 v18, v18, v19
v_mul_f32 v20, v20, v21
v_cvt_pk_bf16_f32 v18, v18, v20
v_lshlrev_b32 v19, 16, v18
v_and_b32 v20, s43, v18
v_add_f32 v16, v16, v19
v_add_f32 v17, v17, v20
v_lshlrev_b32 v18, 16, v58
v_lshlrev_b32 v19, 16, v62
v_and_b32 v20, s43, v58
v_and_b32 v21, s43, v62
v_mul_f32 v18, v18, v19
v_mul_f32 v20, v20, v21
v_cvt_pk_bf16_f32 v18, v18, v20
v_lshlrev_b32 v19, 16, v18
v_and_b32 v20, s43, v18
v_add_f32 v16, v16, v19
v_add_f32 v17, v17, v20
v_lshlrev_b32 v18, 16, v59
v_lshlrev_b32 v19, 16, v63
v_and_b32 v20, s43, v59
v_and_b32 v21, s43, v63
v_mul_f32 v18, v18, v19
v_mul_f32 v20, v20, v21
v_cvt_pk_bf16_f32 v18, v18, v20
v_lshlrev_b32 v19, 16, v18
v_and_b32 v20, s43, v18
v_add_f32 v16, v16, v19
v_add_f32 v17, v17, v20
s_waitcnt vmcnt(8)
v_lshlrev_b32 v18, 16, v64
v_lshlrev_b32 v19, 16, v68
v_and_b32 v20, s43, v64
v_and_b32 v21, s43, v68
v_mul_f32 v18, v18, v19
v_mul_f32 v20, v20, v21
v_cvt_pk_bf16_f32 v18, v18, v20
v_lshlrev_b32 v19, 16, v18
v_and_b32 v20, s43, v18
v_add_f32 v16, v16, v19
v_add_f32 v17, v17, v20
v_lshlrev_b32 v18, 16, v65
v_lshlrev_b32 v19, 16, v69
v_and_b32 v20, s43, v65
v_and_b32 v21, s43, v69
v_mul_f32 v18, v18, v19
v_mul_f32 v20, v20, v21
v_cvt_pk_bf16_f32 v18, v18, v20
v_lshlrev_b32 v19, 16, v18
v_and_b32 v20, s43, v18
v_add_f32 v16, v16, v19
v_add_f32 v17, v17, v20
v_lshlrev_b32 v18, 16, v66
v_lshlrev_b32 v19, 16, v70
v_and_b32 v20, s43, v66
v_and_b32 v21, s43, v70
v_mul_f32 v18, v18, v19
v_mul_f32 v20, v20, v21
v_cvt_pk_bf16_f32 v18, v18, v20
v_lshlrev_b32 v19, 16, v18
v_and_b32 v20, s43, v18
v_add_f32 v16, v16, v19
v_add_f32 v17, v17, v20
v_lshlrev_b32 v18, 16, v67
v_lshlrev_b32 v19, 16, v71
v_and_b32 v20, s43, v67
v_and_b32 v21, s43, v71
v_mul_f32 v18, v18, v19
v_mul_f32 v20, v20, v21
v_cvt_pk_bf16_f32 v18, v18, v20
v_lshlrev_b32 v19, 16, v18
v_and_b32 v20, s43, v18
v_add_f32 v16, v16, v19
v_add_f32 v17, v17, v20
s_waitcnt vmcnt(6)
v_lshlrev_b32 v18, 16, v72
v_lshlrev_b32 v19, 16, v76
v_and_b32 v20, s43, v72
v_and_b32 v21, s43, v76
v_mul_f32 v18, v18, v19
v_mul_f32 v20, v20, v21
v_cvt_pk_bf16_f32 v18, v18, v20
v_lshlrev_b32 v19, 16, v18
v_and_b32 v20, s43, v18
v_add_f32 v16, v16, v19
v_add_f32 v17, v17, v20
v_lshlrev_b32 v18, 16, v73
v_lshlrev_b32 v19, 16, v77
v_and_b32 v20, s43, v73
v_and_b32 v21, s43, v77
v_mul_f32 v18, v18, v19
v_mul_f32 v20, v20, v21
v_cvt_pk_bf16_f32 v18, v18, v20
v_lshlrev_b32 v19, 16, v18
v_and_b32 v20, s43, v18
v_add_f32 v16, v16, v19
v_add_f32 v17, v17, v20
v_lshlrev_b32 v18, 16, v74
v_lshlrev_b32 v19, 16, v78
v_and_b32 v20, s43, v74
v_and_b32 v21, s43, v78
v_mul_f32 v18, v18, v19
v_mul_f32 v20, v20, v21
v_cvt_pk_bf16_f32 v18, v18, v20
v_lshlrev_b32 v19, 16, v18
v_and_b32 v20, s43, v18
v_add_f32 v16, v16, v19
v_add_f32 v17, v17, v20
v_lshlrev_b32 v18, 16, v75
v_lshlrev_b32 v19, 16, v79
v_and_b32 v20, s43, v75
v_and_b32 v21, s43, v79
v_mul_f32 v18, v18, v19
v_mul_f32 v20, v20, v21
v_cvt_pk_bf16_f32 v18, v18, v20
v_lshlrev_b32 v19, 16, v18
v_and_b32 v20, s43, v18
v_add_f32 v16, v16, v19
v_add_f32 v17, v17, v20
s_waitcnt vmcnt(4)
v_lshlrev_b32 v18, 16, v80
v_lshlrev_b32 v19, 16, v84
v_and_b32 v20, s43, v80
v_and_b32 v21, s43, v84
v_mul_f32 v18, v18, v19
v_mul_f32 v20, v20, v21
v_cvt_pk_bf16_f32 v18, v18, v20
v_lshlrev_b32 v19, 16, v18
v_and_b32 v20, s43, v18
v_add_f32 v16, v16, v19
v_add_f32 v17, v17, v20
v_lshlrev_b32 v18, 16, v81
v_lshlrev_b32 v19, 16, v85
v_and_b32 v20, s43, v81
v_and_b32 v21, s43, v85
v_mul_f32 v18, v18, v19
v_mul_f32 v20, v20, v21
v_cvt_pk_bf16_f32 v18, v18, v20
v_lshlrev_b32 v19, 16, v18
v_and_b32 v20, s43, v18
v_add_f32 v16, v16, v19
v_add_f32 v17, v17, v20
v_lshlrev_b32 v18, 16, v82
v_lshlrev_b32 v19, 16, v86
v_and_b32 v20, s43, v82
v_and_b32 v21, s43, v86
v_mul_f32 v18, v18, v19
v_mul_f32 v20, v20, v21
v_cvt_pk_bf16_f32 v18, v18, v20
v_lshlrev_b32 v19, 16, v18
v_and_b32 v20, s43, v18
v_add_f32 v16, v16, v19
v_add_f32 v17, v17, v20
v_lshlrev_b32 v18, 16, v83
v_lshlrev_b32 v19, 16, v87
v_and_b32 v20, s43, v83
v_and_b32 v21, s43, v87
v_mul_f32 v18, v18, v19
v_mul_f32 v20, v20, v21
v_cvt_pk_bf16_f32 v18, v18, v20
v_lshlrev_b32 v19, 16, v18
v_and_b32 v20, s43, v18
v_add_f32 v16, v16, v19
v_add_f32 v17, v17, v20
s_waitcnt vmcnt(2)
v_lshlrev_b32 v18, 16, v88
v_lshlrev_b32 v19, 16, v92
v_and_b32 v20, s43, v88
v_and_b32 v21, s43, v92
v_mul_f32 v18, v18, v19
v_mul_f32 v20, v20, v21
v_cvt_pk_bf16_f32 v18, v18, v20
v_lshlrev_b32 v19, 16, v18
v_and_b32 v20, s43, v18
v_add_f32 v16, v16, v19
v_add_f32 v17, v17, v20
v_lshlrev_b32 v18, 16, v89
v_lshlrev_b32 v19, 16, v93
v_and_b32 v20, s43, v89
v_and_b32 v21, s43, v93
v_mul_f32 v18, v18, v19
v_mul_f32 v20, v20, v21
v_cvt_pk_bf16_f32 v18, v18, v20
v_lshlrev_b32 v19, 16, v18
v_and_b32 v20, s43, v18
v_add_f32 v16, v16, v19
v_add_f32 v17, v17, v20
v_lshlrev_b32 v18, 16, v90
v_lshlrev_b32 v19, 16, v94
v_and_b32 v20, s43, v90
v_and_b32 v21, s43, v94
v_mul_f32 v18, v18, v19
v_mul_f32 v20, v20, v21
v_cvt_pk_bf16_f32 v18, v18, v20
v_lshlrev_b32 v19, 16, v18
v_and_b32 v20, s43, v18
v_add_f32 v16, v16, v19
v_add_f32 v17, v17, v20
v_lshlrev_b32 v18, 16, v91
v_lshlrev_b32 v19, 16, v95
v_and_b32 v20, s43, v91
v_and_b32 v21, s43, v95
v_mul_f32 v18, v18, v19
v_mul_f32 v20, v20, v21
v_cvt_pk_bf16_f32 v18, v18, v20
v_lshlrev_b32 v19, 16, v18
v_and_b32 v20, s43, v18
v_add_f32 v16, v16, v19
v_add_f32 v17, v17, v20
s_waitcnt vmcnt(0)
v_lshlrev_b32 v18, 16, v96
v_lshlrev_b32 v19, 16, v100
v_and_b32 v20, s43, v96
v_and_b32 v21, s43, v100
v_mul_f32 v18, v18, v19
v_mul_f32 v20, v20, v21
v_cvt_pk_bf16_f32 v18, v18, v20
v_lshlrev_b32 v19, 16, v18
v_and_b32 v20, s43, v18
v_add_f32 v16, v16, v19
v_add_f32 v17, v17, v20
v_lshlrev_b32 v18, 16, v97
v_lshlrev_b32 v19, 16, v101
v_and_b32 v20, s43, v97
v_and_b32 v21, s43, v101
v_mul_f32 v18, v18, v19
v_mul_f32 v20, v20, v21
v_cvt_pk_bf16_f32 v18, v18, v20
v_lshlrev_b32 v19, 16, v18
v_and_b32 v20, s43, v18
v_add_f32 v16, v16, v19
v_add_f32 v17, v17, v20
v_lshlrev_b32 v18, 16, v98
v_lshlrev_b32 v19, 16, v102
v_and_b32 v20, s43, v98
v_and_b32 v21, s43, v102
v_mul_f32 v18, v18, v19
v_mul_f32 v20, v20, v21
v_cvt_pk_bf16_f32 v18, v18, v20
v_lshlrev_b32 v19, 16, v18
v_and_b32 v20, s43, v18
v_add_f32 v16, v16, v19
v_add_f32 v17, v17, v20
v_lshlrev_b32 v18, 16, v99
v_lshlrev_b32 v19, 16, v103
v_and_b32 v20, s43, v99
v_and_b32 v21, s43, v103
v_mul_f32 v18, v18, v19
v_mul_f32 v20, v20, v21
v_cvt_pk_bf16_f32 v18, v18, v20
v_lshlrev_b32 v19, 16, v18
v_and_b32 v20, s43, v18
v_add_f32 v16, v16, v19
v_add_f32 v17, v17, v20
buffer_load_dwordx4 v[24:27], v12, s[8:11], s42 offen offset:640
buffer_load_dwordx4 v[28:31], v13, s[12:15], 0 offen offset:640
buffer_load_dwordx4 v[32:35], v12, s[8:11], s42 offen offset:704
buffer_load_dwordx4 v[36:39], v13, s[12:15], 0 offen offset:704
buffer_load_dwordx4 v[40:43], v12, s[8:11], s42 offen offset:768
buffer_load_dwordx4 v[44:47], v13, s[12:15], 0 offen offset:768
buffer_load_dwordx4 v[48:51], v12, s[8:11], s42 offen offset:832
buffer_load_dwordx4 v[52:55], v13, s[12:15], 0 offen offset:832
buffer_load_dwordx4 v[56:59], v12, s[8:11], s42 offen offset:896
buffer_load_dwordx4 v[60:63], v13, s[12:15], 0 offen offset:896
buffer_load_dwordx4 v[64:67], v12, s[8:11], s42 offen offset:960
buffer_load_dwordx4 v[68:71], v13, s[12:15], 0 offen offset:960
buffer_load_dwordx4 v[72:75], v12, s[8:11], s42 offen offset:1024
buffer_load_dwordx4 v[76:79], v13, s[12:15], 0 offen offset:1024
buffer_load_dwordx4 v[80:83], v12, s[8:11], s42 offen offset:1088
buffer_load_dwordx4 v[84:87], v13, s[12:15], 0 offen offset:1088
buffer_load_dwordx4 v[88:91], v12, s[8:11], s42 offen offset:1152
buffer_load_dwordx4 v[92:95], v13, s[12:15], 0 offen offset:1152
buffer_load_dwordx4 v[96:99], v12, s[8:11], s42 offen offset:1216
buffer_load_dwordx4 v[100:103], v13, s[12:15], 0 offen offset:1216
s_waitcnt vmcnt(18)
v_lshlrev_b32 v18, 16, v24
v_lshlrev_b32 v19, 16, v28
v_and_b32 v20, s43, v24
v_and_b32 v21, s43, v28
v_mul_f32 v18, v18, v19
v_mul_f32 v20, v20, v21
v_cvt_pk_bf16_f32 v18, v18, v20
v_lshlrev_b32 v19, 16, v18
v_and_b32 v20, s43, v18
v_add_f32 v16, v16, v19
v_add_f32 v17, v17, v20
v_lshlrev_b32 v18, 16, v25
v_lshlrev_b32 v19, 16, v29
v_and_b32 v20, s43, v25
v_and_b32 v21, s43, v29
v_mul_f32 v18, v18, v19
v_mul_f32 v20, v20, v21
v_cvt_pk_bf16_f32 v18, v18, v20
v_lshlrev_b32 v19, 16, v18
v_and_b32 v20, s43, v18
v_add_f32 v16, v16, v19
v_add_f32 v17, v17, v20
v_lshlrev_b32 v18, 16, v26
v_lshlrev_b32 v19, 16, v30
v_and_b32 v20, s43, v26
v_and_b32 v21, s43, v30
v_mul_f32 v18, v18, v19
v_mul_f32 v20, v20, v21
v_cvt_pk_bf16_f32 v18, v18, v20
v_lshlrev_b32 v19, 16, v18
v_and_b32 v20, s43, v18
v_add_f32 v16, v16, v19
v_add_f32 v17, v17, v20
v_lshlrev_b32 v18, 16, v27
v_lshlrev_b32 v19, 16, v31
v_and_b32 v20, s43, v27
v_and_b32 v21, s43, v31
v_mul_f32 v18, v18, v19
v_mul_f32 v20, v20, v21
v_cvt_pk_bf16_f32 v18, v18, v20
v_lshlrev_b32 v19, 16, v18
v_and_b32 v20, s43, v18
v_add_f32 v16, v16, v19
v_add_f32 v17, v17, v20
s_waitcnt vmcnt(16)
v_lshlrev_b32 v18, 16, v32
v_lshlrev_b32 v19, 16, v36
v_and_b32 v20, s43, v32
v_and_b32 v21, s43, v36
v_mul_f32 v18, v18, v19
v_mul_f32 v20, v20, v21
v_cvt_pk_bf16_f32 v18, v18, v20
v_lshlrev_b32 v19, 16, v18
v_and_b32 v20, s43, v18
v_add_f32 v16, v16, v19
v_add_f32 v17, v17, v20
v_lshlrev_b32 v18, 16, v33
v_lshlrev_b32 v19, 16, v37
v_and_b32 v20, s43, v33
v_and_b32 v21, s43, v37
v_mul_f32 v18, v18, v19
v_mul_f32 v20, v20, v21
v_cvt_pk_bf16_f32 v18, v18, v20
v_lshlrev_b32 v19, 16, v18
v_and_b32 v20, s43, v18
v_add_f32 v16, v16, v19
v_add_f32 v17, v17, v20
v_lshlrev_b32 v18, 16, v34
v_lshlrev_b32 v19, 16, v38
v_and_b32 v20, s43, v34
v_and_b32 v21, s43, v38
v_mul_f32 v18, v18, v19
v_mul_f32 v20, v20, v21
v_cvt_pk_bf16_f32 v18, v18, v20
v_lshlrev_b32 v19, 16, v18
v_and_b32 v20, s43, v18
v_add_f32 v16, v16, v19
v_add_f32 v17, v17, v20
v_lshlrev_b32 v18, 16, v35
v_lshlrev_b32 v19, 16, v39
v_and_b32 v20, s43, v35
v_and_b32 v21, s43, v39
v_mul_f32 v18, v18, v19
v_mul_f32 v20, v20, v21
v_cvt_pk_bf16_f32 v18, v18, v20
v_lshlrev_b32 v19, 16, v18
v_and_b32 v20, s43, v18
v_add_f32 v16, v16, v19
v_add_f32 v17, v17, v20
s_waitcnt vmcnt(14)
v_lshlrev_b32 v18, 16, v40
v_lshlrev_b32 v19, 16, v44
v_and_b32 v20, s43, v40
v_and_b32 v21, s43, v44
v_mul_f32 v18, v18, v19
v_mul_f32 v20, v20, v21
v_cvt_pk_bf16_f32 v18, v18, v20
v_lshlrev_b32 v19, 16, v18
v_and_b32 v20, s43, v18
v_add_f32 v16, v16, v19
v_add_f32 v17, v17, v20
v_lshlrev_b32 v18, 16, v41
v_lshlrev_b32 v19, 16, v45
v_and_b32 v20, s43, v41
v_and_b32 v21, s43, v45
v_mul_f32 v18, v18, v19
v_mul_f32 v20, v20, v21
v_cvt_pk_bf16_f32 v18, v18, v20
v_lshlrev_b32 v19, 16, v18
v_and_b32 v20, s43, v18
v_add_f32 v16, v16, v19
v_add_f32 v17, v17, v20
v_lshlrev_b32 v18, 16, v42
v_lshlrev_b32 v19, 16, v46
v_and_b32 v20, s43, v42
v_and_b32 v21, s43, v46
v_mul_f32 v18, v18, v19
v_mul_f32 v20, v20, v21
v_cvt_pk_bf16_f32 v18, v18, v20
v_lshlrev_b32 v19, 16, v18
v_and_b32 v20, s43, v18
v_add_f32 v16, v16, v19
v_add_f32 v17, v17, v20
v_lshlrev_b32 v18, 16, v43
v_lshlrev_b32 v19, 16, v47
v_and_b32 v20, s43, v43
v_and_b32 v21, s43, v47
v_mul_f32 v18, v18, v19
v_mul_f32 v20, v20, v21
v_cvt_pk_bf16_f32 v18, v18, v20
v_lshlrev_b32 v19, 16, v18
v_and_b32 v20, s43, v18
v_add_f32 v16, v16, v19
v_add_f32 v17, v17, v20
s_waitcnt vmcnt(12)
v_lshlrev_b32 v18, 16, v48
v_lshlrev_b32 v19, 16, v52
v_and_b32 v20, s43, v48
v_and_b32 v21, s43, v52
v_mul_f32 v18, v18, v19
v_mul_f32 v20, v20, v21
v_cvt_pk_bf16_f32 v18, v18, v20
v_lshlrev_b32 v19, 16, v18
v_and_b32 v20, s43, v18
v_add_f32 v16, v16, v19
v_add_f32 v17, v17, v20
v_lshlrev_b32 v18, 16, v49
v_lshlrev_b32 v19, 16, v53
v_and_b32 v20, s43, v49
v_and_b32 v21, s43, v53
v_mul_f32 v18, v18, v19
v_mul_f32 v20, v20, v21
v_cvt_pk_bf16_f32 v18, v18, v20
v_lshlrev_b32 v19, 16, v18
v_and_b32 v20, s43, v18
v_add_f32 v16, v16, v19
v_add_f32 v17, v17, v20
v_lshlrev_b32 v18, 16, v50
v_lshlrev_b32 v19, 16, v54
v_and_b32 v20, s43, v50
v_and_b32 v21, s43, v54
v_mul_f32 v18, v18, v19
v_mul_f32 v20, v20, v21
v_cvt_pk_bf16_f32 v18, v18, v20
v_lshlrev_b32 v19, 16, v18
v_and_b32 v20, s43, v18
v_add_f32 v16, v16, v19
v_add_f32 v17, v17, v20
v_lshlrev_b32 v18, 16, v51
v_lshlrev_b32 v19, 16, v55
v_and_b32 v20, s43, v51
v_and_b32 v21, s43, v55
v_mul_f32 v18, v18, v19
v_mul_f32 v20, v20, v21
v_cvt_pk_bf16_f32 v18, v18, v20
v_lshlrev_b32 v19, 16, v18
v_and_b32 v20, s43, v18
v_add_f32 v16, v16, v19
v_add_f32 v17, v17, v20
s_waitcnt vmcnt(10)
v_lshlrev_b32 v18, 16, v56
v_lshlrev_b32 v19, 16, v60
v_and_b32 v20, s43, v56
v_and_b32 v21, s43, v60
v_mul_f32 v18, v18, v19
v_mul_f32 v20, v20, v21
v_cvt_pk_bf16_f32 v18, v18, v20
v_lshlrev_b32 v19, 16, v18
v_and_b32 v20, s43, v18
v_add_f32 v16, v16, v19
v_add_f32 v17, v17, v20
v_lshlrev_b32 v18, 16, v57
v_lshlrev_b32 v19, 16, v61
v_and_b32 v20, s43, v57
v_and_b32 v21, s43, v61
v_mul_f32 v18, v18, v19
v_mul_f32 v20, v20, v21
v_cvt_pk_bf16_f32 v18, v18, v20
v_lshlrev_b32 v19, 16, v18
v_and_b32 v20, s43, v18
v_add_f32 v16, v16, v19
v_add_f32 v17, v17, v20
v_lshlrev_b32 v18, 16, v58
v_lshlrev_b32 v19, 16, v62
v_and_b32 v20, s43, v58
v_and_b32 v21, s43, v62
v_mul_f32 v18, v18, v19
v_mul_f32 v20, v20, v21
v_cvt_pk_bf16_f32 v18, v18, v20
v_lshlrev_b32 v19, 16, v18
v_and_b32 v20, s43, v18
v_add_f32 v16, v16, v19
v_add_f32 v17, v17, v20
v_lshlrev_b32 v18, 16, v59
v_lshlrev_b32 v19, 16, v63
v_and_b32 v20, s43, v59
v_and_b32 v21, s43, v63
v_mul_f32 v18, v18, v19
v_mul_f32 v20, v20, v21
v_cvt_pk_bf16_f32 v18, v18, v20
v_lshlrev_b32 v19, 16, v18
v_and_b32 v20, s43, v18
v_add_f32 v16, v16, v19
v_add_f32 v17, v17, v20
s_waitcnt vmcnt(8)
v_lshlrev_b32 v18, 16, v64
v_lshlrev_b32 v19, 16, v68
v_and_b32 v20, s43, v64
v_and_b32 v21, s43, v68
v_mul_f32 v18, v18, v19
v_mul_f32 v20, v20, v21
v_cvt_pk_bf16_f32 v18, v18, v20
v_lshlrev_b32 v19, 16, v18
v_and_b32 v20, s43, v18
v_add_f32 v16, v16, v19
v_add_f32 v17, v17, v20
v_lshlrev_b32 v18, 16, v65
v_lshlrev_b32 v19, 16, v69
v_and_b32 v20, s43, v65
v_and_b32 v21, s43, v69
v_mul_f32 v18, v18, v19
v_mul_f32 v20, v20, v21
v_cvt_pk_bf16_f32 v18, v18, v20
v_lshlrev_b32 v19, 16, v18
v_and_b32 v20, s43, v18
v_add_f32 v16, v16, v19
v_add_f32 v17, v17, v20
v_lshlrev_b32 v18, 16, v66
v_lshlrev_b32 v19, 16, v70
v_and_b32 v20, s43, v66
v_and_b32 v21, s43, v70
v_mul_f32 v18, v18, v19
v_mul_f32 v20, v20, v21
v_cvt_pk_bf16_f32 v18, v18, v20
v_lshlrev_b32 v19, 16, v18
v_and_b32 v20, s43, v18
v_add_f32 v16, v16, v19
v_add_f32 v17, v17, v20
v_lshlrev_b32 v18, 16, v67
v_lshlrev_b32 v19, 16, v71
v_and_b32 v20, s43, v67
v_and_b32 v21, s43, v71
v_mul_f32 v18, v18, v19
v_mul_f32 v20, v20, v21
v_cvt_pk_bf16_f32 v18, v18, v20
v_lshlrev_b32 v19, 16, v18
v_and_b32 v20, s43, v18
v_add_f32 v16, v16, v19
v_add_f32 v17, v17, v20
s_waitcnt vmcnt(6)
v_lshlrev_b32 v18, 16, v72
v_lshlrev_b32 v19, 16, v76
v_and_b32 v20, s43, v72
v_and_b32 v21, s43, v76
v_mul_f32 v18, v18, v19
v_mul_f32 v20, v20, v21
v_cvt_pk_bf16_f32 v18, v18, v20
v_lshlrev_b32 v19, 16, v18
v_and_b32 v20, s43, v18
v_add_f32 v16, v16, v19
v_add_f32 v17, v17, v20
v_lshlrev_b32 v18, 16, v73
v_lshlrev_b32 v19, 16, v77
v_and_b32 v20, s43, v73
v_and_b32 v21, s43, v77
v_mul_f32 v18, v18, v19
v_mul_f32 v20, v20, v21
v_cvt_pk_bf16_f32 v18, v18, v20
v_lshlrev_b32 v19, 16, v18
v_and_b32 v20, s43, v18
v_add_f32 v16, v16, v19
v_add_f32 v17, v17, v20
v_lshlrev_b32 v18, 16, v74
v_lshlrev_b32 v19, 16, v78
v_and_b32 v20, s43, v74
v_and_b32 v21, s43, v78
v_mul_f32 v18, v18, v19
v_mul_f32 v20, v20, v21
v_cvt_pk_bf16_f32 v18, v18, v20
v_lshlrev_b32 v19, 16, v18
v_and_b32 v20, s43, v18
v_add_f32 v16, v16, v19
v_add_f32 v17, v17, v20
v_lshlrev_b32 v18, 16, v75
v_lshlrev_b32 v19, 16, v79
v_and_b32 v20, s43, v75
v_and_b32 v21, s43, v79
v_mul_f32 v18, v18, v19
v_mul_f32 v20, v20, v21
v_cvt_pk_bf16_f32 v18, v18, v20
v_lshlrev_b32 v19, 16, v18
v_and_b32 v20, s43, v18
v_add_f32 v16, v16, v19
v_add_f32 v17, v17, v20
s_waitcnt vmcnt(4)
v_lshlrev_b32 v18, 16, v80
v_lshlrev_b32 v19, 16, v84
v_and_b32 v20, s43, v80
v_and_b32 v21, s43, v84
v_mul_f32 v18, v18, v19
v_mul_f32 v20, v20, v21
v_cvt_pk_bf16_f32 v18, v18, v20
v_lshlrev_b32 v19, 16, v18
v_and_b32 v20, s43, v18
v_add_f32 v16, v16, v19
v_add_f32 v17, v17, v20
v_lshlrev_b32 v18, 16, v81
v_lshlrev_b32 v19, 16, v85
v_and_b32 v20, s43, v81
v_and_b32 v21, s43, v85
v_mul_f32 v18, v18, v19
v_mul_f32 v20, v20, v21
v_cvt_pk_bf16_f32 v18, v18, v20
v_lshlrev_b32 v19, 16, v18
v_and_b32 v20, s43, v18
v_add_f32 v16, v16, v19
v_add_f32 v17, v17, v20
v_lshlrev_b32 v18, 16, v82
v_lshlrev_b32 v19, 16, v86
v_and_b32 v20, s43, v82
v_and_b32 v21, s43, v86
v_mul_f32 v18, v18, v19
v_mul_f32 v20, v20, v21
v_cvt_pk_bf16_f32 v18, v18, v20
v_lshlrev_b32 v19, 16, v18
v_and_b32 v20, s43, v18
v_add_f32 v16, v16, v19
v_add_f32 v17, v17, v20
v_lshlrev_b32 v18, 16, v83
v_lshlrev_b32 v19, 16, v87
v_and_b32 v20, s43, v83
v_and_b32 v21, s43, v87
v_mul_f32 v18, v18, v19
v_mul_f32 v20, v20, v21
v_cvt_pk_bf16_f32 v18, v18, v20
v_lshlrev_b32 v19, 16, v18
v_and_b32 v20, s43, v18
v_add_f32 v16, v16, v19
v_add_f32 v17, v17, v20
s_waitcnt vmcnt(2)
v_lshlrev_b32 v18, 16, v88
v_lshlrev_b32 v19, 16, v92
v_and_b32 v20, s43, v88
v_and_b32 v21, s43, v92
v_mul_f32 v18, v18, v19
v_mul_f32 v20, v20, v21
v_cvt_pk_bf16_f32 v18, v18, v20
v_lshlrev_b32 v19, 16, v18
v_and_b32 v20, s43, v18
v_add_f32 v16, v16, v19
v_add_f32 v17, v17, v20
v_lshlrev_b32 v18, 16, v89
v_lshlrev_b32 v19, 16, v93
v_and_b32 v20, s43, v89
v_and_b32 v21, s43, v93
v_mul_f32 v18, v18, v19
v_mul_f32 v20, v20, v21
v_cvt_pk_bf16_f32 v18, v18, v20
v_lshlrev_b32 v19, 16, v18
v_and_b32 v20, s43, v18
v_add_f32 v16, v16, v19
v_add_f32 v17, v17, v20
v_lshlrev_b32 v18, 16, v90
v_lshlrev_b32 v19, 16, v94
v_and_b32 v20, s43, v90
v_and_b32 v21, s43, v94
v_mul_f32 v18, v18, v19
v_mul_f32 v20, v20, v21
v_cvt_pk_bf16_f32 v18, v18, v20
v_lshlrev_b32 v19, 16, v18
v_and_b32 v20, s43, v18
v_add_f32 v16, v16, v19
v_add_f32 v17, v17, v20
v_lshlrev_b32 v18, 16, v91
v_lshlrev_b32 v19, 16, v95
v_and_b32 v20, s43, v91
v_and_b32 v21, s43, v95
v_mul_f32 v18, v18, v19
v_mul_f32 v20, v20, v21
v_cvt_pk_bf16_f32 v18, v18, v20
v_lshlrev_b32 v19, 16, v18
v_and_b32 v20, s43, v18
v_add_f32 v16, v16, v19
v_add_f32 v17, v17, v20
s_waitcnt vmcnt(0)
v_lshlrev_b32 v18, 16, v96
v_lshlrev_b32 v19, 16, v100
v_and_b32 v20, s43, v96
v_and_b32 v21, s43, v100
v_mul_f32 v18, v18, v19
v_mul_f32 v20, v20, v21
v_cvt_pk_bf16_f32 v18, v18, v20
v_lshlrev_b32 v19, 16, v18
v_and_b32 v20, s43, v18
v_add_f32 v16, v16, v19
v_add_f32 v17, v17, v20
v_lshlrev_b32 v18, 16, v97
v_lshlrev_b32 v19, 16, v101
v_and_b32 v20, s43, v97
v_and_b32 v21, s43, v101
v_mul_f32 v18, v18, v19
v_mul_f32 v20, v20, v21
v_cvt_pk_bf16_f32 v18, v18, v20
v_lshlrev_b32 v19, 16, v18
v_and_b32 v20, s43, v18
v_add_f32 v16, v16, v19
v_add_f32 v17, v17, v20
v_lshlrev_b32 v18, 16, v98
v_lshlrev_b32 v19, 16, v102
v_and_b32 v20, s43, v98
v_and_b32 v21, s43, v102
v_mul_f32 v18, v18, v19
v_mul_f32 v20, v20, v21
v_cvt_pk_bf16_f32 v18, v18, v20
v_lshlrev_b32 v19, 16, v18
v_and_b32 v20, s43, v18
v_add_f32 v16, v16, v19
v_add_f32 v17, v17, v20
v_lshlrev_b32 v18, 16, v99
v_lshlrev_b32 v19, 16, v103
v_and_b32 v20, s43, v99
v_and_b32 v21, s43, v103
v_mul_f32 v18, v18, v19
v_mul_f32 v20, v20, v21
v_cvt_pk_bf16_f32 v18, v18, v20
v_lshlrev_b32 v19, 16, v18
v_and_b32 v20, s43, v18
v_add_f32 v16, v16, v19
v_add_f32 v17, v17, v20
v_add_f32 v16, v16, v17
s_nop 1
v_add_f32_dpp v16, v16, v16 quad_perm:[1,0,3,2] row_mask:0xf bank_mask:0xf
s_nop 1
v_add_f32_dpp v16, v16, v16 quad_perm:[2,3,0,1] row_mask:0xf bank_mask:0xf
v_cvt_pk_bf16_f32 v16, v16, v16
v_lshlrev_b32 v16, 16, v16
v_mul_f32 v16, 0xbfb8aa3b, v16
v_exp_f32 v16, v16
s_nop 0
v_add_f32 v16, 1.0, v16
v_rcp_f32 v16, v16
s_nop 0
v_cvt_pk_bf16_f32 v16, v16, v16
v_lshlrev_b32 v16, 16, v16
v_sub_f32 v17, 1.0, v16
v_cvt_pk_bf16_f32 v17, v17, v17
v_lshlrev_b32 v17, 16, v17
s_lshl_b32 s41, s41, 7
s_add_u32 s41, s41, 233308160
v_lshrrev_b32 v12, 2, v0
v_lshlrev_b32 v12, 3, v12
buffer_store_dwordx2 v[16:17], v12, s[4:7], s41 offen sc1
s_add_u32 s30, s30, 96
s_cmp_lt_u32 s30, 128
s_cbranch_scc1 B1_g
s_and_b32 s32, s25, 3
s_lshl_b32 s32, s32, 4
s_mov_b32 s33, 1
s_lshl_b32 s34, s25, 7
s_add_u32 s34, s34, 4228096
s_and_b32 s41, s26, 1
s_lshl_b32 s41, s41, 4
s_lshl_b32 s42, s24, 2
s_add_u32 s41, s41, s42
s_mov_b32 s55, 196608
s_mov_b32 s56, 3072
s_mov_b32 s45, 221249536
s_mov_b32 s54, 1.0
s_cmp_ge_u32 s26, 2
s_cbranch_scc1 B1_a
s_mov_b32 s55, 98304
s_mov_b32 s56, 1536
s_mov_b32 s45, 227540992
s_mov_b32 s54, 0x3ea52b5c
B1_a:
s_mul_i32 s41, s41, s55
s_add_u32 s45, s45, s41
s_cmp_ge_u32 s26, 4
s_cbranch_scc1 B1_v
s_mul_i32 s29, s24, 20480
v_add_u32 v108, s29, v1
v_add_u32 v12, 0, v0
v_mul_u32_u24 v13, 10923, v12
v_lshrrev_b32 v13, 20, v13
v_mul_u32_u24 v15, 96, v13
v_sub_u32 v14, v12, v15
v_mul_lo_u32 v13, v13, s55
v_lshl_add_u32 v102, v14, 4, v13
v_add_u32 v12, 64, v0
v_mul_u32_u24 v13, 10923, v12
v_lshrrev_b32 v13, 20, v13
v_mul_u32_u24 v15, 96, v13
v_sub_u32 v14, v12, v15
v_mul_lo_u32 v13, v13, s55
v_lshl_add_u32 v103, v14, 4, v13
v_add_u32 v12, 128, v0
v_mul_u32_u24 v13, 10923, v12
v_lshrrev_b32 v13, 20, v13
v_mul_u32_u24 v15, 96, v13
v_sub_u32 v14, v12, v15
v_mul_lo_u32 v13, v13, s55
v_lshl_add_u32 v104, v14, 4, v13
v_add_u32 v12, 192, v0
v_mul_u32_u24 v13, 10923, v12
v_lshrrev_b32 v13, 20, v13
v_mul_u32_u24 v15, 96, v13
v_sub_u32 v14, v12, v15
v_mul_lo_u32 v13, v13, s55
v_lshl_add_u32 v105, v14, 4, v13
v_add_u32 v12, 256, v0
v_mul_u32_u24 v13, 10923, v12
v_lshrrev_b32 v13, 20, v13
v_mul_u32_u24 v15, 96, v13
v_sub_u32 v14, v12, v15
v_mul_lo_u32 v13, v13, s55
v_lshl_add_u32 v106, v14, 4, v13
v_add_u32 v12, 320, v0
v_mul_u32_u24 v13, 10923, v12
v_lshrrev_b32 v13, 20, v13
v_mul_u32_u24 v15, 96, v13
v_sub_u32 v14, v12, v15
v_mul_lo_u32 v13, v13, s55
v_lshl_add_u32 v107, v14, 4, v13
v_mov_b32 v88, 0
v_mov_b32 v89, 0
v_mov_b32 v90, 0
v_mov_b32 v91, 0
ds_write_b128 v108, v[88:91] offset:0
ds_write_b128 v108, v[88:91] offset:1024
ds_write_b128 v108, v[88:91] offset:2048
ds_write_b128 v108, v[88:91] offset:3072
ds_write_b128 v108, v[88:91] offset:4096
ds_write_b128 v108, v[88:91] offset:5120
s_waitcnt lgkmcnt(0)
v_add_u32 v12, 0, v3
v_mul_u32_u24 v13, 209716, v12
v_lshrrev_b32 v13, 20, v13
v_mul_u32_u24 v15, 5, v13
v_sub_u32 v14, v12, v15
v_mul_u32_u24 v13, 1536, v13
v_lshrrev_b32 v15, 1, v14
v_lshlrev_b32 v15, 9, v15
v_and_b32 v14, 1, v14
v_lshl_add_u32 v14, v14, 3, v15
v_lshl_add_u32 v14, v2, 4, v14
v_add3_u32 v96, v13, v14, s29
v_add_u32 v12, 4, v3
v_mul_u32_u24 v13, 209716, v12
v_lshrrev_b32 v13, 20, v13
v_mul_u32_u24 v15, 5, v13
v_sub_u32 v14, v12, v15
v_mul_u32_u24 v13, 1536, v13
v_lshrrev_b32 v15, 1, v14
v_lshlrev_b32 v15, 9, v15
v_and_b32 v14, 1, v14
v_lshl_add_u32 v14, v14, 3, v15
v_lshl_add_u32 v14, v2, 4, v14
v_add3_u32 v97, v13, v14, s29
v_add_u32 v12, 8, v3
v_mul_u32_u24 v13, 209716, v12
v_lshrrev_b32 v13, 20, v13
v_mul_u32_u24 v15, 5, v13
v_sub_u32 v14, v12, v15
v_mul_u32_u24 v13, 1536, v13
v_lshrrev_b32 v15, 1, v14
v_lshlrev_b32 v15, 9, v15
v_and_b32 v14, 1, v14
v_lshl_add_u32 v14, v14, 3, v15
v_lshl_add_u32 v14, v2, 4, v14
v_add3_u32 v98, v13, v14, s29
v_add_u32 v12, 12, v3
v_mul_u32_u24 v13, 209716, v12
v_lshrrev_b32 v13, 20, v13
v_mul_u32_u24 v15, 5, v13
v_sub_u32 v14, v12, v15
v_mul_u32_u24 v13, 1536, v13
v_lshrrev_b32 v15, 1, v14
v_lshlrev_b32 v15, 9, v15
v_and_b32 v14, 1, v14
v_lshl_add_u32 v14, v14, 3, v15
v_lshl_add_u32 v14, v2, 4, v14
v_add3_u32 v99, v13, v14, s29
v_add_u32 v12, 16, v3
v_mul_u32_u24 v13, 209716, v12
v_lshrrev_b32 v13, 20, v13
v_mul_u32_u24 v15, 5, v13
v_sub_u32 v14, v12, v15
v_mul_u32_u24 v13, 1536, v13
v_lshrrev_b32 v15, 1, v14
v_lshlrev_b32 v15, 9, v15
v_and_b32 v14, 1, v14
v_lshl_add_u32 v14, v14, 3, v15
v_lshl_add_u32 v14, v2, 4, v14
v_add3_u32 v100, v13, v14, s29
v_lshrrev_b32 v8, 3, v0
s_lshl_b32 s35, s24, 3
v_add_u32 v7, s35, v8
v_mul_u32_u24 v7, 1280, v7
v_and_b32 v9, 7, v0
v_xor_b32 v9, v9, v8
v_lshl_add_u32 v7, v9, 4, v7
v_and_b32 v8, 7, v2
v_xor_b32 v9, v3, v8
v_lshlrev_b32 v9, 4, v9
v_lshl_add_u32 v9, v8, 7, v9
v_lshrrev_b32 v8, 3, v2
v_mul_u32_u24 v8, 5120, v8
v_add_u32 v10, v8, v9
v_xor_b32 v11, 64, v10
s_mov_b32 s36, 0
s_mov_b32 s37, 0
s_mov_b32 s39, s32
s_mov_b32 s40, 0
s_mov_b32 s44, 98304
s_mov_b32 s48, s4
s_mov_b32 s49, s5
s_mov_b32 s50, 0
s_mov_b32 s51, 0x20000
s_min_u32 s41, s36, 31
s_lshr_b32 s41, s41, 1
s_mul_i32 s41, s41, s33
s_add_u32 s41, s41, s32
s_mul_i32 s41, s41, 40960
s_and_b32 s42, s36, 1
s_mul_i32 s42, s42, 640
s_add_u32 s41, s41, s42
s_mul_i32 s42, s37, 20480
s_mul_i32 s43, s24, 5120
s_add_u32 s42, s42, s43
s_add_u32 s42, s42, 98304
s_add_u32 s36, s36, 1
s_add_u32 s37, s37, 1
s_cmp_eq_u32 s37, 3
s_cselect_b32 s37, 0, s37
s_mov_b32 m0, s42
s_add_u32 s42, s42, 1024
buffer_load_dwordx4 v7, s[8:11], s41 offen lds
s_add_u32 s41, s41, 128
s_mov_b32 m0, s42
s_add_u32 s42, s42, 1024
buffer_load_dwordx4 v7, s[8:11], s41 offen lds
s_add_u32 s41, s41, 128
s_mov_b32 m0, s42
s_add_u32 s42, s42, 1024
buffer_load_dwordx4 v7, s[8:11], s41 offen lds
s_add_u32 s41, s41, 128
s_mov_b32 m0, s42
s_add_u32 s42, s42, 1024
buffer_load_dwordx4 v7, s[8:11], s41 offen lds
s_add_u32 s41, s41, 128
s_mov_b32 m0, s42
s_add_u32 s42, s42, 1024
buffer_load_dwordx4 v7, s[8:11], s41 offen lds
s_add_u32 s41, s41, 128
s_min_u32 s41, s36, 31
s_lshr_b32 s41, s41, 1
s_mul_i32 s41, s41, s33
s_add_u32 s41, s41, s32
s_mul_i32 s41, s41, 40960
s_and_b32 s42, s36, 1
s_mul_i32 s42, s42, 640
s_add_u32 s41, s41, s42
s_mul_i32 s42, s37, 20480
s_mul_i32 s43, s24, 5120
s_add_u32 s42, s42, s43
s_add_u32 s42, s42, 98304
s_add_u32 s36, s36, 1
s_add_u32 s37, s37, 1
s_cmp_eq_u32 s37, 3
s_cselect_b32 s37, 0, s37
s_mov_b32 m0, s42
s_add_u32 s42, s42, 1024
buffer_load_dwordx4 v7, s[8:11], s41 offen lds
s_add_u32 s41, s41, 128
s_mov_b32 m0, s42
s_add_u32 s42, s42, 1024
buffer_load_dwordx4 v7, s[8:11], s41 offen lds
s_add_u32 s41, s41, 128
s_mov_b32 m0, s42
s_add_u32 s42, s42, 1024
buffer_load_dwordx4 v7, s[8:11], s41 offen lds
s_add_u32 s41, s41, 128
s_mov_b32 m0, s42
s_add_u32 s42, s42, 1024
buffer_load_dwordx4 v7, s[8:11], s41 offen lds
s_add_u32 s41, s41, 128
v_lshrrev_b32 v8, 3, v0
s_lshl_b32 s35, s24, 3
v_add_u32 v7, s35, v8
v_mul_u32_u24 v7, 1280, v7
v_and_b32 v9, 7, v0
v_xor_b32 v9, v9, v8
v_lshl_add_u32 v7, v9, 4, v7
v_and_b32 v8, 7, v2
v_xor_b32 v9, v3, v8
v_lshlrev_b32 v9, 4, v9
v_lshl_add_u32 v9, v8, 7, v9
v_lshrrev_b32 v8, 3, v2
v_mul_u32_u24 v8, 5120, v8
v_add_u32 v10, v8, v9
v_xor_b32 v11, 64, v10
s_waitcnt vmcnt(0)
s_barrier
v_add_u32 v4, s44, v10
v_add_u32 v12, s44, v11
ds_read_b128 v[56:59], v4 offset:0
ds_read_b128 v[60:63], v4 offset:10240
ds_read_b128 v[64:67], v12 offset:0
ds_read_b128 v[68:71], v12 offset:10240
B1qloop:
s_waitcnt lgkmcnt(2)
v_mfma_f32_16x16x32_bf16 v[16:19], a[0:3], v[56:59], 0
s_mov_b32 m0, s42
s_add_u32 s42, s42, 1024
v_mfma_f32_16x16x32_bf16 v[20:23], a[0:3], v[60:63], 0
buffer_load_dwordx4 v7, s[8:11], s41 offen lds
s_add_u32 s41, s41, 128
v_mfma_f32_16x16x32_bf16 v[24:27], a[4:7], v[56:59], 0
v_mfma_f32_16x16x32_bf16 v[28:31], a[4:7], v[60:63], 0
s_mul_i32 s52, s47, s56
s_add_u32 s52, s52, s45
ds_read_b128 v[88:91], v108 offset:0
ds_read_b128 v[92:95], v108 offset:1024
v_mfma_f32_16x16x32_bf16 v[32:35], a[8:11], v[56:59], 0
v_mfma_f32_16x16x32_bf16 v[36:39], a[8:11], v[60:63], 0
v_mfma_f32_16x16x32_bf16 v[40:43], a[12:15], v[56:59], 0
ds_read_b128 v[72:75], v4 offset:1024
v_mfma_f32_16x16x32_bf16 v[44:47], a[12:15], v[60:63], 0
ds_read_b128 v[76:79], v4 offset:11264
v_mfma_f32_16x16x32_bf16 v[48:51], a[16:19], v[56:59], 0
v_mfma_f32_16x16x32_bf16 v[52:55], a[16:19], v[60:63], 0
s_waitcnt lgkmcnt(4)
v_mfma_f32_16x16x32_bf16 v[16:19], a[20:23], v[64:67], v[16:19]
v_mfma_f32_16x16x32_bf16 v[20:23], a[20:23], v[68:71], v[20:23]
v_mfma_f32_16x16x32_bf16 v[24:27], a[24:27], v[64:67], v[24:27]
v_mfma_f32_16x16x32_bf16 v[28:31], a[24:27], v[68:71], v[28:31]
s_waitcnt lgkmcnt(3)
buffer_store_dwordx4 v[88:91], v102, s[48:51], s52 offen sc1
s_nop 0
ds_read_b128 v[88:91], v108 offset:2048
v_mfma_f32_16x16x32_bf16 v[32:35], a[28:31], v[64:67], v[32:35]
v_mfma_f32_16x16x32_bf16 v[36:39], a[28:31], v[68:71], v[36:39]
v_mfma_f32_16x16x32_bf16 v[40:43], a[32:35], v[64:67], v[40:43]
ds_read_b128 v[80:83], v12 offset:1024
v_mfma_f32_16x16x32_bf16 v[44:47], a[32:35], v[68:71], v[44:47]
ds_read_b128 v[84:87], v12 offset:11264
v_mfma_f32_16x16x32_bf16 v[48:51], a[36:39], v[64:67], v[48:51]
v_mfma_f32_16x16x32_bf16 v[52:55], a[36:39], v[68:71], v[52:55]
s_waitcnt lgkmcnt(3)
v_mfma_f32_16x16x32_bf16 v[16:19], a[40:43], v[72:75], v[16:19]
v_mfma_f32_16x16x32_bf16 v[20:23], a[40:43], v[76:79], v[20:23]
v_mfma_f32_16x16x32_bf16 v[24:27], a[44:47], v[72:75], v[24:27]
v_mfma_f32_16x16x32_bf16 v[28:31], a[44:47], v[76:79], v[28:31]
buffer_store_dwordx4 v[92:95], v103, s[48:51], s52 offen sc1
s_nop 0
ds_read_b128 v[92:95], v108 offset:3072
v_mfma_f32_16x16x32_bf16 v[32:35], a[48:51], v[72:75], v[32:35]
v_mfma_f32_16x16x32_bf16 v[36:39], a[48:51], v[76:79], v[36:39]
v_mfma_f32_16x16x32_bf16 v[40:43], a[52:55], v[72:75], v[40:43]
ds_read_b128 v[56:59], v4 offset:2048
v_mfma_f32_16x16x32_bf16 v[44:47], a[52:55], v[76:79], v[44:47]
ds_read_b128 v[60:63], v4 offset:12288
v_mfma_f32_16x16x32_bf16 v[48:51], a[56:59], v[72:75], v[48:51]
v_mfma_f32_16x16x32_bf16 v[52:55], a[56:59], v[76:79], v[52:55]
s_waitcnt lgkmcnt(3)
v_mfma_f32_16x16x32_bf16 v[16:19], a[60:63], v[80:83], v[16:19]
v_mfma_f32_16x16x32_bf16 v[20:23], a[60:63], v[84:87], v[20:23]
v_mfma_f32_16x16x32_bf16 v[24:27], a[64:67], v[80:83], v[24:27]
v_mfma_f32_16x16x32_bf16 v[28:31], a[64:67], v[84:87], v[28:31]
buffer_store_dwordx4 v[88:91], v104, s[48:51], s52 offen sc1
s_nop 0
ds_read_b128 v[88:91], v108 offset:4096
v_mfma_f32_16x16x32_bf16 v[32:35], a[68:71], v[80:83], v[32:35]
v_mfma_f32_16x16x32_bf16 v[36:39], a[68:71], v[84:87], v[36:39]
v_mfma_f32_16x16x32_bf16 v[40:43], a[72:75], v[80:83], v[40:43]
ds_read_b128 v[64:67], v12 offset:2048
v_mfma_f32_16x16x32_bf16 v[44:47], a[72:75], v[84:87], v[44:47]
ds_read_b128 v[68:71], v12 offset:12288
v_mfma_f32_16x16x32_bf16 v[48:51], a[76:79], v[80:83], v[48:51]
v_mfma_f32_16x16x32_bf16 v[52:55], a[76:79], v[84:87], v[52:55]
s_waitcnt lgkmcnt(3)
v_mfma_f32_16x16x32_bf16 v[16:19], a[80:83], v[56:59], v[16:19]
v_mfma_f32_16x16x32_bf16 v[20:23], a[80:83], v[60:63], v[20:23]
v_mfma_f32_16x16x32_bf16 v[24:27], a[84:87], v[56:59], v[24:27]
v_mfma_f32_16x16x32_bf16 v[28:31], a[84:87], v[60:63], v[28:31]
buffer_store_dwordx4 v[92:95], v105, s[48:51], s52 offen sc1
s_nop 0
ds_read_b128 v[92:95], v108 offset:5120
v_mfma_f32_16x16x32_bf16 v[32:35], a[88:91], v[56:59], v[32:35]
v_mfma_f32_16x16x32_bf16 v[36:39], a[88:91], v[60:63], v[36:39]
v_mfma_f32_16x16x32_bf16 v[40:43], a[92:95], v[56:59], v[40:43]
ds_read_b128 v[72:75], v4 offset:3072
v_mfma_f32_16x16x32_bf16 v[44:47], a[92:95], v[60:63], v[44:47]
ds_read_b128 v[76:79], v4 offset:13312
v_mfma_f32_16x16x32_bf16 v[48:51], a[96:99], v[56:59], v[48:51]
v_mfma_f32_16x16x32_bf16 v[52:55], a[96:99], v[60:63], v[52:55]
s_waitcnt lgkmcnt(3)
v_mfma_f32_16x16x32_bf16 v[16:19], a[100:103], v[64:67], v[16:19]
v_mfma_f32_16x16x32_bf16 v[20:23], a[100:103], v[68:71], v[20:23]
v_mfma_f32_16x16x32_bf16 v[24:27], a[104:107], v[64:67], v[24:27]
v_mfma_f32_16x16x32_bf16 v[28:31], a[104:107], v[68:71], v[28:31]
buffer_store_dwordx4 v[88:91], v106, s[48:51], s52 offen sc1
v_mfma_f32_16x16x32_bf16 v[32:35], a[108:111], v[64:67], v[32:35]
v_mfma_f32_16x16x32_bf16 v[36:39], a[108:111], v[68:71], v[36:39]
v_mfma_f32_16x16x32_bf16 v[40:43], a[112:115], v[64:67], v[40:43]
ds_read_b128 v[80:83], v12 offset:3072
v_mfma_f32_16x16x32_bf16 v[44:47], a[112:115], v[68:71], v[44:47]
ds_read_b128 v[84:87], v12 offset:13312
v_mfma_f32_16x16x32_bf16 v[48:51], a[116:119], v[64:67], v[48:51]
v_mfma_f32_16x16x32_bf16 v[52:55], a[116:119], v[68:71], v[52:55]
s_waitcnt lgkmcnt(2)
v_mfma_f32_16x16x32_bf16 v[16:19], a[120:123], v[72:75], v[16:19]
v_mfma_f32_16x16x32_bf16 v[20:23], a[120:123], v[76:79], v[20:23]
v_mfma_f32_16x16x32_bf16 v[24:27], a[124:127], v[72:75], v[24:27]
v_mfma_f32_16x16x32_bf16 v[28:31], a[124:127], v[76:79], v[28:31]
buffer_store_dwordx4 v[92:95], v107, s[48:51], s52 offen sc1
v_mfma_f32_16x16x32_bf16 v[32:35], a[128:131], v[72:75], v[32:35]
v_mfma_f32_16x16x32_bf16 v[36:39], a[128:131], v[76:79], v[36:39]
v_mfma_f32_16x16x32_bf16 v[40:43], a[132:135], v[72:75], v[40:43]
ds_read_b128 v[56:59], v4 offset:4096
v_mfma_f32_16x16x32_bf16 v[44:47], a[132:135], v[76:79], v[44:47]
ds_read_b128 v[60:63], v4 offset:14336
v_mfma_f32_16x16x32_bf16 v[48:51], a[136:139], v[72:75], v[48:51]
v_mfma_f32_16x16x32_bf16 v[52:55], a[136:139], v[76:79], v[52:55]
s_waitcnt vmcnt(6)
s_barrier
s_waitcnt lgkmcnt(2)
v_mfma_f32_16x16x32_bf16 v[16:19], a[140:143], v[80:83], v[16:19]
s_add_u32 s44, s44, 20480
s_cmp_eq_u32 s44, 159744
v_mfma_f32_16x16x32_bf16 v[20:23], a[140:143], v[84:87], v[20:23]
s_cselect_b32 s44, 98304, s44
v_add_u32 v9, s44, v10
v_mfma_f32_16x16x32_bf16 v[24:27], a[144:147], v[80:83], v[24:27]
v_add_u32 v13, s44, v11
s_min_u32 s41, s36, 31
v_mfma_f32_16x16x32_bf16 v[28:31], a[144:147], v[84:87], v[28:31]
s_lshr_b32 s41, s41, 1
s_mul_i32 s41, s41, s33
v_mfma_f32_16x16x32_bf16 v[32:35], a[148:151], v[80:83], v[32:35]
s_add_u32 s41, s41, s32
s_mul_i32 s41, s41, 40960
v_mfma_f32_16x16x32_bf16 v[36:39], a[148:151], v[84:87], v[36:39]
s_and_b32 s42, s36, 1
s_mul_i32 s42, s42, 640
v_mfma_f32_16x16x32_bf16 v[40:43], a[152:155], v[80:83], v[40:43]
ds_read_b128 v[64:67], v12 offset:4096
s_add_u32 s41, s41, s42
v_mfma_f32_16x16x32_bf16 v[44:47], a[152:155], v[84:87], v[44:47]
ds_read_b128 v[68:71], v12 offset:14336
s_mul_i32 s42, s37, 20480
v_mfma_f32_16x16x32_bf16 v[48:51], a[156:159], v[80:83], v[48:51]
s_mul_i32 s43, s24, 5120
s_add_u32 s42, s42, s43
v_mfma_f32_16x16x32_bf16 v[52:55], a[156:159], v[84:87], v[52:55]
s_add_u32 s42, s42, 98304
s_add_u32 s36, s36, 1
s_waitcnt lgkmcnt(2)
v_mfma_f32_16x16x32_bf16 v[16:19], a[160:163], v[56:59], v[16:19]
s_add_u32 s37, s37, 1
s_cmp_eq_u32 s37, 3
v_mfma_f32_16x16x32_bf16 v[20:23], a[160:163], v[60:63], v[20:23]
s_cselect_b32 s37, 0, s37
s_mov_b32 m0, s42
v_mfma_f32_16x16x32_bf16 v[24:27], a[164:167], v[56:59], v[24:27]
s_add_u32 s42, s42, 1024
buffer_load_dwordx4 v7, s[8:11], s41 offen lds
v_mfma_f32_16x16x32_bf16 v[28:31], a[164:167], v[60:63], v[28:31]
s_add_u32 s41, s41, 128
s_mov_b32 m0, s42
v_mfma_f32_16x16x32_bf16 v[32:35], a[168:171], v[56:59], v[32:35]
s_add_u32 s42, s42, 1024
buffer_load_dwordx4 v7, s[8:11], s41 offen lds
v_mfma_f32_16x16x32_bf16 v[36:39], a[168:171], v[60:63], v[36:39]
s_add_u32 s41, s41, 128
s_mov_b32 m0, s42
v_mfma_f32_16x16x32_bf16 v[40:43], a[172:175], v[56:59], v[40:43]
ds_read_b128 v[72:75], v9 offset:0
s_add_u32 s42, s42, 1024
v_mfma_f32_16x16x32_bf16 v[44:47], a[172:175], v[60:63], v[44:47]
ds_read_b128 v[76:79], v9 offset:10240
buffer_load_dwordx4 v7, s[8:11], s41 offen lds
v_mfma_f32_16x16x32_bf16 v[48:51], a[176:179], v[56:59], v[48:51]
s_add_u32 s41, s41, 128
s_mov_b32 m0, s42
v_mfma_f32_16x16x32_bf16 v[52:55], a[176:179], v[60:63], v[52:55]
s_add_u32 s42, s42, 1024
buffer_load_dwordx4 v7, s[8:11], s41 offen lds
s_waitcnt lgkmcnt(2)
v_mfma_f32_16x16x32_bf16 v[16:19], a[180:183], v[64:67], v[16:19]
s_add_u32 s41, s41, 128
s_mov_b32 m0, s42
v_mfma_f32_16x16x32_bf16 v[20:23], a[180:183], v[68:71], v[20:23]
s_add_u32 s42, s42, 1024
buffer_load_dwordx4 v7, s[8:11], s41 offen lds
v_mfma_f32_16x16x32_bf16 v[24:27], a[184:187], v[64:67], v[24:27]
s_add_u32 s41, s41, 128
v_mfma_f32_16x16x32_bf16 v[28:31], a[184:187], v[68:71], v[28:31]
v_mfma_f32_16x16x32_bf16 v[32:35], a[188:191], v[64:67], v[32:35]
v_mfma_f32_16x16x32_bf16 v[36:39], a[188:191], v[68:71], v[36:39]
v_mfma_f32_16x16x32_bf16 v[40:43], a[192:195], v[64:67], v[40:43]
ds_read_b128 v[80:83], v13 offset:0
v_mfma_f32_16x16x32_bf16 v[44:47], a[192:195], v[68:71], v[44:47]
ds_read_b128 v[84:87], v13 offset:10240
v_mfma_f32_16x16x32_bf16 v[48:51], a[196:199], v[64:67], v[48:51]
v_mfma_f32_16x16x32_bf16 v[52:55], a[196:199], v[68:71], v[52:55]
v_mov_b32 v4, v9
v_mov_b32 v12, v13
s_waitcnt lgkmcnt(2)
v_mfma_f32_16x16x32_bf16 v[16:19], a[200:203], v[72:75], v[16:19]
v_mfma_f32_16x16x32_bf16 v[20:23], a[200:203], v[76:79], v[20:23]
v_mfma_f32_16x16x32_bf16 v[24:27], a[204:207], v[72:75], v[24:27]
v_mfma_f32_16x16x32_bf16 v[28:31], a[204:207], v[76:79], v[28:31]
v_mfma_f32_16x16x32_bf16 v[32:35], a[208:211], v[72:75], v[32:35]
v_mfma_f32_16x16x32_bf16 v[36:39], a[208:211], v[76:79], v[36:39]
v_mfma_f32_16x16x32_bf16 v[40:43], a[212:215], v[72:75], v[40:43]
ds_read_b128 v[56:59], v4 offset:1024
v_mfma_f32_16x16x32_bf16 v[44:47], a[212:215], v[76:79], v[44:47]
ds_read_b128 v[60:63], v4 offset:11264
v_mfma_f32_16x16x32_bf16 v[48:51], a[216:219], v[72:75], v[48:51]
v_mfma_f32_16x16x32_bf16 v[52:55], a[216:219], v[76:79], v[52:55]
s_waitcnt lgkmcnt(2)
v_mfma_f32_16x16x32_bf16 v[16:19], a[220:223], v[80:83], v[16:19]
v_mfma_f32_16x16x32_bf16 v[20:23], a[220:223], v[84:87], v[20:23]
v_mfma_f32_16x16x32_bf16 v[24:27], a[224:227], v[80:83], v[24:27]
v_mfma_f32_16x16x32_bf16 v[28:31], a[224:227], v[84:87], v[28:31]
v_mfma_f32_16x16x32_bf16 v[32:35], a[228:231], v[80:83], v[32:35]
v_mfma_f32_16x16x32_bf16 v[36:39], a[228:231], v[84:87], v[36:39]
v_mfma_f32_16x16x32_bf16 v[40:43], a[232:235], v[80:83], v[40:43]
ds_read_b128 v[64:67], v12 offset:1024
v_mfma_f32_16x16x32_bf16 v[44:47], a[232:235], v[84:87], v[44:47]
ds_read_b128 v[68:71], v12 offset:11264
v_mfma_f32_16x16x32_bf16 v[48:51], a[236:239], v[80:83], v[48:51]
v_mfma_f32_16x16x32_bf16 v[52:55], a[236:239], v[84:87], v[52:55]
s_waitcnt lgkmcnt(2)
v_mfma_f32_16x16x32_bf16 v[16:19], a[240:243], v[56:59], v[16:19]
v_mfma_f32_16x16x32_bf16 v[20:23], a[240:243], v[60:63], v[20:23]
v_mfma_f32_16x16x32_bf16 v[24:27], a[244:247], v[56:59], v[24:27]
v_mfma_f32_16x16x32_bf16 v[28:31], a[244:247], v[60:63], v[28:31]
v_mfma_f32_16x16x32_bf16 v[32:35], a[248:251], v[56:59], v[32:35]
v_mfma_f32_16x16x32_bf16 v[36:39], a[248:251], v[60:63], v[36:39]
v_mfma_f32_16x16x32_bf16 v[40:43], a[252:255], v[56:59], v[40:43]
ds_read_b128 v[72:75], v4 offset:2048
v_mfma_f32_16x16x32_bf16 v[44:47], a[252:255], v[60:63], v[44:47]
ds_read_b128 v[76:79], v4 offset:12288
v_mfma_f32_16x16x32_bf16 v[48:51], v[112:115], v[56:59], v[48:51]
v_mfma_f32_16x16x32_bf16 v[52:55], v[112:115], v[60:63], v[52:55]
s_waitcnt lgkmcnt(2)
v_mfma_f32_16x16x32_bf16 v[16:19], v[116:119], v[64:67], v[16:19]
v_mfma_f32_16x16x32_bf16 v[20:23], v[116:119], v[68:71], v[20:23]
v_mfma_f32_16x16x32_bf16 v[24:27], v[120:123], v[64:67], v[24:27]
v_mfma_f32_16x16x32_bf16 v[28:31], v[120:123], v[68:71], v[28:31]
v_mfma_f32_16x16x32_bf16 v[32:35], v[124:127], v[64:67], v[32:35]
v_mfma_f32_16x16x32_bf16 v[36:39], v[124:127], v[68:71], v[36:39]
v_mfma_f32_16x16x32_bf16 v[40:43], v[128:131], v[64:67], v[40:43]
ds_read_b128 v[80:83], v12 offset:2048
v_mfma_f32_16x16x32_bf16 v[44:47], v[128:131], v[68:71], v[44:47]
ds_read_b128 v[84:87], v12 offset:12288
v_mfma_f32_16x16x32_bf16 v[48:51], v[132:135], v[64:67], v[48:51]
v_mfma_f32_16x16x32_bf16 v[52:55], v[132:135], v[68:71], v[52:55]
s_waitcnt lgkmcnt(2)
v_mfma_f32_16x16x32_bf16 v[16:19], v[136:139], v[72:75], v[16:19]
v_mfma_f32_16x16x32_bf16 v[20:23], v[136:139], v[76:79], v[20:23]
v_mfma_f32_16x16x32_bf16 v[24:27], v[140:143], v[72:75], v[24:27]
v_mfma_f32_16x16x32_bf16 v[28:31], v[140:143], v[76:79], v[28:31]
v_mfma_f32_16x16x32_bf16 v[32:35], v[144:147], v[72:75], v[32:35]
v_mfma_f32_16x16x32_bf16 v[36:39], v[144:147], v[76:79], v[36:39]
v_mfma_f32_16x16x32_bf16 v[40:43], v[148:151], v[72:75], v[40:43]
ds_read_b128 v[56:59], v4 offset:3072
v_mfma_f32_16x16x32_bf16 v[44:47], v[148:151], v[76:79], v[44:47]
ds_read_b128 v[60:63], v4 offset:13312
v_mfma_f32_16x16x32_bf16 v[48:51], v[152:155], v[72:75], v[48:51]
v_mfma_f32_16x16x32_bf16 v[52:55], v[152:155], v[76:79], v[52:55]
s_waitcnt lgkmcnt(2)
v_mfma_f32_16x16x32_bf16 v[16:19], v[156:159], v[80:83], v[16:19]
v_mfma_f32_16x16x32_bf16 v[20:23], v[156:159], v[84:87], v[20:23]
v_mfma_f32_16x16x32_bf16 v[24:27], v[160:163], v[80:83], v[24:27]
v_mfma_f32_16x16x32_bf16 v[28:31], v[160:163], v[84:87], v[28:31]
v_mfma_f32_16x16x32_bf16 v[32:35], v[164:167], v[80:83], v[32:35]
v_mfma_f32_16x16x32_bf16 v[36:39], v[164:167], v[84:87], v[36:39]
v_mfma_f32_16x16x32_bf16 v[40:43], v[168:171], v[80:83], v[40:43]
ds_read_b128 v[64:67], v12 offset:3072
v_mfma_f32_16x16x32_bf16 v[44:47], v[168:171], v[84:87], v[44:47]
ds_read_b128 v[68:71], v12 offset:13312
v_mfma_f32_16x16x32_bf16 v[48:51], v[172:175], v[80:83], v[48:51]
v_mfma_f32_16x16x32_bf16 v[52:55], v[172:175], v[84:87], v[52:55]
s_waitcnt lgkmcnt(2)
v_mfma_f32_16x16x32_bf16 v[16:19], v[176:179], v[56:59], v[16:19]
v_mfma_f32_16x16x32_bf16 v[20:23], v[176:179], v[60:63], v[20:23]
v_mfma_f32_16x16x32_bf16 v[24:27], v[180:183], v[56:59], v[24:27]
v_mfma_f32_16x16x32_bf16 v[28:31], v[180:183], v[60:63], v[28:31]
v_mfma_f32_16x16x32_bf16 v[32:35], v[184:187], v[56:59], v[32:35]
v_mfma_f32_16x16x32_bf16 v[36:39], v[184:187], v[60:63], v[36:39]
v_mfma_f32_16x16x32_bf16 v[40:43], v[188:191], v[56:59], v[40:43]
ds_read_b128 v[72:75], v4 offset:4096
v_mfma_f32_16x16x32_bf16 v[44:47], v[188:191], v[60:63], v[44:47]
ds_read_b128 v[76:79], v4 offset:14336
v_mfma_f32_16x16x32_bf16 v[48:51], v[192:195], v[56:59], v[48:51]
v_mfma_f32_16x16x32_bf16 v[52:55], v[192:195], v[60:63], v[52:55]
s_waitcnt vmcnt(0)
s_barrier
s_waitcnt lgkmcnt(2)
v_mfma_f32_16x16x32_bf16 v[16:19], v[196:199], v[64:67], v[16:19]
s_add_u32 s44, s44, 20480
s_cmp_eq_u32 s44, 159744
v_mfma_f32_16x16x32_bf16 v[20:23], v[196:199], v[68:71], v[20:23]
s_cselect_b32 s44, 98304, s44
v_add_u32 v9, s44, v10
v_mfma_f32_16x16x32_bf16 v[24:27], v[200:203], v[64:67], v[24:27]
v_add_u32 v13, s44, v11
s_min_u32 s41, s36, 31
v_mfma_f32_16x16x32_bf16 v[28:31], v[200:203], v[68:71], v[28:31]
s_lshr_b32 s41, s41, 1
s_mul_i32 s41, s41, s33
v_mfma_f32_16x16x32_bf16 v[32:35], v[204:207], v[64:67], v[32:35]
s_add_u32 s41, s41, s32
s_mul_i32 s41, s41, 40960
v_mfma_f32_16x16x32_bf16 v[36:39], v[204:207], v[68:71], v[36:39]
s_and_b32 s42, s36, 1
s_mul_i32 s42, s42, 640
v_mfma_f32_16x16x32_bf16 v[40:43], v[208:211], v[64:67], v[40:43]
ds_read_b128 v[80:83], v12 offset:4096
s_add_u32 s41, s41, s42
v_mfma_f32_16x16x32_bf16 v[44:47], v[208:211], v[68:71], v[44:47]
ds_read_b128 v[84:87], v12 offset:14336
s_mul_i32 s42, s37, 20480
v_mfma_f32_16x16x32_bf16 v[48:51], v[212:215], v[64:67], v[48:51]
s_mul_i32 s43, s24, 5120
s_add_u32 s42, s42, s43
v_mfma_f32_16x16x32_bf16 v[52:55], v[212:215], v[68:71], v[52:55]
s_add_u32 s42, s42, 98304
s_add_u32 s36, s36, 1
s_waitcnt lgkmcnt(2)
v_mfma_f32_16x16x32_bf16 v[16:19], v[216:219], v[72:75], v[16:19]
s_add_u32 s37, s37, 1
s_cmp_eq_u32 s37, 3
v_mfma_f32_16x16x32_bf16 v[20:23], v[216:219], v[76:79], v[20:23]
s_cselect_b32 s37, 0, s37
s_add_u32 s61, s57, s40
v_mfma_f32_16x16x32_bf16 v[24:27], v[220:223], v[72:75], v[24:27]
v_mov_b32 v14, s61
v_mov_b32 v15, 0
v_mfma_f32_16x16x32_bf16 v[28:31], v[220:223], v[76:79], v[28:31]
s_mov_b64 exec, 1
buffer_store_dword v14, v15, s[4:7], s34 offen sc1
s_mov_b64 exec, -1
v_mfma_f32_16x16x32_bf16 v[32:35], v[224:227], v[72:75], v[32:35]
s_mov_b32 m0, s42
s_add_u32 s42, s42, 1024
v_mfma_f32_16x16x32_bf16 v[36:39], v[224:227], v[76:79], v[36:39]
buffer_load_dwordx4 v7, s[8:11], s41 offen lds
s_add_u32 s41, s41, 128
v_mfma_f32_16x16x32_bf16 v[40:43], v[228:231], v[72:75], v[40:43]
ds_read_b128 v[56:59], v9 offset:0
s_mov_b32 m0, s42
v_mfma_f32_16x16x32_bf16 v[44:47], v[228:231], v[76:79], v[44:47]
ds_read_b128 v[60:63], v9 offset:10240
s_add_u32 s42, s42, 1024
v_mfma_f32_16x16x32_bf16 v[48:51], v[232:235], v[72:75], v[48:51]
buffer_load_dwordx4 v7, s[8:11], s41 offen lds
s_add_u32 s41, s41, 128
v_mfma_f32_16x16x32_bf16 v[52:55], v[232:235], v[76:79], v[52:55]
s_mov_b32 m0, s42
s_add_u32 s42, s42, 1024
s_waitcnt lgkmcnt(2)
v_mfma_f32_16x16x32_bf16 v[16:19], v[236:239], v[80:83], v[16:19]
buffer_load_dwordx4 v7, s[8:11], s41 offen lds
s_add_u32 s41, s41, 128
v_mfma_f32_16x16x32_bf16 v[20:23], v[236:239], v[84:87], v[20:23]
s_mov_b32 m0, s42
s_add_u32 s42, s42, 1024
v_mfma_f32_16x16x32_bf16 v[24:27], v[240:243], v[80:83], v[24:27]
buffer_load_dwordx4 v7, s[8:11], s41 offen lds
s_add_u32 s41, s41, 128
v_mfma_f32_16x16x32_bf16 v[28:31], v[240:243], v[84:87], v[28:31]
v_mfma_f32_16x16x32_bf16 v[32:35], v[244:247], v[80:83], v[32:35]
v_mfma_f32_16x16x32_bf16 v[36:39], v[244:247], v[84:87], v[36:39]
v_pk_mul_f32 v[16:17], v[16:17], s[54:55] op_sel_hi:[1,0]
v_pk_mul_f32 v[18:19], v[18:19], s[54:55] op_sel_hi:[1,0]
v_cvt_pk_bf16_f32 v88, v16, v17
v_cvt_pk_bf16_f32 v89, v18, v19
ds_write_b64 v96, v[88:89] offset:0
v_pk_mul_f32 v[20:21], v[20:21], s[54:55] op_sel_hi:[1,0]
v_pk_mul_f32 v[22:23], v[22:23], s[54:55] op_sel_hi:[1,0]
v_cvt_pk_bf16_f32 v90, v20, v21
v_cvt_pk_bf16_f32 v91, v22, v23
ds_write_b64 v96, v[90:91] offset:256
v_mfma_f32_16x16x32_bf16 v[40:43], v[248:251], v[80:83], v[40:43]
ds_read_b128 v[64:67], v13 offset:0
v_mfma_f32_16x16x32_bf16 v[44:47], v[248:251], v[84:87], v[44:47]
ds_read_b128 v[68:71], v13 offset:10240
v_pk_mul_f32 v[24:25], v[24:25], s[54:55] op_sel_hi:[1,0]
v_pk_mul_f32 v[26:27], v[26:27], s[54:55] op_sel_hi:[1,0]
v_cvt_pk_bf16_f32 v92, v24, v25
v_cvt_pk_bf16_f32 v93, v26, v27
ds_write_b64 v97, v[92:93] offset:0
v_pk_mul_f32 v[28:29], v[28:29], s[54:55] op_sel_hi:[1,0]
v_pk_mul_f32 v[30:31], v[30:31], s[54:55] op_sel_hi:[1,0]
v_cvt_pk_bf16_f32 v94, v28, v29
v_cvt_pk_bf16_f32 v95, v30, v31
ds_write_b64 v97, v[94:95] offset:256
v_mfma_f32_16x16x32_bf16 v[48:51], v[252:255], v[80:83], v[48:51]
v_mfma_f32_16x16x32_bf16 v[52:55], v[252:255], v[84:87], v[52:55]
v_pk_mul_f32 v[32:33], v[32:33], s[54:55] op_sel_hi:[1,0]
v_pk_mul_f32 v[34:35], v[34:35], s[54:55] op_sel_hi:[1,0]
v_cvt_pk_bf16_f32 v88, v32, v33
v_cvt_pk_bf16_f32 v89, v34, v35
ds_write_b64 v98, v[88:89] offset:0
v_pk_mul_f32 v[36:37], v[36:37], s[54:55] op_sel_hi:[1,0]
v_pk_mul_f32 v[38:39], v[38:39], s[54:55] op_sel_hi:[1,0]
v_cvt_pk_bf16_f32 v90, v36, v37
v_cvt_pk_bf16_f32 v91, v38, v39
ds_write_b64 v98, v[90:91] offset:256
v_mov_b32 v4, v9
v_mov_b32 v12, v13
B1qtail:
v_pk_mul_f32 v[40:41], v[40:41], s[54:55] op_sel_hi:[1,0]
v_pk_mul_f32 v[42:43], v[42:43], s[54:55] op_sel_hi:[1,0]
v_cvt_pk_bf16_f32 v92, v40, v41
v_cvt_pk_bf16_f32 v93, v42, v43
ds_write_b64 v99, v[92:93] offset:0
v_pk_mul_f32 v[44:45], v[44:45], s[54:55] op_sel_hi:[1,0]
v_pk_mul_f32 v[46:47], v[46:47], s[54:55] op_sel_hi:[1,0]
v_cvt_pk_bf16_f32 v94, v44, v45
v_cvt_pk_bf16_f32 v95, v46, v47
ds_write_b64 v99, v[94:95] offset:256
v_pk_mul_f32 v[48:49], v[48:49], s[54:55] op_sel_hi:[1,0]
v_pk_mul_f32 v[50:51], v[50:51], s[54:55] op_sel_hi:[1,0]
v_cvt_pk_bf16_f32 v88, v48, v49
v_cvt_pk_bf16_f32 v89, v50, v51
ds_write_b64 v100, v[88:89] offset:0
v_pk_mul_f32 v[52:53], v[52:53], s[54:55] op_sel_hi:[1,0]
v_pk_mul_f32 v[54:55], v[54:55], s[54:55] op_sel_hi:[1,0]
v_cvt_pk_bf16_f32 v90, v52, v53
v_cvt_pk_bf16_f32 v91, v54, v55
ds_write_b64 v100, v[90:91] offset:256
s_add_u32 s40, s40, 1
s_mov_b32 s47, s39
s_add_u32 s39, s39, s33
s_mov_b32 s50, 0x10000000
s_cmp_le_u32 s40, 0
s_cselect_b32 s43, 1, 0
s_cmp_eq_u32 s40, 16
s_cselect_b32 s43, 1, s43
s_cmp_eq_u32 s43, 0
s_cbranch_scc1 xe_5
s_mul_i32 s52, s47, s56
s_add_u32 s52, s52, s45
ds_read_b128 v[88:91], v108 offset:0
ds_read_b128 v[92:95], v108 offset:1024
s_waitcnt lgkmcnt(1)
buffer_store_dwordx4 v[88:91], v102, s[4:7], s52 offen sc1
s_nop 0
ds_read_b128 v[88:91], v108 offset:2048
s_waitcnt lgkmcnt(1)
buffer_store_dwordx4 v[92:95], v103, s[4:7], s52 offen sc1
s_nop 0
ds_read_b128 v[92:95], v108 offset:3072
s_waitcnt lgkmcnt(1)
buffer_store_dwordx4 v[88:91], v104, s[4:7], s52 offen sc1
s_nop 0
ds_read_b128 v[88:91], v108 offset:4096
s_waitcnt lgkmcnt(1)
buffer_store_dwordx4 v[92:95], v105, s[4:7], s52 offen sc1
s_nop 0
ds_read_b128 v[92:95], v108 offset:5120
s_waitcnt lgkmcnt(1)
buffer_store_dwordx4 v[88:91], v106, s[4:7], s52 offen sc1
s_waitcnt lgkmcnt(0)
buffer_store_dwordx4 v[92:95], v107, s[4:7], s52 offen sc1
s_mov_b32 s50, 0
s_waitcnt vmcnt(0)
s_barrier
s_add_u32 s61, s57, s40
v_mov_b32 v14, s61
v_mov_b32 v15, 0
s_mov_b64 exec, 1
buffer_store_dword v14, v15, s[4:7], s34 offen sc1
s_mov_b64 exec, -1
xe_5:
s_cmp_lt_u32 s40, 16
s_cbranch_scc1 B1qloop
s_waitcnt lgkmcnt(0)
s_waitcnt vmcnt(0)
s_branch L_fin
B1_v:
s_add_u32 s45, s45, 1536
s_mul_i32 s29, s24, 20480
v_add_u32 v108, s29, v1
v_add_u32 v12, 0, v0
v_mul_u32_u24 v13, 10923, v12
v_lshrrev_b32 v13, 20, v13
v_mul_u32_u24 v15, 96, v13
v_sub_u32 v14, v12, v15
v_mul_lo_u32 v13, v13, s55
v_lshl_add_u32 v102, v14, 4, v13
v_add_u32 v12, 64, v0
v_mul_u32_u24 v13, 10923, v12
v_lshrrev_b32 v13, 20, v13
v_mul_u32_u24 v15, 96, v13
v_sub_u32 v14, v12, v15
v_mul_lo_u32 v13, v13, s55
v_lshl_add_u32 v103, v14, 4, v13
v_add_u32 v12, 128, v0
v_mul_u32_u24 v13, 10923, v12
v_lshrrev_b32 v13, 20, v13
v_mul_u32_u24 v15, 96, v13
v_sub_u32 v14, v12, v15
v_mul_lo_u32 v13, v13, s55
v_lshl_add_u32 v104, v14, 4, v13
v_add_u32 v12, 192, v0
v_mul_u32_u24 v13, 10923, v12
v_lshrrev_b32 v13, 20, v13
v_mul_u32_u24 v15, 96, v13
v_sub_u32 v14, v12, v15
v_mul_lo_u32 v13, v13, s55
v_lshl_add_u32 v105, v14, 4, v13
v_add_u32 v12, 256, v0
v_mul_u32_u24 v13, 10923, v12
v_lshrrev_b32 v13, 20, v13
v_mul_u32_u24 v15, 96, v13
v_sub_u32 v14, v12, v15
v_mul_lo_u32 v13, v13, s55
v_lshl_add_u32 v106, v14, 4, v13
v_add_u32 v12, 320, v0
v_mul_u32_u24 v13, 10923, v12
v_lshrrev_b32 v13, 20, v13
v_mul_u32_u24 v15, 96, v13
v_sub_u32 v14, v12, v15
v_mul_lo_u32 v13, v13, s55
v_lshl_add_u32 v107, v14, 4, v13
v_mov_b32 v88, 0x3f803f80
v_mov_b32 v89, 0x3f803f80
v_mov_b32 v90, 0x3f803f80
v_mov_b32 v91, 0x3f803f80
ds_write_b128 v108, v[88:91] offset:0
ds_write_b128 v108, v[88:91] offset:1024
ds_write_b128 v108, v[88:91] offset:2048
ds_write_b128 v108, v[88:91] offset:3072
ds_write_b128 v108, v[88:91] offset:4096
ds_write_b128 v108, v[88:91] offset:5120
s_waitcnt lgkmcnt(0)
v_add_u32 v12, 0, v2
v_mul_u32_u24 v13, 52429, v12
v_lshrrev_b32 v13, 20, v13
v_mul_u32_u24 v15, 20, v13
v_sub_u32 v14, v12, v15
v_mul_u32_u24 v13, 1536, v13
v_lshl_add_u32 v13, v14, 4, v13
v_and_b32 v14, 1, v3
v_mul_u32_u24 v14, 336, v14
v_lshrrev_b32 v15, 1, v3
v_lshl_add_u32 v14, v15, 3, v14
v_add3_u32 v96, v13, v14, s29
v_add_u32 v12, 16, v2
v_mul_u32_u24 v13, 52429, v12
v_lshrrev_b32 v13, 20, v13
v_mul_u32_u24 v15, 20, v13
v_sub_u32 v14, v12, v15
v_mul_u32_u24 v13, 1536, v13
v_lshl_add_u32 v13, v14, 4, v13
v_and_b32 v14, 1, v3
v_mul_u32_u24 v14, 336, v14
v_lshrrev_b32 v15, 1, v3
v_lshl_add_u32 v14, v15, 3, v14
v_add3_u32 v97, v13, v14, s29
v_add_u32 v12, 32, v2
v_mul_u32_u24 v13, 52429, v12
v_lshrrev_b32 v13, 20, v13
v_mul_u32_u24 v15, 20, v13
v_sub_u32 v14, v12, v15
v_mul_u32_u24 v13, 1536, v13
v_lshl_add_u32 v13, v14, 4, v13
v_and_b32 v14, 1, v3
v_mul_u32_u24 v14, 336, v14
v_lshrrev_b32 v15, 1, v3
v_lshl_add_u32 v14, v15, 3, v14
v_add3_u32 v98, v13, v14, s29
v_add_u32 v12, 48, v2
v_mul_u32_u24 v13, 52429, v12
v_lshrrev_b32 v13, 20, v13
v_mul_u32_u24 v15, 20, v13
v_sub_u32 v14, v12, v15
v_mul_u32_u24 v13, 1536, v13
v_lshl_add_u32 v13, v14, 4, v13
v_and_b32 v14, 1, v3
v_mul_u32_u24 v14, 336, v14
v_lshrrev_b32 v15, 1, v3
v_lshl_add_u32 v14, v15, 3, v14
v_add3_u32 v99, v13, v14, s29
v_add_u32 v12, 64, v2
v_mul_u32_u24 v13, 52429, v12
v_lshrrev_b32 v13, 20, v13
v_mul_u32_u24 v15, 20, v13
v_sub_u32 v14, v12, v15
v_mul_u32_u24 v13, 1536, v13
v_lshl_add_u32 v13, v14, 4, v13
v_and_b32 v14, 1, v3
v_mul_u32_u24 v14, 336, v14
v_lshrrev_b32 v15, 1, v3
v_lshl_add_u32 v14, v15, 3, v14
v_add3_u32 v100, v13, v14, s29
v_lshrrev_b32 v8, 3, v0
s_lshl_b32 s35, s24, 3
v_add_u32 v7, s35, v8
v_mul_u32_u24 v7, 1280, v7
v_and_b32 v9, 7, v0
v_xor_b32 v9, v9, v8
v_lshl_add_u32 v7, v9, 4, v7
v_and_b32 v8, 7, v2
v_xor_b32 v9, v3, v8
v_lshlrev_b32 v9, 4, v9
v_lshl_add_u32 v9, v8, 7, v9
v_lshrrev_b32 v8, 3, v2
v_mul_u32_u24 v8, 5120, v8
v_add_u32 v10, v8, v9
v_xor_b32 v11, 64, v10
s_mov_b32 s36, 0
s_mov_b32 s37, 0
s_mov_b32 s39, s32
s_mov_b32 s40, 0
s_mov_b32 s44, 98304
s_mov_b32 s48, s4
s_mov_b32 s49, s5
s_mov_b32 s50, 0
s_mov_b32 s51, 0x20000
s_min_u32 s41, s36, 31
s_lshr_b32 s41, s41, 1
s_mul_i32 s41, s41, s33
s_add_u32 s41, s41, s32
s_mul_i32 s41, s41, 40960
s_and_b32 s42, s36, 1
s_mul_i32 s42, s42, 640
s_add_u32 s41, s41, s42
s_mul_i32 s42, s37, 20480
s_mul_i32 s43, s24, 5120
s_add_u32 s42, s42, s43
s_add_u32 s42, s42, 98304
s_add_u32 s36, s36, 1
s_add_u32 s37, s37, 1
s_cmp_eq_u32 s37, 3
s_cselect_b32 s37, 0, s37
s_mov_b32 m0, s42
s_add_u32 s42, s42, 1024
buffer_load_dwordx4 v7, s[8:11], s41 offen lds
s_add_u32 s41, s41, 128
s_mov_b32 m0, s42
s_add_u32 s42, s42, 1024
buffer_load_dwordx4 v7, s[8:11], s41 offen lds
s_add_u32 s41, s41, 128
s_mov_b32 m0, s42
s_add_u32 s42, s42, 1024
buffer_load_dwordx4 v7, s[8:11], s41 offen lds
s_add_u32 s41, s41, 128
s_mov_b32 m0, s42
s_add_u32 s42, s42, 1024
buffer_load_dwordx4 v7, s[8:11], s41 offen lds
s_add_u32 s41, s41, 128
s_mov_b32 m0, s42
s_add_u32 s42, s42, 1024
buffer_load_dwordx4 v7, s[8:11], s41 offen lds
s_add_u32 s41, s41, 128
s_min_u32 s41, s36, 31
s_lshr_b32 s41, s41, 1
s_mul_i32 s41, s41, s33
s_add_u32 s41, s41, s32
s_mul_i32 s41, s41, 40960
s_and_b32 s42, s36, 1
s_mul_i32 s42, s42, 640
s_add_u32 s41, s41, s42
s_mul_i32 s42, s37, 20480
s_mul_i32 s43, s24, 5120
s_add_u32 s42, s42, s43
s_add_u32 s42, s42, 98304
s_add_u32 s36, s36, 1
s_add_u32 s37, s37, 1
s_cmp_eq_u32 s37, 3
s_cselect_b32 s37, 0, s37
s_mov_b32 m0, s42
s_add_u32 s42, s42, 1024
buffer_load_dwordx4 v7, s[8:11], s41 offen lds
s_add_u32 s41, s41, 128
s_mov_b32 m0, s42
s_add_u32 s42, s42, 1024
buffer_load_dwordx4 v7, s[8:11], s41 offen lds
s_add_u32 s41, s41, 128
s_mov_b32 m0, s42
s_add_u32 s42, s42, 1024
buffer_load_dwordx4 v7, s[8:11], s41 offen lds
s_add_u32 s41, s41, 128
s_mov_b32 m0, s42
s_add_u32 s42, s42, 1024
buffer_load_dwordx4 v7, s[8:11], s41 offen lds
s_add_u32 s41, s41, 128
v_lshrrev_b32 v8, 3, v0
s_lshl_b32 s35, s24, 3
v_add_u32 v7, s35, v8
v_mul_u32_u24 v7, 1280, v7
v_and_b32 v9, 7, v0
v_xor_b32 v9, v9, v8
v_lshl_add_u32 v7, v9, 4, v7
v_and_b32 v8, 7, v2
v_xor_b32 v9, v3, v8
v_lshlrev_b32 v9, 4, v9
v_lshl_add_u32 v9, v8, 7, v9
v_lshrrev_b32 v8, 3, v2
v_mul_u32_u24 v8, 5120, v8
v_add_u32 v10, v8, v9
v_xor_b32 v11, 64, v10
s_waitcnt vmcnt(0)
s_barrier
v_add_u32 v4, s44, v10
v_add_u32 v12, s44, v11
ds_read_b128 v[56:59], v4 offset:0
ds_read_b128 v[60:63], v4 offset:10240
ds_read_b128 v[64:67], v12 offset:0
ds_read_b128 v[68:71], v12 offset:10240
B1vloop:
s_waitcnt lgkmcnt(2)
v_mfma_f32_16x16x32_bf16 v[16:19], v[56:59], a[0:3], 0
s_mov_b32 m0, s42
s_add_u32 s42, s42, 1024
v_mfma_f32_16x16x32_bf16 v[20:23], v[60:63], a[0:3], 0
buffer_load_dwordx4 v7, s[8:11], s41 offen lds
s_add_u32 s41, s41, 128
v_mfma_f32_16x16x32_bf16 v[24:27], v[56:59], a[4:7], 0
v_mfma_f32_16x16x32_bf16 v[28:31], v[60:63], a[4:7], 0
s_mul_i32 s52, s47, s56
s_add_u32 s52, s52, s45
ds_read_b128 v[88:91], v108 offset:0
ds_read_b128 v[92:95], v108 offset:1024
v_mfma_f32_16x16x32_bf16 v[32:35], v[56:59], a[8:11], 0
v_mfma_f32_16x16x32_bf16 v[36:39], v[60:63], a[8:11], 0
v_mfma_f32_16x16x32_bf16 v[40:43], v[56:59], a[12:15], 0
ds_read_b128 v[72:75], v4 offset:1024
v_mfma_f32_16x16x32_bf16 v[44:47], v[60:63], a[12:15], 0
ds_read_b128 v[76:79], v4 offset:11264
v_mfma_f32_16x16x32_bf16 v[48:51], v[56:59], a[16:19], 0
v_mfma_f32_16x16x32_bf16 v[52:55], v[60:63], a[16:19], 0
s_waitcnt lgkmcnt(4)
v_mfma_f32_16x16x32_bf16 v[16:19], v[64:67], a[20:23], v[16:19]
v_mfma_f32_16x16x32_bf16 v[20:23], v[68:71], a[20:23], v[20:23]
v_mfma_f32_16x16x32_bf16 v[24:27], v[64:67], a[24:27], v[24:27]
v_mfma_f32_16x16x32_bf16 v[28:31], v[68:71], a[24:27], v[28:31]
s_waitcnt lgkmcnt(3)
buffer_store_dwordx4 v[88:91], v102, s[48:51], s52 offen sc1
s_nop 0
ds_read_b128 v[88:91], v108 offset:2048
v_mfma_f32_16x16x32_bf16 v[32:35], v[64:67], a[28:31], v[32:35]
v_mfma_f32_16x16x32_bf16 v[36:39], v[68:71], a[28:31], v[36:39]
v_mfma_f32_16x16x32_bf16 v[40:43], v[64:67], a[32:35], v[40:43]
ds_read_b128 v[80:83], v12 offset:1024
v_mfma_f32_16x16x32_bf16 v[44:47], v[68:71], a[32:35], v[44:47]
ds_read_b128 v[84:87], v12 offset:11264
v_mfma_f32_16x16x32_bf16 v[48:51], v[64:67], a[36:39], v[48:51]
v_mfma_f32_16x16x32_bf16 v[52:55], v[68:71], a[36:39], v[52:55]
s_waitcnt lgkmcnt(3)
v_mfma_f32_16x16x32_bf16 v[16:19], v[72:75], a[40:43], v[16:19]
v_mfma_f32_16x16x32_bf16 v[20:23], v[76:79], a[40:43], v[20:23]
v_mfma_f32_16x16x32_bf16 v[24:27], v[72:75], a[44:47], v[24:27]
v_mfma_f32_16x16x32_bf16 v[28:31], v[76:79], a[44:47], v[28:31]
buffer_store_dwordx4 v[92:95], v103, s[48:51], s52 offen sc1
s_nop 0
ds_read_b128 v[92:95], v108 offset:3072
v_mfma_f32_16x16x32_bf16 v[32:35], v[72:75], a[48:51], v[32:35]
v_mfma_f32_16x16x32_bf16 v[36:39], v[76:79], a[48:51], v[36:39]
v_mfma_f32_16x16x32_bf16 v[40:43], v[72:75], a[52:55], v[40:43]
ds_read_b128 v[56:59], v4 offset:2048
v_mfma_f32_16x16x32_bf16 v[44:47], v[76:79], a[52:55], v[44:47]
ds_read_b128 v[60:63], v4 offset:12288
v_mfma_f32_16x16x32_bf16 v[48:51], v[72:75], a[56:59], v[48:51]
v_mfma_f32_16x16x32_bf16 v[52:55], v[76:79], a[56:59], v[52:55]
s_waitcnt lgkmcnt(3)
v_mfma_f32_16x16x32_bf16 v[16:19], v[80:83], a[60:63], v[16:19]
v_mfma_f32_16x16x32_bf16 v[20:23], v[84:87], a[60:63], v[20:23]
v_mfma_f32_16x16x32_bf16 v[24:27], v[80:83], a[64:67], v[24:27]
v_mfma_f32_16x16x32_bf16 v[28:31], v[84:87], a[64:67], v[28:31]
buffer_store_dwordx4 v[88:91], v104, s[48:51], s52 offen sc1
s_nop 0
ds_read_b128 v[88:91], v108 offset:4096
v_mfma_f32_16x16x32_bf16 v[32:35], v[80:83], a[68:71], v[32:35]
v_mfma_f32_16x16x32_bf16 v[36:39], v[84:87], a[68:71], v[36:39]
v_mfma_f32_16x16x32_bf16 v[40:43], v[80:83], a[72:75], v[40:43]
ds_read_b128 v[64:67], v12 offset:2048
v_mfma_f32_16x16x32_bf16 v[44:47], v[84:87], a[72:75], v[44:47]
ds_read_b128 v[68:71], v12 offset:12288
v_mfma_f32_16x16x32_bf16 v[48:51], v[80:83], a[76:79], v[48:51]
v_mfma_f32_16x16x32_bf16 v[52:55], v[84:87], a[76:79], v[52:55]
s_waitcnt lgkmcnt(3)
v_mfma_f32_16x16x32_bf16 v[16:19], v[56:59], a[80:83], v[16:19]
v_mfma_f32_16x16x32_bf16 v[20:23], v[60:63], a[80:83], v[20:23]
v_mfma_f32_16x16x32_bf16 v[24:27], v[56:59], a[84:87], v[24:27]
v_mfma_f32_16x16x32_bf16 v[28:31], v[60:63], a[84:87], v[28:31]
buffer_store_dwordx4 v[92:95], v105, s[48:51], s52 offen sc1
s_nop 0
ds_read_b128 v[92:95], v108 offset:5120
v_mfma_f32_16x16x32_bf16 v[32:35], v[56:59], a[88:91], v[32:35]
v_mfma_f32_16x16x32_bf16 v[36:39], v[60:63], a[88:91], v[36:39]
v_mfma_f32_16x16x32_bf16 v[40:43], v[56:59], a[92:95], v[40:43]
ds_read_b128 v[72:75], v4 offset:3072
v_mfma_f32_16x16x32_bf16 v[44:47], v[60:63], a[92:95], v[44:47]
ds_read_b128 v[76:79], v4 offset:13312
v_mfma_f32_16x16x32_bf16 v[48:51], v[56:59], a[96:99], v[48:51]
v_mfma_f32_16x16x32_bf16 v[52:55], v[60:63], a[96:99], v[52:55]
s_waitcnt lgkmcnt(3)
v_mfma_f32_16x16x32_bf16 v[16:19], v[64:67], a[100:103], v[16:19]
v_mfma_f32_16x16x32_bf16 v[20:23], v[68:71], a[100:103], v[20:23]
v_mfma_f32_16x16x32_bf16 v[24:27], v[64:67], a[104:107], v[24:27]
v_mfma_f32_16x16x32_bf16 v[28:31], v[68:71], a[104:107], v[28:31]
buffer_store_dwordx4 v[88:91], v106, s[48:51], s52 offen sc1
v_mfma_f32_16x16x32_bf16 v[32:35], v[64:67], a[108:111], v[32:35]
v_mfma_f32_16x16x32_bf16 v[36:39], v[68:71], a[108:111], v[36:39]
v_mfma_f32_16x16x32_bf16 v[40:43], v[64:67], a[112:115], v[40:43]
ds_read_b128 v[80:83], v12 offset:3072
v_mfma_f32_16x16x32_bf16 v[44:47], v[68:71], a[112:115], v[44:47]
ds_read_b128 v[84:87], v12 offset:13312
v_mfma_f32_16x16x32_bf16 v[48:51], v[64:67], a[116:119], v[48:51]
v_mfma_f32_16x16x32_bf16 v[52:55], v[68:71], a[116:119], v[52:55]
s_waitcnt lgkmcnt(2)
v_mfma_f32_16x16x32_bf16 v[16:19], v[72:75], a[120:123], v[16:19]
v_mfma_f32_16x16x32_bf16 v[20:23], v[76:79], a[120:123], v[20:23]
v_mfma_f32_16x16x32_bf16 v[24:27], v[72:75], a[124:127], v[24:27]
v_mfma_f32_16x16x32_bf16 v[28:31], v[76:79], a[124:127], v[28:31]
buffer_store_dwordx4 v[92:95], v107, s[48:51], s52 offen sc1
v_mfma_f32_16x16x32_bf16 v[32:35], v[72:75], a[128:131], v[32:35]
v_mfma_f32_16x16x32_bf16 v[36:39], v[76:79], a[128:131], v[36:39]
v_mfma_f32_16x16x32_bf16 v[40:43], v[72:75], a[132:135], v[40:43]
ds_read_b128 v[56:59], v4 offset:4096
v_mfma_f32_16x16x32_bf16 v[44:47], v[76:79], a[132:135], v[44:47]
ds_read_b128 v[60:63], v4 offset:14336
v_mfma_f32_16x16x32_bf16 v[48:51], v[72:75], a[136:139], v[48:51]
v_mfma_f32_16x16x32_bf16 v[52:55], v[76:79], a[136:139], v[52:55]
s_waitcnt vmcnt(6)
s_barrier
s_waitcnt lgkmcnt(2)
v_mfma_f32_16x16x32_bf16 v[16:19], v[80:83], a[140:143], v[16:19]
s_add_u32 s44, s44, 20480
s_cmp_eq_u32 s44, 159744
v_mfma_f32_16x16x32_bf16 v[20:23], v[84:87], a[140:143], v[20:23]
s_cselect_b32 s44, 98304, s44
v_add_u32 v9, s44, v10
v_mfma_f32_16x16x32_bf16 v[24:27], v[80:83], a[144:147], v[24:27]
v_add_u32 v13, s44, v11
s_min_u32 s41, s36, 31
v_mfma_f32_16x16x32_bf16 v[28:31], v[84:87], a[144:147], v[28:31]
s_lshr_b32 s41, s41, 1
s_mul_i32 s41, s41, s33
v_mfma_f32_16x16x32_bf16 v[32:35], v[80:83], a[148:151], v[32:35]
s_add_u32 s41, s41, s32
s_mul_i32 s41, s41, 40960
v_mfma_f32_16x16x32_bf16 v[36:39], v[84:87], a[148:151], v[36:39]
s_and_b32 s42, s36, 1
s_mul_i32 s42, s42, 640
v_mfma_f32_16x16x32_bf16 v[40:43], v[80:83], a[152:155], v[40:43]
ds_read_b128 v[64:67], v12 offset:4096
s_add_u32 s41, s41, s42
v_mfma_f32_16x16x32_bf16 v[44:47], v[84:87], a[152:155], v[44:47]
ds_read_b128 v[68:71], v12 offset:14336
s_mul_i32 s42, s37, 20480
v_mfma_f32_16x16x32_bf16 v[48:51], v[80:83], a[156:159], v[48:51]
s_mul_i32 s43, s24, 5120
s_add_u32 s42, s42, s43
v_mfma_f32_16x16x32_bf16 v[52:55], v[84:87], a[156:159], v[52:55]
s_add_u32 s42, s42, 98304
s_add_u32 s36, s36, 1
s_waitcnt lgkmcnt(2)
v_mfma_f32_16x16x32_bf16 v[16:19], v[56:59], a[160:163], v[16:19]
s_add_u32 s37, s37, 1
s_cmp_eq_u32 s37, 3
v_mfma_f32_16x16x32_bf16 v[20:23], v[60:63], a[160:163], v[20:23]
s_cselect_b32 s37, 0, s37
s_mov_b32 m0, s42
v_mfma_f32_16x16x32_bf16 v[24:27], v[56:59], a[164:167], v[24:27]
s_add_u32 s42, s42, 1024
buffer_load_dwordx4 v7, s[8:11], s41 offen lds
v_mfma_f32_16x16x32_bf16 v[28:31], v[60:63], a[164:167], v[28:31]
s_add_u32 s41, s41, 128
s_mov_b32 m0, s42
v_mfma_f32_16x16x32_bf16 v[32:35], v[56:59], a[168:171], v[32:35]
s_add_u32 s42, s42, 1024
buffer_load_dwordx4 v7, s[8:11], s41 offen lds
v_mfma_f32_16x16x32_bf16 v[36:39], v[60:63], a[168:171], v[36:39]
s_add_u32 s41, s41, 128
s_mov_b32 m0, s42
v_mfma_f32_16x16x32_bf16 v[40:43], v[56:59], a[172:175], v[40:43]
ds_read_b128 v[72:75], v9 offset:0
s_add_u32 s42, s42, 1024
v_mfma_f32_16x16x32_bf16 v[44:47], v[60:63], a[172:175], v[44:47]
ds_read_b128 v[76:79], v9 offset:10240
buffer_load_dwordx4 v7, s[8:11], s41 offen lds
v_mfma_f32_16x16x32_bf16 v[48:51], v[56:59], a[176:179], v[48:51]
s_add_u32 s41, s41, 128
s_mov_b32 m0, s42
v_mfma_f32_16x16x32_bf16 v[52:55], v[60:63], a[176:179], v[52:55]
s_add_u32 s42, s42, 1024
buffer_load_dwordx4 v7, s[8:11], s41 offen lds
s_waitcnt lgkmcnt(2)
v_mfma_f32_16x16x32_bf16 v[16:19], v[64:67], a[180:183], v[16:19]
s_add_u32 s41, s41, 128
s_mov_b32 m0, s42
v_mfma_f32_16x16x32_bf16 v[20:23], v[68:71], a[180:183], v[20:23]
s_add_u32 s42, s42, 1024
buffer_load_dwordx4 v7, s[8:11], s41 offen lds
v_mfma_f32_16x16x32_bf16 v[24:27], v[64:67], a[184:187], v[24:27]
s_add_u32 s41, s41, 128
v_mfma_f32_16x16x32_bf16 v[28:31], v[68:71], a[184:187], v[28:31]
v_mfma_f32_16x16x32_bf16 v[32:35], v[64:67], a[188:191], v[32:35]
v_mfma_f32_16x16x32_bf16 v[36:39], v[68:71], a[188:191], v[36:39]
v_mfma_f32_16x16x32_bf16 v[40:43], v[64:67], a[192:195], v[40:43]
ds_read_b128 v[80:83], v13 offset:0
v_mfma_f32_16x16x32_bf16 v[44:47], v[68:71], a[192:195], v[44:47]
ds_read_b128 v[84:87], v13 offset:10240
v_mfma_f32_16x16x32_bf16 v[48:51], v[64:67], a[196:199], v[48:51]
v_mfma_f32_16x16x32_bf16 v[52:55], v[68:71], a[196:199], v[52:55]
v_mov_b32 v4, v9
v_mov_b32 v12, v13
s_waitcnt lgkmcnt(2)
v_mfma_f32_16x16x32_bf16 v[16:19], v[72:75], a[200:203], v[16:19]
v_mfma_f32_16x16x32_bf16 v[20:23], v[76:79], a[200:203], v[20:23]
v_mfma_f32_16x16x32_bf16 v[24:27], v[72:75], a[204:207], v[24:27]
v_mfma_f32_16x16x32_bf16 v[28:31], v[76:79], a[204:207], v[28:31]
v_mfma_f32_16x16x32_bf16 v[32:35], v[72:75], a[208:211], v[32:35]
v_mfma_f32_16x16x32_bf16 v[36:39], v[76:79], a[208:211], v[36:39]
v_mfma_f32_16x16x32_bf16 v[40:43], v[72:75], a[212:215], v[40:43]
ds_read_b128 v[56:59], v4 offset:1024
v_mfma_f32_16x16x32_bf16 v[44:47], v[76:79], a[212:215], v[44:47]
ds_read_b128 v[60:63], v4 offset:11264
v_mfma_f32_16x16x32_bf16 v[48:51], v[72:75], a[216:219], v[48:51]
v_mfma_f32_16x16x32_bf16 v[52:55], v[76:79], a[216:219], v[52:55]
s_waitcnt lgkmcnt(2)
v_mfma_f32_16x16x32_bf16 v[16:19], v[80:83], a[220:223], v[16:19]
v_mfma_f32_16x16x32_bf16 v[20:23], v[84:87], a[220:223], v[20:23]
v_mfma_f32_16x16x32_bf16 v[24:27], v[80:83], a[224:227], v[24:27]
v_mfma_f32_16x16x32_bf16 v[28:31], v[84:87], a[224:227], v[28:31]
v_mfma_f32_16x16x32_bf16 v[32:35], v[80:83], a[228:231], v[32:35]
v_mfma_f32_16x16x32_bf16 v[36:39], v[84:87], a[228:231], v[36:39]
v_mfma_f32_16x16x32_bf16 v[40:43], v[80:83], a[232:235], v[40:43]
ds_read_b128 v[64:67], v12 offset:1024
v_mfma_f32_16x16x32_bf16 v[44:47], v[84:87], a[232:235], v[44:47]
ds_read_b128 v[68:71], v12 offset:11264
v_mfma_f32_16x16x32_bf16 v[48:51], v[80:83], a[236:239], v[48:51]
v_mfma_f32_16x16x32_bf16 v[52:55], v[84:87], a[236:239], v[52:55]
s_waitcnt lgkmcnt(2)
v_mfma_f32_16x16x32_bf16 v[16:19], v[56:59], a[240:243], v[16:19]
v_mfma_f32_16x16x32_bf16 v[20:23], v[60:63], a[240:243], v[20:23]
v_mfma_f32_16x16x32_bf16 v[24:27], v[56:59], a[244:247], v[24:27]
v_mfma_f32_16x16x32_bf16 v[28:31], v[60:63], a[244:247], v[28:31]
v_mfma_f32_16x16x32_bf16 v[32:35], v[56:59], a[248:251], v[32:35]
v_mfma_f32_16x16x32_bf16 v[36:39], v[60:63], a[248:251], v[36:39]
v_mfma_f32_16x16x32_bf16 v[40:43], v[56:59], a[252:255], v[40:43]
ds_read_b128 v[72:75], v4 offset:2048
v_mfma_f32_16x16x32_bf16 v[44:47], v[60:63], a[252:255], v[44:47]
ds_read_b128 v[76:79], v4 offset:12288
v_mfma_f32_16x16x32_bf16 v[48:51], v[56:59], v[112:115], v[48:51]
v_mfma_f32_16x16x32_bf16 v[52:55], v[60:63], v[112:115], v[52:55]
s_waitcnt lgkmcnt(2)
v_mfma_f32_16x16x32_bf16 v[16:19], v[64:67], v[116:119], v[16:19]
v_mfma_f32_16x16x32_bf16 v[20:23], v[68:71], v[116:119], v[20:23]
v_mfma_f32_16x16x32_bf16 v[24:27], v[64:67], v[120:123], v[24:27]
v_mfma_f32_16x16x32_bf16 v[28:31], v[68:71], v[120:123], v[28:31]
v_mfma_f32_16x16x32_bf16 v[32:35], v[64:67], v[124:127], v[32:35]
v_mfma_f32_16x16x32_bf16 v[36:39], v[68:71], v[124:127], v[36:39]
v_mfma_f32_16x16x32_bf16 v[40:43], v[64:67], v[128:131], v[40:43]
ds_read_b128 v[80:83], v12 offset:2048
v_mfma_f32_16x16x32_bf16 v[44:47], v[68:71], v[128:131], v[44:47]
ds_read_b128 v[84:87], v12 offset:12288
v_mfma_f32_16x16x32_bf16 v[48:51], v[64:67], v[132:135], v[48:51]
v_mfma_f32_16x16x32_bf16 v[52:55], v[68:71], v[132:135], v[52:55]
s_waitcnt lgkmcnt(2)
v_mfma_f32_16x16x32_bf16 v[16:19], v[72:75], v[136:139], v[16:19]
v_mfma_f32_16x16x32_bf16 v[20:23], v[76:79], v[136:139], v[20:23]
v_mfma_f32_16x16x32_bf16 v[24:27], v[72:75], v[140:143], v[24:27]
v_mfma_f32_16x16x32_bf16 v[28:31], v[76:79], v[140:143], v[28:31]
v_mfma_f32_16x16x32_bf16 v[32:35], v[72:75], v[144:147], v[32:35]
v_mfma_f32_16x16x32_bf16 v[36:39], v[76:79], v[144:147], v[36:39]
v_mfma_f32_16x16x32_bf16 v[40:43], v[72:75], v[148:151], v[40:43]
ds_read_b128 v[56:59], v4 offset:3072
v_mfma_f32_16x16x32_bf16 v[44:47], v[76:79], v[148:151], v[44:47]
ds_read_b128 v[60:63], v4 offset:13312
v_mfma_f32_16x16x32_bf16 v[48:51], v[72:75], v[152:155], v[48:51]
v_mfma_f32_16x16x32_bf16 v[52:55], v[76:79], v[152:155], v[52:55]
s_waitcnt lgkmcnt(2)
v_mfma_f32_16x16x32_bf16 v[16:19], v[80:83], v[156:159], v[16:19]
v_mfma_f32_16x16x32_bf16 v[20:23], v[84:87], v[156:159], v[20:23]
v_mfma_f32_16x16x32_bf16 v[24:27], v[80:83], v[160:163], v[24:27]
v_mfma_f32_16x16x32_bf16 v[28:31], v[84:87], v[160:163], v[28:31]
v_mfma_f32_16x16x32_bf16 v[32:35], v[80:83], v[164:167], v[32:35]
v_mfma_f32_16x16x32_bf16 v[36:39], v[84:87], v[164:167], v[36:39]
v_mfma_f32_16x16x32_bf16 v[40:43], v[80:83], v[168:171], v[40:43]
ds_read_b128 v[64:67], v12 offset:3072
v_mfma_f32_16x16x32_bf16 v[44:47], v[84:87], v[168:171], v[44:47]
ds_read_b128 v[68:71], v12 offset:13312
v_mfma_f32_16x16x32_bf16 v[48:51], v[80:83], v[172:175], v[48:51]
v_mfma_f32_16x16x32_bf16 v[52:55], v[84:87], v[172:175], v[52:55]
s_waitcnt lgkmcnt(2)
v_mfma_f32_16x16x32_bf16 v[16:19], v[56:59], v[176:179], v[16:19]
v_mfma_f32_16x16x32_bf16 v[20:23], v[60:63], v[176:179], v[20:23]
v_mfma_f32_16x16x32_bf16 v[24:27], v[56:59], v[180:183], v[24:27]
v_mfma_f32_16x16x32_bf16 v[28:31], v[60:63], v[180:183], v[28:31]
v_mfma_f32_16x16x32_bf16 v[32:35], v[56:59], v[184:187], v[32:35]
v_mfma_f32_16x16x32_bf16 v[36:39], v[60:63], v[184:187], v[36:39]
v_mfma_f32_16x16x32_bf16 v[40:43], v[56:59], v[188:191], v[40:43]
ds_read_b128 v[72:75], v4 offset:4096
v_mfma_f32_16x16x32_bf16 v[44:47], v[60:63], v[188:191], v[44:47]
ds_read_b128 v[76:79], v4 offset:14336
v_mfma_f32_16x16x32_bf16 v[48:51], v[56:59], v[192:195], v[48:51]
v_mfma_f32_16x16x32_bf16 v[52:55], v[60:63], v[192:195], v[52:55]
s_waitcnt vmcnt(0)
s_barrier
s_waitcnt lgkmcnt(2)
v_mfma_f32_16x16x32_bf16 v[16:19], v[64:67], v[196:199], v[16:19]
s_add_u32 s44, s44, 20480
s_cmp_eq_u32 s44, 159744
v_mfma_f32_16x16x32_bf16 v[20:23], v[68:71], v[196:199], v[20:23]
s_cselect_b32 s44, 98304, s44
v_add_u32 v9, s44, v10
v_mfma_f32_16x16x32_bf16 v[24:27], v[64:67], v[200:203], v[24:27]
v_add_u32 v13, s44, v11
s_min_u32 s41, s36, 31
v_mfma_f32_16x16x32_bf16 v[28:31], v[68:71], v[200:203], v[28:31]
s_lshr_b32 s41, s41, 1
s_mul_i32 s41, s41, s33
v_mfma_f32_16x16x32_bf16 v[32:35], v[64:67], v[204:207], v[32:35]
s_add_u32 s41, s41, s32
s_mul_i32 s41, s41, 40960
v_mfma_f32_16x16x32_bf16 v[36:39], v[68:71], v[204:207], v[36:39]
s_and_b32 s42, s36, 1
s_mul_i32 s42, s42, 640
v_mfma_f32_16x16x32_bf16 v[40:43], v[64:67], v[208:211], v[40:43]
ds_read_b128 v[80:83], v12 offset:4096
s_add_u32 s41, s41, s42
v_mfma_f32_16x16x32_bf16 v[44:47], v[68:71], v[208:211], v[44:47]
ds_read_b128 v[84:87], v12 offset:14336
s_mul_i32 s42, s37, 20480
v_mfma_f32_16x16x32_bf16 v[48:51], v[64:67], v[212:215], v[48:51]
s_mul_i32 s43, s24, 5120
s_add_u32 s42, s42, s43
v_mfma_f32_16x16x32_bf16 v[52:55], v[68:71], v[212:215], v[52:55]
s_add_u32 s42, s42, 98304
s_add_u32 s36, s36, 1
s_waitcnt lgkmcnt(2)
v_mfma_f32_16x16x32_bf16 v[16:19], v[72:75], v[216:219], v[16:19]
s_add_u32 s37, s37, 1
s_cmp_eq_u32 s37, 3
v_mfma_f32_16x16x32_bf16 v[20:23], v[76:79], v[216:219], v[20:23]
s_cselect_b32 s37, 0, s37
s_add_u32 s61, s57, s40
v_mfma_f32_16x16x32_bf16 v[24:27], v[72:75], v[220:223], v[24:27]
v_mov_b32 v14, s61
v_mov_b32 v15, 0
v_mfma_f32_16x16x32_bf16 v[28:31], v[76:79], v[220:223], v[28:31]
s_mov_b64 exec, 1
buffer_store_dword v14, v15, s[4:7], s34 offen sc1
s_mov_b64 exec, -1
v_mfma_f32_16x16x32_bf16 v[32:35], v[72:75], v[224:227], v[32:35]
s_mov_b32 m0, s42
s_add_u32 s42, s42, 1024
v_mfma_f32_16x16x32_bf16 v[36:39], v[76:79], v[224:227], v[36:39]
buffer_load_dwordx4 v7, s[8:11], s41 offen lds
s_add_u32 s41, s41, 128
v_mfma_f32_16x16x32_bf16 v[40:43], v[72:75], v[228:231], v[40:43]
ds_read_b128 v[56:59], v9 offset:0
s_mov_b32 m0, s42
v_mfma_f32_16x16x32_bf16 v[44:47], v[76:79], v[228:231], v[44:47]
ds_read_b128 v[60:63], v9 offset:10240
s_add_u32 s42, s42, 1024
v_mfma_f32_16x16x32_bf16 v[48:51], v[72:75], v[232:235], v[48:51]
buffer_load_dwordx4 v7, s[8:11], s41 offen lds
s_add_u32 s41, s41, 128
v_mfma_f32_16x16x32_bf16 v[52:55], v[76:79], v[232:235], v[52:55]
s_mov_b32 m0, s42
s_add_u32 s42, s42, 1024
s_waitcnt lgkmcnt(2)
v_mfma_f32_16x16x32_bf16 v[16:19], v[80:83], v[236:239], v[16:19]
buffer_load_dwordx4 v7, s[8:11], s41 offen lds
s_add_u32 s41, s41, 128
v_mfma_f32_16x16x32_bf16 v[20:23], v[84:87], v[236:239], v[20:23]
s_mov_b32 m0, s42
s_add_u32 s42, s42, 1024
v_mfma_f32_16x16x32_bf16 v[24:27], v[80:83], v[240:243], v[24:27]
buffer_load_dwordx4 v7, s[8:11], s41 offen lds
s_add_u32 s41, s41, 128
v_mfma_f32_16x16x32_bf16 v[28:31], v[84:87], v[240:243], v[28:31]
v_mfma_f32_16x16x32_bf16 v[32:35], v[80:83], v[244:247], v[32:35]
v_mfma_f32_16x16x32_bf16 v[36:39], v[84:87], v[244:247], v[36:39]
v_cvt_pk_bf16_f32 v88, v16, v17
v_cvt_pk_bf16_f32 v89, v18, v19
ds_write_b64 v96, v[88:89] offset:0
v_cvt_pk_bf16_f32 v90, v20, v21
v_cvt_pk_bf16_f32 v91, v22, v23
ds_write_b64 v96, v[90:91] offset:672
v_mfma_f32_16x16x32_bf16 v[40:43], v[80:83], v[248:251], v[40:43]
ds_read_b128 v[64:67], v13 offset:0
v_mfma_f32_16x16x32_bf16 v[44:47], v[84:87], v[248:251], v[44:47]
ds_read_b128 v[68:71], v13 offset:10240
v_cvt_pk_bf16_f32 v92, v24, v25
v_cvt_pk_bf16_f32 v93, v26, v27
ds_write_b64 v97, v[92:93] offset:0
v_cvt_pk_bf16_f32 v94, v28, v29
v_cvt_pk_bf16_f32 v95, v30, v31
ds_write_b64 v97, v[94:95] offset:672
v_mfma_f32_16x16x32_bf16 v[48:51], v[80:83], v[252:255], v[48:51]
v_mfma_f32_16x16x32_bf16 v[52:55], v[84:87], v[252:255], v[52:55]
v_cvt_pk_bf16_f32 v88, v32, v33
v_cvt_pk_bf16_f32 v89, v34, v35
ds_write_b64 v98, v[88:89] offset:0
v_cvt_pk_bf16_f32 v90, v36, v37
v_cvt_pk_bf16_f32 v91, v38, v39
ds_write_b64 v98, v[90:91] offset:672
v_mov_b32 v4, v9
v_mov_b32 v12, v13
B1vtail:
v_cvt_pk_bf16_f32 v92, v40, v41
v_cvt_pk_bf16_f32 v93, v42, v43
ds_write_b64 v99, v[92:93] offset:0
v_cvt_pk_bf16_f32 v94, v44, v45
v_cvt_pk_bf16_f32 v95, v46, v47
ds_write_b64 v99, v[94:95] offset:672
v_cvt_pk_bf16_f32 v88, v48, v49
v_cvt_pk_bf16_f32 v89, v50, v51
ds_write_b64 v100, v[88:89] offset:0
v_cvt_pk_bf16_f32 v90, v52, v53
v_cvt_pk_bf16_f32 v91, v54, v55
ds_write_b64 v100, v[90:91] offset:672
s_add_u32 s40, s40, 1
s_mov_b32 s47, s39
s_add_u32 s39, s39, s33
s_mov_b32 s50, 0x10000000
s_cmp_le_u32 s40, 0
s_cselect_b32 s43, 1, 0
s_cmp_eq_u32 s40, 16
s_cselect_b32 s43, 1, s43
s_cmp_eq_u32 s43, 0
s_cbranch_scc1 xe_6
s_mul_i32 s52, s47, s56
s_add_u32 s52, s52, s45
ds_read_b128 v[88:91], v108 offset:0
ds_read_b128 v[92:95], v108 offset:1024
s_waitcnt lgkmcnt(1)
buffer_store_dwordx4 v[88:91], v102, s[4:7], s52 offen sc1
s_nop 0
ds_read_b128 v[88:91], v108 offset:2048
s_waitcnt lgkmcnt(1)
buffer_store_dwordx4 v[92:95], v103, s[4:7], s52 offen sc1
s_nop 0
ds_read_b128 v[92:95], v108 offset:3072
s_waitcnt lgkmcnt(1)
buffer_store_dwordx4 v[88:91], v104, s[4:7], s52 offen sc1
s_nop 0
ds_read_b128 v[88:91], v108 offset:4096
s_waitcnt lgkmcnt(1)
buffer_store_dwordx4 v[92:95], v105, s[4:7], s52 offen sc1
s_nop 0
ds_read_b128 v[92:95], v108 offset:5120
s_waitcnt lgkmcnt(1)
buffer_store_dwordx4 v[88:91], v106, s[4:7], s52 offen sc1
s_waitcnt lgkmcnt(0)
buffer_store_dwordx4 v[92:95], v107, s[4:7], s52 offen sc1
s_mov_b32 s50, 0
s_waitcnt vmcnt(0)
s_barrier
s_add_u32 s61, s57, s40
v_mov_b32 v14, s61
v_mov_b32 v15, 0
s_mov_b64 exec, 1
buffer_store_dword v14, v15, s[4:7], s34 offen sc1
s_mov_b64 exec, -1
xe_6:
s_cmp_lt_u32 s40, 16
s_cbranch_scc1 B1vloop
s_waitcnt lgkmcnt(0)
s_waitcnt vmcnt(0)
s_branch L_fin
L_T:
s_barrier
s_cmp_lg_u32 s24, 0
s_cbranch_scc1 T_q
v_mov_b32 v180, 1
v_mov_b32 v15, 4
s_mov_b64 exec, 1
buffer_atomic_add v180, v15, s[20:23], 0 offen sc0 sc1
s_mov_b64 exec, -1
s_waitcnt vmcnt(0)
v_mov_b32 v15, 0x14000
s_mov_b64 exec, 1
ds_write_b32 v15, v180 offset:0
s_mov_b64 exec, -1
s_waitcnt lgkmcnt(0)
T_q:
v_min_u32 v13, 23, v0
v_lshlrev_b32 v13, 7, v13
s_mov_b32 s41, 4228096
s_mov_b32 s62, 0
s_add_u32 s61, s57, 16
s_branch T_w_go
T_w:
v_readfirstlane_b32 s60, v14
s_sleep 16
s_cmp_ge_i32 s60, -1
s_cbranch_scc1 T_w_go
s_sleep 48
T_w_go:
s_add_u32 s62, s62, 1
s_mov_b32 s63, 11
s_cmp_gt_u32 s62, 400000
s_cbranch_scc1 L_err
buffer_load_dword v14, v13, s[4:7], s41 offen sc1
s_waitcnt vmcnt(0)
v_subrev_u32 v14, s61, v14
v_cmp_lt_u32 vcc, 64, v14
s_cbranch_vccnz T_w
s_barrier
v_mov_b32 v15, 0x14000
ds_read_b32 v14, v15 offset:0
s_waitcnt lgkmcnt(0)
v_readfirstlane_b32 s25, v14
s_mov_b32 s71, 0
s_cmp_ge_u32 s25, 256
s_cbranch_scc1 L_F
s_mov_b32 s47, 0
s_mov_b32 s33, -1
s_mul_i32 s31, s24, 6144
s_mov_b32 s46, 0x41000000
v_and_b32 v5, 31, v0
v_min_u32 v6, 20, v5
v_lshlrev_b32 v5, 4, v5
v_add_u32 v5, 1024, v5
v_lshrrev_b32 v7, 5, v0
v_mul_u32_u24 v7, 336, v7
v_lshl_add_u32 v6, v6, 4, v7
v_add_u32 v6, 1536, v6
v_mov_b64 v[20:21], 0
v_mov_b64 v[22:23], 0
v_mov_b64 v[28:29], 0
v_mov_b64 v[30:31], 0
s_and_b32 s41, s2, 7
s_lshr_b32 s42, s2, 3
s_and_b32 s26, s42, 7
s_lshr_b32 s42, s42, 3
s_lshl_b32 s42, s42, 2
s_add_u32 s29, s41, s42
s_sub_u32 s29, s29, 4
s_cmp_lt_u32 s41, 4
s_cselect_b32 s29, 64, s29
s_cmp_eq_u32 s29, 64
s_cselect_b32 s75, 1, 63
s_mov_b32 s71, 0
v_and_b32 v12, 31, v0
s_lshl_b32 s41, s24, 4
s_add_u32 s41, s41, 128
v_add_u32 v13, s41, v12
s_lshl_b32 s41, s24, 3
s_add_u32 s42, s41, 176
v_add_u32 v14, s42, v12
v_cmp_gt_u32 vcc, 16, v12
s_nop 1
v_cndmask_b32 v13, v14, v13, vcc
s_add_u32 s42, s41, 8
v_add_u32 v14, s42, v12
v_cmp_gt_u32 vcc, 24, v12
s_nop 1
v_cndmask_b32 v13, v14, v13, vcc
v_lshlrev_b32 v253, 7, v13
v_cndmask_b32_e64 v254, 1, 0, vcc
v_mov_b32 v181, v1
v_mul_u32_u24 v252, 2560, v3
v_lshl_add_u32 v252, v2, 4, v252
v_add_u32 v252, 1024, v252
T_cold:
s_and_b32 s30, s25, 31
s_mul_i32 s30, s30, 196608
s_add_u32 s30, s30, s31
s_add_u32 s30, s30, 221249536
s_mov_b32 s32, s30
s_mov_b32 s37, s31
s_mov_b32 s38, 0
s_mov_b32 m0, s37
s_add_u32 s41, s30, 4096
buffer_load_dwordx4 v1, s[4:7], s30 offen sc1 lds
buffer_load_dwordx4 v1, s[4:7], s30 offen offset:1024 sc1 lds
buffer_load_dwordx4 v1, s[4:7], s30 offen offset:2048 sc1 lds
buffer_load_dwordx4 v1, s[4:7], s30 offen offset:3072 sc1 lds
s_add_u32 m0, s37, 4096
s_add_u32 s30, s30, 24576
buffer_load_dwordx4 v1, s[4:7], s41 offen sc1 lds
buffer_load_dwordx4 v1, s[4:7], s41 offen offset:1024 sc1 lds
s_add_u32 s37, s37, 24576
s_cmp_ge_u32 s37, 73728
s_cselect_b32 s37, s31, s37
s_lshr_b32 s43, s25, 5
s_and_b32 s43, s43, 7
s_lshl_b32 s43, s43, 3
s_lshl_b32 s44, s24, 1
s_add_u32 s43, s43, s44
s_mul_i32 s44, s43, 1536
s_and_b32 s45, s25, 31
s_mul_i32 s45, s45, 98304
s_add_u32 s44, s44, s45
s_add_u32 s44, s44, 227540992
buffer_load_dwordx4 v[16:19], v1, s[4:7], s44 offen offset:0 sc1
s_mov_b32 exec_hi, 0
buffer_load_dwordx4 v[20:23], v1, s[4:7], s44 offen offset:1024 sc1
s_mov_b32 exec_hi, -1
buffer_load_dwordx4 v[24:27], v1, s[4:7], s44 offen offset:1536 sc1
s_mov_b32 exec_hi, 0
buffer_load_dwordx4 v[28:31], v1, s[4:7], s44 offen offset:2560 sc1
s_mov_b32 exec_hi, -1
s_mov_b32 m0, s37
s_add_u32 s41, s30, 4096
buffer_load_dwordx4 v1, s[4:7], s30 offen sc1 lds
buffer_load_dwordx4 v1, s[4:7], s30 offen offset:1024 sc1 lds
buffer_load_dwordx4 v1, s[4:7], s30 offen offset:2048 sc1 lds
buffer_load_dwordx4 v1, s[4:7], s30 offen offset:3072 sc1 lds
s_add_u32 m0, s37, 4096
s_add_u32 s30, s30, 24576
buffer_load_dwordx4 v1, s[4:7], s41 offen sc1 lds
buffer_load_dwordx4 v1, s[4:7], s41 offen offset:1024 sc1 lds
s_add_u32 s37, s37, 24576
s_cmp_ge_u32 s37, 73728
s_cselect_b32 s37, s31, s37
v_mov_b32 v8, v1
v_mov_b32 v9, v5
v_mov_b32 v10, v6
s_waitcnt vmcnt(6)
s_barrier
ds_read_b128 v[144:147], v8 offset:0
ds_read_b128 v[148:151], v9 offset:0
ds_read_b128 v[160:163], v10 offset:0
ds_read_b128 v[164:167], v10 offset:672
s_waitcnt lgkmcnt(0)
T_go:
v_mfma_f32_32x32x16_bf16 v[96:111], v[144:147], v[16:19], 0
v_mfma_f32_32x32x16_bf16 v[96:111], v[148:151], v[20:23], v[96:111]
v_mfma_f32_32x32x16_bf16 v[112:127], v[144:147], v[24:27], 0
v_mfma_f32_32x32x16_bf16 v[112:127], v[148:151], v[28:31], v[112:127]
v_mov_b64 v[64:65], 0
v_mov_b64 v[66:67], 0
v_mov_b64 v[68:69], 0
v_mov_b64 v[70:71], 0
v_mov_b64 v[72:73], 0
v_mov_b64 v[74:75], 0
v_mov_b64 v[76:77], 0
v_mov_b64 v[78:79], 0
v_mov_b64 v[80:81], 0
v_mov_b64 v[82:83], 0
v_mov_b64 v[84:85], 0
v_mov_b64 v[86:87], 0
v_mov_b64 v[88:89], 0
v_mov_b64 v[90:91], 0
v_mov_b64 v[92:93], 0
v_mov_b64 v[94:95], 0
v_mov_b64 v[136:137], 0
v_mov_b64 v[138:139], 0
v_mov_b64 v[140:141], 0
v_mov_b64 v[142:143], 0
v_mov_b64 v[168:169], 0
v_mov_b64 v[170:171], 0
v_mov_b64 v[172:173], 0
v_mov_b64 v[174:175], 0
s_mov_b32 s40, 0
s_cmp_lg_u32 s47, 0
s_cbranch_scc1 T_nf
s_cmp_lg_u32 s24, 0
s_cbranch_scc1 T_nf
v_mov_b32 v180, 0x100
s_sub_u32 s75, s75, 1
s_cmp_eq_u32 s75, 0
s_cbranch_scc1 T_nf
v_mov_b32 v180, 1
v_mov_b32 v15, 4
s_mov_b64 exec, 1
buffer_atomic_add v180, v15, s[20:23], 0 offen sc0 sc1
s_mov_b64 exec, -1
T_nf:
s_mov_b32 s70, 0
s_mov_b32 s74, 2560
s_cmp_lg_u32 s47, 0
s_cbranch_scc1 T_na
s_cmp_ge_u32 s71, 2
s_cbranch_scc1 T_na
s_lshl_b32 s72, s71, 4
s_add_u32 s72, s72, s29
s_cmp_ge_u32 s72, 64
s_cbranch_scc1 T_na
s_and_b32 s41, s72, 1
s_lshl_b32 s41, s41, 13
v_mul_lo_u32 v12, v254, s41
v_add_u32 v12, v12, v253
s_mov_b32 s41, 4194304
buffer_load_dword v14, v12, s[4:7], s41 offen sc1
s_add_u32 s41, s72, 1
s_lshr_b32 s42, s41, 1
v_mul_lo_u32 v13, v254, s42
s_add_u32 s41, s41, s57
v_sub_u32 v13, s41, v13
s_waitcnt vmcnt(0)
v_sub_u32 v14, v14, v13
v_cmp_lt_u32 vcc, 64, v14
s_cbranch_vccnz T_na
s_mov_b32 s70, 1
s_mul_i32 s41, s72, 40
s_mul_i32 s42, s26, 5
s_add_u32 s73, s41, s42
s_lshl_b32 s43, s73, 2
s_add_u32 s43, s43, s24
s_lshl_b32 s64, s43, 14
s_add_u32 s64, s64, 5242880
s_bfe_u32 s61, s64, 0x10015
s_xor_b32 s61, s61, s3
s_lshl_b32 s61, s61, 13
s_add_u32 s64, s64, s61
s_add_u32 s43, s43, 4
s_lshl_b32 s65, s43, 14
s_add_u32 s65, s65, 5242880
s_bfe_u32 s61, s65, 0x10015
s_xor_b32 s61, s61, s3
s_lshl_b32 s61, s61, 13
s_add_u32 s65, s65, s61
s_add_u32 s43, s43, 4
s_lshl_b32 s66, s43, 14
s_add_u32 s66, s66, 5242880
s_bfe_u32 s61, s66, 0x10015
s_xor_b32 s61, s61, s3
s_lshl_b32 s61, s61, 13
s_add_u32 s66, s66, s61
s_add_u32 s43, s43, 4
s_lshl_b32 s67, s43, 14
s_add_u32 s67, s67, 5242880
s_bfe_u32 s61, s67, 0x10015
s_xor_b32 s61, s61, s3
s_lshl_b32 s61, s61, 13
s_add_u32 s67, s67, s61
s_add_u32 s43, s43, 4
s_lshl_b32 s68, s43, 14
s_add_u32 s68, s68, 5242880
s_bfe_u32 s61, s68, 0x10015
s_xor_b32 s61, s61, s3
s_lshl_b32 s61, s61, 13
s_add_u32 s68, s68, s61
s_add_u32 s43, s43, 4
s_lshl_b32 s41, s72, 5
s_lshl_b32 s42, s24, 3
s_add_u32 s41, s41, s42
s_mul_i32 s69, s41, 2560
s_add_u32 s69, s69, 216006656
v_mov_b32 v181, v1
v_mov_b64 v[184:185], 0
v_mov_b64 v[186:187], 0
v_mov_b64 v[188:189], 0
v_mov_b64 v[190:191], 0
v_mov_b64 v[192:193], 0
v_mov_b64 v[194:195], 0
v_mov_b64 v[196:197], 0
v_mov_b64 v[198:199], 0
v_mov_b64 v[200:201], 0
v_mov_b64 v[202:203], 0
v_mov_b64 v[204:205], 0
v_mov_b64 v[206:207], 0
v_mov_b64 v[208:209], 0
v_mov_b64 v[210:211], 0
v_mov_b64 v[212:213], 0
v_mov_b64 v[214:215], 0
v_mov_b64 v[216:217], 0
v_mov_b64 v[218:219], 0
v_mov_b64 v[220:221], 0
v_mov_b64 v[222:223], 0
v_accvgpr_write_b32 a0, 0
v_accvgpr_write_b32 a1, 0
v_accvgpr_write_b32 a2, 0
v_accvgpr_write_b32 a3, 0
v_accvgpr_write_b32 a4, 0
v_accvgpr_write_b32 a5, 0
v_accvgpr_write_b32 a6, 0
v_accvgpr_write_b32 a7, 0
v_accvgpr_write_b32 a8, 0
v_accvgpr_write_b32 a9, 0
v_accvgpr_write_b32 a10, 0
v_accvgpr_write_b32 a11, 0
v_accvgpr_write_b32 a12, 0
v_accvgpr_write_b32 a13, 0
v_accvgpr_write_b32 a14, 0
v_accvgpr_write_b32 a15, 0
v_accvgpr_write_b32 a16, 0
v_accvgpr_write_b32 a17, 0
v_accvgpr_write_b32 a18, 0
v_accvgpr_write_b32 a19, 0
v_accvgpr_write_b32 a20, 0
v_accvgpr_write_b32 a21, 0
v_accvgpr_write_b32 a22, 0
v_accvgpr_write_b32 a23, 0
v_accvgpr_write_b32 a24, 0
v_accvgpr_write_b32 a25, 0
v_accvgpr_write_b32 a26, 0
v_accvgpr_write_b32 a27, 0
v_accvgpr_write_b32 a28, 0
v_accvgpr_write_b32 a29, 0
v_accvgpr_write_b32 a30, 0
v_accvgpr_write_b32 a31, 0
v_accvgpr_write_b32 a32, 0
v_accvgpr_write_b32 a33, 0
v_accvgpr_write_b32 a34, 0
v_accvgpr_write_b32 a35, 0
v_accvgpr_write_b32 a36, 0
v_accvgpr_write_b32 a37, 0
v_accvgpr_write_b32 a38, 0
v_accvgpr_write_b32 a39, 0
v_accvgpr_write_b32 a40, 0
v_accvgpr_write_b32 a41, 0
v_accvgpr_write_b32 a42, 0
v_accvgpr_write_b32 a43, 0
v_accvgpr_write_b32 a44, 0
v_accvgpr_write_b32 a45, 0
v_accvgpr_write_b32 a46, 0
v_accvgpr_write_b32 a47, 0
v_accvgpr_write_b32 a48, 0
v_accvgpr_write_b32 a49, 0
v_accvgpr_write_b32 a50, 0
v_accvgpr_write_b32 a51, 0
v_accvgpr_write_b32 a52, 0
v_accvgpr_write_b32 a53, 0
v_accvgpr_write_b32 a54, 0
v_accvgpr_write_b32 a55, 0
T_na:
s_mov_b32 s48, s4
s_mov_b32 s49, s5
s_mov_b32 s50, 0x10000000
s_mov_b32 s51, 0x20000
v_max3_f32 v176, v96, v97, v98
v_max3_f32 v177, v99, v100, v101
v_max3_f32 v176, v176, v102, v103
v_max3_f32 v177, v177, v104, v105
v_max3_f32 v176, v176, v106, v107
v_max3_f32 v177, v177, v108, v109
v_max3_f32 v176, v176, v110, v111
v_max_f32 v176, v176, v177
v_mov_b32 v177, v176
s_nop 1
v_permlane32_swap_b32 v176, v177
v_max_f32 v176, v176, v177
v_sub_f32 v32, 0, v176
v_sub_f32 v33, 0, v176
v_sub_f32 v34, 0, v176
v_sub_f32 v35, 0, v176
v_sub_f32 v36, 0, v176
v_sub_f32 v37, 0, v176
v_sub_f32 v38, 0, v176
v_sub_f32 v39, 0, v176
v_sub_f32 v40, 0, v176
v_sub_f32 v41, 0, v176
v_sub_f32 v42, 0, v176
v_sub_f32 v43, 0, v176
v_sub_f32 v44, 0, v176
v_sub_f32 v45, 0, v176
v_sub_f32 v46, 0, v176
v_sub_f32 v47, 0, v176
v_max3_f32 v176, v112, v113, v114
v_max3_f32 v177, v115, v116, v117
v_max3_f32 v176, v176, v118, v119
v_max3_f32 v177, v177, v120, v121
v_max3_f32 v176, v176, v122, v123
v_max3_f32 v177, v177, v124, v125
v_max3_f32 v176, v176, v126, v127
v_max_f32 v176, v176, v177
v_mov_b32 v177, v176
s_nop 1
v_permlane32_swap_b32 v176, v177
v_max_f32 v176, v176, v177
v_sub_f32 v48, 0, v176
v_sub_f32 v49, 0, v176
v_sub_f32 v50, 0, v176
v_sub_f32 v51, 0, v176
v_sub_f32 v52, 0, v176
v_sub_f32 v53, 0, v176
v_sub_f32 v54, 0, v176
v_sub_f32 v55, 0, v176
v_sub_f32 v56, 0, v176
v_sub_f32 v57, 0, v176
v_sub_f32 v58, 0, v176
v_sub_f32 v59, 0, v176
v_sub_f32 v60, 0, v176
v_sub_f32 v61, 0, v176
v_sub_f32 v62, 0, v176
v_sub_f32 v63, 0, v176
v_mfma_f32_32x32x16_bf16 v[96:111], v[144:147], v[16:19], v[32:47]
v_mfma_f32_32x32x16_bf16 v[96:111], v[148:151], v[20:23], v[96:111]
s_nop 7
s_nop 3
s_cmp_lg_u32 s47, 0
s_cbranch_scc1 T_safe
s_cmp_eq_u32 s70, 0
s_cbranch_scc1 T_fast
T_fa:
s_cmp_lg_u32 s40, 4
s_cbranch_scc1 Ta_p
s_add_u32 s43, s73, 10240
s_lshl_b32 s42, s24, 11
s_lshl_b32 s64, s43, 14
s_add_u32 s64, s64, 5242880
s_bfe_u32 s61, s64, 0x10015
s_xor_b32 s61, s61, s3
s_lshl_b32 s61, s61, 13
s_add_u32 s64, s64, s61
s_add_u32 s64, s64, s42
s_add_u32 s43, s43, 1
s_lshl_b32 s65, s43, 14
s_add_u32 s65, s65, 5242880
s_bfe_u32 s61, s65, 0x10015
s_xor_b32 s61, s61, s3
s_lshl_b32 s61, s61, 13
s_add_u32 s65, s65, s61
s_add_u32 s65, s65, s42
s_add_u32 s43, s43, 1
s_lshl_b32 s66, s43, 14
s_add_u32 s66, s66, 5242880
s_bfe_u32 s61, s66, 0x10015
s_xor_b32 s61, s61, s3
s_lshl_b32 s61, s61, 13
s_add_u32 s66, s66, s61
s_add_u32 s66, s66, s42
s_add_u32 s43, s43, 1
s_lshl_b32 s67, s43, 14
s_add_u32 s67, s67, 5242880
s_bfe_u32 s61, s67, 0x10015
s_xor_b32 s61, s61, s3
s_lshl_b32 s61, s61, 13
s_add_u32 s67, s67, s61
s_add_u32 s67, s67, s42
s_add_u32 s43, s43, 1
s_lshl_b32 s68, s43, 14
s_add_u32 s68, s68, 5242880
s_bfe_u32 s61, s68, 0x10015
s_xor_b32 s61, s61, s3
s_lshl_b32 s61, s61, 13
s_add_u32 s68, s68, s61
s_add_u32 s68, s68, s42
s_add_u32 s43, s43, 1
s_sub_u32 s69, s69, 20480
v_mov_b32 v181, v252
s_mov_b32 s74, 10240
Ta_p:
s_cmp_eq_u32 s40, 5
s_cselect_b32 s50, 0, s50
v_mfma_f32_32x32x16_bf16 v[112:127], v[144:147], v[24:27], v[48:63]
v_exp_f32 v96, v96
v_exp_f32 v97, v97
v_exp_f32 v98, v98
v_exp_f32 v99, v99
v_mfma_f32_32x32x16_bf16 v[80:95], v[168:171], v[136:139], v[80:95]
v_exp_f32 v100, v100
v_exp_f32 v101, v101
v_exp_f32 v102, v102
v_exp_f32 v103, v103
v_cvt_pk_bf16_f32 v128, v96, v97
v_mfma_f32_32x32x16_bf16 v[112:127], v[148:151], v[28:31], v[112:127]
v_exp_f32 v104, v104
v_exp_f32 v105, v105
v_exp_f32 v106, v106
v_exp_f32 v107, v107
v_cvt_pk_bf16_f32 v129, v98, v99
v_cvt_pk_bf16_f32 v130, v100, v101
v_mfma_f32_32x32x16_bf16 v[80:95], v[172:175], v[140:143], v[80:95]
ds_read_b128 v[152:155], v8 offset:3072
ds_read_b128 v[156:159], v9 offset:3072
v_exp_f32 v108, v108
v_exp_f32 v109, v109
v_cvt_pk_bf16_f32 v131, v102, v103
v_exp_f32 v110, v110
v_exp_f32 v111, v111
v_cvt_pk_bf16_f32 v132, v104, v105
v_cvt_pk_bf16_f32 v133, v106, v107
v_cvt_pk_bf16_f32 v134, v108, v109
v_cvt_pk_bf16_f32 v135, v110, v111
s_waitcnt lgkmcnt(0)
v_mfma_f32_32x32x16_bf16 v[96:111], v[152:155], v[16:19], v[32:47]
v_exp_f32 v112, v112
v_exp_f32 v113, v113
v_exp_f32 v114, v114
v_exp_f32 v115, v115
v_mfma_f32_32x32x16_bf16 v[64:79], v[160:163], v[128:131], v[64:79]
v_exp_f32 v116, v116
v_exp_f32 v117, v117
v_exp_f32 v118, v118
v_exp_f32 v119, v119
v_cvt_pk_bf16_f32 v136, v112, v113
v_mfma_f32_32x32x16_bf16 v[96:111], v[156:159], v[20:23], v[96:111]
v_exp_f32 v120, v120
v_exp_f32 v121, v121
v_exp_f32 v122, v122
v_exp_f32 v123, v123
v_cvt_pk_bf16_f32 v137, v114, v115
v_cvt_pk_bf16_f32 v138, v116, v117
v_mfma_f32_32x32x16_bf16 v[64:79], v[164:167], v[132:135], v[64:79]
ds_read_b128 v[168:171], v10 offset:3072
ds_read_b128 v[172:175], v10 offset:3744
v_exp_f32 v124, v124
v_exp_f32 v125, v125
v_cvt_pk_bf16_f32 v139, v118, v119
v_exp_f32 v126, v126
v_exp_f32 v127, v127
v_cvt_pk_bf16_f32 v140, v120, v121
v_cvt_pk_bf16_f32 v141, v122, v123
v_cvt_pk_bf16_f32 v142, v124, v125
v_cvt_pk_bf16_f32 v143, v126, v127
s_waitcnt vmcnt(13)
v_mfma_f32_32x32x16_bf16 v[112:127], v[152:155], v[24:27], v[48:63]
v_exp_f32 v96, v96
v_exp_f32 v97, v97
v_exp_f32 v98, v98
v_exp_f32 v99, v99
v_mfma_f32_32x32x16_bf16 v[80:95], v[160:163], v[136:139], v[80:95]
v_exp_f32 v100, v100
v_exp_f32 v101, v101
v_exp_f32 v102, v102
v_exp_f32 v103, v103
v_cvt_pk_bf16_f32 v128, v96, v97
v_mfma_f32_32x32x16_bf16 v[112:127], v[156:159], v[28:31], v[112:127]
v_exp_f32 v104, v104
v_exp_f32 v105, v105
v_exp_f32 v106, v106
v_mfma_f32_16x16x32_bf16 v[184:187], a[0:3], a[20:23], v[184:187]
v_exp_f32 v107, v107
v_cvt_pk_bf16_f32 v129, v98, v99
v_cvt_pk_bf16_f32 v130, v100, v101
v_mfma_f32_32x32x16_bf16 v[80:95], v[164:167], v[140:143], v[80:95]
ds_read_b128 v[144:147], v8 offset:6144
ds_read_b128 v[148:151], v9 offset:6144
v_exp_f32 v108, v108
v_exp_f32 v109, v109
v_cvt_pk_bf16_f32 v131, v102, v103
v_mfma_f32_16x16x32_bf16 v[188:191], a[0:3], a[24:27], v[188:191]
v_exp_f32 v110, v110
v_exp_f32 v111, v111
v_mfma_f32_16x16x32_bf16 v[192:195], a[4:7], a[20:23], v[192:195]
v_cvt_pk_bf16_f32 v132, v104, v105
v_cvt_pk_bf16_f32 v133, v106, v107
v_cvt_pk_bf16_f32 v134, v108, v109
v_cvt_pk_bf16_f32 v135, v110, v111
s_waitcnt lgkmcnt(0)
v_mfma_f32_32x32x16_bf16 v[96:111], v[144:147], v[16:19], v[32:47]
v_exp_f32 v112, v112
v_exp_f32 v113, v113
v_exp_f32 v114, v114
v_exp_f32 v115, v115
v_mfma_f32_32x32x16_bf16 v[64:79], v[168:171], v[128:131], v[64:79]
v_exp_f32 v116, v116
v_exp_f32 v117, v117
v_exp_f32 v118, v118
v_exp_f32 v119, v119
v_cvt_pk_bf16_f32 v136, v112, v113
v_mfma_f32_32x32x16_bf16 v[96:111], v[148:151], v[20:23], v[96:111]
v_exp_f32 v120, v120
v_exp_f32 v121, v121
v_exp_f32 v122, v122
v_mfma_f32_16x16x32_bf16 v[196:199], a[4:7], a[24:27], v[196:199]
v_exp_f32 v123, v123
v_cvt_pk_bf16_f32 v137, v114, v115
v_cvt_pk_bf16_f32 v138, v116, v117
v_mfma_f32_32x32x16_bf16 v[64:79], v[172:175], v[132:135], v[64:79]
ds_read_b128 v[160:163], v10 offset:6144
ds_read_b128 v[164:167], v10 offset:6816
v_exp_f32 v124, v124
v_exp_f32 v125, v125
v_cvt_pk_bf16_f32 v139, v118, v119
v_mfma_f32_16x16x32_bf16 v[200:203], a[8:11], a[20:23], v[200:203]
v_exp_f32 v126, v126
v_exp_f32 v127, v127
v_mfma_f32_16x16x32_bf16 v[204:207], a[8:11], a[24:27], v[204:207]
v_cvt_pk_bf16_f32 v140, v120, v121
v_cvt_pk_bf16_f32 v141, v122, v123
v_cvt_pk_bf16_f32 v142, v124, v125
v_cvt_pk_bf16_f32 v143, v126, v127
v_mfma_f32_32x32x16_bf16 v[112:127], v[144:147], v[24:27], v[48:63]
v_exp_f32 v96, v96
v_exp_f32 v97, v97
v_exp_f32 v98, v98
v_exp_f32 v99, v99
v_mfma_f32_32x32x16_bf16 v[80:95], v[168:171], v[136:139], v[80:95]
v_exp_f32 v100, v100
v_exp_f32 v101, v101
v_exp_f32 v102, v102
v_exp_f32 v103, v103
v_cvt_pk_bf16_f32 v128, v96, v97
v_mfma_f32_32x32x16_bf16 v[112:127], v[148:151], v[28:31], v[112:127]
v_exp_f32 v104, v104
v_exp_f32 v105, v105
v_exp_f32 v106, v106
v_mfma_f32_16x16x32_bf16 v[208:211], a[12:15], a[20:23], v[208:211]
v_exp_f32 v107, v107
v_cvt_pk_bf16_f32 v129, v98, v99
v_cvt_pk_bf16_f32 v130, v100, v101
v_mfma_f32_32x32x16_bf16 v[80:95], v[172:175], v[140:143], v[80:95]
ds_read_b128 v[152:155], v8 offset:9216
ds_read_b128 v[156:159], v9 offset:9216
v_exp_f32 v108, v108
v_exp_f32 v109, v109
v_cvt_pk_bf16_f32 v131, v102, v103
v_mfma_f32_16x16x32_bf16 v[212:215], a[12:15], a[24:27], v[212:215]
v_exp_f32 v110, v110
v_exp_f32 v111, v111
v_mfma_f32_16x16x32_bf16 v[216:219], a[16:19], a[20:23], v[216:219]
v_cvt_pk_bf16_f32 v132, v104, v105
v_cvt_pk_bf16_f32 v133, v106, v107
v_cvt_pk_bf16_f32 v134, v108, v109
v_cvt_pk_bf16_f32 v135, v110, v111
s_waitcnt lgkmcnt(0)
v_mfma_f32_32x32x16_bf16 v[96:111], v[152:155], v[16:19], v[32:47]
v_exp_f32 v112, v112
v_exp_f32 v113, v113
v_exp_f32 v114, v114
v_exp_f32 v115, v115
v_mfma_f32_32x32x16_bf16 v[64:79], v[160:163], v[128:131], v[64:79]
v_exp_f32 v116, v116
v_exp_f32 v117, v117
v_exp_f32 v118, v118
v_exp_f32 v119, v119
v_cvt_pk_bf16_f32 v136, v112, v113
v_mfma_f32_32x32x16_bf16 v[96:111], v[156:159], v[20:23], v[96:111]
v_exp_f32 v120, v120
v_exp_f32 v121, v121
v_exp_f32 v122, v122
v_mfma_f32_16x16x32_bf16 v[220:223], a[16:19], a[24:27], v[220:223]
v_exp_f32 v123, v123
v_cvt_pk_bf16_f32 v137, v114, v115
v_cvt_pk_bf16_f32 v138, v116, v117
v_mfma_f32_32x32x16_bf16 v[64:79], v[164:167], v[132:135], v[64:79]
ds_read_b128 v[168:171], v10 offset:9216
ds_read_b128 v[172:175], v10 offset:9888
v_exp_f32 v124, v124
v_exp_f32 v125, v125
v_cvt_pk_bf16_f32 v139, v118, v119
v_exp_f32 v126, v126
v_exp_f32 v127, v127
buffer_load_dwordx4 a[0:3], v1, s[48:51], s64 offen offset:0 sc1
buffer_load_dwordx4 a[4:7], v1, s[48:51], s65 offen offset:0 sc1
buffer_load_dwordx4 a[8:11], v1, s[48:51], s66 offen offset:0 sc1
buffer_load_dwordx4 a[12:15], v1, s[48:51], s67 offen offset:0 sc1
v_cvt_pk_bf16_f32 v140, v120, v121
v_cvt_pk_bf16_f32 v141, v122, v123
v_cvt_pk_bf16_f32 v142, v124, v125
v_cvt_pk_bf16_f32 v143, v126, v127
v_mfma_f32_32x32x16_bf16 v[112:127], v[152:155], v[24:27], v[48:63]
v_exp_f32 v96, v96
v_exp_f32 v97, v97
v_exp_f32 v98, v98
v_exp_f32 v99, v99
v_mfma_f32_32x32x16_bf16 v[80:95], v[160:163], v[136:139], v[80:95]
v_exp_f32 v100, v100
v_exp_f32 v101, v101
v_exp_f32 v102, v102
v_exp_f32 v103, v103
v_cvt_pk_bf16_f32 v128, v96, v97
v_mfma_f32_32x32x16_bf16 v[112:127], v[156:159], v[28:31], v[112:127]
v_exp_f32 v104, v104
v_exp_f32 v105, v105
v_exp_f32 v106, v106
v_exp_f32 v107, v107
v_cvt_pk_bf16_f32 v129, v98, v99
v_cvt_pk_bf16_f32 v130, v100, v101
v_mfma_f32_32x32x16_bf16 v[80:95], v[164:167], v[140:143], v[80:95]
ds_read_b128 v[144:147], v8 offset:12288
ds_read_b128 v[148:151], v9 offset:12288
v_exp_f32 v108, v108
v_exp_f32 v109, v109
v_cvt_pk_bf16_f32 v131, v102, v103
v_exp_f32 v110, v110
v_exp_f32 v111, v111
buffer_load_dwordx4 a[16:19], v1, s[48:51], s68 offen offset:0 sc1
buffer_load_dwordx4 a[20:23], v181, s[48:51], s69 offen sc1
buffer_load_dwordx4 a[24:27], v181, s[48:51], s69 offen offset:1280 sc1
s_add_u32 s69, s69, s74
v_cvt_pk_bf16_f32 v132, v104, v105
v_cvt_pk_bf16_f32 v133, v106, v107
v_cvt_pk_bf16_f32 v134, v108, v109
v_cvt_pk_bf16_f32 v135, v110, v111
s_waitcnt lgkmcnt(0)
v_mfma_f32_32x32x16_bf16 v[96:111], v[144:147], v[16:19], v[32:47]
v_exp_f32 v112, v112
v_exp_f32 v113, v113
v_exp_f32 v114, v114
v_exp_f32 v115, v115
v_mfma_f32_32x32x16_bf16 v[64:79], v[168:171], v[128:131], v[64:79]
v_exp_f32 v116, v116
v_exp_f32 v117, v117
v_exp_f32 v118, v118
v_exp_f32 v119, v119
v_cvt_pk_bf16_f32 v136, v112, v113
v_mfma_f32_32x32x16_bf16 v[96:111], v[148:151], v[20:23], v[96:111]
v_exp_f32 v120, v120
v_exp_f32 v121, v121
v_exp_f32 v122, v122
v_exp_f32 v123, v123
v_cvt_pk_bf16_f32 v137, v114, v115
v_cvt_pk_bf16_f32 v138, v116, v117
v_mfma_f32_32x32x16_bf16 v[64:79], v[172:175], v[132:135], v[64:79]
ds_read_b128 v[160:163], v10 offset:12288
ds_read_b128 v[164:167], v10 offset:12960
v_exp_f32 v124, v124
v_exp_f32 v125, v125
v_cvt_pk_bf16_f32 v139, v118, v119
v_exp_f32 v126, v126
v_exp_f32 v127, v127
v_cvt_pk_bf16_f32 v140, v120, v121
v_cvt_pk_bf16_f32 v141, v122, v123
v_cvt_pk_bf16_f32 v142, v124, v125
v_cvt_pk_bf16_f32 v143, v126, v127
v_mfma_f32_32x32x16_bf16 v[112:127], v[144:147], v[24:27], v[48:63]
v_exp_f32 v96, v96
v_exp_f32 v97, v97
v_exp_f32 v98, v98
v_exp_f32 v99, v99
v_mfma_f32_32x32x16_bf16 v[80:95], v[168:171], v[136:139], v[80:95]
v_exp_f32 v100, v100
v_exp_f32 v101, v101
v_exp_f32 v102, v102
v_exp_f32 v103, v103
v_cvt_pk_bf16_f32 v128, v96, v97
v_mfma_f32_32x32x16_bf16 v[112:127], v[148:151], v[28:31], v[112:127]
v_exp_f32 v104, v104
v_exp_f32 v105, v105
v_exp_f32 v106, v106
v_exp_f32 v107, v107
v_cvt_pk_bf16_f32 v129, v98, v99
v_cvt_pk_bf16_f32 v130, v100, v101
v_mfma_f32_32x32x16_bf16 v[80:95], v[172:175], v[140:143], v[80:95]
ds_read_b128 v[152:155], v8 offset:15360
ds_read_b128 v[156:159], v9 offset:15360
v_exp_f32 v108, v108
v_exp_f32 v109, v109
v_cvt_pk_bf16_f32 v131, v102, v103
v_exp_f32 v110, v110
v_exp_f32 v111, v111
v_cvt_pk_bf16_f32 v132, v104, v105
v_cvt_pk_bf16_f32 v133, v106, v107
v_cvt_pk_bf16_f32 v134, v108, v109
v_cvt_pk_bf16_f32 v135, v110, v111
s_waitcnt lgkmcnt(0)
v_mfma_f32_32x32x16_bf16 v[96:111], v[152:155], v[16:19], v[32:47]
v_exp_f32 v112, v112
v_exp_f32 v113, v113
v_exp_f32 v114, v114
v_exp_f32 v115, v115
v_mfma_f32_32x32x16_bf16 v[64:79], v[160:163], v[128:131], v[64:79]
v_exp_f32 v116, v116
v_exp_f32 v117, v117
v_exp_f32 v118, v118
v_exp_f32 v119, v119
v_cvt_pk_bf16_f32 v136, v112, v113
v_mfma_f32_32x32x16_bf16 v[96:111], v[156:159], v[20:23], v[96:111]
v_exp_f32 v120, v120
v_exp_f32 v121, v121
v_exp_f32 v122, v122
v_exp_f32 v123, v123
v_cvt_pk_bf16_f32 v137, v114, v115
v_cvt_pk_bf16_f32 v138, v116, v117
v_mfma_f32_32x32x16_bf16 v[64:79], v[164:167], v[132:135], v[64:79]
ds_read_b128 v[168:171], v10 offset:15360
ds_read_b128 v[172:175], v10 offset:16032
v_exp_f32 v124, v124
v_exp_f32 v125, v125
v_cvt_pk_bf16_f32 v139, v118, v119
v_exp_f32 v126, v126
v_exp_f32 v127, v127
v_cvt_pk_bf16_f32 v140, v120, v121
v_cvt_pk_bf16_f32 v141, v122, v123
v_cvt_pk_bf16_f32 v142, v124, v125
v_cvt_pk_bf16_f32 v143, v126, v127
s_waitcnt vmcnt(7)
s_cmp_lg_u32 s40, 1
s_cbranch_scc1 tn_7
s_cmp_lg_u32 s24, 0
s_cbranch_scc1 tn_7
v_mov_b32 v15, 0x14000
s_mov_b64 exec, 1
ds_write_b32 v15, v180 offset:0
s_mov_b64 exec, -1
s_waitcnt lgkmcnt(0)
tn_7:
s_barrier
s_cmp_gt_u32 s40, 1
s_cbranch_scc1 tn_8
s_cmp_eq_u32 s40, 1
s_cbranch_scc1 tn_9
s_cmp_eq_u32 s33, -1
s_cbranch_scc1 tn_8
s_add_u32 s61, s57, 1
v_mov_b32 v14, s61
v_mov_b32 v15, 0
s_mov_b64 exec, 1
buffer_store_dword v14, v15, s[4:7], s33 offen sc1
s_mov_b64 exec, -1
s_branch tn_8
tn_9:
v_mov_b32 v15, 0x14000
ds_read_b32 v14, v15 offset:0
s_waitcnt lgkmcnt(0)
v_readfirstlane_b32 s35, v14
s_and_b32 s32, s35, 31
s_mul_i32 s32, s32, 196608
s_add_u32 s32, s32, s31
s_add_u32 s32, s32, 221249536
tn_8:
s_cmp_eq_u32 s40, 6
s_cselect_b32 s30, s32, s30
s_add_u32 s38, s38, 24576
s_cmp_eq_u32 s38, 73728
s_cselect_b32 s38, 0, s38
v_add_u32 v11, s38, v1
v_add_u32 v12, s38, v5
v_add_u32 v13, s38, v6
v_mfma_f32_32x32x16_bf16 v[112:127], v[152:155], v[24:27], v[48:63]
v_exp_f32 v96, v96
v_exp_f32 v97, v97
v_exp_f32 v98, v98
v_exp_f32 v99, v99
v_mfma_f32_32x32x16_bf16 v[80:95], v[160:163], v[136:139], v[80:95]
v_exp_f32 v100, v100
v_exp_f32 v101, v101
v_exp_f32 v102, v102
v_exp_f32 v103, v103
v_cvt_pk_bf16_f32 v128, v96, v97
v_mfma_f32_32x32x16_bf16 v[112:127], v[156:159], v[28:31], v[112:127]
v_exp_f32 v104, v104
v_exp_f32 v105, v105
v_exp_f32 v106, v106
v_mfma_f32_16x16x32_bf16 v[184:187], a[28:31], a[48:51], v[184:187]
v_exp_f32 v107, v107
v_cvt_pk_bf16_f32 v129, v98, v99
v_cvt_pk_bf16_f32 v130, v100, v101
v_mfma_f32_32x32x16_bf16 v[80:95], v[164:167], v[140:143], v[80:95]
ds_read_b128 v[144:147], v8 offset:18432
ds_read_b128 v[148:151], v9 offset:18432
v_exp_f32 v108, v108
v_exp_f32 v109, v109
v_cvt_pk_bf16_f32 v131, v102, v103
v_mfma_f32_16x16x32_bf16 v[188:191], a[28:31], a[52:55], v[188:191]
v_exp_f32 v110, v110
v_exp_f32 v111, v111
v_mfma_f32_16x16x32_bf16 v[192:195], a[32:35], a[48:51], v[192:195]
s_mov_b32 m0, s37
s_add_u32 s41, s30, 4096
buffer_load_dwordx4 v1, s[4:7], s30 offen sc1 lds
buffer_load_dwordx4 v1, s[4:7], s30 offen offset:1024 sc1 lds
v_cvt_pk_bf16_f32 v132, v104, v105
v_cvt_pk_bf16_f32 v133, v106, v107
v_cvt_pk_bf16_f32 v134, v108, v109
v_cvt_pk_bf16_f32 v135, v110, v111
s_waitcnt lgkmcnt(0)
v_mfma_f32_32x32x16_bf16 v[96:111], v[144:147], v[16:19], v[32:47]
v_exp_f32 v112, v112
v_exp_f32 v113, v113
v_exp_f32 v114, v114
v_exp_f32 v115, v115
v_mfma_f32_32x32x16_bf16 v[64:79], v[168:171], v[128:131], v[64:79]
v_exp_f32 v116, v116
v_exp_f32 v117, v117
v_exp_f32 v118, v118
v_exp_f32 v119, v119
v_cvt_pk_bf16_f32 v136, v112, v113
v_mfma_f32_32x32x16_bf16 v[96:111], v[148:151], v[20:23], v[96:111]
v_exp_f32 v120, v120
v_exp_f32 v121, v121
v_exp_f32 v122, v122
v_mfma_f32_16x16x32_bf16 v[196:199], a[32:35], a[52:55], v[196:199]
v_exp_f32 v123, v123
v_cvt_pk_bf16_f32 v137, v114, v115
v_cvt_pk_bf16_f32 v138, v116, v117
v_mfma_f32_32x32x16_bf16 v[64:79], v[172:175], v[132:135], v[64:79]
ds_read_b128 v[160:163], v10 offset:18432
ds_read_b128 v[164:167], v10 offset:19104
v_exp_f32 v124, v124
v_exp_f32 v125, v125
v_cvt_pk_bf16_f32 v139, v118, v119
v_mfma_f32_16x16x32_bf16 v[200:203], a[36:39], a[48:51], v[200:203]
v_exp_f32 v126, v126
v_exp_f32 v127, v127
v_mfma_f32_16x16x32_bf16 v[204:207], a[36:39], a[52:55], v[204:207]
buffer_load_dwordx4 v1, s[4:7], s30 offen offset:2048 sc1 lds
buffer_load_dwordx4 v1, s[4:7], s30 offen offset:3072 sc1 lds
v_cvt_pk_bf16_f32 v140, v120, v121
v_cvt_pk_bf16_f32 v141, v122, v123
v_cvt_pk_bf16_f32 v142, v124, v125
v_cvt_pk_bf16_f32 v143, v126, v127
v_mfma_f32_32x32x16_bf16 v[112:127], v[144:147], v[24:27], v[48:63]
v_exp_f32 v96, v96
v_exp_f32 v97, v97
v_exp_f32 v98, v98
v_exp_f32 v99, v99
v_mfma_f32_32x32x16_bf16 v[80:95], v[168:171], v[136:139], v[80:95]
v_exp_f32 v100, v100
v_exp_f32 v101, v101
v_exp_f32 v102, v102
v_exp_f32 v103, v103
v_cvt_pk_bf16_f32 v128, v96, v97
v_mfma_f32_32x32x16_bf16 v[112:127], v[148:151], v[28:31], v[112:127]
v_exp_f32 v104, v104
v_exp_f32 v105, v105
v_exp_f32 v106, v106
v_mfma_f32_16x16x32_bf16 v[208:211], a[40:43], a[48:51], v[208:211]
v_exp_f32 v107, v107
v_cvt_pk_bf16_f32 v129, v98, v99
v_cvt_pk_bf16_f32 v130, v100, v101
v_mfma_f32_32x32x16_bf16 v[80:95], v[172:175], v[140:143], v[80:95]
ds_read_b128 v[152:155], v8 offset:21504
ds_read_b128 v[156:159], v9 offset:21504
v_exp_f32 v108, v108
v_exp_f32 v109, v109
v_cvt_pk_bf16_f32 v131, v102, v103
v_mfma_f32_16x16x32_bf16 v[212:215], a[40:43], a[52:55], v[212:215]
v_exp_f32 v110, v110
v_exp_f32 v111, v111
v_mfma_f32_16x16x32_bf16 v[216:219], a[44:47], a[48:51], v[216:219]
s_add_u32 m0, s37, 4096
s_add_u32 s30, s30, 24576
buffer_load_dwordx4 v1, s[4:7], s41 offen sc1 lds
buffer_load_dwordx4 v1, s[4:7], s41 offen offset:1024 sc1 lds
s_add_u32 s37, s37, 24576
s_cmp_ge_u32 s37, 73728
s_cselect_b32 s37, s31, s37
v_cvt_pk_bf16_f32 v132, v104, v105
v_cvt_pk_bf16_f32 v133, v106, v107
v_cvt_pk_bf16_f32 v134, v108, v109
v_cvt_pk_bf16_f32 v135, v110, v111
s_waitcnt lgkmcnt(0)
v_mfma_f32_32x32x16_bf16 v[96:111], v[152:155], v[16:19], v[32:47]
v_exp_f32 v112, v112
v_exp_f32 v113, v113
v_exp_f32 v114, v114
v_exp_f32 v115, v115
v_mfma_f32_32x32x16_bf16 v[64:79], v[160:163], v[128:131], v[64:79]
v_exp_f32 v116, v116
v_exp_f32 v117, v117
v_exp_f32 v118, v118
v_exp_f32 v119, v119
v_cvt_pk_bf16_f32 v136, v112, v113
v_mfma_f32_32x32x16_bf16 v[96:111], v[156:159], v[20:23], v[96:111]
v_exp_f32 v120, v120
v_exp_f32 v121, v121
v_exp_f32 v122, v122
v_mfma_f32_16x16x32_bf16 v[220:223], a[44:47], a[52:55], v[220:223]
v_exp_f32 v123, v123
v_cvt_pk_bf16_f32 v137, v114, v115
v_cvt_pk_bf16_f32 v138, v116, v117
v_mfma_f32_32x32x16_bf16 v[64:79], v[164:167], v[132:135], v[64:79]
ds_read_b128 v[168:171], v10 offset:21504
ds_read_b128 v[172:175], v10 offset:22176
v_exp_f32 v124, v124
v_exp_f32 v125, v125
v_cvt_pk_bf16_f32 v139, v118, v119
v_exp_f32 v126, v126
v_exp_f32 v127, v127
buffer_load_dwordx4 a[28:31], v1, s[48:51], s64 offen offset:1024 sc1
buffer_load_dwordx4 a[32:35], v1, s[48:51], s65 offen offset:1024 sc1
buffer_load_dwordx4 a[36:39], v1, s[48:51], s66 offen offset:1024 sc1
buffer_load_dwordx4 a[40:43], v1, s[48:51], s67 offen offset:1024 sc1
v_cvt_pk_bf16_f32 v140, v120, v121
v_cvt_pk_bf16_f32 v141, v122, v123
v_cvt_pk_bf16_f32 v142, v124, v125
v_cvt_pk_bf16_f32 v143, v126, v127
v_mfma_f32_32x32x16_bf16 v[112:127], v[152:155], v[24:27], v[48:63]
v_exp_f32 v96, v96
v_exp_f32 v97, v97
v_exp_f32 v98, v98
v_exp_f32 v99, v99
v_mfma_f32_32x32x16_bf16 v[80:95], v[160:163], v[136:139], v[80:95]
v_exp_f32 v100, v100
v_exp_f32 v101, v101
v_exp_f32 v102, v102
v_exp_f32 v103, v103
v_cvt_pk_bf16_f32 v128, v96, v97
v_mfma_f32_32x32x16_bf16 v[112:127], v[156:159], v[28:31], v[112:127]
v_exp_f32 v104, v104
v_exp_f32 v105, v105
v_exp_f32 v106, v106
v_exp_f32 v107, v107
v_cvt_pk_bf16_f32 v129, v98, v99
v_cvt_pk_bf16_f32 v130, v100, v101
v_mfma_f32_32x32x16_bf16 v[80:95], v[164:167], v[140:143], v[80:95]
ds_read_b128 v[144:147], v11 offset:0
ds_read_b128 v[148:151], v12 offset:0
v_exp_f32 v108, v108
v_exp_f32 v109, v109
v_cvt_pk_bf16_f32 v131, v102, v103
v_exp_f32 v110, v110
v_exp_f32 v111, v111
buffer_load_dwordx4 a[44:47], v1, s[48:51], s68 offen offset:1024 sc1
buffer_load_dwordx4 a[48:51], v181, s[48:51], s69 offen sc1
buffer_load_dwordx4 a[52:55], v181, s[48:51], s69 offen offset:1280 sc1
s_add_u32 s69, s69, s74
v_cvt_pk_bf16_f32 v132, v104, v105
v_cvt_pk_bf16_f32 v133, v106, v107
v_cvt_pk_bf16_f32 v134, v108, v109
v_cvt_pk_bf16_f32 v135, v110, v111
s_waitcnt lgkmcnt(0)
v_mfma_f32_32x32x16_bf16 v[96:111], v[144:147], v[16:19], v[32:47]
v_exp_f32 v112, v112
v_exp_f32 v113, v113
v_exp_f32 v114, v114
v_exp_f32 v115, v115
v_mfma_f32_32x32x16_bf16 v[64:79], v[168:171], v[128:131], v[64:79]
v_exp_f32 v116, v116
v_exp_f32 v117, v117
v_exp_f32 v118, v118
v_exp_f32 v119, v119
v_cvt_pk_bf16_f32 v136, v112, v113
v_mfma_f32_32x32x16_bf16 v[96:111], v[148:151], v[20:23], v[96:111]
v_exp_f32 v120, v120
v_exp_f32 v121, v121
v_exp_f32 v122, v122
v_exp_f32 v123, v123
v_cvt_pk_bf16_f32 v137, v114, v115
v_cvt_pk_bf16_f32 v138, v116, v117
v_mfma_f32_32x32x16_bf16 v[64:79], v[172:175], v[132:135], v[64:79]
ds_read_b128 v[160:163], v13 offset:0
ds_read_b128 v[164:167], v13 offset:672
v_exp_f32 v124, v124
v_exp_f32 v125, v125
v_cvt_pk_bf16_f32 v139, v118, v119
v_exp_f32 v126, v126
v_exp_f32 v127, v127
v_cvt_pk_bf16_f32 v140, v120, v121
v_cvt_pk_bf16_f32 v141, v122, v123
v_cvt_pk_bf16_f32 v142, v124, v125
v_cvt_pk_bf16_f32 v143, v126, v127
s_add_u32 s64, s64, 2048
s_add_u32 s65, s65, 2048
s_add_u32 s66, s66, 2048
s_add_u32 s67, s67, 2048
s_add_u32 s68, s68, 2048
v_mov_b32 v8, v11
v_mov_b32 v9, v12
v_mov_b32 v10, v13
s_add_u32 s40, s40, 1
s_cmp_lt_u32 s40, 6
s_cbranch_scc1 T_fa
T_fast:
v_mfma_f32_32x32x16_bf16 v[112:127], v[144:147], v[24:27], v[48:63]
v_exp_f32 v96, v96
v_exp_f32 v97, v97
v_exp_f32 v98, v98
v_exp_f32 v99, v99
v_mfma_f32_32x32x16_bf16 v[80:95], v[168:171], v[136:139], v[80:95]
v_exp_f32 v100, v100
v_exp_f32 v101, v101
v_exp_f32 v102, v102
v_exp_f32 v103, v103
v_cvt_pk_bf16_f32 v128, v96, v97
v_mfma_f32_32x32x16_bf16 v[112:127], v[148:151], v[28:31], v[112:127]
v_exp_f32 v104, v104
v_exp_f32 v105, v105
v_exp_f32 v106, v106
v_exp_f32 v107, v107
v_cvt_pk_bf16_f32 v129, v98, v99
v_cvt_pk_bf16_f32 v130, v100, v101
v_mfma_f32_32x32x16_bf16 v[80:95], v[172:175], v[140:143], v[80:95]
ds_read_b128 v[152:155], v8 offset:3072
ds_read_b128 v[156:159], v9 offset:3072
v_exp_f32 v108, v108
v_exp_f32 v109, v109
v_cvt_pk_bf16_f32 v131, v102, v103
v_exp_f32 v110, v110
v_exp_f32 v111, v111
v_cvt_pk_bf16_f32 v132, v104, v105
v_cvt_pk_bf16_f32 v133, v106, v107
v_cvt_pk_bf16_f32 v134, v108, v109
v_cvt_pk_bf16_f32 v135, v110, v111
s_waitcnt lgkmcnt(0)
v_mfma_f32_32x32x16_bf16 v[96:111], v[152:155], v[16:19], v[32:47]
v_exp_f32 v112, v112
v_exp_f32 v113, v113
v_exp_f32 v114, v114
v_exp_f32 v115, v115
v_mfma_f32_32x32x16_bf16 v[64:79], v[160:163], v[128:131], v[64:79]
v_exp_f32 v116, v116
v_exp_f32 v117, v117
v_exp_f32 v118, v118
v_exp_f32 v119, v119
v_cvt_pk_bf16_f32 v136, v112, v113
v_mfma_f32_32x32x16_bf16 v[96:111], v[156:159], v[20:23], v[96:111]
v_exp_f32 v120, v120
v_exp_f32 v121, v121
v_exp_f32 v122, v122
v_exp_f32 v123, v123
v_cvt_pk_bf16_f32 v137, v114, v115
v_cvt_pk_bf16_f32 v138, v116, v117
v_mfma_f32_32x32x16_bf16 v[64:79], v[164:167], v[132:135], v[64:79]
ds_read_b128 v[168:171], v10 offset:3072
ds_read_b128 v[172:175], v10 offset:3744
v_exp_f32 v124, v124
v_exp_f32 v125, v125
v_cvt_pk_bf16_f32 v139, v118, v119
v_exp_f32 v126, v126
v_exp_f32 v127, v127
v_cvt_pk_bf16_f32 v140, v120, v121
v_cvt_pk_bf16_f32 v141, v122, v123
v_cvt_pk_bf16_f32 v142, v124, v125
v_cvt_pk_bf16_f32 v143, v126, v127
v_mfma_f32_32x32x16_bf16 v[112:127], v[152:155], v[24:27], v[48:63]
v_exp_f32 v96, v96
v_exp_f32 v97, v97
v_exp_f32 v98, v98
v_exp_f32 v99, v99
v_mfma_f32_32x32x16_bf16 v[80:95], v[160:163], v[136:139], v[80:95]
v_exp_f32 v100, v100
v_exp_f32 v101, v101
v_exp_f32 v102, v102
v_exp_f32 v103, v103
v_cvt_pk_bf16_f32 v128, v96, v97
v_mfma_f32_32x32x16_bf16 v[112:127], v[156:159], v[28:31], v[112:127]
v_exp_f32 v104, v104
v_exp_f32 v105, v105
v_exp_f32 v106, v106
v_exp_f32 v107, v107
v_cvt_pk_bf16_f32 v129, v98, v99
v_cvt_pk_bf16_f32 v130, v100, v101
v_mfma_f32_32x32x16_bf16 v[80:95], v[164:167], v[140:143], v[80:95]
ds_read_b128 v[144:147], v8 offset:6144
ds_read_b128 v[148:151], v9 offset:6144
v_exp_f32 v108, v108
v_exp_f32 v109, v109
v_cvt_pk_bf16_f32 v131, v102, v103
v_exp_f32 v110, v110
v_exp_f32 v111, v111
v_cvt_pk_bf16_f32 v132, v104, v105
v_cvt_pk_bf16_f32 v133, v106, v107
v_cvt_pk_bf16_f32 v134, v108, v109
v_cvt_pk_bf16_f32 v135, v110, v111
s_waitcnt lgkmcnt(0)
v_mfma_f32_32x32x16_bf16 v[96:111], v[144:147], v[16:19], v[32:47]
v_exp_f32 v112, v112
v_exp_f32 v113, v113
v_exp_f32 v114, v114
v_exp_f32 v115, v115
v_mfma_f32_32x32x16_bf16 v[64:79], v[168:171], v[128:131], v[64:79]
v_exp_f32 v116, v116
v_exp_f32 v117, v117
v_exp_f32 v118, v118
v_exp_f32 v119, v119
v_cvt_pk_bf16_f32 v136, v112, v113
v_mfma_f32_32x32x16_bf16 v[96:111], v[148:151], v[20:23], v[96:111]
v_exp_f32 v120, v120
v_exp_f32 v121, v121
v_exp_f32 v122, v122
v_exp_f32 v123, v123
v_cvt_pk_bf16_f32 v137, v114, v115
v_cvt_pk_bf16_f32 v138, v116, v117
v_mfma_f32_32x32x16_bf16 v[64:79], v[172:175], v[132:135], v[64:79]
ds_read_b128 v[160:163], v10 offset:6144
ds_read_b128 v[164:167], v10 offset:6816
v_exp_f32 v124, v124
v_exp_f32 v125, v125
v_cvt_pk_bf16_f32 v139, v118, v119
v_exp_f32 v126, v126
v_exp_f32 v127, v127
v_cvt_pk_bf16_f32 v140, v120, v121
v_cvt_pk_bf16_f32 v141, v122, v123
v_cvt_pk_bf16_f32 v142, v124, v125
v_cvt_pk_bf16_f32 v143, v126, v127
v_mfma_f32_32x32x16_bf16 v[112:127], v[144:147], v[24:27], v[48:63]
v_exp_f32 v96, v96
v_exp_f32 v97, v97
v_exp_f32 v98, v98
v_exp_f32 v99, v99
v_mfma_f32_32x32x16_bf16 v[80:95], v[168:171], v[136:139], v[80:95]
v_exp_f32 v100, v100
v_exp_f32 v101, v101
v_exp_f32 v102, v102
v_exp_f32 v103, v103
v_cvt_pk_bf16_f32 v128, v96, v97
v_mfma_f32_32x32x16_bf16 v[112:127], v[148:151], v[28:31], v[112:127]
v_exp_f32 v104, v104
v_exp_f32 v105, v105
v_exp_f32 v106, v106
v_exp_f32 v107, v107
v_cvt_pk_bf16_f32 v129, v98, v99
v_cvt_pk_bf16_f32 v130, v100, v101
v_mfma_f32_32x32x16_bf16 v[80:95], v[172:175], v[140:143], v[80:95]
ds_read_b128 v[152:155], v8 offset:9216
ds_read_b128 v[156:159], v9 offset:9216
v_exp_f32 v108, v108
v_exp_f32 v109, v109
v_cvt_pk_bf16_f32 v131, v102, v103
v_exp_f32 v110, v110
v_exp_f32 v111, v111
v_cvt_pk_bf16_f32 v132, v104, v105
v_cvt_pk_bf16_f32 v133, v106, v107
v_cvt_pk_bf16_f32 v134, v108, v109
v_cvt_pk_bf16_f32 v135, v110, v111
s_waitcnt lgkmcnt(0)
v_mfma_f32_32x32x16_bf16 v[96:111], v[152:155], v[16:19], v[32:47]
v_exp_f32 v112, v112
v_exp_f32 v113, v113
v_exp_f32 v114, v114
v_exp_f32 v115, v115
v_mfma_f32_32x32x16_bf16 v[64:79], v[160:163], v[128:131], v[64:79]
v_exp_f32 v116, v116
v_exp_f32 v117, v117
v_exp_f32 v118, v118
v_exp_f32 v119, v119
v_cvt_pk_bf16_f32 v136, v112, v113
v_mfma_f32_32x32x16_bf16 v[96:111], v[156:159], v[20:23], v[96:111]
v_exp_f32 v120, v120
v_exp_f32 v121, v121
v_exp_f32 v122, v122
v_exp_f32 v123, v123
v_cvt_pk_bf16_f32 v137, v114, v115
v_cvt_pk_bf16_f32 v138, v116, v117
v_mfma_f32_32x32x16_bf16 v[64:79], v[164:167], v[132:135], v[64:79]
ds_read_b128 v[168:171], v10 offset:9216
ds_read_b128 v[172:175], v10 offset:9888
v_exp_f32 v124, v124
v_exp_f32 v125, v125
v_cvt_pk_bf16_f32 v139, v118, v119
v_exp_f32 v126, v126
v_exp_f32 v127, v127
v_cvt_pk_bf16_f32 v140, v120, v121
v_cvt_pk_bf16_f32 v141, v122, v123
v_cvt_pk_bf16_f32 v142, v124, v125
v_cvt_pk_bf16_f32 v143, v126, v127
v_mfma_f32_32x32x16_bf16 v[112:127], v[152:155], v[24:27], v[48:63]
v_exp_f32 v96, v96
v_exp_f32 v97, v97
v_exp_f32 v98, v98
v_exp_f32 v99, v99
v_mfma_f32_32x32x16_bf16 v[80:95], v[160:163], v[136:139], v[80:95]
v_exp_f32 v100, v100
v_exp_f32 v101, v101
v_exp_f32 v102, v102
v_exp_f32 v103, v103
v_cvt_pk_bf16_f32 v128, v96, v97
v_mfma_f32_32x32x16_bf16 v[112:127], v[156:159], v[28:31], v[112:127]
v_exp_f32 v104, v104
v_exp_f32 v105, v105
v_exp_f32 v106, v106
v_exp_f32 v107, v107
v_cvt_pk_bf16_f32 v129, v98, v99
v_cvt_pk_bf16_f32 v130, v100, v101
v_mfma_f32_32x32x16_bf16 v[80:95], v[164:167], v[140:143], v[80:95]
ds_read_b128 v[144:147], v8 offset:12288
ds_read_b128 v[148:151], v9 offset:12288
v_exp_f32 v108, v108
v_exp_f32 v109, v109
v_cvt_pk_bf16_f32 v131, v102, v103
v_exp_f32 v110, v110
v_exp_f32 v111, v111
v_cvt_pk_bf16_f32 v132, v104, v105
v_cvt_pk_bf16_f32 v133, v106, v107
v_cvt_pk_bf16_f32 v134, v108, v109
v_cvt_pk_bf16_f32 v135, v110, v111
s_waitcnt lgkmcnt(0)
v_mfma_f32_32x32x16_bf16 v[96:111], v[144:147], v[16:19], v[32:47]
v_exp_f32 v112, v112
v_exp_f32 v113, v113
v_exp_f32 v114, v114
v_exp_f32 v115, v115
v_mfma_f32_32x32x16_bf16 v[64:79], v[168:171], v[128:131], v[64:79]
v_exp_f32 v116, v116
v_exp_f32 v117, v117
v_exp_f32 v118, v118
v_exp_f32 v119, v119
v_cvt_pk_bf16_f32 v136, v112, v113
v_mfma_f32_32x32x16_bf16 v[96:111], v[148:151], v[20:23], v[96:111]
v_exp_f32 v120, v120
v_exp_f32 v121, v121
v_exp_f32 v122, v122
v_exp_f32 v123, v123
v_cvt_pk_bf16_f32 v137, v114, v115
v_cvt_pk_bf16_f32 v138, v116, v117
v_mfma_f32_32x32x16_bf16 v[64:79], v[172:175], v[132:135], v[64:79]
ds_read_b128 v[160:163], v10 offset:12288
ds_read_b128 v[164:167], v10 offset:12960
v_exp_f32 v124, v124
v_exp_f32 v125, v125
v_cvt_pk_bf16_f32 v139, v118, v119
v_exp_f32 v126, v126
v_exp_f32 v127, v127
v_cvt_pk_bf16_f32 v140, v120, v121
v_cvt_pk_bf16_f32 v141, v122, v123
v_cvt_pk_bf16_f32 v142, v124, v125
v_cvt_pk_bf16_f32 v143, v126, v127
v_mfma_f32_32x32x16_bf16 v[112:127], v[144:147], v[24:27], v[48:63]
v_exp_f32 v96, v96
v_exp_f32 v97, v97
v_exp_f32 v98, v98
v_exp_f32 v99, v99
v_mfma_f32_32x32x16_bf16 v[80:95], v[168:171], v[136:139], v[80:95]
v_exp_f32 v100, v100
v_exp_f32 v101, v101
v_exp_f32 v102, v102
v_exp_f32 v103, v103
v_cvt_pk_bf16_f32 v128, v96, v97
v_mfma_f32_32x32x16_bf16 v[112:127], v[148:151], v[28:31], v[112:127]
v_exp_f32 v104, v104
v_exp_f32 v105, v105
v_exp_f32 v106, v106
v_exp_f32 v107, v107
v_cvt_pk_bf16_f32 v129, v98, v99
v_cvt_pk_bf16_f32 v130, v100, v101
v_mfma_f32_32x32x16_bf16 v[80:95], v[172:175], v[140:143], v[80:95]
ds_read_b128 v[152:155], v8 offset:15360
ds_read_b128 v[156:159], v9 offset:15360
v_exp_f32 v108, v108
v_exp_f32 v109, v109
v_cvt_pk_bf16_f32 v131, v102, v103
v_exp_f32 v110, v110
v_exp_f32 v111, v111
v_cvt_pk_bf16_f32 v132, v104, v105
v_cvt_pk_bf16_f32 v133, v106, v107
v_cvt_pk_bf16_f32 v134, v108, v109
v_cvt_pk_bf16_f32 v135, v110, v111
s_waitcnt lgkmcnt(0)
v_mfma_f32_32x32x16_bf16 v[96:111], v[152:155], v[16:19], v[32:47]
v_exp_f32 v112, v112
v_exp_f32 v113, v113
v_exp_f32 v114, v114
v_exp_f32 v115, v115
v_mfma_f32_32x32x16_bf16 v[64:79], v[160:163], v[128:131], v[64:79]
v_exp_f32 v116, v116
v_exp_f32 v117, v117
v_exp_f32 v118, v118
v_exp_f32 v119, v119
v_cvt_pk_bf16_f32 v136, v112, v113
v_mfma_f32_32x32x16_bf16 v[96:111], v[156:159], v[20:23], v[96:111]
v_exp_f32 v120, v120
v_exp_f32 v121, v121
v_exp_f32 v122, v122
v_exp_f32 v123, v123
v_cvt_pk_bf16_f32 v137, v114, v115
v_cvt_pk_bf16_f32 v138, v116, v117
v_mfma_f32_32x32x16_bf16 v[64:79], v[164:167], v[132:135], v[64:79]
ds_read_b128 v[168:171], v10 offset:15360
ds_read_b128 v[172:175], v10 offset:16032
v_exp_f32 v124, v124
v_exp_f32 v125, v125
v_cvt_pk_bf16_f32 v139, v118, v119
v_exp_f32 v126, v126
v_exp_f32 v127, v127
v_cvt_pk_bf16_f32 v140, v120, v121
v_cvt_pk_bf16_f32 v141, v122, v123
v_cvt_pk_bf16_f32 v142, v124, v125
v_cvt_pk_bf16_f32 v143, v126, v127
s_waitcnt vmcnt(0)
s_cmp_lg_u32 s40, 1
s_cbranch_scc1 tn_10
s_cmp_lg_u32 s24, 0
s_cbranch_scc1 tn_10
v_mov_b32 v15, 0x14000
s_mov_b64 exec, 1
ds_write_b32 v15, v180 offset:0
s_mov_b64 exec, -1
s_waitcnt lgkmcnt(0)
tn_10:
s_barrier
s_cmp_gt_u32 s40, 1
s_cbranch_scc1 tn_11
s_cmp_eq_u32 s40, 1
s_cbranch_scc1 tn_12
s_cmp_eq_u32 s33, -1
s_cbranch_scc1 tn_11
s_add_u32 s61, s57, 1
v_mov_b32 v14, s61
v_mov_b32 v15, 0
s_mov_b64 exec, 1
buffer_store_dword v14, v15, s[4:7], s33 offen sc1
s_mov_b64 exec, -1
s_branch tn_11
tn_12:
v_mov_b32 v15, 0x14000
ds_read_b32 v14, v15 offset:0
s_waitcnt lgkmcnt(0)
v_readfirstlane_b32 s35, v14
s_and_b32 s32, s35, 31
s_mul_i32 s32, s32, 196608
s_add_u32 s32, s32, s31
s_add_u32 s32, s32, 221249536
tn_11:
s_cmp_eq_u32 s40, 6
s_cselect_b32 s30, s32, s30
s_add_u32 s38, s38, 24576
s_cmp_eq_u32 s38, 73728
s_cselect_b32 s38, 0, s38
v_add_u32 v11, s38, v1
v_add_u32 v12, s38, v5
v_add_u32 v13, s38, v6
v_mfma_f32_32x32x16_bf16 v[112:127], v[152:155], v[24:27], v[48:63]
v_exp_f32 v96, v96
v_exp_f32 v97, v97
v_exp_f32 v98, v98
v_exp_f32 v99, v99
v_mfma_f32_32x32x16_bf16 v[80:95], v[160:163], v[136:139], v[80:95]
v_exp_f32 v100, v100
v_exp_f32 v101, v101
v_exp_f32 v102, v102
v_exp_f32 v103, v103
v_cvt_pk_bf16_f32 v128, v96, v97
v_mfma_f32_32x32x16_bf16 v[112:127], v[156:159], v[28:31], v[112:127]
v_exp_f32 v104, v104
v_exp_f32 v105, v105
v_exp_f32 v106, v106
v_exp_f32 v107, v107
v_cvt_pk_bf16_f32 v129, v98, v99
v_cvt_pk_bf16_f32 v130, v100, v101
v_mfma_f32_32x32x16_bf16 v[80:95], v[164:167], v[140:143], v[80:95]
ds_read_b128 v[144:147], v8 offset:18432
ds_read_b128 v[148:151], v9 offset:18432
v_exp_f32 v108, v108
v_exp_f32 v109, v109
v_cvt_pk_bf16_f32 v131, v102, v103
v_exp_f32 v110, v110
v_exp_f32 v111, v111
s_mov_b32 m0, s37
s_add_u32 s41, s30, 4096
buffer_load_dwordx4 v1, s[4:7], s30 offen sc1 lds
buffer_load_dwordx4 v1, s[4:7], s30 offen offset:1024 sc1 lds
v_cvt_pk_bf16_f32 v132, v104, v105
v_cvt_pk_bf16_f32 v133, v106, v107
v_cvt_pk_bf16_f32 v134, v108, v109
v_cvt_pk_bf16_f32 v135, v110, v111
s_waitcnt lgkmcnt(0)
v_mfma_f32_32x32x16_bf16 v[96:111], v[144:147], v[16:19], v[32:47]
v_exp_f32 v112, v112
v_exp_f32 v113, v113
v_exp_f32 v114, v114
v_exp_f32 v115, v115
v_mfma_f32_32x32x16_bf16 v[64:79], v[168:171], v[128:131], v[64:79]
v_exp_f32 v116, v116
v_exp_f32 v117, v117
v_exp_f32 v118, v118
v_exp_f32 v119, v119
v_cvt_pk_bf16_f32 v136, v112, v113
v_mfma_f32_32x32x16_bf16 v[96:111], v[148:151], v[20:23], v[96:111]
v_exp_f32 v120, v120
v_exp_f32 v121, v121
v_exp_f32 v122, v122
v_exp_f32 v123, v123
v_cvt_pk_bf16_f32 v137, v114, v115
v_cvt_pk_bf16_f32 v138, v116, v117
v_mfma_f32_32x32x16_bf16 v[64:79], v[172:175], v[132:135], v[64:79]
ds_read_b128 v[160:163], v10 offset:18432
ds_read_b128 v[164:167], v10 offset:19104
v_exp_f32 v124, v124
v_exp_f32 v125, v125
v_cvt_pk_bf16_f32 v139, v118, v119
v_exp_f32 v126, v126
v_exp_f32 v127, v127
buffer_load_dwordx4 v1, s[4:7], s30 offen offset:2048 sc1 lds
buffer_load_dwordx4 v1, s[4:7], s30 offen offset:3072 sc1 lds
v_cvt_pk_bf16_f32 v140, v120, v121
v_cvt_pk_bf16_f32 v141, v122, v123
v_cvt_pk_bf16_f32 v142, v124, v125
v_cvt_pk_bf16_f32 v143, v126, v127
v_mfma_f32_32x32x16_bf16 v[112:127], v[144:147], v[24:27], v[48:63]
v_exp_f32 v96, v96
v_exp_f32 v97, v97
v_exp_f32 v98, v98
v_exp_f32 v99, v99
v_mfma_f32_32x32x16_bf16 v[80:95], v[168:171], v[136:139], v[80:95]
v_exp_f32 v100, v100
v_exp_f32 v101, v101
v_exp_f32 v102, v102
v_exp_f32 v103, v103
v_cvt_pk_bf16_f32 v128, v96, v97
v_mfma_f32_32x32x16_bf16 v[112:127], v[148:151], v[28:31], v[112:127]
v_exp_f32 v104, v104
v_exp_f32 v105, v105
v_exp_f32 v106, v106
v_exp_f32 v107, v107
v_cvt_pk_bf16_f32 v129, v98, v99
v_cvt_pk_bf16_f32 v130, v100, v101
v_mfma_f32_32x32x16_bf16 v[80:95], v[172:175], v[140:143], v[80:95]
ds_read_b128 v[152:155], v8 offset:21504
ds_read_b128 v[156:159], v9 offset:21504
v_exp_f32 v108, v108
v_exp_f32 v109, v109
v_cvt_pk_bf16_f32 v131, v102, v103
v_exp_f32 v110, v110
v_exp_f32 v111, v111
s_add_u32 m0, s37, 4096
s_add_u32 s30, s30, 24576
buffer_load_dwordx4 v1, s[4:7], s41 offen sc1 lds
buffer_load_dwordx4 v1, s[4:7], s41 offen offset:1024 sc1 lds
s_add_u32 s37, s37, 24576
s_cmp_ge_u32 s37, 73728
s_cselect_b32 s37, s31, s37
v_cvt_pk_bf16_f32 v132, v104, v105
v_cvt_pk_bf16_f32 v133, v106, v107
v_cvt_pk_bf16_f32 v134, v108, v109
v_cvt_pk_bf16_f32 v135, v110, v111
s_waitcnt lgkmcnt(0)
v_mfma_f32_32x32x16_bf16 v[96:111], v[152:155], v[16:19], v[32:47]
v_exp_f32 v112, v112
v_exp_f32 v113, v113
v_exp_f32 v114, v114
v_exp_f32 v115, v115
v_mfma_f32_32x32x16_bf16 v[64:79], v[160:163], v[128:131], v[64:79]
v_exp_f32 v116, v116
v_exp_f32 v117, v117
v_exp_f32 v118, v118
v_exp_f32 v119, v119
v_cvt_pk_bf16_f32 v136, v112, v113
v_mfma_f32_32x32x16_bf16 v[96:111], v[156:159], v[20:23], v[96:111]
v_exp_f32 v120, v120
v_exp_f32 v121, v121
v_exp_f32 v122, v122
v_exp_f32 v123, v123
v_cvt_pk_bf16_f32 v137, v114, v115
v_cvt_pk_bf16_f32 v138, v116, v117
v_mfma_f32_32x32x16_bf16 v[64:79], v[164:167], v[132:135], v[64:79]
ds_read_b128 v[168:171], v10 offset:21504
ds_read_b128 v[172:175], v10 offset:22176
v_exp_f32 v124, v124
v_exp_f32 v125, v125
v_cvt_pk_bf16_f32 v139, v118, v119
v_exp_f32 v126, v126
v_exp_f32 v127, v127
v_cvt_pk_bf16_f32 v140, v120, v121
v_cvt_pk_bf16_f32 v141, v122, v123
v_cvt_pk_bf16_f32 v142, v124, v125
v_cvt_pk_bf16_f32 v143, v126, v127
v_mfma_f32_32x32x16_bf16 v[112:127], v[152:155], v[24:27], v[48:63]
v_exp_f32 v96, v96
v_exp_f32 v97, v97
v_exp_f32 v98, v98
v_exp_f32 v99, v99
v_mfma_f32_32x32x16_bf16 v[80:95], v[160:163], v[136:139], v[80:95]
v_exp_f32 v100, v100
v_exp_f32 v101, v101
v_exp_f32 v102, v102
v_exp_f32 v103, v103
v_cvt_pk_bf16_f32 v128, v96, v97
v_mfma_f32_32x32x16_bf16 v[112:127], v[156:159], v[28:31], v[112:127]
v_exp_f32 v104, v104
v_exp_f32 v105, v105
v_exp_f32 v106, v106
v_exp_f32 v107, v107
v_cvt_pk_bf16_f32 v129, v98, v99
v_cvt_pk_bf16_f32 v130, v100, v101
v_mfma_f32_32x32x16_bf16 v[80:95], v[164:167], v[140:143], v[80:95]
ds_read_b128 v[144:147], v11 offset:0
ds_read_b128 v[148:151], v12 offset:0
v_exp_f32 v108, v108
v_exp_f32 v109, v109
v_cvt_pk_bf16_f32 v131, v102, v103
v_exp_f32 v110, v110
v_exp_f32 v111, v111
v_cvt_pk_bf16_f32 v132, v104, v105
v_cvt_pk_bf16_f32 v133, v106, v107
v_cvt_pk_bf16_f32 v134, v108, v109
v_cvt_pk_bf16_f32 v135, v110, v111
s_waitcnt lgkmcnt(0)
v_mfma_f32_32x32x16_bf16 v[96:111], v[144:147], v[16:19], v[32:47]
v_exp_f32 v112, v112
v_exp_f32 v113, v113
v_exp_f32 v114, v114
v_exp_f32 v115, v115
v_mfma_f32_32x32x16_bf16 v[64:79], v[168:171], v[128:131], v[64:79]
v_exp_f32 v116, v116
v_exp_f32 v117, v117
v_exp_f32 v118, v118
v_exp_f32 v119, v119
v_cvt_pk_bf16_f32 v136, v112, v113
v_mfma_f32_32x32x16_bf16 v[96:111], v[148:151], v[20:23], v[96:111]
v_exp_f32 v120, v120
v_exp_f32 v121, v121
v_exp_f32 v122, v122
v_exp_f32 v123, v123
v_cvt_pk_bf16_f32 v137, v114, v115
v_cvt_pk_bf16_f32 v138, v116, v117
v_mfma_f32_32x32x16_bf16 v[64:79], v[172:175], v[132:135], v[64:79]
ds_read_b128 v[160:163], v13 offset:0
ds_read_b128 v[164:167], v13 offset:672
v_exp_f32 v124, v124
v_exp_f32 v125, v125
v_cvt_pk_bf16_f32 v139, v118, v119
v_exp_f32 v126, v126
v_exp_f32 v127, v127
v_cvt_pk_bf16_f32 v140, v120, v121
v_cvt_pk_bf16_f32 v141, v122, v123
v_cvt_pk_bf16_f32 v142, v124, v125
v_cvt_pk_bf16_f32 v143, v126, v127
v_mov_b32 v8, v11
v_mov_b32 v9, v12
v_mov_b32 v10, v13
s_add_u32 s40, s40, 1
s_cmp_lt_u32 s40, 8
s_cbranch_scc1 T_fast
s_waitcnt lgkmcnt(0)
T_end:
v_mfma_f32_32x32x16_bf16 v[80:95], v[168:171], v[136:139], v[80:95]
v_mfma_f32_32x32x16_bf16 v[80:95], v[172:175], v[140:143], v[80:95]
s_cmp_lg_u32 s47, 0
s_cbranch_scc1 T_ok
s_cmp_eq_u32 s70, 0
s_cbranch_scc1 T_a2
s_cmp_eq_u32 s71, 0
s_cbranch_scc0 T_a1
v_accvgpr_write_b32 a160, v184
v_accvgpr_write_b32 a161, v185
v_accvgpr_write_b32 a162, v186
v_accvgpr_write_b32 a163, v187
v_accvgpr_write_b32 a164, v188
v_accvgpr_write_b32 a165, v189
v_accvgpr_write_b32 a166, v190
v_accvgpr_write_b32 a167, v191
v_accvgpr_write_b32 a168, v192
v_accvgpr_write_b32 a169, v193
v_accvgpr_write_b32 a170, v194
v_accvgpr_write_b32 a171, v195
v_accvgpr_write_b32 a172, v196
v_accvgpr_write_b32 a173, v197
v_accvgpr_write_b32 a174, v198
v_accvgpr_write_b32 a175, v199
v_accvgpr_write_b32 a176, v200
v_accvgpr_write_b32 a177, v201
v_accvgpr_write_b32 a178, v202
v_accvgpr_write_b32 a179, v203
v_accvgpr_write_b32 a180, v204
v_accvgpr_write_b32 a181, v205
v_accvgpr_write_b32 a182, v206
v_accvgpr_write_b32 a183, v207
v_accvgpr_write_b32 a184, v208
v_accvgpr_write_b32 a185, v209
v_accvgpr_write_b32 a186, v210
v_accvgpr_write_b32 a187, v211
v_accvgpr_write_b32 a188, v212
v_accvgpr_write_b32 a189, v213
v_accvgpr_write_b32 a190, v214
v_accvgpr_write_b32 a191, v215
v_accvgpr_write_b32 a192, v216
v_accvgpr_write_b32 a193, v217
v_accvgpr_write_b32 a194, v218
v_accvgpr_write_b32 a195, v219
v_accvgpr_write_b32 a196, v220
v_accvgpr_write_b32 a197, v221
v_accvgpr_write_b32 a198, v222
v_accvgpr_write_b32 a199, v223
s_mov_b32 s71, 1
s_branch T_a2
T_a1:
v_accvgpr_write_b32 a200, v184
v_accvgpr_write_b32 a201, v185
v_accvgpr_write_b32 a202, v186
v_accvgpr_write_b32 a203, v187
v_accvgpr_write_b32 a204, v188
v_accvgpr_write_b32 a205, v189
v_accvgpr_write_b32 a206, v190
v_accvgpr_write_b32 a207, v191
v_accvgpr_write_b32 a208, v192
v_accvgpr_write_b32 a209, v193
v_accvgpr_write_b32 a210, v194
v_accvgpr_write_b32 a211, v195
v_accvgpr_write_b32 a212, v196
v_accvgpr_write_b32 a213, v197
v_accvgpr_write_b32 a214, v198
v_accvgpr_write_b32 a215, v199
v_accvgpr_write_b32 a216, v200
v_accvgpr_write_b32 a217, v201
v_accvgpr_write_b32 a218, v202
v_accvgpr_write_b32 a219, v203
v_accvgpr_write_b32 a220, v204
v_accvgpr_write_b32 a221, v205
v_accvgpr_write_b32 a222, v206
v_accvgpr_write_b32 a223, v207
v_accvgpr_write_b32 a224, v208
v_accvgpr_write_b32 a225, v209
v_accvgpr_write_b32 a226, v210
v_accvgpr_write_b32 a227, v211
v_accvgpr_write_b32 a228, v212
v_accvgpr_write_b32 a229, v213
v_accvgpr_write_b32 a230, v214
v_accvgpr_write_b32 a231, v215
v_accvgpr_write_b32 a232, v216
v_accvgpr_write_b32 a233, v217
v_accvgpr_write_b32 a234, v218
v_accvgpr_write_b32 a235, v219
v_accvgpr_write_b32 a236, v220
v_accvgpr_write_b32 a237, v221
v_accvgpr_write_b32 a238, v222
v_accvgpr_write_b32 a239, v223
s_mov_b32 s71, 2
T_a2:
s_lshr_b32 s43, s35, 5
s_and_b32 s43, s43, 7
s_lshl_b32 s43, s43, 3
s_lshl_b32 s44, s24, 1
s_add_u32 s43, s43, s44
s_mul_i32 s44, s43, 1536
s_and_b32 s45, s35, 31
s_mul_i32 s45, s45, 98304
s_add_u32 s44, s44, s45
s_add_u32 s44, s44, 227540992
buffer_load_dwordx4 v[16:19], v1, s[4:7], s44 offen offset:0 sc1
s_mov_b32 exec_hi, 0
buffer_load_dwordx4 v[20:23], v1, s[4:7], s44 offen offset:1024 sc1
s_mov_b32 exec_hi, -1
buffer_load_dwordx4 v[24:27], v1, s[4:7], s44 offen offset:1536 sc1
s_mov_b32 exec_hi, 0
buffer_load_dwordx4 v[28:31], v1, s[4:7], s44 offen offset:2560 sc1
s_mov_b32 exec_hi, -1
s_mov_b32 s41, 0x4e800000
v_cmp_ngt_f32 s[42:43], s41, v72
v_cmp_ngt_f32 vcc, s41, v88
s_or_b32 s41, s43, vcc_hi
v_mov_b32 v14, s41
s_lshl_b32 s42, s24, 2
s_add_u32 s42, s42, 0x14000
v_mov_b32 v15, s42
ds_write_b32 v15, v14 offset:16
s_waitcnt lgkmcnt(0)
s_barrier
v_mov_b32 v15, 0x14000
ds_read_b128 v[176:179], v15 offset:16
s_waitcnt lgkmcnt(0)
v_or3_b32 v14, v176, v177, v178
v_or_b32 v14, v14, v179
s_nop 0
v_readfirstlane_b32 s41, v14
s_cmp_eq_u32 s41, 0
s_cbranch_scc1 T_ok
s_mov_b32 s47, 1
s_waitcnt vmcnt(0)
s_barrier
s_branch T_cold
T_ok:
s_lshr_b32 s43, s25, 5
s_lshl_b32 s43, s43, 4
s_lshl_b32 s44, s24, 2
s_add_u32 s43, s43, s44
s_mul_i32 s43, s43, 20480
s_add_u32 s43, s43, 230686720
s_add_u32 s44, s43, 40960
v_bfe_u32 v12, v0, 4, 1
v_mul_u32_u24 v12, 20480, v12
v_lshl_add_u32 v12, v2, 3, v12
v_lshrrev_b32 v13, 5, v0
v_lshl_add_u32 v12, v13, 7, v12
s_and_b32 s45, s25, 31
s_mul_i32 s45, s45, 640
v_add_u32 v12, s45, v12
v_mov_b32 v176, v72
v_mov_b32 v177, v72
s_nop 1
v_permlane32_swap_b32 v176, v177
v_rcp_f32 v176, v177
s_nop 0
v_pk_mul_f32 v[64:65], v[64:65], v[176:177] op_sel_hi:[1,0]
v_pk_mul_f32 v[66:67], v[66:67], v[176:177] op_sel_hi:[1,0]
v_pk_mul_f32 v[68:69], v[68:69], v[176:177] op_sel_hi:[1,0]
v_pk_mul_f32 v[70:71], v[70:71], v[176:177] op_sel_hi:[1,0]
v_pk_mul_f32 v[72:73], v[72:73], v[176:177] op_sel_hi:[1,0]
v_pk_mul_f32 v[74:75], v[74:75], v[176:177] op_sel_hi:[1,0]
v_cvt_pk_bf16_f32 v96, v64, v65
v_cvt_pk_bf16_f32 v97, v66, v67
v_cvt_pk_bf16_f32 v98, v68, v69
v_cvt_pk_bf16_f32 v99, v70, v71
v_cvt_pk_bf16_f32 v100, v72, v73
v_cvt_pk_bf16_f32 v101, v74, v75
buffer_store_dwordx2 v[96:97], v12, s[4:7], s43 offen offset:0 sc1
buffer_store_dwordx2 v[98:99], v12, s[4:7], s43 offen offset:256 sc1
s_mov_b32 exec_hi, 0
buffer_store_dwordx2 v[100:101], v12, s[4:7], s43 offen offset:512 sc1
s_mov_b32 exec_hi, -1
v_mov_b32 v176, v88
v_mov_b32 v177, v88
s_nop 1
v_permlane32_swap_b32 v176, v177
v_rcp_f32 v176, v177
s_nop 0
v_pk_mul_f32 v[80:81], v[80:81], v[176:177] op_sel_hi:[1,0]
v_pk_mul_f32 v[82:83], v[82:83], v[176:177] op_sel_hi:[1,0]
v_pk_mul_f32 v[84:85], v[84:85], v[176:177] op_sel_hi:[1,0]
v_pk_mul_f32 v[86:87], v[86:87], v[176:177] op_sel_hi:[1,0]
v_pk_mul_f32 v[88:89], v[88:89], v[176:177] op_sel_hi:[1,0]
v_pk_mul_f32 v[90:91], v[90:91], v[176:177] op_sel_hi:[1,0]
v_cvt_pk_bf16_f32 v104, v80, v81
v_cvt_pk_bf16_f32 v105, v82, v83
v_cvt_pk_bf16_f32 v106, v84, v85
v_cvt_pk_bf16_f32 v107, v86, v87
v_cvt_pk_bf16_f32 v108, v88, v89
v_cvt_pk_bf16_f32 v109, v90, v91
buffer_store_dwordx2 v[104:105], v12, s[4:7], s44 offen offset:0 sc1
buffer_store_dwordx2 v[106:107], v12, s[4:7], s44 offen offset:256 sc1
s_mov_b32 exec_hi, 0
buffer_store_dwordx2 v[108:109], v12, s[4:7], s44 offen offset:512 sc1
s_mov_b32 exec_hi, -1
s_lshl_b32 s33, s25, 7
s_add_u32 s33, s33, 4231168
s_mov_b32 s25, s35
s_cmp_ge_u32 s25, 256
s_cbranch_scc1 T_fin
s_cmp_lg_u32 s47, 0
s_cbranch_scc1 T_rs
s_waitcnt vmcnt(6)
s_branch T_go
T_rs:
s_mov_b32 s47, 0
s_waitcnt vmcnt(0)
s_barrier
s_branch T_cold
T_fin:
s_waitcnt vmcnt(0)
s_barrier
s_add_u32 s61, s57, 1
v_mov_b32 v14, s61
v_mov_b32 v15, 0
s_mov_b64 exec, 1
buffer_store_dword v14, v15, s[4:7], s33 offen sc1
s_mov_b64 exec, -1
s_branch L_F
T_safe:
v_mfma_f32_32x32x16_bf16 v[112:127], v[144:147], v[24:27], v[48:63]
v_max3_f32 v176, v96, v97, v98
v_max3_f32 v177, v99, v100, v101
v_max3_f32 v176, v176, v102, v103
v_max3_f32 v177, v177, v104, v105
v_max3_f32 v176, v176, v106, v107
v_max3_f32 v177, v177, v108, v109
v_max3_f32 v176, v176, v110, v111
v_max_f32 v176, v176, v177
v_cmp_lt_f32 vcc, s46, v176
s_cbranch_vccnz T_r0
T_b0:
v_mfma_f32_32x32x16_bf16 v[80:95], v[168:171], v[136:139], v[80:95]
v_exp_f32 v96, v96
v_exp_f32 v97, v97
v_exp_f32 v98, v98
v_mfma_f32_32x32x16_bf16 v[112:127], v[148:151], v[28:31], v[112:127]
v_exp_f32 v99, v99
v_exp_f32 v100, v100
v_exp_f32 v101, v101
v_mfma_f32_32x32x16_bf16 v[80:95], v[172:175], v[140:143], v[80:95]
ds_read_b128 v[152:155], v8 offset:3072
ds_read_b128 v[156:159], v9 offset:3072
v_exp_f32 v102, v102
v_exp_f32 v103, v103
v_exp_f32 v104, v104
v_exp_f32 v105, v105
v_exp_f32 v106, v106
v_exp_f32 v107, v107
v_exp_f32 v108, v108
v_exp_f32 v109, v109
v_exp_f32 v110, v110
v_exp_f32 v111, v111
v_cvt_pk_bf16_f32 v128, v96, v97
v_cvt_pk_bf16_f32 v129, v98, v99
v_cvt_pk_bf16_f32 v130, v100, v101
v_cvt_pk_bf16_f32 v131, v102, v103
v_cvt_pk_bf16_f32 v132, v104, v105
v_cvt_pk_bf16_f32 v133, v106, v107
v_cvt_pk_bf16_f32 v134, v108, v109
v_cvt_pk_bf16_f32 v135, v110, v111
s_waitcnt lgkmcnt(0)
v_mfma_f32_32x32x16_bf16 v[96:111], v[152:155], v[16:19], v[32:47]
v_max3_f32 v176, v112, v113, v114
v_max3_f32 v177, v115, v116, v117
v_max3_f32 v176, v176, v118, v119
v_max3_f32 v177, v177, v120, v121
v_max3_f32 v176, v176, v122, v123
v_max3_f32 v177, v177, v124, v125
v_max3_f32 v176, v176, v126, v127
v_max_f32 v176, v176, v177
v_cmp_lt_f32 vcc, s46, v176
s_cbranch_vccnz T_r1
T_b1:
v_mfma_f32_32x32x16_bf16 v[64:79], v[160:163], v[128:131], v[64:79]
v_exp_f32 v112, v112
v_exp_f32 v113, v113
v_exp_f32 v114, v114
v_mfma_f32_32x32x16_bf16 v[96:111], v[156:159], v[20:23], v[96:111]
v_exp_f32 v115, v115
v_exp_f32 v116, v116
v_exp_f32 v117, v117
v_mfma_f32_32x32x16_bf16 v[64:79], v[164:167], v[132:135], v[64:79]
ds_read_b128 v[168:171], v10 offset:3072
ds_read_b128 v[172:175], v10 offset:3744
v_exp_f32 v118, v118
v_exp_f32 v119, v119
v_exp_f32 v120, v120
v_exp_f32 v121, v121
v_exp_f32 v122, v122
v_exp_f32 v123, v123
v_exp_f32 v124, v124
v_exp_f32 v125, v125
v_exp_f32 v126, v126
v_exp_f32 v127, v127
v_cvt_pk_bf16_f32 v136, v112, v113
v_cvt_pk_bf16_f32 v137, v114, v115
v_cvt_pk_bf16_f32 v138, v116, v117
v_cvt_pk_bf16_f32 v139, v118, v119
v_cvt_pk_bf16_f32 v140, v120, v121
v_cvt_pk_bf16_f32 v141, v122, v123
v_cvt_pk_bf16_f32 v142, v124, v125
v_cvt_pk_bf16_f32 v143, v126, v127
v_mfma_f32_32x32x16_bf16 v[112:127], v[152:155], v[24:27], v[48:63]
v_max3_f32 v176, v96, v97, v98
v_max3_f32 v177, v99, v100, v101
v_max3_f32 v176, v176, v102, v103
v_max3_f32 v177, v177, v104, v105
v_max3_f32 v176, v176, v106, v107
v_max3_f32 v177, v177, v108, v109
v_max3_f32 v176, v176, v110, v111
v_max_f32 v176, v176, v177
v_cmp_lt_f32 vcc, s46, v176
s_cbranch_vccnz T_r2
T_b2:
v_mfma_f32_32x32x16_bf16 v[80:95], v[160:163], v[136:139], v[80:95]
v_exp_f32 v96, v96
v_exp_f32 v97, v97
v_exp_f32 v98, v98
v_mfma_f32_32x32x16_bf16 v[112:127], v[156:159], v[28:31], v[112:127]
v_exp_f32 v99, v99
v_exp_f32 v100, v100
v_exp_f32 v101, v101
v_mfma_f32_32x32x16_bf16 v[80:95], v[164:167], v[140:143], v[80:95]
ds_read_b128 v[144:147], v8 offset:6144
ds_read_b128 v[148:151], v9 offset:6144
v_exp_f32 v102, v102
v_exp_f32 v103, v103
v_exp_f32 v104, v104
v_exp_f32 v105, v105
v_exp_f32 v106, v106
v_exp_f32 v107, v107
v_exp_f32 v108, v108
v_exp_f32 v109, v109
v_exp_f32 v110, v110
v_exp_f32 v111, v111
v_cvt_pk_bf16_f32 v128, v96, v97
v_cvt_pk_bf16_f32 v129, v98, v99
v_cvt_pk_bf16_f32 v130, v100, v101
v_cvt_pk_bf16_f32 v131, v102, v103
v_cvt_pk_bf16_f32 v132, v104, v105
v_cvt_pk_bf16_f32 v133, v106, v107
v_cvt_pk_bf16_f32 v134, v108, v109
v_cvt_pk_bf16_f32 v135, v110, v111
s_waitcnt lgkmcnt(0)
v_mfma_f32_32x32x16_bf16 v[96:111], v[144:147], v[16:19], v[32:47]
v_max3_f32 v176, v112, v113, v114
v_max3_f32 v177, v115, v116, v117
v_max3_f32 v176, v176, v118, v119
v_max3_f32 v177, v177, v120, v121
v_max3_f32 v176, v176, v122, v123
v_max3_f32 v177, v177, v124, v125
v_max3_f32 v176, v176, v126, v127
v_max_f32 v176, v176, v177
v_cmp_lt_f32 vcc, s46, v176
s_cbranch_vccnz T_r3
T_b3:
v_mfma_f32_32x32x16_bf16 v[64:79], v[168:171], v[128:131], v[64:79]
v_exp_f32 v112, v112
v_exp_f32 v113, v113
v_exp_f32 v114, v114
v_mfma_f32_32x32x16_bf16 v[96:111], v[148:151], v[20:23], v[96:111]
v_exp_f32 v115, v115
v_exp_f32 v116, v116
v_exp_f32 v117, v117
v_mfma_f32_32x32x16_bf16 v[64:79], v[172:175], v[132:135], v[64:79]
ds_read_b128 v[160:163], v10 offset:6144
ds_read_b128 v[164:167], v10 offset:6816
v_exp_f32 v118, v118
v_exp_f32 v119, v119
v_exp_f32 v120, v120
v_exp_f32 v121, v121
v_exp_f32 v122, v122
v_exp_f32 v123, v123
v_exp_f32 v124, v124
v_exp_f32 v125, v125
v_exp_f32 v126, v126
v_exp_f32 v127, v127
v_cvt_pk_bf16_f32 v136, v112, v113
v_cvt_pk_bf16_f32 v137, v114, v115
v_cvt_pk_bf16_f32 v138, v116, v117
v_cvt_pk_bf16_f32 v139, v118, v119
v_cvt_pk_bf16_f32 v140, v120, v121
v_cvt_pk_bf16_f32 v141, v122, v123
v_cvt_pk_bf16_f32 v142, v124, v125
v_cvt_pk_bf16_f32 v143, v126, v127
v_mfma_f32_32x32x16_bf16 v[112:127], v[144:147], v[24:27], v[48:63]
v_max3_f32 v176, v96, v97, v98
v_max3_f32 v177, v99, v100, v101
v_max3_f32 v176, v176, v102, v103
v_max3_f32 v177, v177, v104, v105
v_max3_f32 v176, v176, v106, v107
v_max3_f32 v177, v177, v108, v109
v_max3_f32 v176, v176, v110, v111
v_max_f32 v176, v176, v177
v_cmp_lt_f32 vcc, s46, v176
s_cbranch_vccnz T_r4
T_b4:
v_mfma_f32_32x32x16_bf16 v[80:95], v[168:171], v[136:139], v[80:95]
v_exp_f32 v96, v96
v_exp_f32 v97, v97
v_exp_f32 v98, v98
v_mfma_f32_32x32x16_bf16 v[112:127], v[148:151], v[28:31], v[112:127]
v_exp_f32 v99, v99
v_exp_f32 v100, v100
v_exp_f32 v101, v101
v_mfma_f32_32x32x16_bf16 v[80:95], v[172:175], v[140:143], v[80:95]
ds_read_b128 v[152:155], v8 offset:9216
ds_read_b128 v[156:159], v9 offset:9216
v_exp_f32 v102, v102
v_exp_f32 v103, v103
v_exp_f32 v104, v104
v_exp_f32 v105, v105
v_exp_f32 v106, v106
v_exp_f32 v107, v107
v_exp_f32 v108, v108
v_exp_f32 v109, v109
v_exp_f32 v110, v110
v_exp_f32 v111, v111
v_cvt_pk_bf16_f32 v128, v96, v97
v_cvt_pk_bf16_f32 v129, v98, v99
v_cvt_pk_bf16_f32 v130, v100, v101
v_cvt_pk_bf16_f32 v131, v102, v103
v_cvt_pk_bf16_f32 v132, v104, v105
v_cvt_pk_bf16_f32 v133, v106, v107
v_cvt_pk_bf16_f32 v134, v108, v109
v_cvt_pk_bf16_f32 v135, v110, v111
s_waitcnt lgkmcnt(0)
v_mfma_f32_32x32x16_bf16 v[96:111], v[152:155], v[16:19], v[32:47]
v_max3_f32 v176, v112, v113, v114
v_max3_f32 v177, v115, v116, v117
v_max3_f32 v176, v176, v118, v119
v_max3_f32 v177, v177, v120, v121
v_max3_f32 v176, v176, v122, v123
v_max3_f32 v177, v177, v124, v125
v_max3_f32 v176, v176, v126, v127
v_max_f32 v176, v176, v177
v_cmp_lt_f32 vcc, s46, v176
s_cbranch_vccnz T_r5
T_b5:
v_mfma_f32_32x32x16_bf16 v[64:79], v[160:163], v[128:131], v[64:79]
v_exp_f32 v112, v112
v_exp_f32 v113, v113
v_exp_f32 v114, v114
v_mfma_f32_32x32x16_bf16 v[96:111], v[156:159], v[20:23], v[96:111]
v_exp_f32 v115, v115
v_exp_f32 v116, v116
v_exp_f32 v117, v117
v_mfma_f32_32x32x16_bf16 v[64:79], v[164:167], v[132:135], v[64:79]
ds_read_b128 v[168:171], v10 offset:9216
ds_read_b128 v[172:175], v10 offset:9888
v_exp_f32 v118, v118
v_exp_f32 v119, v119
v_exp_f32 v120, v120
v_exp_f32 v121, v121
v_exp_f32 v122, v122
v_exp_f32 v123, v123
v_exp_f32 v124, v124
v_exp_f32 v125, v125
v_exp_f32 v126, v126
v_exp_f32 v127, v127
v_cvt_pk_bf16_f32 v136, v112, v113
v_cvt_pk_bf16_f32 v137, v114, v115
v_cvt_pk_bf16_f32 v138, v116, v117
v_cvt_pk_bf16_f32 v139, v118, v119
v_cvt_pk_bf16_f32 v140, v120, v121
v_cvt_pk_bf16_f32 v141, v122, v123
v_cvt_pk_bf16_f32 v142, v124, v125
v_cvt_pk_bf16_f32 v143, v126, v127
v_mfma_f32_32x32x16_bf16 v[112:127], v[152:155], v[24:27], v[48:63]
v_max3_f32 v176, v96, v97, v98
v_max3_f32 v177, v99, v100, v101
v_max3_f32 v176, v176, v102, v103
v_max3_f32 v177, v177, v104, v105
v_max3_f32 v176, v176, v106, v107
v_max3_f32 v177, v177, v108, v109
v_max3_f32 v176, v176, v110, v111
v_max_f32 v176, v176, v177
v_cmp_lt_f32 vcc, s46, v176
s_cbranch_vccnz T_r6
T_b6:
v_mfma_f32_32x32x16_bf16 v[80:95], v[160:163], v[136:139], v[80:95]
v_exp_f32 v96, v96
v_exp_f32 v97, v97
v_exp_f32 v98, v98
v_mfma_f32_32x32x16_bf16 v[112:127], v[156:159], v[28:31], v[112:127]
v_exp_f32 v99, v99
v_exp_f32 v100, v100
v_exp_f32 v101, v101
v_mfma_f32_32x32x16_bf16 v[80:95], v[164:167], v[140:143], v[80:95]
ds_read_b128 v[144:147], v8 offset:12288
ds_read_b128 v[148:151], v9 offset:12288
v_exp_f32 v102, v102
v_exp_f32 v103, v103
v_exp_f32 v104, v104
v_exp_f32 v105, v105
v_exp_f32 v106, v106
v_exp_f32 v107, v107
v_exp_f32 v108, v108
v_exp_f32 v109, v109
v_exp_f32 v110, v110
v_exp_f32 v111, v111
v_cvt_pk_bf16_f32 v128, v96, v97
v_cvt_pk_bf16_f32 v129, v98, v99
v_cvt_pk_bf16_f32 v130, v100, v101
v_cvt_pk_bf16_f32 v131, v102, v103
v_cvt_pk_bf16_f32 v132, v104, v105
v_cvt_pk_bf16_f32 v133, v106, v107
v_cvt_pk_bf16_f32 v134, v108, v109
v_cvt_pk_bf16_f32 v135, v110, v111
s_waitcnt lgkmcnt(0)
v_mfma_f32_32x32x16_bf16 v[96:111], v[144:147], v[16:19], v[32:47]
v_max3_f32 v176, v112, v113, v114
v_max3_f32 v177, v115, v116, v117
v_max3_f32 v176, v176, v118, v119
v_max3_f32 v177, v177, v120, v121
v_max3_f32 v176, v176, v122, v123
v_max3_f32 v177, v177, v124, v125
v_max3_f32 v176, v176, v126, v127
v_max_f32 v176, v176, v177
v_cmp_lt_f32 vcc, s46, v176
s_cbranch_vccnz T_r7
T_b7:
v_mfma_f32_32x32x16_bf16 v[64:79], v[168:171], v[128:131], v[64:79]
v_exp_f32 v112, v112
v_exp_f32 v113, v113
v_exp_f32 v114, v114
v_mfma_f32_32x32x16_bf16 v[96:111], v[148:151], v[20:23], v[96:111]
v_exp_f32 v115, v115
v_exp_f32 v116, v116
v_exp_f32 v117, v117
v_mfma_f32_32x32x16_bf16 v[64:79], v[172:175], v[132:135], v[64:79]
ds_read_b128 v[160:163], v10 offset:12288
ds_read_b128 v[164:167], v10 offset:12960
v_exp_f32 v118, v118
v_exp_f32 v119, v119
v_exp_f32 v120, v120
v_exp_f32 v121, v121
v_exp_f32 v122, v122
v_exp_f32 v123, v123
v_exp_f32 v124, v124
v_exp_f32 v125, v125
v_exp_f32 v126, v126
v_exp_f32 v127, v127
v_cvt_pk_bf16_f32 v136, v112, v113
v_cvt_pk_bf16_f32 v137, v114, v115
v_cvt_pk_bf16_f32 v138, v116, v117
v_cvt_pk_bf16_f32 v139, v118, v119
v_cvt_pk_bf16_f32 v140, v120, v121
v_cvt_pk_bf16_f32 v141, v122, v123
v_cvt_pk_bf16_f32 v142, v124, v125
v_cvt_pk_bf16_f32 v143, v126, v127
v_mfma_f32_32x32x16_bf16 v[112:127], v[144:147], v[24:27], v[48:63]
v_max3_f32 v176, v96, v97, v98
v_max3_f32 v177, v99, v100, v101
v_max3_f32 v176, v176, v102, v103
v_max3_f32 v177, v177, v104, v105
v_max3_f32 v176, v176, v106, v107
v_max3_f32 v177, v177, v108, v109
v_max3_f32 v176, v176, v110, v111
v_max_f32 v176, v176, v177
v_cmp_lt_f32 vcc, s46, v176
s_cbranch_vccnz T_r8
T_b8:
v_mfma_f32_32x32x16_bf16 v[80:95], v[168:171], v[136:139], v[80:95]
v_exp_f32 v96, v96
v_exp_f32 v97, v97
v_exp_f32 v98, v98
v_mfma_f32_32x32x16_bf16 v[112:127], v[148:151], v[28:31], v[112:127]
v_exp_f32 v99, v99
v_exp_f32 v100, v100
v_exp_f32 v101, v101
v_mfma_f32_32x32x16_bf16 v[80:95], v[172:175], v[140:143], v[80:95]
ds_read_b128 v[152:155], v8 offset:15360
ds_read_b128 v[156:159], v9 offset:15360
v_exp_f32 v102, v102
v_exp_f32 v103, v103
v_exp_f32 v104, v104
v_exp_f32 v105, v105
v_exp_f32 v106, v106
v_exp_f32 v107, v107
v_exp_f32 v108, v108
v_exp_f32 v109, v109
v_exp_f32 v110, v110
v_exp_f32 v111, v111
v_cvt_pk_bf16_f32 v128, v96, v97
v_cvt_pk_bf16_f32 v129, v98, v99
v_cvt_pk_bf16_f32 v130, v100, v101
v_cvt_pk_bf16_f32 v131, v102, v103
v_cvt_pk_bf16_f32 v132, v104, v105
v_cvt_pk_bf16_f32 v133, v106, v107
v_cvt_pk_bf16_f32 v134, v108, v109
v_cvt_pk_bf16_f32 v135, v110, v111
s_waitcnt lgkmcnt(0)
v_mfma_f32_32x32x16_bf16 v[96:111], v[152:155], v[16:19], v[32:47]
v_max3_f32 v176, v112, v113, v114
v_max3_f32 v177, v115, v116, v117
v_max3_f32 v176, v176, v118, v119
v_max3_f32 v177, v177, v120, v121
v_max3_f32 v176, v176, v122, v123
v_max3_f32 v177, v177, v124, v125
v_max3_f32 v176, v176, v126, v127
v_max_f32 v176, v176, v177
v_cmp_lt_f32 vcc, s46, v176
s_cbranch_vccnz T_r9
T_b9:
v_mfma_f32_32x32x16_bf16 v[64:79], v[160:163], v[128:131], v[64:79]
v_exp_f32 v112, v112
v_exp_f32 v113, v113
v_exp_f32 v114, v114
v_mfma_f32_32x32x16_bf16 v[96:111], v[156:159], v[20:23], v[96:111]
v_exp_f32 v115, v115
v_exp_f32 v116, v116
v_exp_f32 v117, v117
v_mfma_f32_32x32x16_bf16 v[64:79], v[164:167], v[132:135], v[64:79]
ds_read_b128 v[168:171], v10 offset:15360
ds_read_b128 v[172:175], v10 offset:16032
v_exp_f32 v118, v118
v_exp_f32 v119, v119
v_exp_f32 v120, v120
v_exp_f32 v121, v121
v_exp_f32 v122, v122
v_exp_f32 v123, v123
v_exp_f32 v124, v124
v_exp_f32 v125, v125
v_exp_f32 v126, v126
v_exp_f32 v127, v127
v_cvt_pk_bf16_f32 v136, v112, v113
v_cvt_pk_bf16_f32 v137, v114, v115
v_cvt_pk_bf16_f32 v138, v116, v117
v_cvt_pk_bf16_f32 v139, v118, v119
v_cvt_pk_bf16_f32 v140, v120, v121
v_cvt_pk_bf16_f32 v141, v122, v123
v_cvt_pk_bf16_f32 v142, v124, v125
v_cvt_pk_bf16_f32 v143, v126, v127
s_waitcnt vmcnt(0)
s_barrier
s_cmp_eq_u32 s40, 6
s_cselect_b32 s30, s32, s30
s_add_u32 s38, s38, 24576
s_cmp_eq_u32 s38, 73728
s_cselect_b32 s38, 0, s38
v_add_u32 v11, s38, v1
v_add_u32 v12, s38, v5
v_add_u32 v13, s38, v6
v_mfma_f32_32x32x16_bf16 v[112:127], v[152:155], v[24:27], v[48:63]
v_max3_f32 v176, v96, v97, v98
v_max3_f32 v177, v99, v100, v101
v_max3_f32 v176, v176, v102, v103
v_max3_f32 v177, v177, v104, v105
v_max3_f32 v176, v176, v106, v107
v_max3_f32 v177, v177, v108, v109
v_max3_f32 v176, v176, v110, v111
v_max_f32 v176, v176, v177
v_cmp_lt_f32 vcc, s46, v176
s_cbranch_vccnz T_r10
T_b10:
v_mfma_f32_32x32x16_bf16 v[80:95], v[160:163], v[136:139], v[80:95]
v_exp_f32 v96, v96
v_exp_f32 v97, v97
v_exp_f32 v98, v98
v_mfma_f32_32x32x16_bf16 v[112:127], v[156:159], v[28:31], v[112:127]
v_exp_f32 v99, v99
v_exp_f32 v100, v100
v_exp_f32 v101, v101
v_mfma_f32_32x32x16_bf16 v[80:95], v[164:167], v[140:143], v[80:95]
ds_read_b128 v[144:147], v8 offset:18432
ds_read_b128 v[148:151], v9 offset:18432
v_exp_f32 v102, v102
v_exp_f32 v103, v103
v_exp_f32 v104, v104
v_exp_f32 v105, v105
v_exp_f32 v106, v106
v_exp_f32 v107, v107
v_exp_f32 v108, v108
v_exp_f32 v109, v109
v_exp_f32 v110, v110
v_exp_f32 v111, v111
s_mov_b32 m0, s37
s_add_u32 s41, s30, 4096
buffer_load_dwordx4 v1, s[4:7], s30 offen sc1 lds
buffer_load_dwordx4 v1, s[4:7], s30 offen offset:1024 sc1 lds
v_cvt_pk_bf16_f32 v128, v96, v97
v_cvt_pk_bf16_f32 v129, v98, v99
v_cvt_pk_bf16_f32 v130, v100, v101
v_cvt_pk_bf16_f32 v131, v102, v103
v_cvt_pk_bf16_f32 v132, v104, v105
v_cvt_pk_bf16_f32 v133, v106, v107
v_cvt_pk_bf16_f32 v134, v108, v109
v_cvt_pk_bf16_f32 v135, v110, v111
s_waitcnt lgkmcnt(0)
v_mfma_f32_32x32x16_bf16 v[96:111], v[144:147], v[16:19], v[32:47]
v_max3_f32 v176, v112, v113, v114
v_max3_f32 v177, v115, v116, v117
v_max3_f32 v176, v176, v118, v119
v_max3_f32 v177, v177, v120, v121
v_max3_f32 v176, v176, v122, v123
v_max3_f32 v177, v177, v124, v125
v_max3_f32 v176, v176, v126, v127
v_max_f32 v176, v176, v177
v_cmp_lt_f32 vcc, s46, v176
s_cbranch_vccnz T_r11
T_b11:
v_mfma_f32_32x32x16_bf16 v[64:79], v[168:171], v[128:131], v[64:79]
v_exp_f32 v112, v112
v_exp_f32 v113, v113
v_exp_f32 v114, v114
v_mfma_f32_32x32x16_bf16 v[96:111], v[148:151], v[20:23], v[96:111]
v_exp_f32 v115, v115
v_exp_f32 v116, v116
v_exp_f32 v117, v117
v_mfma_f32_32x32x16_bf16 v[64:79], v[172:175], v[132:135], v[64:79]
ds_read_b128 v[160:163], v10 offset:18432
ds_read_b128 v[164:167], v10 offset:19104
v_exp_f32 v118, v118
v_exp_f32 v119, v119
v_exp_f32 v120, v120
v_exp_f32 v121, v121
v_exp_f32 v122, v122
v_exp_f32 v123, v123
v_exp_f32 v124, v124
v_exp_f32 v125, v125
v_exp_f32 v126, v126
v_exp_f32 v127, v127
buffer_load_dwordx4 v1, s[4:7], s30 offen offset:2048 sc1 lds
buffer_load_dwordx4 v1, s[4:7], s30 offen offset:3072 sc1 lds
v_cvt_pk_bf16_f32 v136, v112, v113
v_cvt_pk_bf16_f32 v137, v114, v115
v_cvt_pk_bf16_f32 v138, v116, v117
v_cvt_pk_bf16_f32 v139, v118, v119
v_cvt_pk_bf16_f32 v140, v120, v121
v_cvt_pk_bf16_f32 v141, v122, v123
v_cvt_pk_bf16_f32 v142, v124, v125
v_cvt_pk_bf16_f32 v143, v126, v127
v_mfma_f32_32x32x16_bf16 v[112:127], v[144:147], v[24:27], v[48:63]
v_max3_f32 v176, v96, v97, v98
v_max3_f32 v177, v99, v100, v101
v_max3_f32 v176, v176, v102, v103
v_max3_f32 v177, v177, v104, v105
v_max3_f32 v176, v176, v106, v107
v_max3_f32 v177, v177, v108, v109
v_max3_f32 v176, v176, v110, v111
v_max_f32 v176, v176, v177
v_cmp_lt_f32 vcc, s46, v176
s_cbranch_vccnz T_r12
T_b12:
v_mfma_f32_32x32x16_bf16 v[80:95], v[168:171], v[136:139], v[80:95]
v_exp_f32 v96, v96
v_exp_f32 v97, v97
v_exp_f32 v98, v98
v_mfma_f32_32x32x16_bf16 v[112:127], v[148:151], v[28:31], v[112:127]
v_exp_f32 v99, v99
v_exp_f32 v100, v100
v_exp_f32 v101, v101
v_mfma_f32_32x32x16_bf16 v[80:95], v[172:175], v[140:143], v[80:95]
ds_read_b128 v[152:155], v8 offset:21504
ds_read_b128 v[156:159], v9 offset:21504
v_exp_f32 v102, v102
v_exp_f32 v103, v103
v_exp_f32 v104, v104
v_exp_f32 v105, v105
v_exp_f32 v106, v106
v_exp_f32 v107, v107
v_exp_f32 v108, v108
v_exp_f32 v109, v109
v_exp_f32 v110, v110
v_exp_f32 v111, v111
s_add_u32 m0, s37, 4096
s_add_u32 s30, s30, 24576
buffer_load_dwordx4 v1, s[4:7], s41 offen sc1 lds
buffer_load_dwordx4 v1, s[4:7], s41 offen offset:1024 sc1 lds
s_add_u32 s37, s37, 24576
s_cmp_ge_u32 s37, 73728
s_cselect_b32 s37, s31, s37
v_cvt_pk_bf16_f32 v128, v96, v97
v_cvt_pk_bf16_f32 v129, v98, v99
v_cvt_pk_bf16_f32 v130, v100, v101
v_cvt_pk_bf16_f32 v131, v102, v103
v_cvt_pk_bf16_f32 v132, v104, v105
v_cvt_pk_bf16_f32 v133, v106, v107
v_cvt_pk_bf16_f32 v134, v108, v109
v_cvt_pk_bf16_f32 v135, v110, v111
s_waitcnt lgkmcnt(0)
v_mfma_f32_32x32x16_bf16 v[96:111], v[152:155], v[16:19], v[32:47]
v_max3_f32 v176, v112, v113, v114
v_max3_f32 v177, v115, v116, v117
v_max3_f32 v176, v176, v118, v119
v_max3_f32 v177, v177, v120, v121
v_max3_f32 v176, v176, v122, v123
v_max3_f32 v177, v177, v124, v125
v_max3_f32 v176, v176, v126, v127
v_max_f32 v176, v176, v177
v_cmp_lt_f32 vcc, s46, v176
s_cbranch_vccnz T_r13
T_b13:
v_mfma_f32_32x32x16_bf16 v[64:79], v[160:163], v[128:131], v[64:79]
v_exp_f32 v112, v112
v_exp_f32 v113, v113
v_exp_f32 v114, v114
v_mfma_f32_32x32x16_bf16 v[96:111], v[156:159], v[20:23], v[96:111]
v_exp_f32 v115, v115
v_exp_f32 v116, v116
v_exp_f32 v117, v117
v_mfma_f32_32x32x16_bf16 v[64:79], v[164:167], v[132:135], v[64:79]
ds_read_b128 v[168:171], v10 offset:21504
ds_read_b128 v[172:175], v10 offset:22176
v_exp_f32 v118, v118
v_exp_f32 v119, v119
v_exp_f32 v120, v120
v_exp_f32 v121, v121
v_exp_f32 v122, v122
v_exp_f32 v123, v123
v_exp_f32 v124, v124
v_exp_f32 v125, v125
v_exp_f32 v126, v126
v_exp_f32 v127, v127
v_cvt_pk_bf16_f32 v136, v112, v113
v_cvt_pk_bf16_f32 v137, v114, v115
v_cvt_pk_bf16_f32 v138, v116, v117
v_cvt_pk_bf16_f32 v139, v118, v119
v_cvt_pk_bf16_f32 v140, v120, v121
v_cvt_pk_bf16_f32 v141, v122, v123
v_cvt_pk_bf16_f32 v142, v124, v125
v_cvt_pk_bf16_f32 v143, v126, v127
v_mfma_f32_32x32x16_bf16 v[112:127], v[152:155], v[24:27], v[48:63]
v_max3_f32 v176, v96, v97, v98
v_max3_f32 v177, v99, v100, v101
v_max3_f32 v176, v176, v102, v103
v_max3_f32 v177, v177, v104, v105
v_max3_f32 v176, v176, v106, v107
v_max3_f32 v177, v177, v108, v109
v_max3_f32 v176, v176, v110, v111
v_max_f32 v176, v176, v177
v_cmp_lt_f32 vcc, s46, v176
s_cbranch_vccnz T_r14
T_b14:
v_mfma_f32_32x32x16_bf16 v[80:95], v[160:163], v[136:139], v[80:95]
v_exp_f32 v96, v96
v_exp_f32 v97, v97
v_exp_f32 v98, v98
v_mfma_f32_32x32x16_bf16 v[112:127], v[156:159], v[28:31], v[112:127]
v_exp_f32 v99, v99
v_exp_f32 v100, v100
v_exp_f32 v101, v101
v_mfma_f32_32x32x16_bf16 v[80:95], v[164:167], v[140:143], v[80:95]
ds_read_b128 v[144:147], v11 offset:0
ds_read_b128 v[148:151], v12 offset:0
v_exp_f32 v102, v102
v_exp_f32 v103, v103
v_exp_f32 v104, v104
v_exp_f32 v105, v105
v_exp_f32 v106, v106
v_exp_f32 v107, v107
v_exp_f32 v108, v108
v_exp_f32 v109, v109
v_exp_f32 v110, v110
v_exp_f32 v111, v111
v_cvt_pk_bf16_f32 v128, v96, v97
v_cvt_pk_bf16_f32 v129, v98, v99
v_cvt_pk_bf16_f32 v130, v100, v101
v_cvt_pk_bf16_f32 v131, v102, v103
v_cvt_pk_bf16_f32 v132, v104, v105
v_cvt_pk_bf16_f32 v133, v106, v107
v_cvt_pk_bf16_f32 v134, v108, v109
v_cvt_pk_bf16_f32 v135, v110, v111
s_waitcnt lgkmcnt(0)
v_mfma_f32_32x32x16_bf16 v[96:111], v[144:147], v[16:19], v[32:47]
v_max3_f32 v176, v112, v113, v114
v_max3_f32 v177, v115, v116, v117
v_max3_f32 v176, v176, v118, v119
v_max3_f32 v177, v177, v120, v121
v_max3_f32 v176, v176, v122, v123
v_max3_f32 v177, v177, v124, v125
v_max3_f32 v176, v176, v126, v127
v_max_f32 v176, v176, v177
v_cmp_lt_f32 vcc, s46, v176
s_cbranch_vccnz T_r15
T_b15:
v_mfma_f32_32x32x16_bf16 v[64:79], v[168:171], v[128:131], v[64:79]
v_exp_f32 v112, v112
v_exp_f32 v113, v113
v_exp_f32 v114, v114
v_mfma_f32_32x32x16_bf16 v[96:111], v[148:151], v[20:23], v[96:111]
v_exp_f32 v115, v115
v_exp_f32 v116, v116
v_exp_f32 v117, v117
v_mfma_f32_32x32x16_bf16 v[64:79], v[172:175], v[132:135], v[64:79]
ds_read_b128 v[160:163], v13 offset:0
ds_read_b128 v[164:167], v13 offset:672
v_exp_f32 v118, v118
v_exp_f32 v119, v119
v_exp_f32 v120, v120
v_exp_f32 v121, v121
v_exp_f32 v122, v122
v_exp_f32 v123, v123
v_exp_f32 v124, v124
v_exp_f32 v125, v125
v_exp_f32 v126, v126
v_exp_f32 v127, v127
v_cvt_pk_bf16_f32 v136, v112, v113
v_cvt_pk_bf16_f32 v137, v114, v115
v_cvt_pk_bf16_f32 v138, v116, v117
v_cvt_pk_bf16_f32 v139, v118, v119
v_cvt_pk_bf16_f32 v140, v120, v121
v_cvt_pk_bf16_f32 v141, v122, v123
v_cvt_pk_bf16_f32 v142, v124, v125
v_cvt_pk_bf16_f32 v143, v126, v127
v_mov_b32 v8, v11
v_mov_b32 v9, v12
v_mov_b32 v10, v13
s_add_u32 s40, s40, 1
s_cmp_lt_u32 s40, 8
s_cbranch_scc1 T_safe
s_waitcnt lgkmcnt(0)
s_branch T_end
T_r0:
v_mov_b32 v177, v176
s_nop 1
v_permlane32_swap_b32 v176, v177
v_max_f32 v176, v176, v177
v_max_f32 v176, 0, v176
v_sub_f32 v178, 0, v176
v_exp_f32 v178, v178
v_sub_f32 v96, v96, v176
v_sub_f32 v32, v32, v176
v_mul_f32 v64, v64, v178
v_sub_f32 v97, v97, v176
v_sub_f32 v33, v33, v176
v_mul_f32 v65, v65, v178
v_sub_f32 v98, v98, v176
v_sub_f32 v34, v34, v176
v_mul_f32 v66, v66, v178
v_sub_f32 v99, v99, v176
v_sub_f32 v35, v35, v176
v_mul_f32 v67, v67, v178
v_sub_f32 v100, v100, v176
v_sub_f32 v36, v36, v176
v_mul_f32 v68, v68, v178
v_sub_f32 v101, v101, v176
v_sub_f32 v37, v37, v176
v_mul_f32 v69, v69, v178
v_sub_f32 v102, v102, v176
v_sub_f32 v38, v38, v176
v_mul_f32 v70, v70, v178
v_sub_f32 v103, v103, v176
v_sub_f32 v39, v39, v176
v_mul_f32 v71, v71, v178
v_sub_f32 v104, v104, v176
v_sub_f32 v40, v40, v176
v_mul_f32 v72, v72, v178
v_sub_f32 v105, v105, v176
v_sub_f32 v41, v41, v176
v_mul_f32 v73, v73, v178
v_sub_f32 v106, v106, v176
v_sub_f32 v42, v42, v176
v_mul_f32 v74, v74, v178
v_sub_f32 v107, v107, v176
v_sub_f32 v43, v43, v176
v_mul_f32 v75, v75, v178
v_sub_f32 v108, v108, v176
v_sub_f32 v44, v44, v176
v_mul_f32 v76, v76, v178
v_sub_f32 v109, v109, v176
v_sub_f32 v45, v45, v176
v_mul_f32 v77, v77, v178
v_sub_f32 v110, v110, v176
v_sub_f32 v46, v46, v176
v_mul_f32 v78, v78, v178
v_sub_f32 v111, v111, v176
v_sub_f32 v47, v47, v176
v_mul_f32 v79, v79, v178
s_branch T_b0
T_r1:
v_mov_b32 v177, v176
s_nop 1
v_permlane32_swap_b32 v176, v177
v_max_f32 v176, v176, v177
v_max_f32 v176, 0, v176
v_sub_f32 v178, 0, v176
v_exp_f32 v178, v178
v_sub_f32 v112, v112, v176
v_sub_f32 v48, v48, v176
v_mul_f32 v80, v80, v178
v_sub_f32 v113, v113, v176
v_sub_f32 v49, v49, v176
v_mul_f32 v81, v81, v178
v_sub_f32 v114, v114, v176
v_sub_f32 v50, v50, v176
v_mul_f32 v82, v82, v178
v_sub_f32 v115, v115, v176
v_sub_f32 v51, v51, v176
v_mul_f32 v83, v83, v178
v_sub_f32 v116, v116, v176
v_sub_f32 v52, v52, v176
v_mul_f32 v84, v84, v178
v_sub_f32 v117, v117, v176
v_sub_f32 v53, v53, v176
v_mul_f32 v85, v85, v178
v_sub_f32 v118, v118, v176
v_sub_f32 v54, v54, v176
v_mul_f32 v86, v86, v178
v_sub_f32 v119, v119, v176
v_sub_f32 v55, v55, v176
v_mul_f32 v87, v87, v178
v_sub_f32 v120, v120, v176
v_sub_f32 v56, v56, v176
v_mul_f32 v88, v88, v178
v_sub_f32 v121, v121, v176
v_sub_f32 v57, v57, v176
v_mul_f32 v89, v89, v178
v_sub_f32 v122, v122, v176
v_sub_f32 v58, v58, v176
v_mul_f32 v90, v90, v178
v_sub_f32 v123, v123, v176
v_sub_f32 v59, v59, v176
v_mul_f32 v91, v91, v178
v_sub_f32 v124, v124, v176
v_sub_f32 v60, v60, v176
v_mul_f32 v92, v92, v178
v_sub_f32 v125, v125, v176
v_sub_f32 v61, v61, v176
v_mul_f32 v93, v93, v178
v_sub_f32 v126, v126, v176
v_sub_f32 v62, v62, v176
v_mul_f32 v94, v94, v178
v_sub_f32 v127, v127, v176
v_sub_f32 v63, v63, v176
v_mul_f32 v95, v95, v178
s_branch T_b1
T_r2:
v_mov_b32 v177, v176
s_nop 1
v_permlane32_swap_b32 v176, v177
v_max_f32 v176, v176, v177
v_max_f32 v176, 0, v176
v_sub_f32 v178, 0, v176
v_exp_f32 v178, v178
v_sub_f32 v96, v96, v176
v_sub_f32 v32, v32, v176
v_mul_f32 v64, v64, v178
v_sub_f32 v97, v97, v176
v_sub_f32 v33, v33, v176
v_mul_f32 v65, v65, v178
v_sub_f32 v98, v98, v176
v_sub_f32 v34, v34, v176
v_mul_f32 v66, v66, v178
v_sub_f32 v99, v99, v176
v_sub_f32 v35, v35, v176
v_mul_f32 v67, v67, v178
v_sub_f32 v100, v100, v176
v_sub_f32 v36, v36, v176
v_mul_f32 v68, v68, v178
v_sub_f32 v101, v101, v176
v_sub_f32 v37, v37, v176
v_mul_f32 v69, v69, v178
v_sub_f32 v102, v102, v176
v_sub_f32 v38, v38, v176
v_mul_f32 v70, v70, v178
v_sub_f32 v103, v103, v176
v_sub_f32 v39, v39, v176
v_mul_f32 v71, v71, v178
v_sub_f32 v104, v104, v176
v_sub_f32 v40, v40, v176
v_mul_f32 v72, v72, v178
v_sub_f32 v105, v105, v176
v_sub_f32 v41, v41, v176
v_mul_f32 v73, v73, v178
v_sub_f32 v106, v106, v176
v_sub_f32 v42, v42, v176
v_mul_f32 v74, v74, v178
v_sub_f32 v107, v107, v176
v_sub_f32 v43, v43, v176
v_mul_f32 v75, v75, v178
v_sub_f32 v108, v108, v176
v_sub_f32 v44, v44, v176
v_mul_f32 v76, v76, v178
v_sub_f32 v109, v109, v176
v_sub_f32 v45, v45, v176
v_mul_f32 v77, v77, v178
v_sub_f32 v110, v110, v176
v_sub_f32 v46, v46, v176
v_mul_f32 v78, v78, v178
v_sub_f32 v111, v111, v176
v_sub_f32 v47, v47, v176
v_mul_f32 v79, v79, v178
s_branch T_b2
T_r3:
v_mov_b32 v177, v176
s_nop 1
v_permlane32_swap_b32 v176, v177
v_max_f32 v176, v176, v177
v_max_f32 v176, 0, v176
v_sub_f32 v178, 0, v176
v_exp_f32 v178, v178
v_sub_f32 v112, v112, v176
v_sub_f32 v48, v48, v176
v_mul_f32 v80, v80, v178
v_sub_f32 v113, v113, v176
v_sub_f32 v49, v49, v176
v_mul_f32 v81, v81, v178
v_sub_f32 v114, v114, v176
v_sub_f32 v50, v50, v176
v_mul_f32 v82, v82, v178
v_sub_f32 v115, v115, v176
v_sub_f32 v51, v51, v176
v_mul_f32 v83, v83, v178
v_sub_f32 v116, v116, v176
v_sub_f32 v52, v52, v176
v_mul_f32 v84, v84, v178
v_sub_f32 v117, v117, v176
v_sub_f32 v53, v53, v176
v_mul_f32 v85, v85, v178
v_sub_f32 v118, v118, v176
v_sub_f32 v54, v54, v176
v_mul_f32 v86, v86, v178
v_sub_f32 v119, v119, v176
v_sub_f32 v55, v55, v176
v_mul_f32 v87, v87, v178
v_sub_f32 v120, v120, v176
v_sub_f32 v56, v56, v176
v_mul_f32 v88, v88, v178
v_sub_f32 v121, v121, v176
v_sub_f32 v57, v57, v176
v_mul_f32 v89, v89, v178
v_sub_f32 v122, v122, v176
v_sub_f32 v58, v58, v176
v_mul_f32 v90, v90, v178
v_sub_f32 v123, v123, v176
v_sub_f32 v59, v59, v176
v_mul_f32 v91, v91, v178
v_sub_f32 v124, v124, v176
v_sub_f32 v60, v60, v176
v_mul_f32 v92, v92, v178
v_sub_f32 v125, v125, v176
v_sub_f32 v61, v61, v176
v_mul_f32 v93, v93, v178
v_sub_f32 v126, v126, v176
v_sub_f32 v62, v62, v176
v_mul_f32 v94, v94, v178
v_sub_f32 v127, v127, v176
v_sub_f32 v63, v63, v176
v_mul_f32 v95, v95, v178
s_branch T_b3
T_r4:
v_mov_b32 v177, v176
s_nop 1
v_permlane32_swap_b32 v176, v177
v_max_f32 v176, v176, v177
v_max_f32 v176, 0, v176
v_sub_f32 v178, 0, v176
v_exp_f32 v178, v178
v_sub_f32 v96, v96, v176
v_sub_f32 v32, v32, v176
v_mul_f32 v64, v64, v178
v_sub_f32 v97, v97, v176
v_sub_f32 v33, v33, v176
v_mul_f32 v65, v65, v178
v_sub_f32 v98, v98, v176
v_sub_f32 v34, v34, v176
v_mul_f32 v66, v66, v178
v_sub_f32 v99, v99, v176
v_sub_f32 v35, v35, v176
v_mul_f32 v67, v67, v178
v_sub_f32 v100, v100, v176
v_sub_f32 v36, v36, v176
v_mul_f32 v68, v68, v178
v_sub_f32 v101, v101, v176
v_sub_f32 v37, v37, v176
v_mul_f32 v69, v69, v178
v_sub_f32 v102, v102, v176
v_sub_f32 v38, v38, v176
v_mul_f32 v70, v70, v178
v_sub_f32 v103, v103, v176
v_sub_f32 v39, v39, v176
v_mul_f32 v71, v71, v178
v_sub_f32 v104, v104, v176
v_sub_f32 v40, v40, v176
v_mul_f32 v72, v72, v178
v_sub_f32 v105, v105, v176
v_sub_f32 v41, v41, v176
v_mul_f32 v73, v73, v178
v_sub_f32 v106, v106, v176
v_sub_f32 v42, v42, v176
v_mul_f32 v74, v74, v178
v_sub_f32 v107, v107, v176
v_sub_f32 v43, v43, v176
v_mul_f32 v75, v75, v178
v_sub_f32 v108, v108, v176
v_sub_f32 v44, v44, v176
v_mul_f32 v76, v76, v178
v_sub_f32 v109, v109, v176
v_sub_f32 v45, v45, v176
v_mul_f32 v77, v77, v178
v_sub_f32 v110, v110, v176
v_sub_f32 v46, v46, v176
v_mul_f32 v78, v78, v178
v_sub_f32 v111, v111, v176
v_sub_f32 v47, v47, v176
v_mul_f32 v79, v79, v178
s_branch T_b4
T_r5:
v_mov_b32 v177, v176
s_nop 1
v_permlane32_swap_b32 v176, v177
v_max_f32 v176, v176, v177
v_max_f32 v176, 0, v176
v_sub_f32 v178, 0, v176
v_exp_f32 v178, v178
v_sub_f32 v112, v112, v176
v_sub_f32 v48, v48, v176
v_mul_f32 v80, v80, v178
v_sub_f32 v113, v113, v176
v_sub_f32 v49, v49, v176
v_mul_f32 v81, v81, v178
v_sub_f32 v114, v114, v176
v_sub_f32 v50, v50, v176
v_mul_f32 v82, v82, v178
v_sub_f32 v115, v115, v176
v_sub_f32 v51, v51, v176
v_mul_f32 v83, v83, v178
v_sub_f32 v116, v116, v176
v_sub_f32 v52, v52, v176
v_mul_f32 v84, v84, v178
v_sub_f32 v117, v117, v176
v_sub_f32 v53, v53, v176
v_mul_f32 v85, v85, v178
v_sub_f32 v118, v118, v176
v_sub_f32 v54, v54, v176
v_mul_f32 v86, v86, v178
v_sub_f32 v119, v119, v176
v_sub_f32 v55, v55, v176
v_mul_f32 v87, v87, v178
v_sub_f32 v120, v120, v176
v_sub_f32 v56, v56, v176
v_mul_f32 v88, v88, v178
v_sub_f32 v121, v121, v176
v_sub_f32 v57, v57, v176
v_mul_f32 v89, v89, v178
v_sub_f32 v122, v122, v176
v_sub_f32 v58, v58, v176
v_mul_f32 v90, v90, v178
v_sub_f32 v123, v123, v176
v_sub_f32 v59, v59, v176
v_mul_f32 v91, v91, v178
v_sub_f32 v124, v124, v176
v_sub_f32 v60, v60, v176
v_mul_f32 v92, v92, v178
v_sub_f32 v125, v125, v176
v_sub_f32 v61, v61, v176
v_mul_f32 v93, v93, v178
v_sub_f32 v126, v126, v176
v_sub_f32 v62, v62, v176
v_mul_f32 v94, v94, v178
v_sub_f32 v127, v127, v176
v_sub_f32 v63, v63, v176
v_mul_f32 v95, v95, v178
s_branch T_b5
T_r6:
v_mov_b32 v177, v176
s_nop 1
v_permlane32_swap_b32 v176, v177
v_max_f32 v176, v176, v177
v_max_f32 v176, 0, v176
v_sub_f32 v178, 0, v176
v_exp_f32 v178, v178
v_sub_f32 v96, v96, v176
v_sub_f32 v32, v32, v176
v_mul_f32 v64, v64, v178
v_sub_f32 v97, v97, v176
v_sub_f32 v33, v33, v176
v_mul_f32 v65, v65, v178
v_sub_f32 v98, v98, v176
v_sub_f32 v34, v34, v176
v_mul_f32 v66, v66, v178
v_sub_f32 v99, v99, v176
v_sub_f32 v35, v35, v176
v_mul_f32 v67, v67, v178
v_sub_f32 v100, v100, v176
v_sub_f32 v36, v36, v176
v_mul_f32 v68, v68, v178
v_sub_f32 v101, v101, v176
v_sub_f32 v37, v37, v176
v_mul_f32 v69, v69, v178
v_sub_f32 v102, v102, v176
v_sub_f32 v38, v38, v176
v_mul_f32 v70, v70, v178
v_sub_f32 v103, v103, v176
v_sub_f32 v39, v39, v176
v_mul_f32 v71, v71, v178
v_sub_f32 v104, v104, v176
v_sub_f32 v40, v40, v176
v_mul_f32 v72, v72, v178
v_sub_f32 v105, v105, v176
v_sub_f32 v41, v41, v176
v_mul_f32 v73, v73, v178
v_sub_f32 v106, v106, v176
v_sub_f32 v42, v42, v176
v_mul_f32 v74, v74, v178
v_sub_f32 v107, v107, v176
v_sub_f32 v43, v43, v176
v_mul_f32 v75, v75, v178
v_sub_f32 v108, v108, v176
v_sub_f32 v44, v44, v176
v_mul_f32 v76, v76, v178
v_sub_f32 v109, v109, v176
v_sub_f32 v45, v45, v176
v_mul_f32 v77, v77, v178
v_sub_f32 v110, v110, v176
v_sub_f32 v46, v46, v176
v_mul_f32 v78, v78, v178
v_sub_f32 v111, v111, v176
v_sub_f32 v47, v47, v176
v_mul_f32 v79, v79, v178
s_branch T_b6
T_r7:
v_mov_b32 v177, v176
s_nop 1
v_permlane32_swap_b32 v176, v177
v_max_f32 v176, v176, v177
v_max_f32 v176, 0, v176
v_sub_f32 v178, 0, v176
v_exp_f32 v178, v178
v_sub_f32 v112, v112, v176
v_sub_f32 v48, v48, v176
v_mul_f32 v80, v80, v178
v_sub_f32 v113, v113, v176
v_sub_f32 v49, v49, v176
v_mul_f32 v81, v81, v178
v_sub_f32 v114, v114, v176
v_sub_f32 v50, v50, v176
v_mul_f32 v82, v82, v178
v_sub_f32 v115, v115, v176
v_sub_f32 v51, v51, v176
v_mul_f32 v83, v83, v178
v_sub_f32 v116, v116, v176
v_sub_f32 v52, v52, v176
v_mul_f32 v84, v84, v178
v_sub_f32 v117, v117, v176
v_sub_f32 v53, v53, v176
v_mul_f32 v85, v85, v178
v_sub_f32 v118, v118, v176
v_sub_f32 v54, v54, v176
v_mul_f32 v86, v86, v178
v_sub_f32 v119, v119, v176
v_sub_f32 v55, v55, v176
v_mul_f32 v87, v87, v178
v_sub_f32 v120, v120, v176
v_sub_f32 v56, v56, v176
v_mul_f32 v88, v88, v178
v_sub_f32 v121, v121, v176
v_sub_f32 v57, v57, v176
v_mul_f32 v89, v89, v178
v_sub_f32 v122, v122, v176
v_sub_f32 v58, v58, v176
v_mul_f32 v90, v90, v178
v_sub_f32 v123, v123, v176
v_sub_f32 v59, v59, v176
v_mul_f32 v91, v91, v178
v_sub_f32 v124, v124, v176
v_sub_f32 v60, v60, v176
v_mul_f32 v92, v92, v178
v_sub_f32 v125, v125, v176
v_sub_f32 v61, v61, v176
v_mul_f32 v93, v93, v178
v_sub_f32 v126, v126, v176
v_sub_f32 v62, v62, v176
v_mul_f32 v94, v94, v178
v_sub_f32 v127, v127, v176
v_sub_f32 v63, v63, v176
v_mul_f32 v95, v95, v178
s_branch T_b7
T_r8:
v_mov_b32 v177, v176
s_nop 1
v_permlane32_swap_b32 v176, v177
v_max_f32 v176, v176, v177
v_max_f32 v176, 0, v176
v_sub_f32 v178, 0, v176
v_exp_f32 v178, v178
v_sub_f32 v96, v96, v176
v_sub_f32 v32, v32, v176
v_mul_f32 v64, v64, v178
v_sub_f32 v97, v97, v176
v_sub_f32 v33, v33, v176
v_mul_f32 v65, v65, v178
v_sub_f32 v98, v98, v176
v_sub_f32 v34, v34, v176
v_mul_f32 v66, v66, v178
v_sub_f32 v99, v99, v176
v_sub_f32 v35, v35, v176
v_mul_f32 v67, v67, v178
v_sub_f32 v100, v100, v176
v_sub_f32 v36, v36, v176
v_mul_f32 v68, v68, v178
v_sub_f32 v101, v101, v176
v_sub_f32 v37, v37, v176
v_mul_f32 v69, v69, v178
v_sub_f32 v102, v102, v176
v_sub_f32 v38, v38, v176
v_mul_f32 v70, v70, v178
v_sub_f32 v103, v103, v176
v_sub_f32 v39, v39, v176
v_mul_f32 v71, v71, v178
v_sub_f32 v104, v104, v176
v_sub_f32 v40, v40, v176
v_mul_f32 v72, v72, v178
v_sub_f32 v105, v105, v176
v_sub_f32 v41, v41, v176
v_mul_f32 v73, v73, v178
v_sub_f32 v106, v106, v176
v_sub_f32 v42, v42, v176
v_mul_f32 v74, v74, v178
v_sub_f32 v107, v107, v176
v_sub_f32 v43, v43, v176
v_mul_f32 v75, v75, v178
v_sub_f32 v108, v108, v176
v_sub_f32 v44, v44, v176
v_mul_f32 v76, v76, v178
v_sub_f32 v109, v109, v176
v_sub_f32 v45, v45, v176
v_mul_f32 v77, v77, v178
v_sub_f32 v110, v110, v176
v_sub_f32 v46, v46, v176
v_mul_f32 v78, v78, v178
v_sub_f32 v111, v111, v176
v_sub_f32 v47, v47, v176
v_mul_f32 v79, v79, v178
s_branch T_b8
T_r9:
v_mov_b32 v177, v176
s_nop 1
v_permlane32_swap_b32 v176, v177
v_max_f32 v176, v176, v177
v_max_f32 v176, 0, v176
v_sub_f32 v178, 0, v176
v_exp_f32 v178, v178
v_sub_f32 v112, v112, v176
v_sub_f32 v48, v48, v176
v_mul_f32 v80, v80, v178
v_sub_f32 v113, v113, v176
v_sub_f32 v49, v49, v176
v_mul_f32 v81, v81, v178
v_sub_f32 v114, v114, v176
v_sub_f32 v50, v50, v176
v_mul_f32 v82, v82, v178
v_sub_f32 v115, v115, v176
v_sub_f32 v51, v51, v176
v_mul_f32 v83, v83, v178
v_sub_f32 v116, v116, v176
v_sub_f32 v52, v52, v176
v_mul_f32 v84, v84, v178
v_sub_f32 v117, v117, v176
v_sub_f32 v53, v53, v176
v_mul_f32 v85, v85, v178
v_sub_f32 v118, v118, v176
v_sub_f32 v54, v54, v176
v_mul_f32 v86, v86, v178
v_sub_f32 v119, v119, v176
v_sub_f32 v55, v55, v176
v_mul_f32 v87, v87, v178
v_sub_f32 v120, v120, v176
v_sub_f32 v56, v56, v176
v_mul_f32 v88, v88, v178
v_sub_f32 v121, v121, v176
v_sub_f32 v57, v57, v176
v_mul_f32 v89, v89, v178
v_sub_f32 v122, v122, v176
v_sub_f32 v58, v58, v176
v_mul_f32 v90, v90, v178
v_sub_f32 v123, v123, v176
v_sub_f32 v59, v59, v176
v_mul_f32 v91, v91, v178
v_sub_f32 v124, v124, v176
v_sub_f32 v60, v60, v176
v_mul_f32 v92, v92, v178
v_sub_f32 v125, v125, v176
v_sub_f32 v61, v61, v176
v_mul_f32 v93, v93, v178
v_sub_f32 v126, v126, v176
v_sub_f32 v62, v62, v176
v_mul_f32 v94, v94, v178
v_sub_f32 v127, v127, v176
v_sub_f32 v63, v63, v176
v_mul_f32 v95, v95, v178
s_branch T_b9
T_r10:
v_mov_b32 v177, v176
s_nop 1
v_permlane32_swap_b32 v176, v177
v_max_f32 v176, v176, v177
v_max_f32 v176, 0, v176
v_sub_f32 v178, 0, v176
v_exp_f32 v178, v178
v_sub_f32 v96, v96, v176
v_sub_f32 v32, v32, v176
v_mul_f32 v64, v64, v178
v_sub_f32 v97, v97, v176
v_sub_f32 v33, v33, v176
v_mul_f32 v65, v65, v178
v_sub_f32 v98, v98, v176
v_sub_f32 v34, v34, v176
v_mul_f32 v66, v66, v178
v_sub_f32 v99, v99, v176
v_sub_f32 v35, v35, v176
v_mul_f32 v67, v67, v178
v_sub_f32 v100, v100, v176
v_sub_f32 v36, v36, v176
v_mul_f32 v68, v68, v178
v_sub_f32 v101, v101, v176
v_sub_f32 v37, v37, v176
v_mul_f32 v69, v69, v178
v_sub_f32 v102, v102, v176
v_sub_f32 v38, v38, v176
v_mul_f32 v70, v70, v178
v_sub_f32 v103, v103, v176
v_sub_f32 v39, v39, v176
v_mul_f32 v71, v71, v178
v_sub_f32 v104, v104, v176
v_sub_f32 v40, v40, v176
v_mul_f32 v72, v72, v178
v_sub_f32 v105, v105, v176
v_sub_f32 v41, v41, v176
v_mul_f32 v73, v73, v178
v_sub_f32 v106, v106, v176
v_sub_f32 v42, v42, v176
v_mul_f32 v74, v74, v178
v_sub_f32 v107, v107, v176
v_sub_f32 v43, v43, v176
v_mul_f32 v75, v75, v178
v_sub_f32 v108, v108, v176
v_sub_f32 v44, v44, v176
v_mul_f32 v76, v76, v178
v_sub_f32 v109, v109, v176
v_sub_f32 v45, v45, v176
v_mul_f32 v77, v77, v178
v_sub_f32 v110, v110, v176
v_sub_f32 v46, v46, v176
v_mul_f32 v78, v78, v178
v_sub_f32 v111, v111, v176
v_sub_f32 v47, v47, v176
v_mul_f32 v79, v79, v178
s_branch T_b10
T_r11:
v_mov_b32 v177, v176
s_nop 1
v_permlane32_swap_b32 v176, v177
v_max_f32 v176, v176, v177
v_max_f32 v176, 0, v176
v_sub_f32 v178, 0, v176
v_exp_f32 v178, v178
v_sub_f32 v112, v112, v176
v_sub_f32 v48, v48, v176
v_mul_f32 v80, v80, v178
v_sub_f32 v113, v113, v176
v_sub_f32 v49, v49, v176
v_mul_f32 v81, v81, v178
v_sub_f32 v114, v114, v176
v_sub_f32 v50, v50, v176
v_mul_f32 v82, v82, v178
v_sub_f32 v115, v115, v176
v_sub_f32 v51, v51, v176
v_mul_f32 v83, v83, v178
v_sub_f32 v116, v116, v176
v_sub_f32 v52, v52, v176
v_mul_f32 v84, v84, v178
v_sub_f32 v117, v117, v176
v_sub_f32 v53, v53, v176
v_mul_f32 v85, v85, v178
v_sub_f32 v118, v118, v176
v_sub_f32 v54, v54, v176
v_mul_f32 v86, v86, v178
v_sub_f32 v119, v119, v176
v_sub_f32 v55, v55, v176
v_mul_f32 v87, v87, v178
v_sub_f32 v120, v120, v176
v_sub_f32 v56, v56, v176
v_mul_f32 v88, v88, v178
v_sub_f32 v121, v121, v176
v_sub_f32 v57, v57, v176
v_mul_f32 v89, v89, v178
v_sub_f32 v122, v122, v176
v_sub_f32 v58, v58, v176
v_mul_f32 v90, v90, v178
v_sub_f32 v123, v123, v176
v_sub_f32 v59, v59, v176
v_mul_f32 v91, v91, v178
v_sub_f32 v124, v124, v176
v_sub_f32 v60, v60, v176
v_mul_f32 v92, v92, v178
v_sub_f32 v125, v125, v176
v_sub_f32 v61, v61, v176
v_mul_f32 v93, v93, v178
v_sub_f32 v126, v126, v176
v_sub_f32 v62, v62, v176
v_mul_f32 v94, v94, v178
v_sub_f32 v127, v127, v176
v_sub_f32 v63, v63, v176
v_mul_f32 v95, v95, v178
s_branch T_b11
T_r12:
v_mov_b32 v177, v176
s_nop 1
v_permlane32_swap_b32 v176, v177
v_max_f32 v176, v176, v177
v_max_f32 v176, 0, v176
v_sub_f32 v178, 0, v176
v_exp_f32 v178, v178
v_sub_f32 v96, v96, v176
v_sub_f32 v32, v32, v176
v_mul_f32 v64, v64, v178
v_sub_f32 v97, v97, v176
v_sub_f32 v33, v33, v176
v_mul_f32 v65, v65, v178
v_sub_f32 v98, v98, v176
v_sub_f32 v34, v34, v176
v_mul_f32 v66, v66, v178
v_sub_f32 v99, v99, v176
v_sub_f32 v35, v35, v176
v_mul_f32 v67, v67, v178
v_sub_f32 v100, v100, v176
v_sub_f32 v36, v36, v176
v_mul_f32 v68, v68, v178
v_sub_f32 v101, v101, v176
v_sub_f32 v37, v37, v176
v_mul_f32 v69, v69, v178
v_sub_f32 v102, v102, v176
v_sub_f32 v38, v38, v176
v_mul_f32 v70, v70, v178
v_sub_f32 v103, v103, v176
v_sub_f32 v39, v39, v176
v_mul_f32 v71, v71, v178
v_sub_f32 v104, v104, v176
v_sub_f32 v40, v40, v176
v_mul_f32 v72, v72, v178
v_sub_f32 v105, v105, v176
v_sub_f32 v41, v41, v176
v_mul_f32 v73, v73, v178
v_sub_f32 v106, v106, v176
v_sub_f32 v42, v42, v176
v_mul_f32 v74, v74, v178
v_sub_f32 v107, v107, v176
v_sub_f32 v43, v43, v176
v_mul_f32 v75, v75, v178
v_sub_f32 v108, v108, v176
v_sub_f32 v44, v44, v176
v_mul_f32 v76, v76, v178
v_sub_f32 v109, v109, v176
v_sub_f32 v45, v45, v176
v_mul_f32 v77, v77, v178
v_sub_f32 v110, v110, v176
v_sub_f32 v46, v46, v176
v_mul_f32 v78, v78, v178
v_sub_f32 v111, v111, v176
v_sub_f32 v47, v47, v176
v_mul_f32 v79, v79, v178
s_branch T_b12
T_r13:
v_mov_b32 v177, v176
s_nop 1
v_permlane32_swap_b32 v176, v177
v_max_f32 v176, v176, v177
v_max_f32 v176, 0, v176
v_sub_f32 v178, 0, v176
v_exp_f32 v178, v178
v_sub_f32 v112, v112, v176
v_sub_f32 v48, v48, v176
v_mul_f32 v80, v80, v178
v_sub_f32 v113, v113, v176
v_sub_f32 v49, v49, v176
v_mul_f32 v81, v81, v178
v_sub_f32 v114, v114, v176
v_sub_f32 v50, v50, v176
v_mul_f32 v82, v82, v178
v_sub_f32 v115, v115, v176
v_sub_f32 v51, v51, v176
v_mul_f32 v83, v83, v178
v_sub_f32 v116, v116, v176
v_sub_f32 v52, v52, v176
v_mul_f32 v84, v84, v178
v_sub_f32 v117, v117, v176
v_sub_f32 v53, v53, v176
v_mul_f32 v85, v85, v178
v_sub_f32 v118, v118, v176
v_sub_f32 v54, v54, v176
v_mul_f32 v86, v86, v178
v_sub_f32 v119, v119, v176
v_sub_f32 v55, v55, v176
v_mul_f32 v87, v87, v178
v_sub_f32 v120, v120, v176
v_sub_f32 v56, v56, v176
v_mul_f32 v88, v88, v178
v_sub_f32 v121, v121, v176
v_sub_f32 v57, v57, v176
v_mul_f32 v89, v89, v178
v_sub_f32 v122, v122, v176
v_sub_f32 v58, v58, v176
v_mul_f32 v90, v90, v178
v_sub_f32 v123, v123, v176
v_sub_f32 v59, v59, v176
v_mul_f32 v91, v91, v178
v_sub_f32 v124, v124, v176
v_sub_f32 v60, v60, v176
v_mul_f32 v92, v92, v178
v_sub_f32 v125, v125, v176
v_sub_f32 v61, v61, v176
v_mul_f32 v93, v93, v178
v_sub_f32 v126, v126, v176
v_sub_f32 v62, v62, v176
v_mul_f32 v94, v94, v178
v_sub_f32 v127, v127, v176
v_sub_f32 v63, v63, v176
v_mul_f32 v95, v95, v178
s_branch T_b13
T_r14:
v_mov_b32 v177, v176
s_nop 1
v_permlane32_swap_b32 v176, v177
v_max_f32 v176, v176, v177
v_max_f32 v176, 0, v176
v_sub_f32 v178, 0, v176
v_exp_f32 v178, v178
v_sub_f32 v96, v96, v176
v_sub_f32 v32, v32, v176
v_mul_f32 v64, v64, v178
v_sub_f32 v97, v97, v176
v_sub_f32 v33, v33, v176
v_mul_f32 v65, v65, v178
v_sub_f32 v98, v98, v176
v_sub_f32 v34, v34, v176
v_mul_f32 v66, v66, v178
v_sub_f32 v99, v99, v176
v_sub_f32 v35, v35, v176
v_mul_f32 v67, v67, v178
v_sub_f32 v100, v100, v176
v_sub_f32 v36, v36, v176
v_mul_f32 v68, v68, v178
v_sub_f32 v101, v101, v176
v_sub_f32 v37, v37, v176
v_mul_f32 v69, v69, v178
v_sub_f32 v102, v102, v176
v_sub_f32 v38, v38, v176
v_mul_f32 v70, v70, v178
v_sub_f32 v103, v103, v176
v_sub_f32 v39, v39, v176
v_mul_f32 v71, v71, v178
v_sub_f32 v104, v104, v176
v_sub_f32 v40, v40, v176
v_mul_f32 v72, v72, v178
v_sub_f32 v105, v105, v176
v_sub_f32 v41, v41, v176
v_mul_f32 v73, v73, v178
v_sub_f32 v106, v106, v176
v_sub_f32 v42, v42, v176
v_mul_f32 v74, v74, v178
v_sub_f32 v107, v107, v176
v_sub_f32 v43, v43, v176
v_mul_f32 v75, v75, v178
v_sub_f32 v108, v108, v176
v_sub_f32 v44, v44, v176
v_mul_f32 v76, v76, v178
v_sub_f32 v109, v109, v176
v_sub_f32 v45, v45, v176
v_mul_f32 v77, v77, v178
v_sub_f32 v110, v110, v176
v_sub_f32 v46, v46, v176
v_mul_f32 v78, v78, v178
v_sub_f32 v111, v111, v176
v_sub_f32 v47, v47, v176
v_mul_f32 v79, v79, v178
s_branch T_b14
T_r15:
v_mov_b32 v177, v176
s_nop 1
v_permlane32_swap_b32 v176, v177
v_max_f32 v176, v176, v177
v_max_f32 v176, 0, v176
v_sub_f32 v178, 0, v176
v_exp_f32 v178, v178
v_sub_f32 v112, v112, v176
v_sub_f32 v48, v48, v176
v_mul_f32 v80, v80, v178
v_sub_f32 v113, v113, v176
v_sub_f32 v49, v49, v176
v_mul_f32 v81, v81, v178
v_sub_f32 v114, v114, v176
v_sub_f32 v50, v50, v176
v_mul_f32 v82, v82, v178
v_sub_f32 v115, v115, v176
v_sub_f32 v51, v51, v176
v_mul_f32 v83, v83, v178
v_sub_f32 v116, v116, v176
v_sub_f32 v52, v52, v176
v_mul_f32 v84, v84, v178
v_sub_f32 v117, v117, v176
v_sub_f32 v53, v53, v176
v_mul_f32 v85, v85, v178
v_sub_f32 v118, v118, v176
v_sub_f32 v54, v54, v176
v_mul_f32 v86, v86, v178
v_sub_f32 v119, v119, v176
v_sub_f32 v55, v55, v176
v_mul_f32 v87, v87, v178
v_sub_f32 v120, v120, v176
v_sub_f32 v56, v56, v176
v_mul_f32 v88, v88, v178
v_sub_f32 v121, v121, v176
v_sub_f32 v57, v57, v176
v_mul_f32 v89, v89, v178
v_sub_f32 v122, v122, v176
v_sub_f32 v58, v58, v176
v_mul_f32 v90, v90, v178
v_sub_f32 v123, v123, v176
v_sub_f32 v59, v59, v176
v_mul_f32 v91, v91, v178
v_sub_f32 v124, v124, v176
v_sub_f32 v60, v60, v176
v_mul_f32 v92, v92, v178
v_sub_f32 v125, v125, v176
v_sub_f32 v61, v61, v176
v_mul_f32 v93, v93, v178
v_sub_f32 v126, v126, v176
v_sub_f32 v62, v62, v176
v_mul_f32 v94, v94, v178
v_sub_f32 v127, v127, v176
v_sub_f32 v63, v63, v176
v_mul_f32 v95, v95, v178
s_branch T_b15
L_F:
s_and_b32 s41, s2, 7
s_lshr_b32 s42, s2, 3
s_and_b32 s26, s42, 7
s_lshr_b32 s42, s42, 3
s_lshl_b32 s42, s42, 2
s_add_u32 s29, s41, s42
s_sub_u32 s29, s29, 4
s_cmp_lt_u32 s41, 4
s_cselect_b32 s29, 64, s29
s_cmp_ge_u32 s29, 64
s_cbranch_scc1 L_fin
s_mul_i32 s30, s26, 160
s_mul_i32 s31, s24, 204800
s_mov_b32 s12, s82
s_and_b32 s13, s83, 0xffff
s_mov_b32 s14, 0xc8000
s_mov_b32 s15, 0x20000
s_mul_i32 s28, s24, 25600
v_add_u32 v24, 0, v0
v_mul_u32_u24 v25, 104858, v24
v_lshrrev_b32 v25, 20, v25
v_mul_u32_u24 v27, 10, v25
v_sub_u32 v26, v24, v27
v_mul_u32_u24 v25, 1280, v25
v_lshlrev_b32 v26, 4, v26
v_add3_u32 v16, v25, v26, s30
v_add_u32 v24, 64, v0
v_mul_u32_u24 v25, 104858, v24
v_lshrrev_b32 v25, 20, v25
v_mul_u32_u24 v27, 10, v25
v_sub_u32 v26, v24, v27
v_mul_u32_u24 v25, 1280, v25
v_lshlrev_b32 v26, 4, v26
v_add3_u32 v17, v25, v26, s30
v_add_u32 v24, 128, v0
v_mul_u32_u24 v25, 104858, v24
v_lshrrev_b32 v25, 20, v25
v_mul_u32_u24 v27, 10, v25
v_sub_u32 v26, v24, v27
v_mul_u32_u24 v25, 1280, v25
v_lshlrev_b32 v26, 4, v26
v_add3_u32 v18, v25, v26, s30
v_add_u32 v24, 192, v0
v_mul_u32_u24 v25, 104858, v24
v_lshrrev_b32 v25, 20, v25
v_mul_u32_u24 v27, 10, v25
v_sub_u32 v26, v24, v27
v_mul_u32_u24 v25, 1280, v25
v_lshlrev_b32 v26, 4, v26
v_add3_u32 v19, v25, v26, s30
v_add_u32 v24, 256, v0
v_mul_u32_u24 v25, 104858, v24
v_lshrrev_b32 v25, 20, v25
v_mul_u32_u24 v27, 10, v25
v_sub_u32 v26, v24, v27
v_mul_u32_u24 v25, 1280, v25
v_lshlrev_b32 v26, 4, v26
v_add3_u32 v20, v25, v26, s30
v_bfe_u32 v24, v0, 2, 2
v_mad_u32_u24 v24, v3, 8, v24
v_mul_u32_u24 v24, 160, v24
v_and_b32 v25, 3, v0
v_lshlrev_b32 v25, 3, v25
v_add3_u32 v5, v24, v25, s28
s_add_u32 s60, s31, 0
s_add_u32 m0, s28, 0
s_nop 0
buffer_load_dwordx4 v16, s[12:15], s60 offen lds
s_add_u32 m0, s28, 1024
s_nop 0
buffer_load_dwordx4 v17, s[12:15], s60 offen lds
s_add_u32 m0, s28, 2048
s_nop 0
buffer_load_dwordx4 v18, s[12:15], s60 offen lds
s_add_u32 m0, s28, 3072
s_nop 0
buffer_load_dwordx4 v19, s[12:15], s60 offen lds
s_add_u32 m0, s28, 4096
s_nop 0
buffer_load_dwordx4 v20, s[12:15], s60 offen lds
s_add_u32 s60, s31, 40960
s_add_u32 m0, s28, 5120
s_nop 0
buffer_load_dwordx4 v16, s[12:15], s60 offen lds
s_add_u32 m0, s28, 6144
s_nop 0
buffer_load_dwordx4 v17, s[12:15], s60 offen lds
s_add_u32 m0, s28, 7168
s_nop 0
buffer_load_dwordx4 v18, s[12:15], s60 offen lds
s_add_u32 m0, s28, 8192
s_nop 0
buffer_load_dwordx4 v19, s[12:15], s60 offen lds
s_add_u32 m0, s28, 9216
s_nop 0
buffer_load_dwordx4 v20, s[12:15], s60 offen lds
s_add_u32 s60, s31, 81920
s_add_u32 m0, s28, 10240
s_nop 0
buffer_load_dwordx4 v16, s[12:15], s60 offen lds
s_add_u32 m0, s28, 11264
s_nop 0
buffer_load_dwordx4 v17, s[12:15], s60 offen lds
s_add_u32 m0, s28, 12288
s_nop 0
buffer_load_dwordx4 v18, s[12:15], s60 offen lds
s_add_u32 m0, s28, 13312
s_nop 0
buffer_load_dwordx4 v19, s[12:15], s60 offen lds
s_add_u32 m0, s28, 14336
s_nop 0
buffer_load_dwordx4 v20, s[12:15], s60 offen lds
s_add_u32 s60, s31, 122880
s_add_u32 m0, s28, 15360
s_nop 0
buffer_load_dwordx4 v16, s[12:15], s60 offen lds
s_add_u32 m0, s28, 16384
s_nop 0
buffer_load_dwordx4 v17, s[12:15], s60 offen lds
s_add_u32 m0, s28, 17408
s_nop 0
buffer_load_dwordx4 v18, s[12:15], s60 offen lds
s_add_u32 m0, s28, 18432
s_nop 0
buffer_load_dwordx4 v19, s[12:15], s60 offen lds
s_add_u32 m0, s28, 19456
s_nop 0
buffer_load_dwordx4 v20, s[12:15], s60 offen lds
s_add_u32 s60, s31, 163840
s_add_u32 m0, s28, 20480
s_nop 0
buffer_load_dwordx4 v16, s[12:15], s60 offen lds
s_add_u32 m0, s28, 21504
s_nop 0
buffer_load_dwordx4 v17, s[12:15], s60 offen lds
s_add_u32 m0, s28, 22528
s_nop 0
buffer_load_dwordx4 v18, s[12:15], s60 offen lds
s_add_u32 m0, s28, 23552
s_nop 0
buffer_load_dwordx4 v19, s[12:15], s60 offen lds
s_add_u32 m0, s28, 24576
s_nop 0
buffer_load_dwordx4 v20, s[12:15], s60 offen lds
s_waitcnt vmcnt(20)
ds_read_b64_tr_b16 a[0:1], v5 offset:0
ds_read_b64_tr_b16 a[2:3], v5 offset:640
ds_read_b64_tr_b16 a[4:5], v5 offset:32
ds_read_b64_tr_b16 a[6:7], v5 offset:672
ds_read_b64_tr_b16 a[8:9], v5 offset:64
ds_read_b64_tr_b16 a[10:11], v5 offset:704
ds_read_b64_tr_b16 a[12:13], v5 offset:96
ds_read_b64_tr_b16 a[14:15], v5 offset:736
ds_read_b64_tr_b16 a[16:17], v5 offset:128
ds_read_b64_tr_b16 a[18:19], v5 offset:768
s_waitcnt lgkmcnt(0)
s_waitcnt vmcnt(15)
ds_read_b64_tr_b16 a[20:21], v5 offset:5120
ds_read_b64_tr_b16 a[22:23], v5 offset:5760
ds_read_b64_tr_b16 a[24:25], v5 offset:5152
ds_read_b64_tr_b16 a[26:27], v5 offset:5792
ds_read_b64_tr_b16 a[28:29], v5 offset:5184
ds_read_b64_tr_b16 a[30:31], v5 offset:5824
ds_read_b64_tr_b16 a[32:33], v5 offset:5216
ds_read_b64_tr_b16 a[34:35], v5 offset:5856
ds_read_b64_tr_b16 a[36:37], v5 offset:5248
ds_read_b64_tr_b16 a[38:39], v5 offset:5888
s_waitcnt lgkmcnt(0)
s_waitcnt vmcnt(10)
ds_read_b64_tr_b16 a[40:41], v5 offset:10240
ds_read_b64_tr_b16 a[42:43], v5 offset:10880
ds_read_b64_tr_b16 a[44:45], v5 offset:10272
ds_read_b64_tr_b16 a[46:47], v5 offset:10912
ds_read_b64_tr_b16 a[48:49], v5 offset:10304
ds_read_b64_tr_b16 a[50:51], v5 offset:10944
ds_read_b64_tr_b16 a[52:53], v5 offset:10336
ds_read_b64_tr_b16 a[54:55], v5 offset:10976
ds_read_b64_tr_b16 a[56:57], v5 offset:10368
ds_read_b64_tr_b16 a[58:59], v5 offset:11008
s_waitcnt lgkmcnt(0)
s_waitcnt vmcnt(5)
ds_read_b64_tr_b16 a[60:61], v5 offset:15360
ds_read_b64_tr_b16 a[62:63], v5 offset:16000
ds_read_b64_tr_b16 a[64:65], v5 offset:15392
ds_read_b64_tr_b16 a[66:67], v5 offset:16032
ds_read_b64_tr_b16 a[68:69], v5 offset:15424
ds_read_b64_tr_b16 a[70:71], v5 offset:16064
ds_read_b64_tr_b16 a[72:73], v5 offset:15456
ds_read_b64_tr_b16 a[74:75], v5 offset:16096
ds_read_b64_tr_b16 a[76:77], v5 offset:15488
ds_read_b64_tr_b16 a[78:79], v5 offset:16128
s_waitcnt lgkmcnt(0)
s_waitcnt vmcnt(0)
ds_read_b64_tr_b16 a[80:81], v5 offset:20480
ds_read_b64_tr_b16 a[82:83], v5 offset:21120
ds_read_b64_tr_b16 a[84:85], v5 offset:20512
ds_read_b64_tr_b16 a[86:87], v5 offset:21152
ds_read_b64_tr_b16 a[88:89], v5 offset:20544
ds_read_b64_tr_b16 a[90:91], v5 offset:21184
ds_read_b64_tr_b16 a[92:93], v5 offset:20576
ds_read_b64_tr_b16 a[94:95], v5 offset:21216
ds_read_b64_tr_b16 a[96:97], v5 offset:20608
ds_read_b64_tr_b16 a[98:99], v5 offset:21248
s_waitcnt lgkmcnt(0)
s_waitcnt vmcnt(0)
s_mov_b32 s16, s86
s_and_b32 s17, s87, 0xffff
s_mov_b32 s18, 0x280000
s_mov_b32 s19, 0x20000
v_and_b32 v12, 15, v0
s_lshl_b32 s41, s24, 4
v_add_u32 v6, s41, v12
v_lshlrev_b32 v6, 7, v6
v_and_b32 v7, 7, v0
s_lshl_b32 s41, s24, 3
s_add_u32 s41, s41, 32
v_add_u32 v7, s41, v7
v_lshlrev_b32 v7, 7, v7
v_and_b32 v8, 31, v0
v_lshlrev_b32 v8, 7, v8
v_mul_u32_u24 v9, 2560, v3
v_lshl_add_u32 v9, v2, 4, v9
v_lshlrev_b32 v10, 3, v2
v_lshl_add_u32 v11, v3, 8, v10
s_mul_i32 s41, s24, 10240
v_add_u32 v4, s41, v1
v_lshrrev_b32 v12, 3, v0
v_and_b32 v12, 7, v12
s_lshl_b32 s41, s24, 3
v_add_u32 v12, s41, v12
v_and_b32 v13, 7, v0
v_add_u32 v13, 0, v13
v_mul_u32_u24 v14, 1280, v12
v_lshl_add_u32 v232, v13, 4, v14
v_lshrrev_b32 v14, 4, v12
v_mul_u32_u24 v14, 5120, v14
v_and_b32 v12, 15, v12
v_lshl_add_u32 v14, v12, 4, v14
v_lshl_add_u32 v234, v13, 9, v14
v_lshrrev_b32 v12, 1, v0
v_and_b32 v12, 7, v12
s_lshl_b32 s41, s24, 3
v_add_u32 v12, s41, v12
v_and_b32 v13, 1, v0
v_add_u32 v13, 8, v13
v_mul_u32_u24 v14, 1280, v12
v_lshl_add_u32 v233, v13, 4, v14
v_lshrrev_b32 v14, 4, v12
v_mul_u32_u24 v14, 5120, v14
v_and_b32 v12, 15, v12
v_lshl_add_u32 v14, v12, 4, v14
v_lshl_add_u32 v235, v13, 9, v14
s_mov_b32 s40, s29
F_loop:
s_lshr_b32 s41, s40, 3
s_lshl_b32 s41, s41, 12
s_add_u32 s41, s41, 4231168
s_mov_b32 s62, 0
s_add_u32 s61, s57, 1
s_branch F_t_go
F_t:
v_readfirstlane_b32 s60, v14
s_sleep 16
s_cmp_ge_i32 s60, -1
s_cbranch_scc1 F_t_go
s_sleep 48
F_t_go:
s_add_u32 s62, s62, 1
s_mov_b32 s63, 13
s_cmp_gt_u32 s62, 400000
s_cbranch_scc1 L_err
buffer_load_dword v14, v8, s[4:7], s41 offen sc1
s_waitcnt vmcnt(0)
v_subrev_u32 v14, s61, v14
v_cmp_lt_u32 vcc, 64, v14
s_cbranch_vccnz F_t
s_mul_i32 s41, s40, 40960
s_mul_i32 s42, s24, 5120
s_add_u32 s41, s41, s42
s_add_u32 s41, s41, 230686720
buffer_load_dwordx2 v[16:17], v11, s[4:7], s41 offen offset:0 sc1
buffer_load_dwordx2 v[18:19], v11, s[4:7], s41 offen offset:128 sc1
s_add_u32 s41, s41, 1024
buffer_load_dwordx2 v[20:21], v11, s[4:7], s41 offen offset:0 sc1
buffer_load_dwordx2 v[22:23], v11, s[4:7], s41 offen offset:128 sc1
s_add_u32 s41, s41, 1024
buffer_load_dwordx2 v[24:25], v11, s[4:7], s41 offen offset:0 sc1
buffer_load_dwordx2 v[26:27], v11, s[4:7], s41 offen offset:128 sc1
s_add_u32 s41, s41, 1024
buffer_load_dwordx2 v[28:29], v11, s[4:7], s41 offen offset:0 sc1
buffer_load_dwordx2 v[30:31], v11, s[4:7], s41 offen offset:128 sc1
s_add_u32 s41, s41, 1024
buffer_load_dwordx2 v[32:33], v11, s[4:7], s41 offen offset:0 sc1
buffer_load_dwordx2 v[34:35], v11, s[4:7], s41 offen offset:128 sc1
s_add_u32 s41, s41, 16384
buffer_load_dwordx2 v[36:37], v11, s[4:7], s41 offen offset:0 sc1
buffer_load_dwordx2 v[38:39], v11, s[4:7], s41 offen offset:128 sc1
s_add_u32 s41, s41, 1024
buffer_load_dwordx2 v[40:41], v11, s[4:7], s41 offen offset:0 sc1
buffer_load_dwordx2 v[42:43], v11, s[4:7], s41 offen offset:128 sc1
s_add_u32 s41, s41, 1024
buffer_load_dwordx2 v[44:45], v11, s[4:7], s41 offen offset:0 sc1
buffer_load_dwordx2 v[46:47], v11, s[4:7], s41 offen offset:128 sc1
s_add_u32 s41, s41, 1024
buffer_load_dwordx2 v[48:49], v11, s[4:7], s41 offen offset:0 sc1
buffer_load_dwordx2 v[50:51], v11, s[4:7], s41 offen offset:128 sc1
s_add_u32 s41, s41, 1024
buffer_load_dwordx2 v[52:53], v11, s[4:7], s41 offen offset:0 sc1
buffer_load_dwordx2 v[54:55], v11, s[4:7], s41 offen offset:128 sc1
s_add_u32 s41, s41, 16384
s_lshl_b32 s41, s40, 8
s_add_u32 s41, s41, 233308160
buffer_load_dwordx2 v[216:217], v10, s[4:7], s41 offen sc1
buffer_load_dwordx2 v[218:219], v10, s[4:7], s41 offen offset:128 sc1
s_lshr_b32 s45, s40, 4
s_cmp_lt_u32 s45, s71
s_cbranch_scc1 F_nu
s_and_b32 s41, s40, 1
s_lshl_b32 s41, s41, 13
s_add_u32 s41, s41, 4194304
s_lshr_b32 s42, s40, 1
s_add_u32 s42, s42, 1
s_mov_b32 s62, 0
s_add_u32 s61, s57, s42
F_x:
s_add_u32 s62, s62, 1
s_mov_b32 s63, 14
s_cmp_gt_u32 s62, 400000
s_cbranch_scc1 L_err
buffer_load_dword v14, v7, s[4:7], s41 offen sc1
s_waitcnt vmcnt(0)
v_subrev_u32 v14, s61, v14
v_cmp_lt_u32 vcc, 64, v14
s_cbranch_vccnz F_x
s_mul_i32 s41, s40, 40
s_mul_i32 s42, s26, 5
s_add_u32 s43, s41, s42
s_lshl_b32 s44, s43, 2
s_add_u32 s44, s44, s24
s_lshl_b32 s41, s44, 14
s_add_u32 s41, s41, 5242880
s_bfe_u32 s61, s41, 0x10015
s_xor_b32 s61, s61, s3
s_lshl_b32 s61, s61, 13
s_add_u32 s41, s41, s61
s_add_u32 s44, s44, 4
buffer_load_dwordx4 a[100:103], v1, s[4:7], s41 offen offset:0 sc1
buffer_load_dwordx4 a[104:107], v1, s[4:7], s41 offen offset:1024 sc1
buffer_load_dwordx4 a[108:111], v1, s[4:7], s41 offen offset:2048 sc1
buffer_load_dwordx4 a[112:115], v1, s[4:7], s41 offen offset:3072 sc1
s_add_u32 s41, s41, 4096
buffer_load_dwordx4 a[116:119], v1, s[4:7], s41 offen offset:0 sc1
buffer_load_dwordx4 a[120:123], v1, s[4:7], s41 offen offset:1024 sc1
buffer_load_dwordx4 a[124:127], v1, s[4:7], s41 offen offset:2048 sc1
buffer_load_dwordx4 a[128:131], v1, s[4:7], s41 offen offset:3072 sc1
s_lshl_b32 s41, s44, 14
s_add_u32 s41, s41, 5242880
s_bfe_u32 s61, s41, 0x10015
s_xor_b32 s61, s61, s3
s_lshl_b32 s61, s61, 13
s_add_u32 s41, s41, s61
s_add_u32 s44, s44, 4
buffer_load_dwordx4 a[132:135], v1, s[4:7], s41 offen offset:0 sc1
buffer_load_dwordx4 a[136:139], v1, s[4:7], s41 offen offset:1024 sc1
buffer_load_dwordx4 a[140:143], v1, s[4:7], s41 offen offset:2048 sc1
buffer_load_dwordx4 a[144:147], v1, s[4:7], s41 offen offset:3072 sc1
s_add_u32 s41, s41, 4096
buffer_load_dwordx4 a[148:151], v1, s[4:7], s41 offen offset:0 sc1
buffer_load_dwordx4 a[152:155], v1, s[4:7], s41 offen offset:1024 sc1
buffer_load_dwordx4 a[156:159], v1, s[4:7], s41 offen offset:2048 sc1
buffer_load_dwordx4 a[160:163], v1, s[4:7], s41 offen offset:3072 sc1
s_lshl_b32 s41, s44, 14
s_add_u32 s41, s41, 5242880
s_bfe_u32 s61, s41, 0x10015
s_xor_b32 s61, s61, s3
s_lshl_b32 s61, s61, 13
s_add_u32 s41, s41, s61
s_add_u32 s44, s44, 4
buffer_load_dwordx4 a[164:167], v1, s[4:7], s41 offen offset:0 sc1
buffer_load_dwordx4 a[168:171], v1, s[4:7], s41 offen offset:1024 sc1
buffer_load_dwordx4 a[172:175], v1, s[4:7], s41 offen offset:2048 sc1
buffer_load_dwordx4 a[176:179], v1, s[4:7], s41 offen offset:3072 sc1
s_add_u32 s41, s41, 4096
buffer_load_dwordx4 a[180:183], v1, s[4:7], s41 offen offset:0 sc1
buffer_load_dwordx4 a[184:187], v1, s[4:7], s41 offen offset:1024 sc1
buffer_load_dwordx4 a[188:191], v1, s[4:7], s41 offen offset:2048 sc1
buffer_load_dwordx4 a[192:195], v1, s[4:7], s41 offen offset:3072 sc1
s_lshl_b32 s41, s44, 14
s_add_u32 s41, s41, 5242880
s_bfe_u32 s61, s41, 0x10015
s_xor_b32 s61, s61, s3
s_lshl_b32 s61, s61, 13
s_add_u32 s41, s41, s61
s_add_u32 s44, s44, 4
buffer_load_dwordx4 a[196:199], v1, s[4:7], s41 offen offset:0 sc1
buffer_load_dwordx4 a[200:203], v1, s[4:7], s41 offen offset:1024 sc1
buffer_load_dwordx4 a[204:207], v1, s[4:7], s41 offen offset:2048 sc1
buffer_load_dwordx4 a[208:211], v1, s[4:7], s41 offen offset:3072 sc1
s_add_u32 s41, s41, 4096
buffer_load_dwordx4 a[212:215], v1, s[4:7], s41 offen offset:0 sc1
buffer_load_dwordx4 a[216:219], v1, s[4:7], s41 offen offset:1024 sc1
buffer_load_dwordx4 a[220:223], v1, s[4:7], s41 offen offset:2048 sc1
buffer_load_dwordx4 a[224:227], v1, s[4:7], s41 offen offset:3072 sc1
s_lshl_b32 s41, s44, 14
s_add_u32 s41, s41, 5242880
s_bfe_u32 s61, s41, 0x10015
s_xor_b32 s61, s61, s3
s_lshl_b32 s61, s61, 13
s_add_u32 s41, s41, s61
s_add_u32 s44, s44, 4
buffer_load_dwordx4 a[228:231], v1, s[4:7], s41 offen offset:0 sc1
buffer_load_dwordx4 a[232:235], v1, s[4:7], s41 offen offset:1024 sc1
buffer_load_dwordx4 a[236:239], v1, s[4:7], s41 offen offset:2048 sc1
buffer_load_dwordx4 a[240:243], v1, s[4:7], s41 offen offset:3072 sc1
s_add_u32 s41, s41, 4096
buffer_load_dwordx4 a[244:247], v1, s[4:7], s41 offen offset:0 sc1
buffer_load_dwordx4 a[248:251], v1, s[4:7], s41 offen offset:1024 sc1
buffer_load_dwordx4 a[252:255], v1, s[4:7], s41 offen offset:2048 sc1
buffer_load_dwordx4 v[236:239], v1, s[4:7], s41 offen offset:3072 sc1
F_nu:
s_cmp_lt_u32 s45, s71
s_cselect_b32 s41, 1, 0
s_waitcnt vmcnt(40)
s_cmp_eq_u32 s41, 0
s_cbranch_scc1 F_nw
s_waitcnt vmcnt(0)
F_nw:
v_mfma_f32_16x16x32_bf16 v[176:179], a[0:3], v[16:19], 0
v_mfma_f32_16x16x32_bf16 v[180:183], a[0:3], v[36:39], 0
v_mfma_f32_16x16x32_bf16 v[184:187], a[4:7], v[16:19], 0
v_mfma_f32_16x16x32_bf16 v[188:191], a[4:7], v[36:39], 0
v_mfma_f32_16x16x32_bf16 v[192:195], a[8:11], v[16:19], 0
v_mfma_f32_16x16x32_bf16 v[196:199], a[8:11], v[36:39], 0
v_mfma_f32_16x16x32_bf16 v[200:203], a[12:15], v[16:19], 0
v_mfma_f32_16x16x32_bf16 v[204:207], a[12:15], v[36:39], 0
v_mfma_f32_16x16x32_bf16 v[208:211], a[16:19], v[16:19], 0
v_mfma_f32_16x16x32_bf16 v[212:215], a[16:19], v[36:39], 0
v_mfma_f32_16x16x32_bf16 v[176:179], a[20:23], v[20:23], v[176:179]
v_mfma_f32_16x16x32_bf16 v[180:183], a[20:23], v[40:43], v[180:183]
v_mfma_f32_16x16x32_bf16 v[184:187], a[24:27], v[20:23], v[184:187]
v_mfma_f32_16x16x32_bf16 v[188:191], a[24:27], v[40:43], v[188:191]
v_mfma_f32_16x16x32_bf16 v[192:195], a[28:31], v[20:23], v[192:195]
v_mfma_f32_16x16x32_bf16 v[196:199], a[28:31], v[40:43], v[196:199]
v_mfma_f32_16x16x32_bf16 v[200:203], a[32:35], v[20:23], v[200:203]
v_mfma_f32_16x16x32_bf16 v[204:207], a[32:35], v[40:43], v[204:207]
v_mfma_f32_16x16x32_bf16 v[208:211], a[36:39], v[20:23], v[208:211]
v_mfma_f32_16x16x32_bf16 v[212:215], a[36:39], v[40:43], v[212:215]
v_mfma_f32_16x16x32_bf16 v[176:179], a[40:43], v[24:27], v[176:179]
v_mfma_f32_16x16x32_bf16 v[180:183], a[40:43], v[44:47], v[180:183]
v_mfma_f32_16x16x32_bf16 v[184:187], a[44:47], v[24:27], v[184:187]
v_mfma_f32_16x16x32_bf16 v[188:191], a[44:47], v[44:47], v[188:191]
v_mfma_f32_16x16x32_bf16 v[192:195], a[48:51], v[24:27], v[192:195]
v_mfma_f32_16x16x32_bf16 v[196:199], a[48:51], v[44:47], v[196:199]
v_mfma_f32_16x16x32_bf16 v[200:203], a[52:55], v[24:27], v[200:203]
v_mfma_f32_16x16x32_bf16 v[204:207], a[52:55], v[44:47], v[204:207]
v_mfma_f32_16x16x32_bf16 v[208:211], a[56:59], v[24:27], v[208:211]
v_mfma_f32_16x16x32_bf16 v[212:215], a[56:59], v[44:47], v[212:215]
v_mfma_f32_16x16x32_bf16 v[176:179], a[60:63], v[28:31], v[176:179]
v_mfma_f32_16x16x32_bf16 v[180:183], a[60:63], v[48:51], v[180:183]
v_mfma_f32_16x16x32_bf16 v[184:187], a[64:67], v[28:31], v[184:187]
v_mfma_f32_16x16x32_bf16 v[188:191], a[64:67], v[48:51], v[188:191]
v_mfma_f32_16x16x32_bf16 v[192:195], a[68:71], v[28:31], v[192:195]
v_mfma_f32_16x16x32_bf16 v[196:199], a[68:71], v[48:51], v[196:199]
v_mfma_f32_16x16x32_bf16 v[200:203], a[72:75], v[28:31], v[200:203]
v_mfma_f32_16x16x32_bf16 v[204:207], a[72:75], v[48:51], v[204:207]
v_mfma_f32_16x16x32_bf16 v[208:211], a[76:79], v[28:31], v[208:211]
v_mfma_f32_16x16x32_bf16 v[212:215], a[76:79], v[48:51], v[212:215]
v_mfma_f32_16x16x32_bf16 v[176:179], a[80:83], v[32:35], v[176:179]
v_mfma_f32_16x16x32_bf16 v[180:183], a[80:83], v[52:55], v[180:183]
v_mfma_f32_16x16x32_bf16 v[184:187], a[84:87], v[32:35], v[184:187]
v_mfma_f32_16x16x32_bf16 v[188:191], a[84:87], v[52:55], v[188:191]
v_mfma_f32_16x16x32_bf16 v[192:195], a[88:91], v[32:35], v[192:195]
v_mfma_f32_16x16x32_bf16 v[196:199], a[88:91], v[52:55], v[196:199]
v_mfma_f32_16x16x32_bf16 v[200:203], a[92:95], v[32:35], v[200:203]
v_mfma_f32_16x16x32_bf16 v[204:207], a[92:95], v[52:55], v[204:207]
v_mfma_f32_16x16x32_bf16 v[208:211], a[96:99], v[32:35], v[208:211]
v_mfma_f32_16x16x32_bf16 v[212:215], a[96:99], v[52:55], v[212:215]
s_cmp_lt_u32 s45, s71
s_cbranch_scc1 F_pre
s_add_u32 s42, s40, 1
s_mov_b32 s41, 4218880
v_lshrrev_b32 v13, 8, v6
v_lshlrev_b32 v13, 7, v13
s_mov_b32 s62, 0
s_add_u32 s61, s57, s42
s_branch F_b_go
F_b:
v_readfirstlane_b32 s60, v14
s_sleep 2
s_cmp_ge_i32 s60, -1
s_cbranch_scc1 F_b_go
s_sleep 48
F_b_go:
s_add_u32 s62, s62, 1
s_mov_b32 s63, 15
s_cmp_gt_u32 s62, 400000
s_cbranch_scc1 L_err
buffer_load_dword v14, v13, s[4:7], s41 offen sc1
s_waitcnt vmcnt(0)
v_subrev_u32 v14, s61, v14
v_cmp_lt_u32 vcc, 64, v14
s_cbranch_vccnz F_b
s_add_u32 s43, s43, 10240
s_lshl_b32 s42, s24, 11
s_lshl_b32 s41, s43, 14
s_add_u32 s41, s41, 5242880
s_bfe_u32 s61, s41, 0x10015
s_xor_b32 s61, s61, s3
s_lshl_b32 s61, s61, 13
s_add_u32 s41, s41, s61
s_add_u32 s41, s41, s42
s_add_u32 s43, s43, 1
buffer_load_dwordx4 v[96:99], v1, s[4:7], s41 offen offset:0 sc1
buffer_load_dwordx4 v[100:103], v1, s[4:7], s41 offen offset:1024 sc1
s_lshl_b32 s41, s43, 14
s_add_u32 s41, s41, 5242880
s_bfe_u32 s61, s41, 0x10015
s_xor_b32 s61, s61, s3
s_lshl_b32 s61, s61, 13
s_add_u32 s41, s41, s61
s_add_u32 s41, s41, s42
s_add_u32 s43, s43, 1
buffer_load_dwordx4 v[104:107], v1, s[4:7], s41 offen offset:0 sc1
buffer_load_dwordx4 v[108:111], v1, s[4:7], s41 offen offset:1024 sc1
s_lshl_b32 s41, s43, 14
s_add_u32 s41, s41, 5242880
s_bfe_u32 s61, s41, 0x10015
s_xor_b32 s61, s61, s3
s_lshl_b32 s61, s61, 13
s_add_u32 s41, s41, s61
s_add_u32 s41, s41, s42
s_add_u32 s43, s43, 1
buffer_load_dwordx4 v[112:115], v1, s[4:7], s41 offen offset:0 sc1
buffer_load_dwordx4 v[116:119], v1, s[4:7], s41 offen offset:1024 sc1
s_lshl_b32 s41, s43, 14
s_add_u32 s41, s41, 5242880
s_bfe_u32 s61, s41, 0x10015
s_xor_b32 s61, s61, s3
s_lshl_b32 s61, s61, 13
s_add_u32 s41, s41, s61
s_add_u32 s41, s41, s42
s_add_u32 s43, s43, 1
buffer_load_dwordx4 v[120:123], v1, s[4:7], s41 offen offset:0 sc1
buffer_load_dwordx4 v[124:127], v1, s[4:7], s41 offen offset:1024 sc1
s_lshl_b32 s41, s43, 14
s_add_u32 s41, s41, 5242880
s_bfe_u32 s61, s41, 0x10015
s_xor_b32 s61, s61, s3
s_lshl_b32 s61, s61, 13
s_add_u32 s41, s41, s61
s_add_u32 s41, s41, s42
s_add_u32 s43, s43, 1
buffer_load_dwordx4 v[128:131], v1, s[4:7], s41 offen offset:0 sc1
buffer_load_dwordx4 v[132:135], v1, s[4:7], s41 offen offset:1024 sc1
s_add_u32 s42, s40, 1
s_mov_b32 s41, 4210688
s_mov_b32 s62, 0
s_add_u32 s61, s57, s42
s_branch F_a_go
F_a:
v_readfirstlane_b32 s60, v14
s_sleep 1
s_cmp_ge_i32 s60, -1
s_cbranch_scc1 F_a_go
s_sleep 48
F_a_go:
s_add_u32 s62, s62, 1
s_mov_b32 s63, 15
s_cmp_gt_u32 s62, 400000
s_cbranch_scc1 L_err
buffer_load_dword v14, v6, s[4:7], s41 offen sc1
s_waitcnt vmcnt(0)
v_subrev_u32 v14, s61, v14
v_cmp_lt_u32 vcc, 64, v14
s_cbranch_vccnz F_a
s_lshl_b32 s41, s40, 5
s_lshl_b32 s42, s24, 3
s_add_u32 s41, s41, s42
s_mul_i32 s41, s41, 2560
s_add_u32 s41, s41, 216006656
s_mov_b32 s44, s41
buffer_load_dwordx4 v[16:19], v1, s[4:7], s41 offen offset:0 sc1
buffer_load_dwordx4 v[20:23], v1, s[4:7], s41 offen offset:1280 sc1
s_add_u32 s41, s41, 2560
buffer_load_dwordx4 v[24:27], v1, s[4:7], s41 offen offset:0 sc1
buffer_load_dwordx4 v[28:31], v1, s[4:7], s41 offen offset:1280 sc1
s_add_u32 s41, s41, 2560
buffer_load_dwordx4 v[32:35], v1, s[4:7], s41 offen offset:0 sc1
buffer_load_dwordx4 v[36:39], v1, s[4:7], s41 offen offset:1280 sc1
s_add_u32 s41, s41, 2560
buffer_load_dwordx4 v[40:43], v1, s[4:7], s41 offen offset:0 sc1
buffer_load_dwordx4 v[44:47], v1, s[4:7], s41 offen offset:1280 sc1
s_add_u32 s41, s41, 2560
buffer_load_dwordx4 v[48:51], v1, s[4:7], s41 offen offset:0 sc1
buffer_load_dwordx4 v[52:55], v1, s[4:7], s41 offen offset:1280 sc1
s_add_u32 s41, s41, 2560
buffer_load_dwordx4 v[56:59], v1, s[4:7], s41 offen offset:0 sc1
buffer_load_dwordx4 v[60:63], v1, s[4:7], s41 offen offset:1280 sc1
s_add_u32 s41, s41, 2560
buffer_load_dwordx4 v[64:67], v1, s[4:7], s41 offen offset:0 sc1
buffer_load_dwordx4 v[68:71], v1, s[4:7], s41 offen offset:1280 sc1
s_add_u32 s41, s41, 2560
buffer_load_dwordx4 v[72:75], v1, s[4:7], s41 offen offset:0 sc1
buffer_load_dwordx4 v[76:79], v1, s[4:7], s41 offen offset:1280 sc1
s_add_u32 s41, s41, 2560
buffer_load_dwordx4 v[80:83], v9, s[4:7], s44 offen offset:1024 sc1
buffer_load_dwordx4 v[84:87], v9, s[4:7], s44 offen offset:2304 sc1
s_add_u32 s44, s44, 10240
buffer_load_dwordx4 v[88:91], v9, s[4:7], s44 offen offset:1024 sc1
buffer_load_dwordx4 v[92:95], v9, s[4:7], s44 offen offset:2304 sc1
s_add_u32 s44, s44, 10240
s_waitcnt vmcnt(18)
v_mfma_f32_16x16x32_bf16 v[136:139], a[100:103], v[16:19], 0
v_mfma_f32_16x16x32_bf16 v[140:143], a[100:103], v[20:23], 0
v_mfma_f32_16x16x32_bf16 v[144:147], a[132:135], v[16:19], 0
v_mfma_f32_16x16x32_bf16 v[148:151], a[132:135], v[20:23], 0
v_mfma_f32_16x16x32_bf16 v[152:155], a[164:167], v[16:19], 0
v_mfma_f32_16x16x32_bf16 v[156:159], a[164:167], v[20:23], 0
v_mfma_f32_16x16x32_bf16 v[160:163], a[196:199], v[16:19], 0
v_mfma_f32_16x16x32_bf16 v[164:167], a[196:199], v[20:23], 0
v_mfma_f32_16x16x32_bf16 v[168:171], a[228:231], v[16:19], 0
v_mfma_f32_16x16x32_bf16 v[172:175], a[228:231], v[20:23], 0
s_waitcnt vmcnt(16)
v_mfma_f32_16x16x32_bf16 v[136:139], a[104:107], v[24:27], v[136:139]
v_mfma_f32_16x16x32_bf16 v[140:143], a[104:107], v[28:31], v[140:143]
v_mfma_f32_16x16x32_bf16 v[144:147], a[136:139], v[24:27], v[144:147]
v_mfma_f32_16x16x32_bf16 v[148:151], a[136:139], v[28:31], v[148:151]
v_mfma_f32_16x16x32_bf16 v[152:155], a[168:171], v[24:27], v[152:155]
v_mfma_f32_16x16x32_bf16 v[156:159], a[168:171], v[28:31], v[156:159]
v_mfma_f32_16x16x32_bf16 v[160:163], a[200:203], v[24:27], v[160:163]
v_mfma_f32_16x16x32_bf16 v[164:167], a[200:203], v[28:31], v[164:167]
v_mfma_f32_16x16x32_bf16 v[168:171], a[232:235], v[24:27], v[168:171]
v_mfma_f32_16x16x32_bf16 v[172:175], a[232:235], v[28:31], v[172:175]
s_waitcnt vmcnt(14)
v_mfma_f32_16x16x32_bf16 v[136:139], a[108:111], v[32:35], v[136:139]
v_mfma_f32_16x16x32_bf16 v[140:143], a[108:111], v[36:39], v[140:143]
v_mfma_f32_16x16x32_bf16 v[144:147], a[140:143], v[32:35], v[144:147]
v_mfma_f32_16x16x32_bf16 v[148:151], a[140:143], v[36:39], v[148:151]
v_mfma_f32_16x16x32_bf16 v[152:155], a[172:175], v[32:35], v[152:155]
v_mfma_f32_16x16x32_bf16 v[156:159], a[172:175], v[36:39], v[156:159]
v_mfma_f32_16x16x32_bf16 v[160:163], a[204:207], v[32:35], v[160:163]
v_mfma_f32_16x16x32_bf16 v[164:167], a[204:207], v[36:39], v[164:167]
v_mfma_f32_16x16x32_bf16 v[168:171], a[236:239], v[32:35], v[168:171]
v_mfma_f32_16x16x32_bf16 v[172:175], a[236:239], v[36:39], v[172:175]
s_waitcnt vmcnt(12)
v_mfma_f32_16x16x32_bf16 v[136:139], a[112:115], v[40:43], v[136:139]
v_mfma_f32_16x16x32_bf16 v[140:143], a[112:115], v[44:47], v[140:143]
v_mfma_f32_16x16x32_bf16 v[144:147], a[144:147], v[40:43], v[144:147]
v_mfma_f32_16x16x32_bf16 v[148:151], a[144:147], v[44:47], v[148:151]
v_mfma_f32_16x16x32_bf16 v[152:155], a[176:179], v[40:43], v[152:155]
v_mfma_f32_16x16x32_bf16 v[156:159], a[176:179], v[44:47], v[156:159]
v_mfma_f32_16x16x32_bf16 v[160:163], a[208:211], v[40:43], v[160:163]
v_mfma_f32_16x16x32_bf16 v[164:167], a[208:211], v[44:47], v[164:167]
v_mfma_f32_16x16x32_bf16 v[168:171], a[240:243], v[40:43], v[168:171]
v_mfma_f32_16x16x32_bf16 v[172:175], a[240:243], v[44:47], v[172:175]
s_waitcnt vmcnt(10)
v_mfma_f32_16x16x32_bf16 v[136:139], a[116:119], v[48:51], v[136:139]
v_mfma_f32_16x16x32_bf16 v[140:143], a[116:119], v[52:55], v[140:143]
v_mfma_f32_16x16x32_bf16 v[144:147], a[148:151], v[48:51], v[144:147]
v_mfma_f32_16x16x32_bf16 v[148:151], a[148:151], v[52:55], v[148:151]
v_mfma_f32_16x16x32_bf16 v[152:155], a[180:183], v[48:51], v[152:155]
v_mfma_f32_16x16x32_bf16 v[156:159], a[180:183], v[52:55], v[156:159]
v_mfma_f32_16x16x32_bf16 v[160:163], a[212:215], v[48:51], v[160:163]
v_mfma_f32_16x16x32_bf16 v[164:167], a[212:215], v[52:55], v[164:167]
v_mfma_f32_16x16x32_bf16 v[168:171], a[244:247], v[48:51], v[168:171]
v_mfma_f32_16x16x32_bf16 v[172:175], a[244:247], v[52:55], v[172:175]
s_waitcnt vmcnt(8)
v_mfma_f32_16x16x32_bf16 v[136:139], a[120:123], v[56:59], v[136:139]
v_mfma_f32_16x16x32_bf16 v[140:143], a[120:123], v[60:63], v[140:143]
v_mfma_f32_16x16x32_bf16 v[144:147], a[152:155], v[56:59], v[144:147]
v_mfma_f32_16x16x32_bf16 v[148:151], a[152:155], v[60:63], v[148:151]
v_mfma_f32_16x16x32_bf16 v[152:155], a[184:187], v[56:59], v[152:155]
v_mfma_f32_16x16x32_bf16 v[156:159], a[184:187], v[60:63], v[156:159]
v_mfma_f32_16x16x32_bf16 v[160:163], a[216:219], v[56:59], v[160:163]
v_mfma_f32_16x16x32_bf16 v[164:167], a[216:219], v[60:63], v[164:167]
v_mfma_f32_16x16x32_bf16 v[168:171], a[248:251], v[56:59], v[168:171]
v_mfma_f32_16x16x32_bf16 v[172:175], a[248:251], v[60:63], v[172:175]
s_waitcnt vmcnt(6)
v_mfma_f32_16x16x32_bf16 v[136:139], a[124:127], v[64:67], v[136:139]
v_mfma_f32_16x16x32_bf16 v[140:143], a[124:127], v[68:71], v[140:143]
v_mfma_f32_16x16x32_bf16 v[144:147], a[156:159], v[64:67], v[144:147]
v_mfma_f32_16x16x32_bf16 v[148:151], a[156:159], v[68:71], v[148:151]
v_mfma_f32_16x16x32_bf16 v[152:155], a[188:191], v[64:67], v[152:155]
v_mfma_f32_16x16x32_bf16 v[156:159], a[188:191], v[68:71], v[156:159]
v_mfma_f32_16x16x32_bf16 v[160:163], a[220:223], v[64:67], v[160:163]
v_mfma_f32_16x16x32_bf16 v[164:167], a[220:223], v[68:71], v[164:167]
v_mfma_f32_16x16x32_bf16 v[168:171], a[252:255], v[64:67], v[168:171]
v_mfma_f32_16x16x32_bf16 v[172:175], a[252:255], v[68:71], v[172:175]
s_waitcnt vmcnt(4)
v_mfma_f32_16x16x32_bf16 v[136:139], a[128:131], v[72:75], v[136:139]
v_mfma_f32_16x16x32_bf16 v[140:143], a[128:131], v[76:79], v[140:143]
v_mfma_f32_16x16x32_bf16 v[144:147], a[160:163], v[72:75], v[144:147]
v_mfma_f32_16x16x32_bf16 v[148:151], a[160:163], v[76:79], v[148:151]
v_mfma_f32_16x16x32_bf16 v[152:155], a[192:195], v[72:75], v[152:155]
v_mfma_f32_16x16x32_bf16 v[156:159], a[192:195], v[76:79], v[156:159]
v_mfma_f32_16x16x32_bf16 v[160:163], a[224:227], v[72:75], v[160:163]
v_mfma_f32_16x16x32_bf16 v[164:167], a[224:227], v[76:79], v[164:167]
v_mfma_f32_16x16x32_bf16 v[168:171], v[236:239], v[72:75], v[168:171]
v_mfma_f32_16x16x32_bf16 v[172:175], v[236:239], v[76:79], v[172:175]
s_waitcnt vmcnt(0)
v_mfma_f32_16x16x32_bf16 v[136:139], v[96:99], v[80:83], v[136:139]
v_mfma_f32_16x16x32_bf16 v[140:143], v[96:99], v[84:87], v[140:143]
v_mfma_f32_16x16x32_bf16 v[136:139], v[100:103], v[88:91], v[136:139]
v_mfma_f32_16x16x32_bf16 v[140:143], v[100:103], v[92:95], v[140:143]
v_mfma_f32_16x16x32_bf16 v[144:147], v[104:107], v[80:83], v[144:147]
v_mfma_f32_16x16x32_bf16 v[148:151], v[104:107], v[84:87], v[148:151]
v_mfma_f32_16x16x32_bf16 v[144:147], v[108:111], v[88:91], v[144:147]
v_mfma_f32_16x16x32_bf16 v[148:151], v[108:111], v[92:95], v[148:151]
v_mfma_f32_16x16x32_bf16 v[152:155], v[112:115], v[80:83], v[152:155]
v_mfma_f32_16x16x32_bf16 v[156:159], v[112:115], v[84:87], v[156:159]
v_mfma_f32_16x16x32_bf16 v[152:155], v[116:119], v[88:91], v[152:155]
v_mfma_f32_16x16x32_bf16 v[156:159], v[116:119], v[92:95], v[156:159]
v_mfma_f32_16x16x32_bf16 v[160:163], v[120:123], v[80:83], v[160:163]
v_mfma_f32_16x16x32_bf16 v[164:167], v[120:123], v[84:87], v[164:167]
v_mfma_f32_16x16x32_bf16 v[160:163], v[124:127], v[88:91], v[160:163]
v_mfma_f32_16x16x32_bf16 v[164:167], v[124:127], v[92:95], v[164:167]
v_mfma_f32_16x16x32_bf16 v[168:171], v[128:131], v[80:83], v[168:171]
v_mfma_f32_16x16x32_bf16 v[172:175], v[128:131], v[84:87], v[172:175]
v_mfma_f32_16x16x32_bf16 v[168:171], v[132:135], v[88:91], v[168:171]
v_mfma_f32_16x16x32_bf16 v[172:175], v[132:135], v[92:95], v[172:175]
F_mix:
s_barrier
v_pk_mul_f32 v[176:177], v[176:177], v[216:217] op_sel:[0,1]
v_pk_fma_f32 v[136:137], v[136:137], v[216:217], v[176:177] op_sel_hi:[1,0,1]
v_pk_mul_f32 v[178:179], v[178:179], v[216:217] op_sel:[0,1]
v_pk_fma_f32 v[138:139], v[138:139], v[216:217], v[178:179] op_sel_hi:[1,0,1]
ds_write_b128 v4, v[136:139] offset:0
v_pk_mul_f32 v[180:181], v[180:181], v[218:219] op_sel:[0,1]
v_pk_fma_f32 v[140:141], v[140:141], v[218:219], v[180:181] op_sel_hi:[1,0,1]
v_pk_mul_f32 v[182:183], v[182:183], v[218:219] op_sel:[0,1]
v_pk_fma_f32 v[142:143], v[142:143], v[218:219], v[182:183] op_sel_hi:[1,0,1]
ds_write_b128 v4, v[140:143] offset:5120
v_pk_mul_f32 v[184:185], v[184:185], v[216:217] op_sel:[0,1]
v_pk_fma_f32 v[144:145], v[144:145], v[216:217], v[184:185] op_sel_hi:[1,0,1]
v_pk_mul_f32 v[186:187], v[186:187], v[216:217] op_sel:[0,1]
v_pk_fma_f32 v[146:147], v[146:147], v[216:217], v[186:187] op_sel_hi:[1,0,1]
ds_write_b128 v4, v[144:147] offset:1024
v_pk_mul_f32 v[188:189], v[188:189], v[218:219] op_sel:[0,1]
v_pk_fma_f32 v[148:149], v[148:149], v[218:219], v[188:189] op_sel_hi:[1,0,1]
v_pk_mul_f32 v[190:191], v[190:191], v[218:219] op_sel:[0,1]
v_pk_fma_f32 v[150:151], v[150:151], v[218:219], v[190:191] op_sel_hi:[1,0,1]
ds_write_b128 v4, v[148:151] offset:6144
v_pk_mul_f32 v[192:193], v[192:193], v[216:217] op_sel:[0,1]
v_pk_fma_f32 v[152:153], v[152:153], v[216:217], v[192:193] op_sel_hi:[1,0,1]
v_pk_mul_f32 v[194:195], v[194:195], v[216:217] op_sel:[0,1]
v_pk_fma_f32 v[154:155], v[154:155], v[216:217], v[194:195] op_sel_hi:[1,0,1]
ds_write_b128 v4, v[152:155] offset:2048
v_pk_mul_f32 v[196:197], v[196:197], v[218:219] op_sel:[0,1]
v_pk_fma_f32 v[156:157], v[156:157], v[218:219], v[196:197] op_sel_hi:[1,0,1]
v_pk_mul_f32 v[198:199], v[198:199], v[218:219] op_sel:[0,1]
v_pk_fma_f32 v[158:159], v[158:159], v[218:219], v[198:199] op_sel_hi:[1,0,1]
ds_write_b128 v4, v[156:159] offset:7168
v_pk_mul_f32 v[200:201], v[200:201], v[216:217] op_sel:[0,1]
v_pk_fma_f32 v[160:161], v[160:161], v[216:217], v[200:201] op_sel_hi:[1,0,1]
v_pk_mul_f32 v[202:203], v[202:203], v[216:217] op_sel:[0,1]
v_pk_fma_f32 v[162:163], v[162:163], v[216:217], v[202:203] op_sel_hi:[1,0,1]
ds_write_b128 v4, v[160:163] offset:3072
v_pk_mul_f32 v[204:205], v[204:205], v[218:219] op_sel:[0,1]
v_pk_fma_f32 v[164:165], v[164:165], v[218:219], v[204:205] op_sel_hi:[1,0,1]
v_pk_mul_f32 v[206:207], v[206:207], v[218:219] op_sel:[0,1]
v_pk_fma_f32 v[166:167], v[166:167], v[218:219], v[206:207] op_sel_hi:[1,0,1]
ds_write_b128 v4, v[164:167] offset:8192
v_pk_mul_f32 v[208:209], v[208:209], v[216:217] op_sel:[0,1]
v_pk_fma_f32 v[168:169], v[168:169], v[216:217], v[208:209] op_sel_hi:[1,0,1]
v_pk_mul_f32 v[210:211], v[210:211], v[216:217] op_sel:[0,1]
v_pk_fma_f32 v[170:171], v[170:171], v[216:217], v[210:211] op_sel_hi:[1,0,1]
ds_write_b128 v4, v[168:171] offset:4096
v_pk_mul_f32 v[212:213], v[212:213], v[218:219] op_sel:[0,1]
v_pk_fma_f32 v[172:173], v[172:173], v[218:219], v[212:213] op_sel_hi:[1,0,1]
v_pk_mul_f32 v[214:215], v[214:215], v[218:219] op_sel:[0,1]
v_pk_fma_f32 v[174:175], v[174:175], v[218:219], v[214:215] op_sel_hi:[1,0,1]
ds_write_b128 v4, v[172:175] offset:9216
s_waitcnt lgkmcnt(0)
s_barrier
s_mul_i32 s41, s40, 40960
s_mul_i32 s42, s26, 160
s_add_u32 s41, s41, s42
ds_read_b128 v[16:19], v234 offset:0
ds_read_b128 v[20:23], v234 offset:256
ds_read_b128 v[24:27], v234 offset:10240
ds_read_b128 v[28:31], v234 offset:10496
ds_read_b128 v[32:35], v234 offset:20480
ds_read_b128 v[36:39], v234 offset:20736
ds_read_b128 v[40:43], v234 offset:30720
ds_read_b128 v[44:47], v234 offset:30976
ds_read_b128 v[56:59], v235 offset:0
ds_read_b128 v[60:63], v235 offset:256
ds_read_b128 v[64:67], v235 offset:10240
ds_read_b128 v[68:71], v235 offset:10496
ds_read_b128 v[72:75], v235 offset:20480
ds_read_b128 v[76:79], v235 offset:20736
ds_read_b128 v[80:83], v235 offset:30720
ds_read_b128 v[84:87], v235 offset:30976
s_waitcnt lgkmcnt(12)
v_pk_add_f32 v[16:17], v[16:17], v[24:25]
v_pk_add_f32 v[18:19], v[18:19], v[26:27]
v_pk_add_f32 v[20:21], v[20:21], v[28:29]
v_pk_add_f32 v[22:23], v[22:23], v[30:31]
s_waitcnt lgkmcnt(10)
v_pk_add_f32 v[16:17], v[16:17], v[32:33]
v_pk_add_f32 v[18:19], v[18:19], v[34:35]
v_pk_add_f32 v[20:21], v[20:21], v[36:37]
v_pk_add_f32 v[22:23], v[22:23], v[38:39]
s_waitcnt lgkmcnt(8)
v_pk_add_f32 v[16:17], v[16:17], v[40:41]
v_pk_add_f32 v[18:19], v[18:19], v[42:43]
v_pk_add_f32 v[20:21], v[20:21], v[44:45]
v_pk_add_f32 v[22:23], v[22:23], v[46:47]
v_cvt_pk_bf16_f32 v48, v16, v17
v_cvt_pk_bf16_f32 v49, v18, v19
v_cvt_pk_bf16_f32 v50, v20, v21
v_cvt_pk_bf16_f32 v51, v22, v23
buffer_store_dwordx4 v[48:51], v232, s[16:19], s41 offen
s_waitcnt lgkmcnt(4)
v_pk_add_f32 v[56:57], v[56:57], v[64:65]
v_pk_add_f32 v[58:59], v[58:59], v[66:67]
v_pk_add_f32 v[60:61], v[60:61], v[68:69]
v_pk_add_f32 v[62:63], v[62:63], v[70:71]
s_waitcnt lgkmcnt(2)
v_pk_add_f32 v[56:57], v[56:57], v[72:73]
v_pk_add_f32 v[58:59], v[58:59], v[74:75]
v_pk_add_f32 v[60:61], v[60:61], v[76:77]
v_pk_add_f32 v[62:63], v[62:63], v[78:79]
s_waitcnt lgkmcnt(0)
v_pk_add_f32 v[56:57], v[56:57], v[80:81]
v_pk_add_f32 v[58:59], v[58:59], v[82:83]
v_pk_add_f32 v[60:61], v[60:61], v[84:85]
v_pk_add_f32 v[62:63], v[62:63], v[86:87]
v_cvt_pk_bf16_f32 v88, v56, v57
v_cvt_pk_bf16_f32 v89, v58, v59
v_cvt_pk_bf16_f32 v90, v60, v61
v_cvt_pk_bf16_f32 v91, v62, v63
s_mov_b64 exec, 0xffff
buffer_store_dwordx4 v[88:91], v233, s[16:19], s41 offen
s_mov_b64 exec, -1
s_add_u32 s40, s40, 16
s_cmp_lt_u32 s40, 64
s_cbranch_scc1 F_loop
s_branch L_fin
F_pre:
s_cmp_eq_u32 s45, 0
s_cbranch_scc0 F_pr1
v_accvgpr_read_b32 v136, a160
v_accvgpr_read_b32 v137, a161
v_accvgpr_read_b32 v138, a162
v_accvgpr_read_b32 v139, a163
v_accvgpr_read_b32 v140, a164
v_accvgpr_read_b32 v141, a165
v_accvgpr_read_b32 v142, a166
v_accvgpr_read_b32 v143, a167
v_accvgpr_read_b32 v144, a168
v_accvgpr_read_b32 v145, a169
v_accvgpr_read_b32 v146, a170
v_accvgpr_read_b32 v147, a171
v_accvgpr_read_b32 v148, a172
v_accvgpr_read_b32 v149, a173
v_accvgpr_read_b32 v150, a174
v_accvgpr_read_b32 v151, a175
v_accvgpr_read_b32 v152, a176
v_accvgpr_read_b32 v153, a177
v_accvgpr_read_b32 v154, a178
v_accvgpr_read_b32 v155, a179
v_accvgpr_read_b32 v156, a180
v_accvgpr_read_b32 v157, a181
v_accvgpr_read_b32 v158, a182
v_accvgpr_read_b32 v159, a183
v_accvgpr_read_b32 v160, a184
v_accvgpr_read_b32 v161, a185
v_accvgpr_read_b32 v162, a186
v_accvgpr_read_b32 v163, a187
v_accvgpr_read_b32 v164, a188
v_accvgpr_read_b32 v165, a189
v_accvgpr_read_b32 v166, a190
v_accvgpr_read_b32 v167, a191
v_accvgpr_read_b32 v168, a192
v_accvgpr_read_b32 v169, a193
v_accvgpr_read_b32 v170, a194
v_accvgpr_read_b32 v171, a195
v_accvgpr_read_b32 v172, a196
v_accvgpr_read_b32 v173, a197
v_accvgpr_read_b32 v174, a198
v_accvgpr_read_b32 v175, a199
s_branch F_mix
F_pr1:
v_accvgpr_read_b32 v136, a200
v_accvgpr_read_b32 v137, a201
v_accvgpr_read_b32 v138, a202
v_accvgpr_read_b32 v139, a203
v_accvgpr_read_b32 v140, a204
v_accvgpr_read_b32 v141, a205
v_accvgpr_read_b32 v142, a206
v_accvgpr_read_b32 v143, a207
v_accvgpr_read_b32 v144, a208
v_accvgpr_read_b32 v145, a209
v_accvgpr_read_b32 v146, a210
v_accvgpr_read_b32 v147, a211
v_accvgpr_read_b32 v148, a212
v_accvgpr_read_b32 v149, a213
v_accvgpr_read_b32 v150, a214
v_accvgpr_read_b32 v151, a215
v_accvgpr_read_b32 v152, a216
v_accvgpr_read_b32 v153, a217
v_accvgpr_read_b32 v154, a218
v_accvgpr_read_b32 v155, a219
v_accvgpr_read_b32 v156, a220
v_accvgpr_read_b32 v157, a221
v_accvgpr_read_b32 v158, a222
v_accvgpr_read_b32 v159, a223
v_accvgpr_read_b32 v160, a224
v_accvgpr_read_b32 v161, a225
v_accvgpr_read_b32 v162, a226
v_accvgpr_read_b32 v163, a227
v_accvgpr_read_b32 v164, a228
v_accvgpr_read_b32 v165, a229
v_accvgpr_read_b32 v166, a230
v_accvgpr_read_b32 v167, a231
v_accvgpr_read_b32 v168, a232
v_accvgpr_read_b32 v169, a233
v_accvgpr_read_b32 v170, a234
v_accvgpr_read_b32 v171, a235
v_accvgpr_read_b32 v172, a236
v_accvgpr_read_b32 v173, a237
v_accvgpr_read_b32 v174, a238
v_accvgpr_read_b32 v175, a239
s_branch F_mix
L_fin:
s_endpgm
L_err:
v_mov_b32 v14, s63
v_mov_b32 v15, 8
s_mov_b64 exec, 1
buffer_store_dword v14, v15, s[20:23], 0 offen sc1
s_waitcnt vmcnt(0)
L_end:
s_endpgm
.section .rodata,"a"
.p2align 6
.amdhsa_kernel gated_mix__memory_aug_recurrent_mem_tr__mha_block__prompt_kernel
  .amdhsa_next_free_vgpr 512
  .amdhsa_next_free_sgpr 102
  .amdhsa_accum_offset 256
  .amdhsa_group_segment_fixed_size 0
  .amdhsa_kernarg_size 112
  .amdhsa_user_sgpr_count 2
  .amdhsa_user_sgpr_kernarg_segment_ptr 1
  .amdhsa_system_sgpr_workgroup_id_x 1
.end_amdhsa_kernel
```
